```python
import torch

def _softmax(x, axis=-1):
    return torch.softmax(x, dim=axis)
def _gelu(x):
    return torch.nn.functional.gelu(x, approximate="tanh")
def _silu(x):
    return torch.nn.functional.silu(x)
def _sigmoid(x):
    return torch.sigmoid(x)
def _layernorm(x, axis=-1, eps=1e-5):
    m = x.mean(dim=axis, keepdim=True)
    v = x.var(dim=axis, keepdim=True, unbiased=False)
    return (x - m) / torch.sqrt(v + eps)
def _scatter_add(tgt, idx, src, axis=0):
    return tgt.clone().index_add_(axis, idx, src)
def _segment_sum(src, seg, n):
    out = torch.zeros((n,) + src.shape[1:], dtype=src.dtype)
    return out.index_add_(0, seg, src)
def _pad(x, pw):
    flat = tuple(v for pair in reversed(pw) for v in pair)
    return torch.nn.functional.pad(x, flat)

kernel_name = 'gated_mix__sliding_local_dilated__glu_gated_glu__prompt'

def setup_inputs():

    _w = (lambda a: (lambda t: t.to(torch.bfloat16) if t.is_floating_point() else t)(torch.as_tensor(a)))
    def _A_setup():
        B, S, D = 1, 2048, 576
        return {
            "x": _w((lambda *s: torch.randn(*s, dtype=torch.bfloat16) * 0.05)(B, S, D)),
            "wqkv": _w((lambda *s: torch.randn(*s, dtype=torch.bfloat16) * 0.8)(D, 3 * D)),
            "wo": _w((lambda *s: torch.randn(*s, dtype=torch.bfloat16) * 0.05)(D, D)),
        }
    _A_in = _A_setup()

    def _B_setup():
        B, S, D, F = 1, 2048, 576, 4608
        return {
            "x": _w((lambda *s: torch.randn(*s, dtype=torch.bfloat16) * 0.05)(B, S, D)),
            "w_gate": _w((lambda *s: torch.randn(*s, dtype=torch.bfloat16) * 1.6)(D, F)),
            "w_up": _w((lambda *s: torch.randn(*s, dtype=torch.bfloat16) * 0.1)(D, F)),
            "w_down": _w((lambda *s: torch.randn(*s, dtype=torch.bfloat16) * 0.1)(F, D)),
        }
    _B_in = _B_setup()

    return {
        "A_x": _A_in["x"],
        "A_wqkv": _A_in["wqkv"],
        "A_wo": _A_in["wo"],
        "B_x": _B_in["x"],
        "B_w_gate": _B_in["w_gate"],
        "B_w_up": _B_in["w_up"],
        "B_w_down": _B_in["w_down"],
        "gate_w": _w((lambda *s: torch.randn(*s, dtype=torch.bfloat16) * 0.05)(576) * 16.0),
    }

def reference(A_x, A_wqkv, A_wo, B_x, B_w_gate, B_w_up, B_w_down, gate_w):
    def _A_ref(x, wqkv, wo):
        B, S, D = x.shape
        H = 32; Dh = D // H
        W, dil = 8, 2
        qkv = (lambda x, *d: x.permute(*d))((x @ wqkv).reshape(B, S, 3, H, Dh), 2, 0, 3, 1, 4)
        q, k, v = qkv[0], qkv[1], qkv[2]
        scale = Dh ** -0.5
        pos = torch.arange(S)
        off = torch.arange(W) * dil
        idx = pos[:, None] - off[None, :]
        mask = idx >= 0
        idx_c = torch.where(mask, idx, 0).reshape(-1)
        kg = k[:, :, idx_c, :].reshape(B, H, S, W, Dh)
        vg = v[:, :, idx_c, :].reshape(B, H, S, W, Dh)
        logits = torch.einsum("bhsd,bhswd->bhsw", q, kg) * scale
        logits = torch.where(mask[None, None, :, :], logits, -1e9)
        attn = _softmax(logits, axis=-1)
        o = torch.einsum("bhsw,bhswd->bhsd", attn, vg)
        return (lambda x, *d: x.permute(*d))(o, 0, 2, 1, 3).reshape(B, S, D) @ wo

    def _B_ref(x, w_gate, w_up, w_down):
        g = torch.einsum("bsd,df->bsf", x, w_gate)
        u = torch.einsum("bsd,df->bsf", x, w_up)
        h = _sigmoid(g) * u
        return torch.einsum("bsf,fd->bsd", h, w_down)

    x = A_x
    g = _sigmoid((x * gate_w).sum(-1, keepdims=True))
    a = _A_ref(x, A_wqkv, A_wo)
    b = _B_ref(x, B_w_gate, B_w_up, B_w_down)
    return g * a + (1 - g) * b
```

```asm
; @launch grid=(256,1,1) block=(256,1,1) lds=163840
.amdgcn_target "amdgcn-amd-amdhsa--gfx950"
.text
.globl gated_mix__sliding_local_dilated__glu_gated_glu__prompt_kernel
.p2align 8
.type gated_mix__sliding_local_dilated__glu_gated_glu__prompt_kernel,@function
gated_mix__sliding_local_dilated__glu_gated_glu__prompt_kernel:
    s_cmp_ge_u32 s2, 256
    s_cbranch_scc1 L_END
    s_load_dwordx4 s[4:7], s[0:1], 0
    s_load_dwordx4 s[24:27], s[0:1], 32
    s_load_dwordx4 s[52:55], s[0:1], 48
    s_load_dwordx4 s[28:31], s[0:1], 64
    s_load_dwordx2 s[58:59], s[0:1], 80
    s_load_dwordx2 s[56:57], s[0:1], 16
    v_lshrrev_b32 v1, 6, v0
    v_and_b32 v0, 63, v0
    s_getpc_b64 s[60:61]
L_PC0:
    s_mov_b32 s62, L_CODE_END-L_PC0
    s_mov_b32 s63, 0x00020000
    v_lshlrev_b32 v8, 7, v0
    buffer_load_dword v9, v8, s[60:63], 0 offen
    v_lshrrev_b32 v2, 3, v0
    v_readfirstlane_b32 s32, v1
    v_and_b32 v3, 7, v0
    v_mul_u32_u24 v7, 1152, v2
    v_lshl_add_u32 v36, v3, 4, v7
    v_add_u32 v37, 9216, v36
    s_and_b32 s50, s2, 7
    s_lshr_b32 s51, s2, 3
    s_lshr_b32 s46, s51, 2
    s_and_b32 s47, s51, 3
    s_mul_i32 s48, s46, 3
    s_add_u32 s48, s48, s47
    s_add_u32 s46, s46, 24
    s_cmp_eq_u32 s47, 3
    s_cselect_b32 s51, s46, s48
    s_and_b32 s46, s50, 1
    s_lshr_b32 s43, s50, 1
    s_lshl_b32 s33, s46, 2
    s_and_b32 s44, s51, 3
    s_add_u32 s33, s33, s44
    s_lshr_b32 s45, s51, 2
    s_lshl_b32 s47, s33, 2
    s_add_u32 s47, s47, s32
    s_mul_i32 s64, s47, 73728
    s_lshl_b32 s3, s44, 1
    s_add_u32 s3, s3, s45
    s_sub_u32 s47, s3, 9
    s_cmp_ge_u32 s3, 9
    s_cselect_b32 s3, s47, s3
    s_mov_b32 s35, s3
    s_lshl_b32 s47, s3, 7
    s_add_u32 s64, s64, s47
    s_add_u32 s65, s64, 18432
    s_add_u32 s66, s64, 36864
    s_add_u32 s67, s64, 55296
    s_lshl_b32 s38, s32, 14
    s_add_u32 s38, s38, 98304
    v_lshrrev_b32 v4, 1, v2
    v_xor_b32 v5, v3, v4
    v_lshl_add_u32 v38, v5, 4, v7
    v_xor_b32 v6, 4, v5
    v_lshl_add_u32 v31, v6, 4, v7
    v_add_u32 v31, 9216, v31
    s_getpc_b64 s[60:61]
L_PC:
    s_sub_u32 s60, s60, L_PC-gated_mix__sliding_local_dilated__glu_gated_glu__prompt_kernel
    s_subb_u32 s61, s61, 0
    s_mov_b32 s62, L_CODE_END-gated_mix__sliding_local_dilated__glu_gated_glu__prompt_kernel
    s_mov_b32 s63, 0x00020000
    s_lshr_b32 s46, s2, 3
    s_lshl_b32 s47, s32, 5
    s_add_u32 s46, s46, s47
    s_lshl_b32 s46, s46, 10
    v_and_b32 v4, 7, v0
    v_lshlrev_b32 v4, 7, v4
    buffer_load_dword v1, v4, s[60:63], s46 offen
    s_waitcnt lgkmcnt(0)
    s_mov_b32 s8, s4
    s_mov_b32 s9, s5
    s_mov_b32 s10, 2359296
    s_mov_b32 s11, 0x00020000
    s_add_u32 m0, s38, 0
    s_nop 0
    buffer_load_dwordx4 v38, s[8:11], s64 offen lds
    s_add_u32 m0, s38, 1024
    s_nop 0
    buffer_load_dwordx4 v31, s[8:11], s64 offen lds
    s_add_u32 m0, s38, 2048
    s_nop 0
    buffer_load_dwordx4 v38, s[8:11], s65 offen lds
    s_add_u32 m0, s38, 3072
    s_nop 0
    buffer_load_dwordx4 v31, s[8:11], s65 offen lds
    s_add_u32 m0, s38, 4096
    s_nop 0
    buffer_load_dwordx4 v38, s[8:11], s66 offen lds
    s_add_u32 m0, s38, 5120
    s_nop 0
    buffer_load_dwordx4 v31, s[8:11], s66 offen lds
    s_add_u32 m0, s38, 6144
    s_nop 0
    buffer_load_dwordx4 v38, s[8:11], s67 offen lds
    s_add_u32 m0, s38, 7168
    s_nop 0
    buffer_load_dwordx4 v31, s[8:11], s67 offen lds
    s_cmp_ge_u32 s51, 24
    s_cbranch_scc1 L_QKV
    s_mul_i32 s34, s43, 6
    s_add_u32 s34, s34, s45
    s_cmp_ge_u32 s32, 2
    s_cselect_b32 s12, s26, s24
    s_cselect_b32 s13, s27, s25
    s_mov_b32 s14, 5308416
    s_mov_b32 s15, 0x00020000
    v_lshrrev_b32 v2, 3, v0
    v_and_b32 v3, 7, v0
    v_bfe_u32 v4, v2, 1, 1
    s_and_b32 s46, s32, 2
    v_or_b32 v4, s46, v4
    v_lshlrev_b32 v4, 1, v4
    v_xor_b32 v3, v3, v4
    s_mov_b32 s47, 9216
    v_mul_lo_u32 v2, v2, s47
    v_lshl_add_u32 v28, v3, 4, v2
    s_and_b32 s46, s32, 1
    s_mul_i32 s36, s46, 73728
    s_lshl_b32 s47, s34, 7
    s_add_u32 s36, s36, s47
    s_mul_i32 s47, s35, 589824
    s_add_u32 s36, s36, s47
    s_lshl_b32 s39, s32, 10
    s_add_u32 m0, s39, 86016
    s_add_u32 s41, s36, 0
    buffer_load_dwordx4 v28, s[12:15], s41 offen lds
    s_add_u32 m0, s39, 90112
    s_add_u32 s41, s36, 147456
    buffer_load_dwordx4 v28, s[12:15], s41 offen lds
    s_add_u32 m0, s39, 94208
    s_add_u32 s41, s36, 294912
    buffer_load_dwordx4 v28, s[12:15], s41 offen lds
    s_add_u32 m0, s39, 61440
    s_add_u32 s41, s36, 442368
    buffer_load_dwordx4 v28, s[12:15], s41 offen lds
    s_add_u32 s3, s3, 1
    s_cmp_eq_u32 s3, 9
    s_cselect_b32 s3, 0, s3
    s_mov_b32 s40, 128
    s_cselect_b32 s40, 4294966272, s40
    s_add_u32 s64, s64, s40
    s_add_u32 s65, s65, s40
    s_add_u32 s66, s66, s40
    s_add_u32 s67, s67, s40
    s_add_u32 m0, s38, 8192
    s_nop 0
    buffer_load_dwordx4 v38, s[8:11], s64 offen lds
    s_add_u32 m0, s38, 9216
    s_nop 0
    buffer_load_dwordx4 v31, s[8:11], s64 offen lds
    s_add_u32 m0, s38, 10240
    s_nop 0
    buffer_load_dwordx4 v38, s[8:11], s65 offen lds
    s_add_u32 m0, s38, 11264
    s_nop 0
    buffer_load_dwordx4 v31, s[8:11], s65 offen lds
    s_add_u32 m0, s38, 12288
    s_nop 0
    buffer_load_dwordx4 v38, s[8:11], s66 offen lds
    s_add_u32 m0, s38, 13312
    s_nop 0
    buffer_load_dwordx4 v31, s[8:11], s66 offen lds
    s_add_u32 m0, s38, 14336
    s_nop 0
    buffer_load_dwordx4 v38, s[8:11], s67 offen lds
    s_add_u32 m0, s38, 15360
    s_nop 0
    buffer_load_dwordx4 v31, s[8:11], s67 offen lds
    s_add_u32 s35, s35, 1
    s_cmp_eq_u32 s35, 9
    s_cselect_b32 s35, 0, s35
    s_mov_b32 s40, 589824
    s_cselect_b32 s40, 4290248704, s40
    s_add_u32 s36, s36, s40
    s_add_u32 m0, s39, 65536
    s_add_u32 s41, s36, 0
    buffer_load_dwordx4 v28, s[12:15], s41 offen lds
    s_add_u32 m0, s39, 69632
    s_add_u32 s41, s36, 147456
    buffer_load_dwordx4 v28, s[12:15], s41 offen lds
    s_add_u32 m0, s39, 73728
    s_add_u32 s41, s36, 294912
    buffer_load_dwordx4 v28, s[12:15], s41 offen lds
    s_add_u32 m0, s39, 77824
    s_add_u32 s41, s36, 442368
    buffer_load_dwordx4 v28, s[12:15], s41 offen lds
    s_add_u32 s35, s35, 1
    s_cmp_eq_u32 s35, 9
    s_cselect_b32 s35, 0, s35
    s_mov_b32 s40, 589824
    s_cselect_b32 s40, 4290248704, s40
    s_add_u32 s36, s36, s40
    s_add_u32 m0, s39, 81920
    s_add_u32 s41, s36, 0
    buffer_load_dwordx4 v28, s[12:15], s41 offen lds
    s_mov_b32 s20, s30
    s_mov_b32 s21, s31
    s_mov_b32 s22, 256
    s_mov_b32 s23, 0x00020000
    s_or_b32 s46, s2, s32
    s_cmp_lg_u32 s46, 0
    s_cbranch_scc1 L_NONCE_SKIP
    s_memrealtime s[46:47]
    s_waitcnt lgkmcnt(0)
    s_or_b32 s46, s46, 1
    v_mov_b32 v4, s46
    v_mov_b32 v5, 0
    s_mov_b64 exec, 1
    buffer_store_dword v4, v5, s[20:23], 0 offen sc0 sc1
    s_mov_b64 exec, -1
L_NONCE_SKIP:
    s_mov_b32 s16, s58
    s_mov_b32 s17, s59
    s_mov_b32 s18, 268435456
    s_mov_b32 s19, 0x00020000
    v_and_b32 v2, 31, v0
    v_lshrrev_b32 v3, 5, v0
    v_bfe_u32 v4, v2, 1, 3
    v_lshlrev_b32 v5, 7, v2
    v_add_u32 v5, s38, v5
    v_add_u32 v6, 0, v3
    v_xor_b32 v6, v6, v4
    v_lshl_add_u32 v32, v6, 4, v5
    v_add_u32 v6, 2, v3
    v_xor_b32 v6, v6, v4
    v_lshl_add_u32 v33, v6, 4, v5
    v_add_u32 v6, 4, v3
    v_xor_b32 v6, v6, v4
    v_lshl_add_u32 v34, v6, 4, v5
    v_add_u32 v6, 6, v3
    v_xor_b32 v6, v6, v4
    v_lshl_add_u32 v35, v6, 4, v5
    v_lshlrev_b32 v39, 4, v0
    v_lshrrev_b32 v2, 4, v0
    v_bfe_u32 v3, v0, 2, 2
    v_and_b32 v4, 3, v0
    v_lshrrev_b32 v5, 1, v4
    v_lshrrev_b32 v6, 1, v2
    v_lshl_add_u32 v6, v6, 3, v3
    v_lshlrev_b32 v6, 7, v6
    v_lshl_add_u32 v6, v5, 11, v6
    v_and_b32 v7, 1, v4
    v_lshl_add_u32 v6, v7, 4, v6
    v_and_b32 v7, 1, v2
    v_lshl_add_u32 v6, v7, 3, v6
    v_lshrrev_b32 v7, 1, v3
    v_lshl_or_b32 v7, v5, 1, v7
    v_xor_b32 v5, 0, v7
    v_lshl_add_u32 v24, v5, 5, v6
    v_add_u32 v40, 0x10000, v24
    v_xor_b32 v5, 1, v7
    v_lshl_add_u32 v25, v5, 5, v6
    v_add_u32 v41, 0x10000, v25
    v_xor_b32 v5, 2, v7
    v_lshl_add_u32 v26, v5, 5, v6
    v_add_u32 v42, 0x10000, v26
    v_xor_b32 v5, 3, v7
    v_lshl_add_u32 v27, v5, 5, v6
    v_add_u32 v43, 0x10000, v27
    s_lshl_b32 s46, s33, 3
    s_lshl_b32 s47, s32, 1
    s_add_u32 s46, s46, s47
    s_mul_i32 s46, s46, 324
    s_mul_i32 s47, s43, 72
    s_add_u32 s46, s46, s47
    s_lshl_b32 s47, s45, 2
    s_add_u32 s46, s46, s47
    s_add_u32 s46, s46, 36
    s_lshl_b32 s37, s46, 10
    s_waitcnt vmcnt(17)
    ds_read_b128 a[0:3], v32 offset:0
    ds_read_b128 a[4:7], v32 offset:4096
    ds_read_b128 a[8:11], v33 offset:0
    ds_read_b128 a[12:15], v33 offset:4096
    ds_read_b128 a[16:19], v34 offset:0
    ds_read_b128 a[20:23], v34 offset:4096
    ds_read_b128 a[24:27], v35 offset:0
    ds_read_b128 a[28:31], v35 offset:4096
    s_waitcnt vmcnt(16)
    s_barrier
    ds_read_b64_tr_b16 v[8:9], v40 offset:20480
    ds_read_b64_tr_b16 v[10:11], v40 offset:20992
    s_waitcnt lgkmcnt(0)
    v_mfma_f32_32x32x16_bf16 v[96:111], v[8:11], a[0:3], 0
    s_waitcnt vmcnt(4)
    s_barrier
    ds_read_b64_tr_b16 v[12:13], v41 offset:20480
    ds_read_b64_tr_b16 v[14:15], v41 offset:20992
    ds_read_b64_tr_b16 v[16:17], v42 offset:20480
    ds_read_b64_tr_b16 v[18:19], v42 offset:20992
    ds_read_b64_tr_b16 v[20:21], v43 offset:20480
    ds_read_b64_tr_b16 v[22:23], v43 offset:20992
    v_mfma_f32_32x32x16_bf16 v[112:127], v[8:11], a[4:7], 0
    s_add_u32 s3, s3, 1
    s_cmp_eq_u32 s3, 9
    s_cselect_b32 s3, 0, s3
    s_mov_b32 s40, 128
    s_cselect_b32 s40, 4294966272, s40
    s_waitcnt lgkmcnt(4)
    v_mfma_f32_32x32x16_bf16 v[128:143], v[12:15], a[0:3], 0
    ds_read_b64_tr_b16 v[8:9], v40 offset:24576
    ds_read_b64_tr_b16 v[10:11], v40 offset:25088
    s_add_u32 s64, s64, s40
    s_add_u32 s65, s65, s40
    s_add_u32 s66, s66, s40
    s_add_u32 s67, s67, s40
    s_add_u32 m0, s38, 0
    v_mfma_f32_32x32x16_bf16 v[144:159], v[12:15], a[4:7], 0
    s_nop 0
    buffer_load_dwordx4 v38, s[8:11], s64 offen lds
    s_waitcnt lgkmcnt(4)
    v_mfma_f32_32x32x16_bf16 v[160:175], v[16:19], a[0:3], 0
    ds_read_b64_tr_b16 v[12:13], v40 offset:28672
    ds_read_b64_tr_b16 v[14:15], v40 offset:29184
    s_add_u32 m0, s38, 1024
    s_nop 0
    v_mfma_f32_32x32x16_bf16 v[176:191], v[16:19], a[4:7], 0
    buffer_load_dwordx4 v31, s[8:11], s64 offen lds
    s_add_u32 m0, s38, 2048
    s_waitcnt lgkmcnt(4)
    v_mfma_f32_32x32x16_bf16 v[192:207], v[20:23], a[0:3], 0
    ds_read_b64_tr_b16 v[16:17], v41 offset:24576
    ds_read_b64_tr_b16 v[18:19], v41 offset:25088
    s_nop 0
    v_mfma_f32_32x32x16_bf16 v[208:223], v[20:23], a[4:7], 0
    buffer_load_dwordx4 v38, s[8:11], s65 offen lds
    s_add_u32 m0, s38, 3072
    s_waitcnt lgkmcnt(4)
    v_mfma_f32_32x32x16_bf16 v[96:111], v[8:11], a[8:11], v[96:111]
    ds_read_b64_tr_b16 v[20:21], v42 offset:24576
    ds_read_b64_tr_b16 v[22:23], v42 offset:25088
    s_nop 0
    v_mfma_f32_32x32x16_bf16 v[112:127], v[8:11], a[12:15], v[112:127]
    buffer_load_dwordx4 v31, s[8:11], s65 offen lds
    s_add_u32 m0, s38, 4096
    s_waitcnt lgkmcnt(4)
    v_mfma_f32_32x32x16_bf16 v[96:111], v[12:15], a[16:19], v[96:111]
    ds_read_b64_tr_b16 v[8:9], v43 offset:24576
    ds_read_b64_tr_b16 v[10:11], v43 offset:25088
    s_nop 0
    v_mfma_f32_32x32x16_bf16 v[112:127], v[12:15], a[20:23], v[112:127]
    buffer_load_dwordx4 v38, s[8:11], s66 offen lds
    s_add_u32 m0, s38, 5120
    s_waitcnt lgkmcnt(4)
    v_mfma_f32_32x32x16_bf16 v[128:143], v[16:19], a[8:11], v[128:143]
    ds_read_b64_tr_b16 v[12:13], v24 offset:61440
    ds_read_b64_tr_b16 v[14:15], v24 offset:61952
    s_nop 0
    v_mfma_f32_32x32x16_bf16 v[144:159], v[16:19], a[12:15], v[144:159]
    buffer_load_dwordx4 v31, s[8:11], s66 offen lds
    s_add_u32 m0, s38, 6144
    s_waitcnt lgkmcnt(4)
    v_mfma_f32_32x32x16_bf16 v[160:175], v[20:23], a[8:11], v[160:175]
    ds_read_b64_tr_b16 v[16:17], v41 offset:28672
    ds_read_b64_tr_b16 v[18:19], v41 offset:29184
    s_nop 0
    v_mfma_f32_32x32x16_bf16 v[176:191], v[20:23], a[12:15], v[176:191]
    buffer_load_dwordx4 v38, s[8:11], s67 offen lds
    s_add_u32 m0, s38, 7168
    s_waitcnt lgkmcnt(4)
    v_mfma_f32_32x32x16_bf16 v[192:207], v[8:11], a[8:11], v[192:207]
    ds_read_b64_tr_b16 v[20:21], v42 offset:28672
    ds_read_b64_tr_b16 v[22:23], v42 offset:29184
    s_nop 0
    v_mfma_f32_32x32x16_bf16 v[208:223], v[8:11], a[12:15], v[208:223]
    buffer_load_dwordx4 v31, s[8:11], s67 offen lds
    s_add_u32 m0, s39, 0
    s_waitcnt lgkmcnt(4)
    v_mfma_f32_32x32x16_bf16 v[96:111], v[12:15], a[24:27], v[96:111]
    ds_read_b64_tr_b16 v[8:9], v43 offset:28672
    ds_read_b64_tr_b16 v[10:11], v43 offset:29184
    s_add_u32 s41, s36, 147456
    v_mfma_f32_32x32x16_bf16 v[112:127], v[12:15], a[28:31], v[112:127]
    buffer_load_dwordx4 v28, s[12:15], s41 offen lds
    s_add_u32 m0, s39, 4096
    s_waitcnt lgkmcnt(4)
    v_mfma_f32_32x32x16_bf16 v[128:143], v[16:19], a[16:19], v[128:143]
    ds_read_b64_tr_b16 v[12:13], v40 offset:0
    ds_read_b64_tr_b16 v[14:15], v40 offset:512
    s_add_u32 s41, s36, 294912
    v_mfma_f32_32x32x16_bf16 v[144:159], v[16:19], a[20:23], v[144:159]
    buffer_load_dwordx4 v28, s[12:15], s41 offen lds
    s_add_u32 m0, s39, 8192
    s_waitcnt lgkmcnt(4)
    v_mfma_f32_32x32x16_bf16 v[160:175], v[20:23], a[16:19], v[160:175]
    ds_read_b64_tr_b16 v[16:17], v25 offset:61440
    ds_read_b64_tr_b16 v[18:19], v25 offset:61952
    s_add_u32 s41, s36, 442368
    v_mfma_f32_32x32x16_bf16 v[176:191], v[20:23], a[20:23], v[176:191]
    buffer_load_dwordx4 v28, s[12:15], s41 offen lds
    s_add_u32 s35, s35, 1
    s_waitcnt lgkmcnt(4)
    v_mfma_f32_32x32x16_bf16 v[192:207], v[8:11], a[16:19], v[192:207]
    ds_read_b64_tr_b16 v[20:21], v26 offset:61440
    ds_read_b64_tr_b16 v[22:23], v26 offset:61952
    s_cmp_eq_u32 s35, 9
    s_cselect_b32 s35, 0, s35
    s_mov_b32 s40, 589824
    s_cselect_b32 s40, 4290248704, s40
    s_add_u32 s36, s36, s40
    v_mfma_f32_32x32x16_bf16 v[208:223], v[8:11], a[20:23], v[208:223]
    s_add_u32 m0, s39, 12288
    s_add_u32 s41, s36, 0
    buffer_load_dwordx4 v28, s[12:15], s41 offen lds
    ds_read_b128 a[32:35], v32 offset:8192
    ds_read_b128 a[36:39], v32 offset:12288
    s_waitcnt lgkmcnt(0)
    v_mfma_f32_32x32x16_bf16 v[96:111], v[12:15], a[32:35], v[96:111]
    s_waitcnt vmcnt(12)
    s_barrier
    ds_read_b64_tr_b16 v[8:9], v27 offset:61440
    ds_read_b64_tr_b16 v[10:11], v27 offset:61952
    s_add_u32 m0, s39, 16384
    s_add_u32 s41, s36, 147456
    v_mfma_f32_32x32x16_bf16 v[112:127], v[12:15], a[36:39], v[112:127]
    buffer_load_dwordx4 v28, s[12:15], s41 offen lds
    s_add_u32 m0, s39, 20480
    v_mfma_f32_32x32x16_bf16 v[128:143], v[16:19], a[24:27], v[128:143]
    ds_read_b64_tr_b16 v[12:13], v40 offset:4096
    ds_read_b64_tr_b16 v[14:15], v40 offset:4608
    s_add_u32 s41, s36, 294912
    v_mfma_f32_32x32x16_bf16 v[144:159], v[16:19], a[28:31], v[144:159]
    buffer_load_dwordx4 v28, s[12:15], s41 offen lds
    ds_read_b128 a[40:43], v33 offset:8192
    ds_read_b128 a[44:47], v33 offset:12288
    ds_read_b128 a[48:51], v34 offset:8192
    ds_read_b128 a[52:55], v34 offset:12288
    ds_read_b128 a[56:59], v35 offset:8192
    ds_read_b128 a[60:63], v35 offset:12288
    s_waitcnt lgkmcnt(0)
    v_mfma_f32_32x32x16_bf16 v[160:175], v[20:23], a[24:27], v[160:175]
    ds_read_b64_tr_b16 v[16:17], v41 offset:0
    ds_read_b64_tr_b16 v[18:19], v41 offset:512
    s_add_u32 s3, s3, 1
    s_cmp_eq_u32 s3, 9
    s_cselect_b32 s3, 0, s3
    s_mov_b32 s40, 128
    s_cselect_b32 s40, 4294966272, s40
    v_mfma_f32_32x32x16_bf16 v[176:191], v[20:23], a[28:31], v[176:191]
    s_add_u32 s64, s64, s40
    s_add_u32 s65, s65, s40
    s_add_u32 s66, s66, s40
    s_add_u32 s67, s67, s40
    s_add_u32 m0, s38, 8192
    s_nop 0
    v_mfma_f32_32x32x16_bf16 v[192:207], v[8:11], a[24:27], v[192:207]
    ds_read_b64_tr_b16 v[20:21], v42 offset:0
    ds_read_b64_tr_b16 v[22:23], v42 offset:512
    buffer_load_dwordx4 v38, s[8:11], s64 offen lds
    v_mfma_f32_32x32x16_bf16 v[208:223], v[8:11], a[28:31], v[208:223]
    s_add_u32 m0, s38, 9216
    s_nop 0
    v_mfma_f32_32x32x16_bf16 v[96:111], v[12:15], a[40:43], v[96:111]
    ds_read_b64_tr_b16 v[8:9], v40 offset:8192
    ds_read_b64_tr_b16 v[10:11], v40 offset:8704
    buffer_load_dwordx4 v31, s[8:11], s64 offen lds
    v_mfma_f32_32x32x16_bf16 v[112:127], v[12:15], a[44:47], v[112:127]
    s_add_u32 m0, s38, 10240
    s_nop 0
    s_waitcnt lgkmcnt(4)
    v_mfma_f32_32x32x16_bf16 v[128:143], v[16:19], a[32:35], v[128:143]
    ds_read_b64_tr_b16 v[12:13], v41 offset:4096
    ds_read_b64_tr_b16 v[14:15], v41 offset:4608
    buffer_load_dwordx4 v38, s[8:11], s65 offen lds
    v_mfma_f32_32x32x16_bf16 v[144:159], v[16:19], a[36:39], v[144:159]
    s_add_u32 m0, s38, 11264
    s_nop 0
    s_waitcnt lgkmcnt(4)
    v_mfma_f32_32x32x16_bf16 v[160:175], v[20:23], a[32:35], v[160:175]
    ds_read_b64_tr_b16 v[16:17], v43 offset:0
    ds_read_b64_tr_b16 v[18:19], v43 offset:512
    buffer_load_dwordx4 v31, s[8:11], s65 offen lds
    v_mfma_f32_32x32x16_bf16 v[176:191], v[20:23], a[36:39], v[176:191]
    s_add_u32 m0, s38, 12288
    s_nop 0
    s_waitcnt lgkmcnt(4)
    v_mfma_f32_32x32x16_bf16 v[96:111], v[8:11], a[48:51], v[96:111]
    ds_read_b64_tr_b16 v[20:21], v40 offset:12288
    ds_read_b64_tr_b16 v[22:23], v40 offset:12800
    buffer_load_dwordx4 v38, s[8:11], s66 offen lds
    v_mfma_f32_32x32x16_bf16 v[112:127], v[8:11], a[52:55], v[112:127]
    s_add_u32 m0, s38, 13312
    s_nop 0
    s_waitcnt lgkmcnt(4)
    v_mfma_f32_32x32x16_bf16 v[128:143], v[12:15], a[40:43], v[128:143]
    ds_read_b64_tr_b16 v[8:9], v41 offset:8192
    ds_read_b64_tr_b16 v[10:11], v41 offset:8704
    buffer_load_dwordx4 v31, s[8:11], s66 offen lds
    v_mfma_f32_32x32x16_bf16 v[144:159], v[12:15], a[44:47], v[144:159]
    s_add_u32 m0, s38, 14336
    s_nop 0
    s_waitcnt lgkmcnt(4)
    v_mfma_f32_32x32x16_bf16 v[192:207], v[16:19], a[32:35], v[192:207]
    ds_read_b64_tr_b16 v[12:13], v42 offset:4096
    ds_read_b64_tr_b16 v[14:15], v42 offset:4608
    buffer_load_dwordx4 v38, s[8:11], s67 offen lds
    v_mfma_f32_32x32x16_bf16 v[208:223], v[16:19], a[36:39], v[208:223]
    s_add_u32 m0, s38, 15360
    s_nop 0
    s_waitcnt lgkmcnt(4)
    v_mfma_f32_32x32x16_bf16 v[96:111], v[20:23], a[56:59], v[96:111]
    ds_read_b64_tr_b16 v[16:17], v43 offset:4096
    ds_read_b64_tr_b16 v[18:19], v43 offset:4608
    buffer_load_dwordx4 v31, s[8:11], s67 offen lds
    v_mfma_f32_32x32x16_bf16 v[112:127], v[20:23], a[60:63], v[112:127]
    s_add_u32 m0, s39, 24576
    s_add_u32 s41, s36, 442368
    s_waitcnt lgkmcnt(4)
    v_mfma_f32_32x32x16_bf16 v[128:143], v[8:11], a[48:51], v[128:143]
    ds_read_b64_tr_b16 v[20:21], v40 offset:16384
    ds_read_b64_tr_b16 v[22:23], v40 offset:16896
    buffer_load_dwordx4 v28, s[12:15], s41 offen lds
    v_mfma_f32_32x32x16_bf16 v[144:159], v[8:11], a[52:55], v[144:159]
    s_add_u32 s35, s35, 1
    s_cmp_eq_u32 s35, 9
    s_cselect_b32 s35, 0, s35
    s_mov_b32 s40, 589824
    s_cselect_b32 s40, 4290248704, s40
    s_add_u32 s36, s36, s40
    s_waitcnt lgkmcnt(4)
    v_mfma_f32_32x32x16_bf16 v[160:175], v[12:15], a[40:43], v[160:175]
    ds_read_b64_tr_b16 v[8:9], v41 offset:12288
    ds_read_b64_tr_b16 v[10:11], v41 offset:12800
    s_add_u32 m0, s39, 28672
    s_add_u32 s41, s36, 0
    v_mfma_f32_32x32x16_bf16 v[176:191], v[12:15], a[44:47], v[176:191]
    buffer_load_dwordx4 v28, s[12:15], s41 offen lds
    s_add_u32 m0, s39, 86016
    s_waitcnt lgkmcnt(4)
    v_mfma_f32_32x32x16_bf16 v[192:207], v[16:19], a[40:43], v[192:207]
    ds_read_b64_tr_b16 v[12:13], v42 offset:8192
    ds_read_b64_tr_b16 v[14:15], v42 offset:8704
    s_add_u32 s41, s36, 147456
    v_mfma_f32_32x32x16_bf16 v[208:223], v[16:19], a[44:47], v[208:223]
    buffer_load_dwordx4 v28, s[12:15], s41 offen lds
    s_add_u32 m0, s39, 90112
    s_add_u32 s41, s36, 294912
    buffer_load_dwordx4 v28, s[12:15], s41 offen lds
    s_waitcnt vmcnt(18)
    ds_read_b128 a[64:67], v32 offset:0
    ds_read_b128 a[68:71], v32 offset:4096
    s_waitcnt lgkmcnt(0)
    v_mfma_f32_32x32x16_bf16 v[96:111], v[20:23], a[64:67], v[96:111]
    s_waitcnt vmcnt(14)
    s_barrier
    ds_read_b64_tr_b16 v[16:17], v43 offset:8192
    ds_read_b64_tr_b16 v[18:19], v43 offset:8704
    s_add_u32 m0, s39, 94208
    s_add_u32 s41, s36, 442368
    v_mfma_f32_32x32x16_bf16 v[112:127], v[20:23], a[68:71], v[112:127]
    buffer_load_dwordx4 v28, s[12:15], s41 offen lds
    s_add_u32 s35, s35, 1
    v_mfma_f32_32x32x16_bf16 v[128:143], v[8:11], a[56:59], v[128:143]
    ds_read_b64_tr_b16 v[20:21], v24 offset:0
    ds_read_b64_tr_b16 v[22:23], v24 offset:512
    s_cmp_eq_u32 s35, 9
    s_cselect_b32 s35, 0, s35
    s_mov_b32 s40, 589824
    s_cselect_b32 s40, 4290248704, s40
    s_add_u32 s36, s36, s40
    v_mfma_f32_32x32x16_bf16 v[144:159], v[8:11], a[60:63], v[144:159]
    s_add_u32 m0, s39, 32768
    s_add_u32 s41, s36, 0
    v_mfma_f32_32x32x16_bf16 v[160:175], v[12:15], a[48:51], v[160:175]
    ds_read_b64_tr_b16 v[8:9], v41 offset:16384
    ds_read_b64_tr_b16 v[10:11], v41 offset:16896
    buffer_load_dwordx4 v28, s[12:15], s41 offen lds
    v_mfma_f32_32x32x16_bf16 v[176:191], v[12:15], a[52:55], v[176:191]
    s_add_u32 m0, s39, 36864
    s_add_u32 s41, s36, 147456
    s_waitcnt lgkmcnt(4)
    v_mfma_f32_32x32x16_bf16 v[192:207], v[16:19], a[48:51], v[192:207]
    ds_read_b64_tr_b16 v[12:13], v42 offset:12288
    ds_read_b64_tr_b16 v[14:15], v42 offset:12800
    buffer_load_dwordx4 v28, s[12:15], s41 offen lds
    v_mfma_f32_32x32x16_bf16 v[208:223], v[16:19], a[52:55], v[208:223]
    ds_read_b128 a[72:75], v33 offset:0
    ds_read_b128 a[76:79], v33 offset:4096
    ds_read_b128 a[80:83], v34 offset:0
    ds_read_b128 a[84:87], v34 offset:4096
    ds_read_b128 a[88:91], v35 offset:0
    ds_read_b128 a[92:95], v35 offset:4096
    s_waitcnt lgkmcnt(0)
    s_add_u32 s3, s3, 1
    s_cmp_eq_u32 s3, 9
    s_cselect_b32 s3, 0, s3
    s_mov_b32 s40, 128
    s_cselect_b32 s40, 4294966272, s40
    v_mfma_f32_32x32x16_bf16 v[96:111], v[20:23], a[72:75], v[96:111]
    ds_read_b64_tr_b16 v[16:17], v24 offset:4096
    ds_read_b64_tr_b16 v[18:19], v24 offset:4608
    s_add_u32 s64, s64, s40
    s_add_u32 s65, s65, s40
    s_add_u32 s66, s66, s40
    s_add_u32 s67, s67, s40
    s_add_u32 m0, s38, 0
    v_mfma_f32_32x32x16_bf16 v[112:127], v[20:23], a[76:79], v[112:127]
    s_nop 0
    buffer_load_dwordx4 v38, s[8:11], s64 offen lds
    v_mfma_f32_32x32x16_bf16 v[128:143], v[8:11], a[64:67], v[128:143]
    ds_read_b64_tr_b16 v[20:21], v25 offset:0
    ds_read_b64_tr_b16 v[22:23], v25 offset:512
    s_add_u32 m0, s38, 1024
    s_nop 0
    v_mfma_f32_32x32x16_bf16 v[144:159], v[8:11], a[68:71], v[144:159]
    buffer_load_dwordx4 v31, s[8:11], s64 offen lds
    s_add_u32 m0, s38, 2048
    v_mfma_f32_32x32x16_bf16 v[160:175], v[12:15], a[56:59], v[160:175]
    ds_read_b64_tr_b16 v[8:9], v42 offset:16384
    ds_read_b64_tr_b16 v[10:11], v42 offset:16896
    s_nop 0
    v_mfma_f32_32x32x16_bf16 v[176:191], v[12:15], a[60:63], v[176:191]
    buffer_load_dwordx4 v38, s[8:11], s65 offen lds
    s_add_u32 m0, s38, 3072
    s_waitcnt lgkmcnt(4)
    v_mfma_f32_32x32x16_bf16 v[96:111], v[16:19], a[80:83], v[96:111]
    ds_read_b64_tr_b16 v[12:13], v43 offset:12288
    ds_read_b64_tr_b16 v[14:15], v43 offset:12800
    s_nop 0
    v_mfma_f32_32x32x16_bf16 v[112:127], v[16:19], a[84:87], v[112:127]
    buffer_load_dwordx4 v31, s[8:11], s65 offen lds
    s_add_u32 m0, s38, 4096
    s_waitcnt lgkmcnt(4)
    v_mfma_f32_32x32x16_bf16 v[128:143], v[20:23], a[72:75], v[128:143]
    ds_read_b64_tr_b16 v[16:17], v24 offset:8192
    ds_read_b64_tr_b16 v[18:19], v24 offset:8704
    s_nop 0
    v_mfma_f32_32x32x16_bf16 v[144:159], v[20:23], a[76:79], v[144:159]
    buffer_load_dwordx4 v38, s[8:11], s66 offen lds
    s_add_u32 m0, s38, 5120
    s_waitcnt lgkmcnt(4)
    v_mfma_f32_32x32x16_bf16 v[160:175], v[8:11], a[64:67], v[160:175]
    ds_read_b64_tr_b16 v[20:21], v26 offset:0
    ds_read_b64_tr_b16 v[22:23], v26 offset:512
    s_nop 0
    v_mfma_f32_32x32x16_bf16 v[176:191], v[8:11], a[68:71], v[176:191]
    buffer_load_dwordx4 v31, s[8:11], s66 offen lds
    s_add_u32 m0, s38, 6144
    s_waitcnt lgkmcnt(4)
    v_mfma_f32_32x32x16_bf16 v[192:207], v[12:15], a[56:59], v[192:207]
    ds_read_b64_tr_b16 v[8:9], v43 offset:16384
    ds_read_b64_tr_b16 v[10:11], v43 offset:16896
    s_nop 0
    v_mfma_f32_32x32x16_bf16 v[208:223], v[12:15], a[60:63], v[208:223]
    buffer_load_dwordx4 v38, s[8:11], s67 offen lds
    s_add_u32 m0, s38, 7168
    s_waitcnt lgkmcnt(4)
    v_mfma_f32_32x32x16_bf16 v[96:111], v[16:19], a[88:91], v[96:111]
    ds_read_b64_tr_b16 v[12:13], v24 offset:12288
    ds_read_b64_tr_b16 v[14:15], v24 offset:12800
    s_nop 0
    v_mfma_f32_32x32x16_bf16 v[112:127], v[16:19], a[92:95], v[112:127]
    buffer_load_dwordx4 v31, s[8:11], s67 offen lds
    s_add_u32 m0, s39, 40960
    s_waitcnt lgkmcnt(4)
    v_mfma_f32_32x32x16_bf16 v[160:175], v[20:23], a[72:75], v[160:175]
    ds_read_b64_tr_b16 v[16:17], v25 offset:4096
    ds_read_b64_tr_b16 v[18:19], v25 offset:4608
    s_add_u32 s41, s36, 294912
    v_mfma_f32_32x32x16_bf16 v[176:191], v[20:23], a[76:79], v[176:191]
    buffer_load_dwordx4 v28, s[12:15], s41 offen lds
    s_add_u32 m0, s39, 61440
    s_waitcnt lgkmcnt(4)
    v_mfma_f32_32x32x16_bf16 v[192:207], v[8:11], a[64:67], v[192:207]
    ds_read_b64_tr_b16 v[20:21], v27 offset:0
    ds_read_b64_tr_b16 v[22:23], v27 offset:512
    s_add_u32 s41, s36, 442368
    v_mfma_f32_32x32x16_bf16 v[208:223], v[8:11], a[68:71], v[208:223]
    buffer_load_dwordx4 v28, s[12:15], s41 offen lds
    s_add_u32 s35, s35, 1
    s_cmp_eq_u32 s35, 9
    s_cselect_b32 s35, 0, s35
    s_mov_b32 s40, 589824
    s_cselect_b32 s40, 4290248704, s40
    s_add_u32 s36, s36, s40
    s_add_u32 m0, s39, 65536
    s_add_u32 s41, s36, 0
    buffer_load_dwordx4 v28, s[12:15], s41 offen lds
    s_waitcnt vmcnt(18)
    ds_read_b128 a[96:99], v32 offset:8192
    ds_read_b128 a[100:103], v32 offset:12288
    s_waitcnt lgkmcnt(0)
    v_mfma_f32_32x32x16_bf16 v[96:111], v[12:15], a[96:99], v[96:111]
    s_waitcnt vmcnt(16)
    s_barrier
    ds_read_b64_tr_b16 v[8:9], v24 offset:16384
    ds_read_b64_tr_b16 v[10:11], v24 offset:16896
    s_add_u32 m0, s39, 69632
    s_add_u32 s41, s36, 147456
    v_mfma_f32_32x32x16_bf16 v[112:127], v[12:15], a[100:103], v[112:127]
    buffer_load_dwordx4 v28, s[12:15], s41 offen lds
    ds_read_b128 a[104:107], v33 offset:8192
    ds_read_b128 a[108:111], v33 offset:12288
    ds_read_b128 a[112:115], v34 offset:8192
    ds_read_b128 a[116:119], v34 offset:12288
    ds_read_b128 a[120:123], v35 offset:8192
    ds_read_b128 a[124:127], v35 offset:12288
    s_waitcnt lgkmcnt(0)
    v_mfma_f32_32x32x16_bf16 v[128:143], v[16:19], a[80:83], v[128:143]
    ds_read_b64_tr_b16 v[12:13], v25 offset:8192
    ds_read_b64_tr_b16 v[14:15], v25 offset:8704
    s_add_u32 s3, s3, 1
    s_cmp_eq_u32 s3, 9
    s_cselect_b32 s3, 0, s3
    s_mov_b32 s40, 128
    s_cselect_b32 s40, 4294966272, s40
    v_mfma_f32_32x32x16_bf16 v[144:159], v[16:19], a[84:87], v[144:159]
    s_add_u32 s64, s64, s40
    s_add_u32 s65, s65, s40
    s_add_u32 s66, s66, s40
    s_add_u32 s67, s67, s40
    s_add_u32 m0, s38, 8192
    s_nop 0
    v_mfma_f32_32x32x16_bf16 v[192:207], v[20:23], a[72:75], v[192:207]
    ds_read_b64_tr_b16 v[16:17], v26 offset:4096
    ds_read_b64_tr_b16 v[18:19], v26 offset:4608
    buffer_load_dwordx4 v38, s[8:11], s64 offen lds
    v_mfma_f32_32x32x16_bf16 v[208:223], v[20:23], a[76:79], v[208:223]
    s_add_u32 m0, s38, 9216
    s_nop 0
    v_mfma_f32_32x32x16_bf16 v[96:111], v[8:11], a[104:107], v[96:111]
    ds_read_b64_tr_b16 v[20:21], v24 offset:20480
    ds_read_b64_tr_b16 v[22:23], v24 offset:20992
    buffer_load_dwordx4 v31, s[8:11], s64 offen lds
    v_mfma_f32_32x32x16_bf16 v[112:127], v[8:11], a[108:111], v[112:127]
    s_add_u32 m0, s38, 10240
    s_nop 0
    s_waitcnt lgkmcnt(4)
    v_mfma_f32_32x32x16_bf16 v[128:143], v[12:15], a[88:91], v[128:143]
    ds_read_b64_tr_b16 v[8:9], v25 offset:12288
    ds_read_b64_tr_b16 v[10:11], v25 offset:12800
    buffer_load_dwordx4 v38, s[8:11], s65 offen lds
    v_mfma_f32_32x32x16_bf16 v[144:159], v[12:15], a[92:95], v[144:159]
    s_add_u32 m0, s38, 11264
    s_nop 0
    s_waitcnt lgkmcnt(4)
    v_mfma_f32_32x32x16_bf16 v[160:175], v[16:19], a[80:83], v[160:175]
    ds_read_b64_tr_b16 v[12:13], v26 offset:8192
    ds_read_b64_tr_b16 v[14:15], v26 offset:8704
    buffer_load_dwordx4 v31, s[8:11], s65 offen lds
    v_mfma_f32_32x32x16_bf16 v[176:191], v[16:19], a[84:87], v[176:191]
    s_add_u32 m0, s38, 12288
    s_nop 0
    s_waitcnt lgkmcnt(4)
    v_mfma_f32_32x32x16_bf16 v[96:111], v[20:23], a[112:115], v[96:111]
    ds_read_b64_tr_b16 v[16:17], v27 offset:4096
    ds_read_b64_tr_b16 v[18:19], v27 offset:4608
    buffer_load_dwordx4 v38, s[8:11], s66 offen lds
    v_mfma_f32_32x32x16_bf16 v[112:127], v[20:23], a[116:119], v[112:127]
    s_add_u32 m0, s38, 13312
    s_nop 0
    s_waitcnt lgkmcnt(4)
    v_mfma_f32_32x32x16_bf16 v[128:143], v[8:11], a[96:99], v[128:143]
    ds_read_b64_tr_b16 v[20:21], v24 offset:24576
    ds_read_b64_tr_b16 v[22:23], v24 offset:25088
    buffer_load_dwordx4 v31, s[8:11], s66 offen lds
    v_mfma_f32_32x32x16_bf16 v[144:159], v[8:11], a[100:103], v[144:159]
    s_add_u32 m0, s38, 14336
    s_nop 0
    s_waitcnt lgkmcnt(4)
    v_mfma_f32_32x32x16_bf16 v[160:175], v[12:15], a[88:91], v[160:175]
    ds_read_b64_tr_b16 v[8:9], v25 offset:16384
    ds_read_b64_tr_b16 v[10:11], v25 offset:16896
    buffer_load_dwordx4 v38, s[8:11], s67 offen lds
    v_mfma_f32_32x32x16_bf16 v[176:191], v[12:15], a[92:95], v[176:191]
    s_add_u32 m0, s38, 15360
    s_nop 0
    s_waitcnt lgkmcnt(4)
    v_mfma_f32_32x32x16_bf16 v[192:207], v[16:19], a[80:83], v[192:207]
    ds_read_b64_tr_b16 v[12:13], v26 offset:12288
    ds_read_b64_tr_b16 v[14:15], v26 offset:12800
    buffer_load_dwordx4 v31, s[8:11], s67 offen lds
    v_mfma_f32_32x32x16_bf16 v[208:223], v[16:19], a[84:87], v[208:223]
    s_add_u32 m0, s39, 45056
    s_add_u32 s41, s36, 294912
    s_waitcnt lgkmcnt(4)
    v_mfma_f32_32x32x16_bf16 v[96:111], v[20:23], a[120:123], v[96:111]
    ds_read_b64_tr_b16 v[16:17], v27 offset:8192
    ds_read_b64_tr_b16 v[18:19], v27 offset:8704
    buffer_load_dwordx4 v28, s[12:15], s41 offen lds
    v_mfma_f32_32x32x16_bf16 v[112:127], v[20:23], a[124:127], v[112:127]
    s_add_u32 m0, s39, 73728
    s_add_u32 s41, s36, 442368
    s_waitcnt lgkmcnt(4)
    v_mfma_f32_32x32x16_bf16 v[128:143], v[8:11], a[104:107], v[128:143]
    ds_read_b64_tr_b16 v[20:21], v24 offset:28672
    ds_read_b64_tr_b16 v[22:23], v24 offset:29184
    buffer_load_dwordx4 v28, s[12:15], s41 offen lds
    v_mfma_f32_32x32x16_bf16 v[144:159], v[8:11], a[108:111], v[144:159]
    s_add_u32 s35, s35, 1
    s_cmp_eq_u32 s35, 9
    s_cselect_b32 s35, 0, s35
    s_mov_b32 s40, 589824
    s_cselect_b32 s40, 4290248704, s40
    s_add_u32 s36, s36, s40
    s_waitcnt lgkmcnt(4)
    v_mfma_f32_32x32x16_bf16 v[160:175], v[12:15], a[96:99], v[160:175]
    ds_read_b64_tr_b16 v[8:9], v25 offset:20480
    ds_read_b64_tr_b16 v[10:11], v25 offset:20992
    s_add_u32 m0, s39, 77824
    s_add_u32 s41, s36, 0
    v_mfma_f32_32x32x16_bf16 v[176:191], v[12:15], a[100:103], v[176:191]
    buffer_load_dwordx4 v28, s[12:15], s41 offen lds
    s_add_u32 m0, s39, 81920
    s_waitcnt lgkmcnt(4)
    v_mfma_f32_32x32x16_bf16 v[192:207], v[16:19], a[88:91], v[192:207]
    ds_read_b64_tr_b16 v[12:13], v26 offset:16384
    ds_read_b64_tr_b16 v[14:15], v26 offset:16896
    s_add_u32 s41, s36, 147456
    v_mfma_f32_32x32x16_bf16 v[208:223], v[16:19], a[92:95], v[208:223]
    buffer_load_dwordx4 v28, s[12:15], s41 offen lds
    s_waitcnt vmcnt(16)
    ds_read_b128 a[128:131], v32 offset:0
    ds_read_b128 a[132:135], v32 offset:4096
    ds_read_b128 a[136:139], v33 offset:0
    ds_read_b128 a[140:143], v33 offset:4096
    ds_read_b128 a[144:147], v34 offset:0
    ds_read_b128 a[148:151], v34 offset:4096
    ds_read_b128 a[152:155], v35 offset:0
    s_waitcnt lgkmcnt(8)
    ds_read_b128 a[156:159], v35 offset:4096
    s_waitcnt lgkmcnt(0)
    v_mfma_f32_32x32x16_bf16 v[96:111], v[20:23], a[128:131], v[96:111]
    s_barrier
    ds_read_b64_tr_b16 v[16:17], v27 offset:12288
    ds_read_b64_tr_b16 v[18:19], v27 offset:12800
    s_add_u32 s3, s3, 1
    s_cmp_eq_u32 s3, 9
    v_mfma_f32_32x32x16_bf16 v[112:127], v[20:23], a[132:135], v[112:127]
    s_cselect_b32 s3, 0, s3
    s_mov_b32 s40, 128
    s_cselect_b32 s40, 4294966272, s40
    s_add_u32 s64, s64, s40
    s_add_u32 s65, s65, s40
    s_add_u32 s66, s66, s40
    v_mfma_f32_32x32x16_bf16 v[128:143], v[8:11], a[112:115], v[128:143]
    ds_read_b64_tr_b16 v[20:21], v40 offset:20480
    ds_read_b64_tr_b16 v[22:23], v40 offset:20992
    s_add_u32 s67, s67, s40
    s_add_u32 m0, s38, 0
    s_nop 0
    v_mfma_f32_32x32x16_bf16 v[144:159], v[8:11], a[116:119], v[144:159]
    buffer_load_dwordx4 v38, s[8:11], s64 offen lds
    s_add_u32 m0, s38, 1024
    v_mfma_f32_32x32x16_bf16 v[160:175], v[12:15], a[104:107], v[160:175]
    ds_read_b64_tr_b16 v[8:9], v25 offset:24576
    ds_read_b64_tr_b16 v[10:11], v25 offset:25088
    s_nop 0
    v_mfma_f32_32x32x16_bf16 v[176:191], v[12:15], a[108:111], v[176:191]
    buffer_load_dwordx4 v31, s[8:11], s64 offen lds
    s_add_u32 m0, s38, 2048
    s_waitcnt lgkmcnt(4)
    v_mfma_f32_32x32x16_bf16 v[192:207], v[16:19], a[96:99], v[192:207]
    ds_read_b64_tr_b16 v[12:13], v40 offset:24576
    ds_read_b64_tr_b16 v[14:15], v40 offset:25088
    s_nop 0
    v_mfma_f32_32x32x16_bf16 v[208:223], v[16:19], a[100:103], v[208:223]
    buffer_load_dwordx4 v38, s[8:11], s65 offen lds
    s_add_u32 m0, s38, 3072
    s_waitcnt lgkmcnt(4)
    v_mfma_f32_32x32x16_bf16 v[96:111], v[20:23], a[136:139], v[96:111]
    ds_read_b64_tr_b16 v[16:17], v25 offset:28672
    ds_read_b64_tr_b16 v[18:19], v25 offset:29184
    s_nop 0
    v_mfma_f32_32x32x16_bf16 v[112:127], v[20:23], a[140:143], v[112:127]
    buffer_load_dwordx4 v31, s[8:11], s65 offen lds
    s_add_u32 m0, s38, 4096
    s_waitcnt lgkmcnt(4)
    v_mfma_f32_32x32x16_bf16 v[128:143], v[8:11], a[120:123], v[128:143]
    ds_read_b64_tr_b16 v[20:21], v26 offset:20480
    ds_read_b64_tr_b16 v[22:23], v26 offset:20992
    s_nop 0
    v_mfma_f32_32x32x16_bf16 v[144:159], v[8:11], a[124:127], v[144:159]
    buffer_load_dwordx4 v38, s[8:11], s66 offen lds
    s_add_u32 m0, s38, 5120
    s_waitcnt lgkmcnt(4)
    v_mfma_f32_32x32x16_bf16 v[96:111], v[12:15], a[144:147], v[96:111]
    ds_read_b64_tr_b16 v[8:9], v27 offset:16384
    ds_read_b64_tr_b16 v[10:11], v27 offset:16896
    s_nop 0
    v_mfma_f32_32x32x16_bf16 v[112:127], v[12:15], a[148:151], v[112:127]
    buffer_load_dwordx4 v31, s[8:11], s66 offen lds
    s_add_u32 m0, s38, 6144
    s_waitcnt lgkmcnt(4)
    v_mfma_f32_32x32x16_bf16 v[128:143], v[16:19], a[128:131], v[128:143]
    ds_read_b64_tr_b16 v[12:13], v40 offset:28672
    ds_read_b64_tr_b16 v[14:15], v40 offset:29184
    s_nop 0
    v_mfma_f32_32x32x16_bf16 v[144:159], v[16:19], a[132:135], v[144:159]
    buffer_load_dwordx4 v38, s[8:11], s67 offen lds
    s_add_u32 m0, s38, 7168
    s_waitcnt lgkmcnt(4)
    v_mfma_f32_32x32x16_bf16 v[160:175], v[20:23], a[112:115], v[160:175]
    ds_read_b64_tr_b16 v[16:17], v41 offset:20480
    ds_read_b64_tr_b16 v[18:19], v41 offset:20992
    s_nop 0
    v_mfma_f32_32x32x16_bf16 v[176:191], v[20:23], a[116:119], v[176:191]
    buffer_load_dwordx4 v31, s[8:11], s67 offen lds
    s_add_u32 m0, s39, 49152
    s_waitcnt lgkmcnt(4)
    v_mfma_f32_32x32x16_bf16 v[192:207], v[8:11], a[104:107], v[192:207]
    ds_read_b64_tr_b16 v[20:21], v26 offset:24576
    ds_read_b64_tr_b16 v[22:23], v26 offset:25088
    s_add_u32 s41, s36, 294912
    v_mfma_f32_32x32x16_bf16 v[208:223], v[8:11], a[108:111], v[208:223]
    buffer_load_dwordx4 v28, s[12:15], s41 offen lds
    s_add_u32 m0, s39, 0
    s_waitcnt lgkmcnt(4)
    v_mfma_f32_32x32x16_bf16 v[96:111], v[12:15], a[152:155], v[96:111]
    ds_read_b64_tr_b16 v[8:9], v27 offset:20480
    ds_read_b64_tr_b16 v[10:11], v27 offset:20992
    s_add_u32 s41, s36, 442368
    v_mfma_f32_32x32x16_bf16 v[112:127], v[12:15], a[156:159], v[112:127]
    buffer_load_dwordx4 v28, s[12:15], s41 offen lds
    s_add_u32 s35, s35, 1
    s_waitcnt lgkmcnt(4)
    v_mfma_f32_32x32x16_bf16 v[128:143], v[16:19], a[136:139], v[128:143]
    ds_read_b64_tr_b16 v[12:13], v24 offset:32768
    ds_read_b64_tr_b16 v[14:15], v24 offset:33280
    s_cmp_eq_u32 s35, 9
    s_cselect_b32 s35, 0, s35
    s_mov_b32 s40, 589824
    s_cselect_b32 s40, 4290248704, s40
    s_add_u32 s36, s36, s40
    v_mfma_f32_32x32x16_bf16 v[144:159], v[16:19], a[140:143], v[144:159]
    s_add_u32 m0, s39, 4096
    s_add_u32 s41, s36, 0
    s_waitcnt lgkmcnt(4)
    v_mfma_f32_32x32x16_bf16 v[160:175], v[20:23], a[120:123], v[160:175]
    ds_read_b64_tr_b16 v[16:17], v41 offset:24576
    ds_read_b64_tr_b16 v[18:19], v41 offset:25088
    buffer_load_dwordx4 v28, s[12:15], s41 offen lds
    v_mfma_f32_32x32x16_bf16 v[176:191], v[20:23], a[124:127], v[176:191]
    s_add_u32 m0, s39, 8192
    s_add_u32 s41, s36, 147456
    s_waitcnt lgkmcnt(4)
    v_mfma_f32_32x32x16_bf16 v[192:207], v[8:11], a[112:115], v[192:207]
    ds_read_b64_tr_b16 v[20:21], v26 offset:28672
    ds_read_b64_tr_b16 v[22:23], v26 offset:29184
    buffer_load_dwordx4 v28, s[12:15], s41 offen lds
    v_mfma_f32_32x32x16_bf16 v[208:223], v[8:11], a[116:119], v[208:223]
    s_waitcnt vmcnt(16)
    ds_read_b128 a[160:163], v32 offset:8192
    ds_read_b128 a[164:167], v32 offset:12288
    ds_read_b128 a[168:171], v33 offset:8192
    ds_read_b128 a[172:175], v33 offset:12288
    ds_read_b128 a[176:179], v34 offset:8192
    ds_read_b128 a[180:183], v34 offset:12288
    ds_read_b128 a[184:187], v35 offset:8192
    s_waitcnt lgkmcnt(8)
    ds_read_b128 a[188:191], v35 offset:12288
    s_waitcnt lgkmcnt(0)
    s_add_u32 s3, s3, 1
    s_cmp_eq_u32 s3, 9
    s_cselect_b32 s3, 0, s3
    s_mov_b32 s40, 128
    s_cselect_b32 s40, 4294966272, s40
    v_mfma_f32_32x32x16_bf16 v[96:111], v[12:15], a[160:163], v[96:111]
    s_barrier
    ds_read_b64_tr_b16 v[8:9], v27 offset:24576
    ds_read_b64_tr_b16 v[10:11], v27 offset:25088
    s_add_u32 s64, s64, s40
    s_add_u32 s65, s65, s40
    v_mfma_f32_32x32x16_bf16 v[112:127], v[12:15], a[164:167], v[112:127]
    s_add_u32 s66, s66, s40
    s_add_u32 s67, s67, s40
    s_add_u32 m0, s38, 8192
    s_nop 0
    v_mfma_f32_32x32x16_bf16 v[128:143], v[16:19], a[144:147], v[128:143]
    ds_read_b64_tr_b16 v[12:13], v24 offset:36864
    ds_read_b64_tr_b16 v[14:15], v24 offset:37376
    buffer_load_dwordx4 v38, s[8:11], s64 offen lds
    v_mfma_f32_32x32x16_bf16 v[144:159], v[16:19], a[148:151], v[144:159]
    s_add_u32 m0, s38, 9216
    s_nop 0
    v_mfma_f32_32x32x16_bf16 v[160:175], v[20:23], a[128:131], v[160:175]
    ds_read_b64_tr_b16 v[16:17], v42 offset:20480
    ds_read_b64_tr_b16 v[18:19], v42 offset:20992
    buffer_load_dwordx4 v31, s[8:11], s64 offen lds
    v_mfma_f32_32x32x16_bf16 v[176:191], v[20:23], a[132:135], v[176:191]
    s_add_u32 m0, s38, 10240
    s_nop 0
    s_waitcnt lgkmcnt(4)
    v_mfma_f32_32x32x16_bf16 v[192:207], v[8:11], a[120:123], v[192:207]
    ds_read_b64_tr_b16 v[20:21], v24 offset:40960
    ds_read_b64_tr_b16 v[22:23], v24 offset:41472
    buffer_load_dwordx4 v38, s[8:11], s65 offen lds
    v_mfma_f32_32x32x16_bf16 v[208:223], v[8:11], a[124:127], v[208:223]
    s_add_u32 m0, s38, 11264
    s_nop 0
    s_waitcnt lgkmcnt(4)
    v_mfma_f32_32x32x16_bf16 v[96:111], v[12:15], a[168:171], v[96:111]
    ds_read_b64_tr_b16 v[8:9], v41 offset:28672
    ds_read_b64_tr_b16 v[10:11], v41 offset:29184
    buffer_load_dwordx4 v31, s[8:11], s65 offen lds
    v_mfma_f32_32x32x16_bf16 v[112:127], v[12:15], a[172:175], v[112:127]
    s_add_u32 m0, s38, 12288
    s_nop 0
    s_waitcnt lgkmcnt(4)
    v_mfma_f32_32x32x16_bf16 v[160:175], v[16:19], a[136:139], v[160:175]
    ds_read_b64_tr_b16 v[12:13], v42 offset:24576
    ds_read_b64_tr_b16 v[14:15], v42 offset:25088
    buffer_load_dwordx4 v38, s[8:11], s66 offen lds
    v_mfma_f32_32x32x16_bf16 v[176:191], v[16:19], a[140:143], v[176:191]
    s_add_u32 m0, s38, 13312
    s_nop 0
    s_waitcnt lgkmcnt(4)
    v_mfma_f32_32x32x16_bf16 v[96:111], v[20:23], a[176:179], v[96:111]
    ds_read_b64_tr_b16 v[16:17], v27 offset:28672
    ds_read_b64_tr_b16 v[18:19], v27 offset:29184
    buffer_load_dwordx4 v31, s[8:11], s66 offen lds
    v_mfma_f32_32x32x16_bf16 v[112:127], v[20:23], a[180:183], v[112:127]
    s_add_u32 m0, s38, 14336
    s_nop 0
    s_waitcnt lgkmcnt(4)
    v_mfma_f32_32x32x16_bf16 v[128:143], v[8:11], a[152:155], v[128:143]
    ds_read_b64_tr_b16 v[20:21], v24 offset:61440
    ds_read_b64_tr_b16 v[22:23], v24 offset:61952
    buffer_load_dwordx4 v38, s[8:11], s67 offen lds
    v_mfma_f32_32x32x16_bf16 v[144:159], v[8:11], a[156:159], v[144:159]
    s_add_u32 m0, s38, 15360
    s_nop 0
    s_waitcnt lgkmcnt(4)
    v_mfma_f32_32x32x16_bf16 v[160:175], v[12:15], a[144:147], v[160:175]
    ds_read_b64_tr_b16 v[8:9], v25 offset:32768
    ds_read_b64_tr_b16 v[10:11], v25 offset:33280
    buffer_load_dwordx4 v31, s[8:11], s67 offen lds
    v_mfma_f32_32x32x16_bf16 v[176:191], v[12:15], a[148:151], v[176:191]
    s_add_u32 m0, s39, 53248
    s_add_u32 s41, s36, 294912
    s_waitcnt lgkmcnt(4)
    v_mfma_f32_32x32x16_bf16 v[192:207], v[16:19], a[128:131], v[192:207]
    ds_read_b64_tr_b16 v[12:13], v43 offset:20480
    ds_read_b64_tr_b16 v[14:15], v43 offset:20992
    buffer_load_dwordx4 v28, s[12:15], s41 offen lds
    v_mfma_f32_32x32x16_bf16 v[208:223], v[16:19], a[132:135], v[208:223]
    s_add_u32 m0, s39, 12288
    s_add_u32 s41, s36, 442368
    s_waitcnt lgkmcnt(4)
    v_mfma_f32_32x32x16_bf16 v[96:111], v[20:23], a[184:187], v[96:111]
    ds_read_b64_tr_b16 v[16:17], v40 offset:0
    ds_read_b64_tr_b16 v[18:19], v40 offset:512
    buffer_load_dwordx4 v28, s[12:15], s41 offen lds
    v_mfma_f32_32x32x16_bf16 v[112:127], v[20:23], a[188:191], v[112:127]
    s_add_u32 s35, s35, 1
    s_cmp_eq_u32 s35, 9
    s_cselect_b32 s35, 0, s35
    s_mov_b32 s40, 589824
    s_cselect_b32 s40, 4290248704, s40
    s_add_u32 s36, s36, s40
    s_waitcnt lgkmcnt(4)
    v_mfma_f32_32x32x16_bf16 v[128:143], v[8:11], a[160:163], v[128:143]
    ds_read_b64_tr_b16 v[20:21], v25 offset:36864
    ds_read_b64_tr_b16 v[22:23], v25 offset:37376
    s_add_u32 m0, s39, 16384
    s_add_u32 s41, s36, 3072
    v_mfma_f32_32x32x16_bf16 v[144:159], v[8:11], a[164:167], v[144:159]
    buffer_load_dwordx4 v28, s[12:15], s41 offen lds
    s_add_u32 m0, s39, 20480
    s_waitcnt lgkmcnt(4)
    v_mfma_f32_32x32x16_bf16 v[192:207], v[12:15], a[136:139], v[192:207]
    ds_read_b64_tr_b16 v[8:9], v42 offset:28672
    ds_read_b64_tr_b16 v[10:11], v42 offset:29184
    s_add_u32 s41, s36, 150528
    v_mfma_f32_32x32x16_bf16 v[208:223], v[12:15], a[140:143], v[208:223]
    buffer_load_dwordx4 v28, s[12:15], s41 offen lds
    s_waitcnt vmcnt(16)
    ds_read_b128 a[192:195], v32 offset:0
    ds_read_b128 a[196:199], v32 offset:4096
    ds_read_b128 a[200:203], v33 offset:0
    ds_read_b128 a[204:207], v33 offset:4096
    ds_read_b128 a[208:211], v34 offset:0
    ds_read_b128 a[212:215], v34 offset:4096
    ds_read_b128 a[216:219], v35 offset:0
    s_waitcnt lgkmcnt(8)
    ds_read_b128 a[220:223], v35 offset:4096
    s_waitcnt lgkmcnt(0)
    v_mfma_f32_32x32x16_bf16 v[96:111], v[16:19], a[192:195], v[96:111]
    s_barrier
    ds_read_b64_tr_b16 v[12:13], v43 offset:24576
    ds_read_b64_tr_b16 v[14:15], v43 offset:25088
    s_add_u32 s3, s3, 1
    s_cmp_eq_u32 s3, 9
    v_mfma_f32_32x32x16_bf16 v[112:127], v[16:19], a[196:199], v[112:127]
    s_cselect_b32 s3, 0, s3
    s_mov_b32 s40, 128
    s_cselect_b32 s40, 4294966272, s40
    s_add_u32 s64, s64, s40
    s_add_u32 s65, s65, s40
    s_add_u32 s66, s66, s40
    v_mfma_f32_32x32x16_bf16 v[128:143], v[20:23], a[168:171], v[128:143]
    ds_read_b64_tr_b16 v[16:17], v40 offset:4096
    ds_read_b64_tr_b16 v[18:19], v40 offset:4608
    s_add_u32 s67, s67, s40
    s_add_u32 m0, s38, 0
    s_nop 0
    v_mfma_f32_32x32x16_bf16 v[144:159], v[20:23], a[172:175], v[144:159]
    buffer_load_dwordx4 v38, s[8:11], s64 offen lds
    s_add_u32 m0, s38, 1024
    v_mfma_f32_32x32x16_bf16 v[160:175], v[8:11], a[152:155], v[160:175]
    ds_read_b64_tr_b16 v[20:21], v25 offset:40960
    ds_read_b64_tr_b16 v[22:23], v25 offset:41472
    s_nop 0
    v_mfma_f32_32x32x16_bf16 v[176:191], v[8:11], a[156:159], v[176:191]
    buffer_load_dwordx4 v31, s[8:11], s64 offen lds
    s_add_u32 m0, s38, 2048
    s_waitcnt lgkmcnt(4)
    v_mfma_f32_32x32x16_bf16 v[192:207], v[12:15], a[144:147], v[192:207]
    ds_read_b64_tr_b16 v[8:9], v26 offset:32768
    ds_read_b64_tr_b16 v[10:11], v26 offset:33280
    s_nop 0
    v_mfma_f32_32x32x16_bf16 v[208:223], v[12:15], a[148:151], v[208:223]
    buffer_load_dwordx4 v38, s[8:11], s65 offen lds
    s_add_u32 m0, s38, 3072
    s_waitcnt lgkmcnt(4)
    v_mfma_f32_32x32x16_bf16 v[96:111], v[16:19], a[200:203], v[96:111]
    ds_read_b64_tr_b16 v[12:13], v24 offset:45056
    ds_read_b64_tr_b16 v[14:15], v24 offset:45568
    s_nop 0
    v_mfma_f32_32x32x16_bf16 v[112:127], v[16:19], a[204:207], v[112:127]
    buffer_load_dwordx4 v31, s[8:11], s65 offen lds
    s_add_u32 m0, s38, 4096
    s_waitcnt lgkmcnt(4)
    v_mfma_f32_32x32x16_bf16 v[128:143], v[20:23], a[176:179], v[128:143]
    ds_read_b64_tr_b16 v[16:17], v25 offset:61440
    ds_read_b64_tr_b16 v[18:19], v25 offset:61952
    s_nop 0
    v_mfma_f32_32x32x16_bf16 v[144:159], v[20:23], a[180:183], v[144:159]
    buffer_load_dwordx4 v38, s[8:11], s66 offen lds
    s_add_u32 m0, s38, 5120
    s_waitcnt lgkmcnt(4)
    v_mfma_f32_32x32x16_bf16 v[160:175], v[8:11], a[160:163], v[160:175]
    ds_read_b64_tr_b16 v[20:21], v26 offset:36864
    ds_read_b64_tr_b16 v[22:23], v26 offset:37376
    s_nop 0
    v_mfma_f32_32x32x16_bf16 v[176:191], v[8:11], a[164:167], v[176:191]
    buffer_load_dwordx4 v31, s[8:11], s66 offen lds
    s_add_u32 m0, s38, 6144
    s_waitcnt lgkmcnt(4)
    v_mfma_f32_32x32x16_bf16 v[96:111], v[12:15], a[208:211], v[96:111]
    ds_read_b64_tr_b16 v[8:9], v43 offset:28672
    ds_read_b64_tr_b16 v[10:11], v43 offset:29184
    s_nop 0
    v_mfma_f32_32x32x16_bf16 v[112:127], v[12:15], a[212:215], v[112:127]
    buffer_load_dwordx4 v38, s[8:11], s67 offen lds
    s_add_u32 m0, s38, 7168
    s_waitcnt lgkmcnt(4)
    v_mfma_f32_32x32x16_bf16 v[128:143], v[16:19], a[184:187], v[128:143]
    ds_read_b64_tr_b16 v[12:13], v40 offset:8192
    ds_read_b64_tr_b16 v[14:15], v40 offset:8704
    s_nop 0
    v_mfma_f32_32x32x16_bf16 v[144:159], v[16:19], a[188:191], v[144:159]
    buffer_load_dwordx4 v31, s[8:11], s67 offen lds
    s_add_u32 m0, s39, 57344
    s_waitcnt lgkmcnt(4)
    v_mfma_f32_32x32x16_bf16 v[160:175], v[20:23], a[168:171], v[160:175]
    ds_read_b64_tr_b16 v[16:17], v41 offset:0
    ds_read_b64_tr_b16 v[18:19], v41 offset:512
    s_add_u32 s41, s36, 297984
    v_mfma_f32_32x32x16_bf16 v[176:191], v[20:23], a[172:175], v[176:191]
    buffer_load_dwordx4 v28, s[12:15], s41 offen lds
    s_add_u32 m0, s39, 86016
    s_waitcnt lgkmcnt(4)
    v_mfma_f32_32x32x16_bf16 v[192:207], v[8:11], a[152:155], v[192:207]
    ds_read_b64_tr_b16 v[20:21], v26 offset:40960
    ds_read_b64_tr_b16 v[22:23], v26 offset:41472
    s_add_u32 s41, s36, 445440
    v_mfma_f32_32x32x16_bf16 v[208:223], v[8:11], a[156:159], v[208:223]
    buffer_load_dwordx4 v28, s[12:15], s41 offen lds
    s_add_u32 s35, s35, 1
    s_waitcnt lgkmcnt(4)
    v_mfma_f32_32x32x16_bf16 v[96:111], v[12:15], a[216:219], v[96:111]
    ds_read_b64_tr_b16 v[8:9], v27 offset:32768
    ds_read_b64_tr_b16 v[10:11], v27 offset:33280
    s_cmp_eq_u32 s35, 9
    s_cselect_b32 s35, 0, s35
    s_mov_b32 s40, 589824
    s_cselect_b32 s40, 4290248704, s40
    s_add_u32 s36, s36, s40
    v_mfma_f32_32x32x16_bf16 v[112:127], v[12:15], a[220:223], v[112:127]
    s_add_u32 m0, s39, 24576
    s_add_u32 s41, s36, 3072
    s_waitcnt lgkmcnt(4)
    v_mfma_f32_32x32x16_bf16 v[128:143], v[16:19], a[192:195], v[128:143]
    ds_read_b64_tr_b16 v[12:13], v40 offset:12288
    ds_read_b64_tr_b16 v[14:15], v40 offset:12800
    buffer_load_dwordx4 v28, s[12:15], s41 offen lds
    v_mfma_f32_32x32x16_bf16 v[144:159], v[16:19], a[196:199], v[144:159]
    s_add_u32 m0, s39, 28672
    s_add_u32 s41, s36, 150528
    s_waitcnt lgkmcnt(4)
    v_mfma_f32_32x32x16_bf16 v[160:175], v[20:23], a[176:179], v[160:175]
    ds_read_b64_tr_b16 v[16:17], v41 offset:4096
    ds_read_b64_tr_b16 v[18:19], v41 offset:4608
    buffer_load_dwordx4 v28, s[12:15], s41 offen lds
    v_mfma_f32_32x32x16_bf16 v[176:191], v[20:23], a[180:183], v[176:191]
    s_waitcnt vmcnt(16)
    ds_read_b128 a[224:227], v32 offset:8192
    ds_read_b128 a[228:231], v32 offset:12288
    s_waitcnt lgkmcnt(6)
    v_mfma_f32_32x32x16_bf16 v[192:207], v[8:11], a[160:163], v[192:207]
    ds_read_b64_tr_b16 v[20:21], v27 offset:36864
    ds_read_b64_tr_b16 v[22:23], v27 offset:37376
    ds_read_b128 a[232:235], v33 offset:8192
    ds_read_b128 a[236:239], v33 offset:12288
    v_mfma_f32_32x32x16_bf16 v[208:223], v[8:11], a[164:167], v[208:223]
    s_waitcnt lgkmcnt(4)
    v_mfma_f32_32x32x16_bf16 v[96:111], v[12:15], a[224:227], v[96:111]
    s_barrier
    ds_read_b64_tr_b16 v[8:9], v40 offset:16384
    ds_read_b64_tr_b16 v[10:11], v40 offset:16896
    s_add_u32 m0, s39, 90112
    s_add_u32 s41, s36, 297984
    v_mfma_f32_32x32x16_bf16 v[112:127], v[12:15], a[228:231], v[112:127]
    buffer_load_dwordx4 v28, s[12:15], s41 offen lds
    s_add_u32 m0, s39, 94208
    v_mfma_f32_32x32x16_bf16 v[128:143], v[16:19], a[200:203], v[128:143]
    ds_read_b64_tr_b16 v[12:13], v25 offset:45056
    ds_read_b64_tr_b16 v[14:15], v25 offset:45568
    s_add_u32 s41, s36, 445440
    v_mfma_f32_32x32x16_bf16 v[144:159], v[16:19], a[204:207], v[144:159]
    buffer_load_dwordx4 v28, s[12:15], s41 offen lds
    s_waitcnt lgkmcnt(6)
    v_mfma_f32_32x32x16_bf16 v[192:207], v[20:23], a[168:171], v[192:207]
    ds_read_b64_tr_b16 v[16:17], v26 offset:61440
    ds_read_b64_tr_b16 v[18:19], v26 offset:61952
    ds_read_b128 a[240:243], v34 offset:8192
    ds_read_b128 a[244:247], v34 offset:12288
    v_mfma_f32_32x32x16_bf16 v[208:223], v[20:23], a[172:175], v[208:223]
    s_waitcnt lgkmcnt(6)
    v_mfma_f32_32x32x16_bf16 v[96:111], v[8:11], a[232:235], v[96:111]
    ds_read_b64_tr_b16 v[20:21], v24 offset:49152
    ds_read_b64_tr_b16 v[22:23], v24 offset:49664
    s_add_u32 s35, s35, 1
    s_cmp_eq_u32 s35, 9
    s_cselect_b32 s35, 0, s35
    s_mov_b32 s40, 589824
    s_cselect_b32 s40, 4290248704, s40
    v_mfma_f32_32x32x16_bf16 v[112:127], v[8:11], a[236:239], v[112:127]
    s_add_u32 s36, s36, s40
    s_add_u32 m0, s39, 32768
    s_add_u32 s41, s36, 3072
    s_waitcnt lgkmcnt(6)
    v_mfma_f32_32x32x16_bf16 v[128:143], v[12:15], a[208:211], v[128:143]
    ds_read_b64_tr_b16 v[8:9], v41 offset:8192
    ds_read_b64_tr_b16 v[10:11], v41 offset:8704
    buffer_load_dwordx4 v28, s[12:15], s41 offen lds
    v_mfma_f32_32x32x16_bf16 v[144:159], v[12:15], a[212:215], v[144:159]
    ds_read_b128 a[248:251], v35 offset:8192
    ds_read_b128 a[252:255], v35 offset:12288
    s_waitcnt lgkmcnt(8)
    v_mfma_f32_32x32x16_bf16 v[160:175], v[16:19], a[184:187], v[160:175]
    ds_read_b64_tr_b16 v[12:13], v42 offset:0
    ds_read_b64_tr_b16 v[14:15], v42 offset:512
    v_mfma_f32_32x32x16_bf16 v[176:191], v[16:19], a[188:191], v[176:191]
    s_waitcnt lgkmcnt(6)
    v_mfma_f32_32x32x16_bf16 v[96:111], v[20:23], a[240:243], v[96:111]
    ds_read_b64_tr_b16 v[16:17], v27 offset:40960
    ds_read_b64_tr_b16 v[18:19], v27 offset:41472
    s_waitcnt vmcnt(7)
    ds_read_b128 v[64:67], v32 offset:0
    ds_read_b128 v[68:71], v32 offset:4096
    v_mfma_f32_32x32x16_bf16 v[112:127], v[20:23], a[244:247], v[112:127]
    s_waitcnt lgkmcnt(8)
    v_mfma_f32_32x32x16_bf16 v[128:143], v[8:11], a[216:219], v[128:143]
    ds_read_b64_tr_b16 v[20:21], v24 offset:0
    ds_read_b64_tr_b16 v[22:23], v24 offset:512
    v_mfma_f32_32x32x16_bf16 v[144:159], v[8:11], a[220:223], v[144:159]
    s_waitcnt lgkmcnt(6)
    v_mfma_f32_32x32x16_bf16 v[160:175], v[12:15], a[192:195], v[160:175]
    ds_read_b64_tr_b16 v[8:9], v42 offset:4096
    ds_read_b64_tr_b16 v[10:11], v42 offset:4608
    ds_read_b128 v[72:75], v33 offset:0
    ds_read_b128 v[76:79], v33 offset:4096
    v_mfma_f32_32x32x16_bf16 v[176:191], v[12:15], a[196:199], v[176:191]
    s_waitcnt lgkmcnt(8)
    v_mfma_f32_32x32x16_bf16 v[192:207], v[16:19], a[176:179], v[192:207]
    ds_read_b64_tr_b16 v[12:13], v27 offset:61440
    ds_read_b64_tr_b16 v[14:15], v27 offset:61952
    v_mfma_f32_32x32x16_bf16 v[208:223], v[16:19], a[180:183], v[208:223]
    s_waitcnt lgkmcnt(6)
    v_mfma_f32_32x32x16_bf16 v[96:111], v[20:23], a[248:251], v[96:111]
    ds_read_b64_tr_b16 v[16:17], v24 offset:4096
    ds_read_b64_tr_b16 v[18:19], v24 offset:4608
    ds_read_b128 v[80:83], v34 offset:0
    ds_read_b128 v[84:87], v34 offset:4096
    v_mfma_f32_32x32x16_bf16 v[112:127], v[20:23], a[252:255], v[112:127]
    s_waitcnt lgkmcnt(8)
    v_mfma_f32_32x32x16_bf16 v[160:175], v[8:11], a[200:203], v[160:175]
    ds_read_b64_tr_b16 v[20:21], v41 offset:12288
    ds_read_b64_tr_b16 v[22:23], v41 offset:12800
    v_mfma_f32_32x32x16_bf16 v[176:191], v[8:11], a[204:207], v[176:191]
    s_waitcnt lgkmcnt(6)
    v_mfma_f32_32x32x16_bf16 v[192:207], v[12:15], a[184:187], v[192:207]
    ds_read_b64_tr_b16 v[8:9], v26 offset:45056
    ds_read_b64_tr_b16 v[10:11], v26 offset:45568
    ds_read_b128 v[88:91], v35 offset:0
    ds_read_b128 v[92:95], v35 offset:4096
    v_mfma_f32_32x32x16_bf16 v[208:223], v[12:15], a[188:191], v[208:223]
    s_waitcnt lgkmcnt(8)
    v_mfma_f32_32x32x16_bf16 v[96:111], v[16:19], v[64:67], v[96:111]
    s_barrier
    ds_read_b64_tr_b16 v[12:13], v43 offset:0
    ds_read_b64_tr_b16 v[14:15], v43 offset:512
    s_add_u32 m0, s39, 61440
    s_add_u32 s41, s36, 150528
    v_mfma_f32_32x32x16_bf16 v[112:127], v[16:19], v[68:71], v[112:127]
    buffer_load_dwordx4 v28, s[12:15], s41 offen lds
    s_add_u32 m0, s39, 36864
    s_waitcnt lgkmcnt(6)
    v_mfma_f32_32x32x16_bf16 v[128:143], v[20:23], a[224:227], v[128:143]
    ds_read_b64_tr_b16 v[16:17], v24 offset:8192
    ds_read_b64_tr_b16 v[18:19], v24 offset:8704
    s_add_u32 s41, s36, 297984
    v_mfma_f32_32x32x16_bf16 v[144:159], v[20:23], a[228:231], v[144:159]
    buffer_load_dwordx4 v28, s[12:15], s41 offen lds
    s_waitcnt lgkmcnt(6)
    v_mfma_f32_32x32x16_bf16 v[160:175], v[8:11], a[208:211], v[160:175]
    ds_read_b64_tr_b16 v[20:21], v41 offset:16384
    ds_read_b64_tr_b16 v[22:23], v41 offset:16896
    v_mfma_f32_32x32x16_bf16 v[176:191], v[8:11], a[212:215], v[176:191]
    s_waitcnt lgkmcnt(4)
    v_mfma_f32_32x32x16_bf16 v[192:207], v[12:15], a[192:195], v[192:207]
    ds_read_b64_tr_b16 v[8:9], v42 offset:8192
    ds_read_b64_tr_b16 v[10:11], v42 offset:8704
    v_mfma_f32_32x32x16_bf16 v[208:223], v[12:15], a[196:199], v[208:223]
    s_waitcnt lgkmcnt(4)
    v_mfma_f32_32x32x16_bf16 v[96:111], v[16:19], v[72:75], v[96:111]
    ds_read_b64_tr_b16 v[12:13], v24 offset:53248
    ds_read_b64_tr_b16 v[14:15], v24 offset:53760
    s_add_u32 m0, s39, 40960
    s_add_u32 s41, s36, 445440
    v_mfma_f32_32x32x16_bf16 v[112:127], v[16:19], v[76:79], v[112:127]
    buffer_load_dwordx4 v28, s[12:15], s41 offen lds
    s_waitcnt lgkmcnt(4)
    v_mfma_f32_32x32x16_bf16 v[128:143], v[20:23], a[232:235], v[128:143]
    ds_read_b64_tr_b16 v[16:17], v25 offset:49152
    ds_read_b64_tr_b16 v[18:19], v25 offset:49664
    v_mfma_f32_32x32x16_bf16 v[144:159], v[20:23], a[236:239], v[144:159]
    s_waitcnt lgkmcnt(4)
    v_mfma_f32_32x32x16_bf16 v[160:175], v[8:11], a[216:219], v[160:175]
    ds_read_b64_tr_b16 v[20:21], v43 offset:4096
    ds_read_b64_tr_b16 v[22:23], v43 offset:4608
    v_mfma_f32_32x32x16_bf16 v[176:191], v[8:11], a[220:223], v[176:191]
    s_waitcnt lgkmcnt(4)
    v_mfma_f32_32x32x16_bf16 v[96:111], v[12:15], v[80:83], v[96:111]
    ds_read_b64_tr_b16 v[8:9], v24 offset:12288
    ds_read_b64_tr_b16 v[10:11], v24 offset:12800
    v_mfma_f32_32x32x16_bf16 v[112:127], v[12:15], v[84:87], v[112:127]
    s_waitcnt lgkmcnt(4)
    v_mfma_f32_32x32x16_bf16 v[128:143], v[16:19], a[240:243], v[128:143]
    ds_read_b64_tr_b16 v[12:13], v25 offset:0
    ds_read_b64_tr_b16 v[14:15], v25 offset:512
    v_mfma_f32_32x32x16_bf16 v[144:159], v[16:19], a[244:247], v[144:159]
    s_waitcnt lgkmcnt(4)
    v_mfma_f32_32x32x16_bf16 v[192:207], v[20:23], a[200:203], v[192:207]
    ds_read_b64_tr_b16 v[16:17], v42 offset:12288
    ds_read_b64_tr_b16 v[18:19], v42 offset:12800
    v_mfma_f32_32x32x16_bf16 v[208:223], v[20:23], a[204:207], v[208:223]
    s_waitcnt lgkmcnt(4)
    v_mfma_f32_32x32x16_bf16 v[96:111], v[8:11], v[88:91], v[96:111]
    ds_read_b64_tr_b16 v[20:21], v27 offset:45056
    ds_read_b64_tr_b16 v[22:23], v27 offset:45568
    v_mfma_f32_32x32x16_bf16 v[112:127], v[8:11], v[92:95], v[112:127]
    s_waitcnt lgkmcnt(4)
    v_mfma_f32_32x32x16_bf16 v[128:143], v[12:15], a[248:251], v[128:143]
    ds_read_b64_tr_b16 v[8:9], v24 offset:16384
    ds_read_b64_tr_b16 v[10:11], v24 offset:16896
    v_mfma_f32_32x32x16_bf16 v[144:159], v[12:15], a[252:255], v[144:159]
    s_waitcnt lgkmcnt(4)
    v_mfma_f32_32x32x16_bf16 v[160:175], v[16:19], a[224:227], v[160:175]
    ds_read_b64_tr_b16 v[12:13], v25 offset:4096
    ds_read_b64_tr_b16 v[14:15], v25 offset:4608
    v_mfma_f32_32x32x16_bf16 v[176:191], v[16:19], a[228:231], v[176:191]
    s_waitcnt lgkmcnt(4)
    v_mfma_f32_32x32x16_bf16 v[192:207], v[20:23], a[208:211], v[192:207]
    ds_read_b64_tr_b16 v[16:17], v42 offset:16384
    ds_read_b64_tr_b16 v[18:19], v42 offset:16896
    v_mul_f32 v44, 0xbfb8aa3b, v96
    v_mul_f32 v45, 0xbfb8aa3b, v97
    v_mul_f32 v46, 0xbfb8aa3b, v98
    v_mul_f32 v47, 0xbfb8aa3b, v99
    v_mul_f32 v48, 0xbfb8aa3b, v104
    v_mfma_f32_32x32x16_bf16 v[208:223], v[20:23], a[212:215], v[208:223]
    v_mul_f32 v49, 0xbfb8aa3b, v105
    v_mul_f32 v50, 0xbfb8aa3b, v106
    v_mul_f32 v51, 0xbfb8aa3b, v107
    v_exp_f32 v44, v44
    s_waitcnt lgkmcnt(4)
    v_mfma_f32_32x32x16_bf16 v[224:239], v[8:11], a[0:3], 0
    s_waitcnt vmcnt(7)
    s_barrier
    ds_read_b64_tr_b16 v[20:21], v43 offset:8192
    ds_read_b64_tr_b16 v[22:23], v43 offset:8704
    s_add_u32 s35, s35, 1
    s_cmp_eq_u32 s35, 9
    v_mfma_f32_32x32x16_bf16 v[240:255], v[8:11], a[4:7], 0
    s_cselect_b32 s35, 0, s35
    s_mov_b32 s40, 589824
    s_cselect_b32 s40, 4290248704, s40
    s_add_u32 s36, s36, s40
    s_add_u32 m0, s39, 122880
    s_add_u32 s41, s36, 3072
    s_waitcnt lgkmcnt(4)
    v_mfma_f32_32x32x16_bf16 v[128:143], v[12:15], v[64:67], v[128:143]
    ds_read_b64_tr_b16 v[8:9], v24 offset:20480
    ds_read_b64_tr_b16 v[10:11], v24 offset:20992
    buffer_load_dwordx4 v28, s[12:15], s41 offen lds
    v_mfma_f32_32x32x16_bf16 v[144:159], v[12:15], v[68:71], v[144:159]
    s_add_u32 m0, s39, 126976
    s_add_u32 s41, s36, 150528
    v_exp_f32 v45, v45
    v_exp_f32 v46, v46
    s_waitcnt lgkmcnt(4)
    v_mfma_f32_32x32x16_bf16 v[160:175], v[16:19], a[232:235], v[160:175]
    ds_read_b64_tr_b16 v[12:13], v25 offset:8192
    ds_read_b64_tr_b16 v[14:15], v25 offset:8704
    buffer_load_dwordx4 v28, s[12:15], s41 offen lds
    v_mfma_f32_32x32x16_bf16 v[176:191], v[16:19], a[236:239], v[176:191]
    v_exp_f32 v47, v47
    v_exp_f32 v48, v48
    v_exp_f32 v49, v49
    s_waitcnt lgkmcnt(4)
    v_mfma_f32_32x32x16_bf16 v[192:207], v[20:23], a[216:219], v[192:207]
    ds_read_b64_tr_b16 v[16:17], v26 offset:49152
    ds_read_b64_tr_b16 v[18:19], v26 offset:49664
    v_exp_f32 v50, v50
    v_exp_f32 v51, v51
    v_add_f32 v44, 1.0, v44
    v_mfma_f32_32x32x16_bf16 v[208:223], v[20:23], a[220:223], v[208:223]
    v_add_f32 v45, 1.0, v45
    v_add_f32 v46, 1.0, v46
    v_add_f32 v47, 1.0, v47
    v_add_f32 v48, 1.0, v48
    v_add_f32 v49, 1.0, v49
    v_add_f32 v50, 1.0, v50
    s_waitcnt lgkmcnt(4)
    v_mfma_f32_32x32x16_bf16 v[224:239], v[8:11], a[8:11], v[224:239]
    ds_read_b64_tr_b16 v[20:21], v24 offset:57344
    ds_read_b64_tr_b16 v[22:23], v24 offset:57856
    s_add_u32 m0, s39, 110592
    s_add_u32 s41, s36, 297984
    v_add_f32 v51, 1.0, v51
    v_rcp_f32 v44, v44
    v_mfma_f32_32x32x16_bf16 v[240:255], v[8:11], a[12:15], v[240:255]
    buffer_load_dwordx4 v28, s[12:15], s41 offen lds
    s_add_u32 m0, s39, 114688
    s_waitcnt lgkmcnt(4)
    v_mfma_f32_32x32x16_bf16 v[128:143], v[12:15], v[72:75], v[128:143]
    ds_read_b64_tr_b16 v[8:9], v25 offset:53248
    ds_read_b64_tr_b16 v[10:11], v25 offset:53760
    s_add_u32 s41, s36, 445440
    v_rcp_f32 v45, v45
    v_rcp_f32 v46, v46
    v_mfma_f32_32x32x16_bf16 v[144:159], v[12:15], v[76:79], v[144:159]
    buffer_load_dwordx4 v28, s[12:15], s41 offen lds
    s_waitcnt lgkmcnt(4)
    v_mfma_f32_32x32x16_bf16 v[160:175], v[16:19], a[240:243], v[160:175]
    ds_read_b64_tr_b16 v[12:13], v26 offset:0
    ds_read_b64_tr_b16 v[14:15], v26 offset:512
    v_rcp_f32 v47, v47
    v_rcp_f32 v48, v48
    v_mfma_f32_32x32x16_bf16 v[176:191], v[16:19], a[244:247], v[176:191]
    v_rcp_f32 v49, v49
    v_rcp_f32 v50, v50
    v_rcp_f32 v51, v51
    s_waitcnt lgkmcnt(4)
    v_mfma_f32_32x32x16_bf16 v[224:239], v[20:23], a[16:19], v[224:239]
    ds_read_b64_tr_b16 v[16:17], v43 offset:12288
    ds_read_b64_tr_b16 v[18:19], v43 offset:12800
    s_add_u32 s35, s35, 1
    s_cmp_eq_u32 s35, 9
    s_cselect_b32 s35, 0, s35
    s_mov_b32 s40, 589824
    s_cselect_b32 s40, 4290248704, s40
    v_mfma_f32_32x32x16_bf16 v[240:255], v[20:23], a[20:23], v[240:255]
    s_add_u32 s36, s36, s40
    s_add_u32 m0, s39, 118784
    s_add_u32 s41, s36, 3072
    v_mul_f32 v44, v44, v100
    v_mul_f32 v45, v45, v101
    v_mul_f32 v46, v46, v102
    s_waitcnt lgkmcnt(4)
    v_mfma_f32_32x32x16_bf16 v[128:143], v[8:11], v[80:83], v[128:143]
    ds_read_b64_tr_b16 v[20:21], v40 offset:20480
    ds_read_b64_tr_b16 v[22:23], v40 offset:20992
    buffer_load_dwordx4 v28, s[12:15], s41 offen lds
    v_mfma_f32_32x32x16_bf16 v[144:159], v[8:11], v[84:87], v[144:159]
    s_add_u32 m0, s39, 98304
    s_add_u32 s41, s36, 150528
    v_mul_f32 v47, v47, v103
    v_mul_f32 v48, v48, v108
    v_mul_f32 v49, v49, v109
    v_mul_f32 v50, v50, v110
    s_waitcnt lgkmcnt(4)
    v_mfma_f32_32x32x16_bf16 v[160:175], v[12:15], a[248:251], v[160:175]
    ds_read_b64_tr_b16 v[8:9], v25 offset:12288
    ds_read_b64_tr_b16 v[10:11], v25 offset:12800
    buffer_load_dwordx4 v28, s[12:15], s41 offen lds
    v_mfma_f32_32x32x16_bf16 v[176:191], v[12:15], a[252:255], v[176:191]
    s_mov_b32 s20, s30
    s_mov_b32 s21, s31
    s_mov_b32 s22, 256
    s_mov_b32 s23, 0x00020000
    v_mov_b32 v61, 0
    v_mul_f32 v51, v51, v111
    s_waitcnt lgkmcnt(4)
    v_mfma_f32_32x32x16_bf16 v[192:207], v[16:19], a[224:227], v[192:207]
    ds_read_b64_tr_b16 v[12:13], v43 offset:16384
    ds_read_b64_tr_b16 v[14:15], v43 offset:16896
    buffer_load_dword v60, v61, s[20:23], 0 offen sc0 sc1
    v_mfma_f32_32x32x16_bf16 v[208:223], v[16:19], a[228:231], v[208:223]
    v_cvt_pk_bf16_f32 v52, v44, v45
    v_cvt_pk_bf16_f32 v53, v46, v47
    v_cvt_pk_bf16_f32 v54, v48, v49
    v_cvt_pk_bf16_f32 v55, v50, v51
    s_add_u32 s42, s37, 0
    v_mul_f32 v44, 0xbfb8aa3b, v112
    s_waitcnt lgkmcnt(4)
    v_mfma_f32_32x32x16_bf16 v[224:239], v[20:23], a[24:27], v[224:239]
    ds_read_b64_tr_b16 v[16:17], v24 offset:24576
    ds_read_b64_tr_b16 v[18:19], v24 offset:25088
    buffer_store_dwordx4 v[52:55], v39, s[16:19], s42 offen sc0 sc1
    v_mfma_f32_32x32x16_bf16 v[240:255], v[20:23], a[28:31], v[240:255]
    s_add_u32 m0, s39, 102400
    s_add_u32 s41, s36, 297984
    v_mul_f32 v45, 0xbfb8aa3b, v113
    v_mul_f32 v46, 0xbfb8aa3b, v114
    v_mul_f32 v47, 0xbfb8aa3b, v115
    v_mul_f32 v48, 0xbfb8aa3b, v120
    s_waitcnt lgkmcnt(4)
    v_mfma_f32_32x32x16_bf16 v[128:143], v[8:11], v[88:91], v[128:143]
    ds_read_b64_tr_b16 v[20:21], v25 offset:16384
    ds_read_b64_tr_b16 v[22:23], v25 offset:16896
    buffer_load_dwordx4 v28, s[12:15], s41 offen lds
    v_mfma_f32_32x32x16_bf16 v[144:159], v[8:11], v[92:95], v[144:159]
    v_mul_f32 v49, 0xbfb8aa3b, v121
    v_mul_f32 v50, 0xbfb8aa3b, v122
    v_mul_f32 v51, 0xbfb8aa3b, v123
    v_exp_f32 v44, v44
    s_waitcnt lgkmcnt(4)
    v_mfma_f32_32x32x16_bf16 v[192:207], v[12:15], a[232:235], v[192:207]
    ds_read_b64_tr_b16 v[8:9], v26 offset:4096
    ds_read_b64_tr_b16 v[10:11], v26 offset:4608
    v_exp_f32 v45, v45
    v_exp_f32 v46, v46
    v_mfma_f32_32x32x16_bf16 v[208:223], v[12:15], a[236:239], v[208:223]
    v_exp_f32 v47, v47
    v_exp_f32 v48, v48
    v_exp_f32 v49, v49
    s_waitcnt lgkmcnt(4)
    v_mfma_f32_32x32x16_bf16 v[224:239], v[16:19], a[32:35], v[224:239]
    s_waitcnt vmcnt(12)
    s_barrier
    ds_read_b64_tr_b16 v[12:13], v27 offset:49152
    ds_read_b64_tr_b16 v[14:15], v27 offset:49664
    s_add_u32 m0, s39, 106496
    s_add_u32 s41, s36, 445440
    v_mfma_f32_32x32x16_bf16 v[240:255], v[16:19], a[36:39], v[240:255]
    buffer_load_dwordx4 v28, s[12:15], s41 offen lds
    v_exp_f32 v50, v50
    v_exp_f32 v51, v51
    v_add_f32 v44, 1.0, v44
    v_add_f32 v45, 1.0, v45
    v_add_f32 v46, 1.0, v46
    v_add_f32 v47, 1.0, v47
    v_add_f32 v48, 1.0, v48
    v_add_f32 v49, 1.0, v49
    v_add_f32 v50, 1.0, v50
    v_add_f32 v51, 1.0, v51
    v_rcp_f32 v44, v44
    v_rcp_f32 v45, v45
    v_rcp_f32 v46, v46
    v_rcp_f32 v47, v47
    v_rcp_f32 v48, v48
    v_rcp_f32 v49, v49
    v_rcp_f32 v50, v50
    v_rcp_f32 v51, v51
    v_mul_f32 v44, v44, v116
    v_mul_f32 v45, v45, v117
    v_mul_f32 v46, v46, v118
    v_mul_f32 v47, v47, v119
    v_mul_f32 v48, v48, v124
    v_mul_f32 v49, v49, v125
    v_mul_f32 v50, v50, v126
    v_mul_f32 v51, v51, v127
    v_cvt_pk_bf16_f32 v56, v44, v45
    v_cvt_pk_bf16_f32 v57, v46, v47
    v_cvt_pk_bf16_f32 v58, v48, v49
    v_cvt_pk_bf16_f32 v59, v50, v51
    s_add_u32 s42, s37, 331776
    buffer_store_dwordx4 v[56:59], v39, s[16:19], s42 offen sc0 sc1
    s_waitcnt lgkmcnt(4)
    v_mfma_f32_32x32x16_bf16 v[96:111], v[20:23], a[0:3], 0
    ds_read_b64_tr_b16 v[16:17], v24 offset:28672
    ds_read_b64_tr_b16 v[18:19], v24 offset:29184
    v_mul_f32 v44, 0xbfb8aa3b, v128
    v_mul_f32 v45, 0xbfb8aa3b, v129
    v_mul_f32 v46, 0xbfb8aa3b, v130
    v_mul_f32 v47, 0xbfb8aa3b, v131
    v_mul_f32 v48, 0xbfb8aa3b, v136
    v_mfma_f32_32x32x16_bf16 v[112:127], v[20:23], a[4:7], 0
    v_mul_f32 v49, 0xbfb8aa3b, v137
    v_mul_f32 v50, 0xbfb8aa3b, v138
    v_mul_f32 v51, 0xbfb8aa3b, v139
    v_exp_f32 v44, v44
    s_waitcnt lgkmcnt(4)
    v_mfma_f32_32x32x16_bf16 v[160:175], v[8:11], v[64:67], v[160:175]
    ds_read_b64_tr_b16 v[20:21], v25 offset:20480
    ds_read_b64_tr_b16 v[22:23], v25 offset:20992
    v_exp_f32 v45, v45
    v_exp_f32 v46, v46
    v_mfma_f32_32x32x16_bf16 v[176:191], v[8:11], v[68:71], v[176:191]
    v_exp_f32 v47, v47
    v_exp_f32 v48, v48
    v_exp_f32 v49, v49
    s_waitcnt lgkmcnt(4)
    v_mfma_f32_32x32x16_bf16 v[192:207], v[12:15], a[240:243], v[192:207]
    ds_read_b64_tr_b16 v[8:9], v26 offset:8192
    ds_read_b64_tr_b16 v[10:11], v26 offset:8704
    v_exp_f32 v50, v50
    v_exp_f32 v51, v51
    v_add_f32 v44, 1.0, v44
    v_mfma_f32_32x32x16_bf16 v[208:223], v[12:15], a[244:247], v[208:223]
    v_add_f32 v45, 1.0, v45
    v_add_f32 v46, 1.0, v46
    v_add_f32 v47, 1.0, v47
    v_add_f32 v48, 1.0, v48
    v_add_f32 v49, 1.0, v49
    v_add_f32 v50, 1.0, v50
    s_waitcnt lgkmcnt(4)
    v_mfma_f32_32x32x16_bf16 v[224:239], v[16:19], a[40:43], v[224:239]
    ds_read_b64_tr_b16 v[12:13], v40 offset:24576
    ds_read_b64_tr_b16 v[14:15], v40 offset:25088
    s_add_u32 s35, s35, 1
    s_cmp_eq_u32 s35, 9
    s_cselect_b32 s35, 0, s35
    s_mov_b32 s40, 589824
    s_cselect_b32 s40, 4290248704, s40
    v_mfma_f32_32x32x16_bf16 v[240:255], v[16:19], a[44:47], v[240:255]
    s_add_u32 s36, s36, s40
    s_add_u32 m0, s39, 65536
    s_add_u32 s41, s36, 3072
    v_add_f32 v51, 1.0, v51
    v_rcp_f32 v44, v44
    s_waitcnt lgkmcnt(4)
    v_mfma_f32_32x32x16_bf16 v[96:111], v[20:23], a[8:11], v[96:111]
    ds_read_b64_tr_b16 v[16:17], v25 offset:57344
    ds_read_b64_tr_b16 v[18:19], v25 offset:57856
    buffer_load_dwordx4 v28, s[12:15], s41 offen lds
    v_mfma_f32_32x32x16_bf16 v[112:127], v[20:23], a[12:15], v[112:127]
    v_rcp_f32 v45, v45
    v_rcp_f32 v46, v46
    v_rcp_f32 v47, v47
    s_waitcnt lgkmcnt(4)
    v_mfma_f32_32x32x16_bf16 v[160:175], v[8:11], v[72:75], v[160:175]
    ds_read_b64_tr_b16 v[20:21], v26 offset:53248
    ds_read_b64_tr_b16 v[22:23], v26 offset:53760
    v_rcp_f32 v48, v48
    v_rcp_f32 v49, v49
    v_mfma_f32_32x32x16_bf16 v[176:191], v[8:11], v[76:79], v[176:191]
    v_rcp_f32 v50, v50
    v_rcp_f32 v51, v51
    v_mul_f32 v44, v44, v132
    v_mul_f32 v45, v45, v133
    s_waitcnt lgkmcnt(4)
    v_mfma_f32_32x32x16_bf16 v[224:239], v[12:15], a[48:51], v[224:239]
    ds_read_b64_tr_b16 v[8:9], v27 offset:0
    ds_read_b64_tr_b16 v[10:11], v27 offset:512
    s_add_u32 m0, s39, 69632
    s_add_u32 s41, s36, 150528
    v_mul_f32 v46, v46, v134
    v_mul_f32 v47, v47, v135
    v_mul_f32 v48, v48, v140
    v_mfma_f32_32x32x16_bf16 v[240:255], v[12:15], a[52:55], v[240:255]
    buffer_load_dwordx4 v28, s[12:15], s41 offen lds
    v_mul_f32 v49, v49, v141
    s_waitcnt lgkmcnt(4)
    v_mfma_f32_32x32x16_bf16 v[96:111], v[16:19], a[16:19], v[96:111]
    ds_read_b64_tr_b16 v[12:13], v40 offset:28672
    ds_read_b64_tr_b16 v[14:15], v40 offset:29184
    v_mul_f32 v50, v50, v142
    v_mul_f32 v51, v51, v143
    v_cvt_pk_bf16_f32 v52, v44, v45
    v_cvt_pk_bf16_f32 v53, v46, v47
    v_cvt_pk_bf16_f32 v54, v48, v49
    v_mfma_f32_32x32x16_bf16 v[112:127], v[16:19], a[20:23], v[112:127]
    v_cvt_pk_bf16_f32 v55, v50, v51
    s_add_u32 s42, s37, 1024
    v_mul_f32 v44, 0xbfb8aa3b, v144
    v_mul_f32 v45, 0xbfb8aa3b, v145
    v_mul_f32 v46, 0xbfb8aa3b, v146
    v_mul_f32 v47, 0xbfb8aa3b, v147
    s_waitcnt lgkmcnt(4)
    v_mfma_f32_32x32x16_bf16 v[160:175], v[20:23], v[80:83], v[160:175]
    ds_read_b64_tr_b16 v[16:17], v41 offset:20480
    ds_read_b64_tr_b16 v[18:19], v41 offset:20992
    buffer_store_dwordx4 v[52:55], v39, s[16:19], s42 offen sc0 sc1
    v_mfma_f32_32x32x16_bf16 v[176:191], v[20:23], v[84:87], v[176:191]
    v_mul_f32 v48, 0xbfb8aa3b, v152
    v_mul_f32 v49, 0xbfb8aa3b, v153
    v_mul_f32 v50, 0xbfb8aa3b, v154
    v_mul_f32 v51, 0xbfb8aa3b, v155
    v_exp_f32 v44, v44
    s_waitcnt lgkmcnt(4)
    v_mfma_f32_32x32x16_bf16 v[192:207], v[8:11], a[248:251], v[192:207]
    ds_read_b64_tr_b16 v[20:21], v26 offset:12288
    ds_read_b64_tr_b16 v[22:23], v26 offset:12800
    v_exp_f32 v45, v45
    v_exp_f32 v46, v46
    v_mfma_f32_32x32x16_bf16 v[208:223], v[8:11], a[252:255], v[208:223]
    v_exp_f32 v47, v47
    v_exp_f32 v48, v48
    v_exp_f32 v49, v49
    s_waitcnt lgkmcnt(4)
    v_mfma_f32_32x32x16_bf16 v[224:239], v[12:15], a[56:59], v[224:239]
    ds_read_b64_tr_b16 v[8:9], v27 offset:4096
    ds_read_b64_tr_b16 v[10:11], v27 offset:4608
    s_add_u32 m0, s39, 73728
    s_add_u32 s41, s36, 297984
    v_exp_f32 v50, v50
    v_mfma_f32_32x32x16_bf16 v[240:255], v[12:15], a[60:63], v[240:255]
    buffer_load_dwordx4 v28, s[12:15], s41 offen lds
    s_waitcnt lgkmcnt(4)
    v_mfma_f32_32x32x16_bf16 v[96:111], v[16:19], a[24:27], v[96:111]
    ds_read_b64_tr_b16 v[12:13], v24 offset:32768
    ds_read_b64_tr_b16 v[14:15], v24 offset:33280
    v_exp_f32 v51, v51
    v_add_f32 v44, 1.0, v44
    v_add_f32 v45, 1.0, v45
    v_add_f32 v46, 1.0, v46
    v_mfma_f32_32x32x16_bf16 v[112:127], v[16:19], a[28:31], v[112:127]
    v_add_f32 v47, 1.0, v47
    v_add_f32 v48, 1.0, v48
    v_add_f32 v49, 1.0, v49
    v_add_f32 v50, 1.0, v50
    v_add_f32 v51, 1.0, v51
    s_waitcnt lgkmcnt(4)
    v_mfma_f32_32x32x16_bf16 v[160:175], v[20:23], v[88:91], v[160:175]
    ds_read_b64_tr_b16 v[16:17], v25 offset:24576
    ds_read_b64_tr_b16 v[18:19], v25 offset:25088
    v_rcp_f32 v44, v44
    v_rcp_f32 v45, v45
    v_mfma_f32_32x32x16_bf16 v[176:191], v[20:23], v[92:95], v[176:191]
    v_rcp_f32 v46, v46
    v_rcp_f32 v47, v47
    v_rcp_f32 v48, v48
    s_waitcnt lgkmcnt(4)
    v_mfma_f32_32x32x16_bf16 v[192:207], v[8:11], v[64:67], v[192:207]
    ds_read_b64_tr_b16 v[20:21], v26 offset:16384
    ds_read_b64_tr_b16 v[22:23], v26 offset:16896
    v_rcp_f32 v49, v49
    v_rcp_f32 v50, v50
    v_mfma_f32_32x32x16_bf16 v[208:223], v[8:11], v[68:71], v[208:223]
    v_rcp_f32 v51, v51
    v_mul_f32 v44, v44, v148
    v_mul_f32 v45, v45, v149
    v_mul_f32 v46, v46, v150
    v_mul_f32 v47, v47, v151
    s_waitcnt lgkmcnt(4)
    v_mfma_f32_32x32x16_bf16 v[224:239], v[12:15], a[64:67], v[224:239]
    s_waitcnt vmcnt(14)
    s_barrier
    ds_read_b64_tr_b16 v[8:9], v27 offset:8192
    ds_read_b64_tr_b16 v[10:11], v27 offset:8704
    s_add_u32 m0, s39, 77824
    s_add_u32 s41, s36, 445440
    v_mfma_f32_32x32x16_bf16 v[240:255], v[12:15], a[68:71], v[240:255]
    buffer_load_dwordx4 v28, s[12:15], s41 offen lds
    v_mul_f32 v48, v48, v156
    s_waitcnt lgkmcnt(4)
    v_mfma_f32_32x32x16_bf16 v[96:111], v[16:19], a[32:35], v[96:111]
    ds_read_b64_tr_b16 v[12:13], v24 offset:61440
    ds_read_b64_tr_b16 v[14:15], v24 offset:61952
    v_mul_f32 v49, v49, v157
    v_mul_f32 v50, v50, v158
    v_mul_f32 v51, v51, v159
    v_cvt_pk_bf16_f32 v56, v44, v45
    v_cvt_pk_bf16_f32 v57, v46, v47
    v_mfma_f32_32x32x16_bf16 v[112:127], v[16:19], a[36:39], v[112:127]
    v_cvt_pk_bf16_f32 v58, v48, v49
    v_cvt_pk_bf16_f32 v59, v50, v51
    s_add_u32 s42, s37, 332800
    v_mul_f32 v44, 0xbfb8aa3b, v160
    v_mul_f32 v45, 0xbfb8aa3b, v161
    v_mul_f32 v46, 0xbfb8aa3b, v162
    s_waitcnt lgkmcnt(4)
    v_mfma_f32_32x32x16_bf16 v[128:143], v[20:23], a[0:3], 0
    ds_read_b64_tr_b16 v[16:17], v25 offset:28672
    ds_read_b64_tr_b16 v[18:19], v25 offset:29184
    buffer_store_dwordx4 v[56:59], v39, s[16:19], s42 offen sc0 sc1
    v_mfma_f32_32x32x16_bf16 v[144:159], v[20:23], a[4:7], 0
    v_mul_f32 v47, 0xbfb8aa3b, v163
    v_mul_f32 v48, 0xbfb8aa3b, v168
    v_mul_f32 v49, 0xbfb8aa3b, v169
    v_mul_f32 v50, 0xbfb8aa3b, v170
    v_mul_f32 v51, 0xbfb8aa3b, v171
    s_waitcnt lgkmcnt(4)
    v_mfma_f32_32x32x16_bf16 v[192:207], v[8:11], v[72:75], v[192:207]
    ds_read_b64_tr_b16 v[20:21], v26 offset:20480
    ds_read_b64_tr_b16 v[22:23], v26 offset:20992
    v_exp_f32 v44, v44
    v_exp_f32 v45, v45
    v_mfma_f32_32x32x16_bf16 v[208:223], v[8:11], v[76:79], v[208:223]
    v_exp_f32 v46, v46
    v_exp_f32 v47, v47
    v_exp_f32 v48, v48
    s_waitcnt lgkmcnt(4)
    v_mfma_f32_32x32x16_bf16 v[224:239], v[12:15], a[72:75], v[224:239]
    ds_read_b64_tr_b16 v[8:9], v24 offset:36864
    ds_read_b64_tr_b16 v[10:11], v24 offset:37376
    s_add_u32 s35, s35, 1
    s_cmp_eq_u32 s35, 9
    s_cselect_b32 s35, 0, s35
    s_mov_b32 s40, 589824
    s_cselect_b32 s40, 4290248704, s40
    v_mfma_f32_32x32x16_bf16 v[240:255], v[12:15], a[76:79], v[240:255]
    s_add_u32 s36, s36, s40
    s_add_u32 m0, s39, 81920
    s_add_u32 s41, s36, 3072
    v_exp_f32 v49, v49
    s_waitcnt lgkmcnt(4)
    v_mfma_f32_32x32x16_bf16 v[96:111], v[16:19], a[40:43], v[96:111]
    ds_read_b64_tr_b16 v[12:13], v41 offset:24576
    ds_read_b64_tr_b16 v[14:15], v41 offset:25088
    buffer_load_dwordx4 v28, s[12:15], s41 offen lds
    v_mfma_f32_32x32x16_bf16 v[112:127], v[16:19], a[44:47], v[112:127]
    v_exp_f32 v50, v50
    v_exp_f32 v51, v51
    v_add_f32 v44, 1.0, v44
    v_add_f32 v45, 1.0, v45
    s_waitcnt lgkmcnt(4)
    v_mfma_f32_32x32x16_bf16 v[128:143], v[20:23], a[8:11], v[128:143]
    ds_read_b64_tr_b16 v[16:17], v26 offset:57344
    ds_read_b64_tr_b16 v[18:19], v26 offset:57856
    v_add_f32 v46, 1.0, v46
    v_add_f32 v47, 1.0, v47
    v_add_f32 v48, 1.0, v48
    v_add_f32 v49, 1.0, v49
    v_add_f32 v50, 1.0, v50
    v_mfma_f32_32x32x16_bf16 v[144:159], v[20:23], a[12:15], v[144:159]
    v_add_f32 v51, 1.0, v51
    v_rcp_f32 v44, v44
    v_rcp_f32 v45, v45
    s_waitcnt lgkmcnt(4)
    v_mfma_f32_32x32x16_bf16 v[224:239], v[8:11], a[80:83], v[224:239]
    ds_read_b64_tr_b16 v[20:21], v27 offset:53248
    ds_read_b64_tr_b16 v[22:23], v27 offset:53760
    s_add_u32 m0, s39, 0
    s_add_u32 s41, s36, 150528
    v_rcp_f32 v46, v46
    v_mfma_f32_32x32x16_bf16 v[240:255], v[8:11], a[84:87], v[240:255]
    buffer_load_dwordx4 v28, s[12:15], s41 offen lds
    s_waitcnt lgkmcnt(4)
    v_mfma_f32_32x32x16_bf16 v[96:111], v[12:15], a[48:51], v[96:111]
    ds_read_b64_tr_b16 v[8:9], v24 offset:40960
    ds_read_b64_tr_b16 v[10:11], v24 offset:41472
    v_rcp_f32 v47, v47
    v_rcp_f32 v48, v48
    v_mfma_f32_32x32x16_bf16 v[112:127], v[12:15], a[52:55], v[112:127]
    v_rcp_f32 v49, v49
    v_rcp_f32 v50, v50
    v_rcp_f32 v51, v51
    s_waitcnt lgkmcnt(4)
    v_mfma_f32_32x32x16_bf16 v[128:143], v[16:19], a[16:19], v[128:143]
    ds_read_b64_tr_b16 v[12:13], v41 offset:28672
    ds_read_b64_tr_b16 v[14:15], v41 offset:29184
    v_mul_f32 v44, v44, v164
    v_mul_f32 v45, v45, v165
    v_mul_f32 v46, v46, v166
    v_mul_f32 v47, v47, v167
    v_mul_f32 v48, v48, v172
    v_mfma_f32_32x32x16_bf16 v[144:159], v[16:19], a[20:23], v[144:159]
    v_mul_f32 v49, v49, v173
    v_mul_f32 v50, v50, v174
    v_mul_f32 v51, v51, v175
    v_cvt_pk_bf16_f32 v52, v44, v45
    v_cvt_pk_bf16_f32 v53, v46, v47
    v_cvt_pk_bf16_f32 v54, v48, v49
    s_waitcnt lgkmcnt(4)
    v_mfma_f32_32x32x16_bf16 v[192:207], v[20:23], v[80:83], v[192:207]
    ds_read_b64_tr_b16 v[16:17], v42 offset:20480
    ds_read_b64_tr_b16 v[18:19], v42 offset:20992
    v_cvt_pk_bf16_f32 v55, v50, v51
    s_add_u32 s42, s37, 2048
    v_mul_f32 v44, 0xbfb8aa3b, v176
    v_mul_f32 v45, 0xbfb8aa3b, v177
    v_mul_f32 v46, 0xbfb8aa3b, v178
    v_mfma_f32_32x32x16_bf16 v[208:223], v[20:23], v[84:87], v[208:223]
    buffer_store_dwordx4 v[52:55], v39, s[16:19], s42 offen sc0 sc1
    v_mul_f32 v47, 0xbfb8aa3b, v179
    s_waitcnt lgkmcnt(4)
    v_mfma_f32_32x32x16_bf16 v[224:239], v[8:11], a[88:91], v[224:239]
    ds_read_b64_tr_b16 v[20:21], v27 offset:12288
    ds_read_b64_tr_b16 v[22:23], v27 offset:12800
    s_add_u32 m0, s39, 4096
    s_add_u32 s41, s36, 297984
    v_mul_f32 v48, 0xbfb8aa3b, v184
    v_mul_f32 v49, 0xbfb8aa3b, v185
    v_mul_f32 v50, 0xbfb8aa3b, v186
    v_mfma_f32_32x32x16_bf16 v[240:255], v[8:11], a[92:95], v[240:255]
    buffer_load_dwordx4 v28, s[12:15], s41 offen lds
    v_mul_f32 v51, 0xbfb8aa3b, v187
    s_waitcnt lgkmcnt(4)
    v_mfma_f32_32x32x16_bf16 v[96:111], v[12:15], a[56:59], v[96:111]
    ds_read_b64_tr_b16 v[8:9], v40 offset:57344
    ds_read_b64_tr_b16 v[10:11], v40 offset:57856
    v_exp_f32 v44, v44
    v_exp_f32 v45, v45
    v_mfma_f32_32x32x16_bf16 v[112:127], v[12:15], a[60:63], v[112:127]
    v_exp_f32 v46, v46
    v_exp_f32 v47, v47
    v_exp_f32 v48, v48
    s_waitcnt lgkmcnt(4)
    v_mfma_f32_32x32x16_bf16 v[128:143], v[16:19], a[24:27], v[128:143]
    ds_read_b64_tr_b16 v[12:13], v25 offset:32768
    ds_read_b64_tr_b16 v[14:15], v25 offset:33280
    v_exp_f32 v49, v49
    v_exp_f32 v50, v50
    v_mfma_f32_32x32x16_bf16 v[144:159], v[16:19], a[28:31], v[144:159]
    v_exp_f32 v51, v51
    v_add_f32 v44, 1.0, v44
    v_add_f32 v45, 1.0, v45
    v_add_f32 v46, 1.0, v46
    v_add_f32 v47, 1.0, v47
    s_waitcnt lgkmcnt(4)
    v_mfma_f32_32x32x16_bf16 v[192:207], v[20:23], v[88:91], v[192:207]
    ds_read_b64_tr_b16 v[16:17], v26 offset:24576
    ds_read_b64_tr_b16 v[18:19], v26 offset:25088
    v_add_f32 v48, 1.0, v48
    v_add_f32 v49, 1.0, v49
    v_add_f32 v50, 1.0, v50
    v_add_f32 v51, 1.0, v51
    v_mfma_f32_32x32x16_bf16 v[208:223], v[20:23], v[92:95], v[208:223]
    v_rcp_f32 v44, v44
    v_rcp_f32 v45, v45
    v_rcp_f32 v46, v46
    s_waitcnt lgkmcnt(4)
    v_mfma_f32_32x32x16_bf16 v[224:239], v[8:11], a[96:99], v[224:239]
    s_waitcnt vmcnt(16)
    s_barrier
    ds_read_b64_tr_b16 v[20:21], v27 offset:16384
    ds_read_b64_tr_b16 v[22:23], v27 offset:16896
    s_add_u32 m0, s39, 8192
    s_add_u32 s41, s36, 445440
    v_mfma_f32_32x32x16_bf16 v[240:255], v[8:11], a[100:103], v[240:255]
    buffer_load_dwordx4 v28, s[12:15], s41 offen lds
    s_waitcnt lgkmcnt(4)
    v_mfma_f32_32x32x16_bf16 v[96:111], v[12:15], a[64:67], v[96:111]
    ds_read_b64_tr_b16 v[8:9], v40 offset:61440
    ds_read_b64_tr_b16 v[10:11], v40 offset:61952
    v_rcp_f32 v47, v47
    v_rcp_f32 v48, v48
    v_mfma_f32_32x32x16_bf16 v[112:127], v[12:15], a[68:71], v[112:127]
    v_rcp_f32 v49, v49
    v_rcp_f32 v50, v50
    v_rcp_f32 v51, v51
    s_waitcnt lgkmcnt(4)
    v_mfma_f32_32x32x16_bf16 v[128:143], v[16:19], a[32:35], v[128:143]
    ds_read_b64_tr_b16 v[12:13], v25 offset:61440
    ds_read_b64_tr_b16 v[14:15], v25 offset:61952
    v_mul_f32 v44, v44, v180
    v_mul_f32 v45, v45, v181
    v_mul_f32 v46, v46, v182
    v_mul_f32 v47, v47, v183
    v_mul_f32 v48, v48, v188
    v_mfma_f32_32x32x16_bf16 v[144:159], v[16:19], a[36:39], v[144:159]
    v_mul_f32 v49, v49, v189
    v_mul_f32 v50, v50, v190
    v_mul_f32 v51, v51, v191
    v_cvt_pk_bf16_f32 v56, v44, v45
    v_cvt_pk_bf16_f32 v57, v46, v47
    v_cvt_pk_bf16_f32 v58, v48, v49
    v_cvt_pk_bf16_f32 v59, v50, v51
    s_add_u32 s42, s37, 333824
    buffer_store_dwordx4 v[56:59], v39, s[16:19], s42 offen sc0 sc1
    s_waitcnt lgkmcnt(4)
    v_mfma_f32_32x32x16_bf16 v[160:175], v[20:23], a[0:3], 0
    ds_read_b64_tr_b16 v[16:17], v26 offset:28672
    ds_read_b64_tr_b16 v[18:19], v26 offset:29184
    v_mul_f32 v44, 0xbfb8aa3b, v192
    v_mul_f32 v45, 0xbfb8aa3b, v193
    v_mul_f32 v46, 0xbfb8aa3b, v194
    v_mul_f32 v47, 0xbfb8aa3b, v195
    v_mul_f32 v48, 0xbfb8aa3b, v200
    v_mfma_f32_32x32x16_bf16 v[176:191], v[20:23], a[4:7], 0
    v_mul_f32 v49, 0xbfb8aa3b, v201
    v_mul_f32 v50, 0xbfb8aa3b, v202
    v_mul_f32 v51, 0xbfb8aa3b, v203
    v_exp_f32 v44, v44
    s_waitcnt lgkmcnt(4)
    v_mfma_f32_32x32x16_bf16 v[224:239], v[8:11], a[104:107], v[224:239]
    ds_read_b64_tr_b16 v[20:21], v27 offset:20480
    ds_read_b64_tr_b16 v[22:23], v27 offset:20992
    s_add_u32 s35, s35, 1
    s_cmp_eq_u32 s35, 9
    s_cselect_b32 s35, 0, s35
    s_mov_b32 s40, 589824
    s_cselect_b32 s40, 4290248704, s40
    v_mfma_f32_32x32x16_bf16 v[240:255], v[8:11], a[108:111], v[240:255]
    s_add_u32 s36, s36, s40
    s_add_u32 m0, s39, 12288
    s_add_u32 s41, s36, 3072
    v_exp_f32 v45, v45
    s_waitcnt lgkmcnt(4)
    v_mfma_f32_32x32x16_bf16 v[96:111], v[12:15], a[72:75], v[96:111]
    ds_read_b64_tr_b16 v[8:9], v40 offset:45056
    ds_read_b64_tr_b16 v[10:11], v40 offset:45568
    buffer_load_dwordx4 v28, s[12:15], s41 offen lds
    v_mfma_f32_32x32x16_bf16 v[112:127], v[12:15], a[76:79], v[112:127]
    v_exp_f32 v46, v46
    v_exp_f32 v47, v47
    v_exp_f32 v48, v48
    s_waitcnt lgkmcnt(4)
    v_mfma_f32_32x32x16_bf16 v[128:143], v[16:19], a[40:43], v[128:143]
    ds_read_b64_tr_b16 v[12:13], v25 offset:36864
    ds_read_b64_tr_b16 v[14:15], v25 offset:37376
    v_exp_f32 v49, v49
    v_exp_f32 v50, v50
    v_mfma_f32_32x32x16_bf16 v[144:159], v[16:19], a[44:47], v[144:159]
    v_exp_f32 v51, v51
    v_add_f32 v44, 1.0, v44
    v_add_f32 v45, 1.0, v45
    v_add_f32 v46, 1.0, v46
    v_add_f32 v47, 1.0, v47
    s_waitcnt lgkmcnt(4)
    v_mfma_f32_32x32x16_bf16 v[160:175], v[20:23], a[8:11], v[160:175]
    ds_read_b64_tr_b16 v[16:17], v42 offset:24576
    ds_read_b64_tr_b16 v[18:19], v42 offset:25088
    v_add_f32 v48, 1.0, v48
    v_add_f32 v49, 1.0, v49
    v_add_f32 v50, 1.0, v50
    v_add_f32 v51, 1.0, v51
    v_mfma_f32_32x32x16_bf16 v[176:191], v[20:23], a[12:15], v[176:191]
    v_rcp_f32 v44, v44
    v_rcp_f32 v45, v45
    v_rcp_f32 v46, v46
    s_waitcnt lgkmcnt(4)
    v_mfma_f32_32x32x16_bf16 v[224:239], v[8:11], a[112:115], v[224:239]
    ds_read_b64_tr_b16 v[20:21], v27 offset:57344
    ds_read_b64_tr_b16 v[22:23], v27 offset:57856
    s_add_u32 m0, s39, 45056
    s_add_u32 s41, s36, 150528
    v_rcp_f32 v47, v47
    v_mfma_f32_32x32x16_bf16 v[240:255], v[8:11], a[116:119], v[240:255]
    buffer_load_dwordx4 v28, s[12:15], s41 offen lds
    s_waitcnt lgkmcnt(4)
    v_mfma_f32_32x32x16_bf16 v[96:111], v[12:15], a[80:83], v[96:111]
    ds_read_b64_tr_b16 v[8:9], v40 offset:49152
    ds_read_b64_tr_b16 v[10:11], v40 offset:49664
    v_rcp_f32 v48, v48
    v_rcp_f32 v49, v49
    v_mfma_f32_32x32x16_bf16 v[112:127], v[12:15], a[84:87], v[112:127]
    v_rcp_f32 v50, v50
    v_rcp_f32 v51, v51
    v_mul_f32 v44, v44, v196
    v_mul_f32 v45, v45, v197
    s_waitcnt lgkmcnt(4)
    v_mfma_f32_32x32x16_bf16 v[128:143], v[16:19], a[48:51], v[128:143]
    ds_read_b64_tr_b16 v[12:13], v25 offset:40960
    ds_read_b64_tr_b16 v[14:15], v25 offset:41472
    v_mul_f32 v46, v46, v198
    v_mul_f32 v47, v47, v199
    v_mul_f32 v48, v48, v204
    v_mul_f32 v49, v49, v205
    v_mul_f32 v50, v50, v206
    v_mfma_f32_32x32x16_bf16 v[144:159], v[16:19], a[52:55], v[144:159]
    v_mul_f32 v51, v51, v207
    v_cvt_pk_bf16_f32 v52, v44, v45
    v_cvt_pk_bf16_f32 v53, v46, v47
    v_cvt_pk_bf16_f32 v54, v48, v49
    v_cvt_pk_bf16_f32 v55, v50, v51
    s_add_u32 s42, s37, 3072
    s_waitcnt lgkmcnt(4)
    v_mfma_f32_32x32x16_bf16 v[160:175], v[20:23], a[16:19], v[160:175]
    ds_read_b64_tr_b16 v[16:17], v42 offset:28672
    ds_read_b64_tr_b16 v[18:19], v42 offset:29184
    buffer_store_dwordx4 v[52:55], v39, s[16:19], s42 offen sc0 sc1
    v_mfma_f32_32x32x16_bf16 v[176:191], v[20:23], a[20:23], v[176:191]
    v_mul_f32 v44, 0xbfb8aa3b, v208
    v_mul_f32 v45, 0xbfb8aa3b, v209
    v_mul_f32 v46, 0xbfb8aa3b, v210
    v_mul_f32 v47, 0xbfb8aa3b, v211
    v_mul_f32 v48, 0xbfb8aa3b, v216
    v_mul_f32 v49, 0xbfb8aa3b, v217
    s_waitcnt lgkmcnt(4)
    v_mfma_f32_32x32x16_bf16 v[224:239], v[8:11], a[120:123], v[224:239]
    ds_read_b64_tr_b16 v[20:21], v43 offset:20480
    ds_read_b64_tr_b16 v[22:23], v43 offset:20992
    s_add_u32 m0, s39, 49152
    s_add_u32 s41, s36, 297984
    v_mul_f32 v50, 0xbfb8aa3b, v218
    v_mul_f32 v51, 0xbfb8aa3b, v219
    v_mfma_f32_32x32x16_bf16 v[240:255], v[8:11], a[124:127], v[240:255]
    buffer_load_dwordx4 v28, s[12:15], s41 offen lds
    s_waitcnt lgkmcnt(4)
    v_mfma_f32_32x32x16_bf16 v[96:111], v[12:15], a[88:91], v[96:111]
    ds_read_b64_tr_b16 v[8:9], v40 offset:53248
    ds_read_b64_tr_b16 v[10:11], v40 offset:53760
    v_exp_f32 v44, v44
    v_exp_f32 v45, v45
    v_mfma_f32_32x32x16_bf16 v[112:127], v[12:15], a[92:95], v[112:127]
    v_exp_f32 v46, v46
    v_exp_f32 v47, v47
    v_exp_f32 v48, v48
    s_waitcnt lgkmcnt(4)
    v_mfma_f32_32x32x16_bf16 v[128:143], v[16:19], a[56:59], v[128:143]
    ds_read_b64_tr_b16 v[12:13], v41 offset:57344
    ds_read_b64_tr_b16 v[14:15], v41 offset:57856
    v_exp_f32 v49, v49
    v_exp_f32 v50, v50
    v_mfma_f32_32x32x16_bf16 v[144:159], v[16:19], a[60:63], v[144:159]
    v_exp_f32 v51, v51
    v_add_f32 v44, 1.0, v44
    v_add_f32 v45, 1.0, v45
    v_add_f32 v46, 1.0, v46
    v_add_f32 v47, 1.0, v47
    s_waitcnt lgkmcnt(4)
    v_mfma_f32_32x32x16_bf16 v[160:175], v[20:23], a[24:27], v[160:175]
    ds_read_b64_tr_b16 v[16:17], v26 offset:32768
    ds_read_b64_tr_b16 v[18:19], v26 offset:33280
    v_add_f32 v48, 1.0, v48
    v_add_f32 v49, 1.0, v49
    v_add_f32 v50, 1.0, v50
    v_add_f32 v51, 1.0, v51
    v_mfma_f32_32x32x16_bf16 v[176:191], v[20:23], a[28:31], v[176:191]
    v_rcp_f32 v44, v44
    v_rcp_f32 v45, v45
    v_rcp_f32 v46, v46
    s_waitcnt lgkmcnt(4)
    v_mfma_f32_32x32x16_bf16 v[224:239], v[8:11], a[128:131], v[224:239]
    s_waitcnt vmcnt(15)
    s_barrier
    ds_read_b64_tr_b16 v[20:21], v27 offset:24576
    ds_read_b64_tr_b16 v[22:23], v27 offset:25088
    s_add_u32 m0, s39, 86016
    s_add_u32 s41, s36, 445440
    v_mfma_f32_32x32x16_bf16 v[240:255], v[8:11], a[132:135], v[240:255]
    buffer_load_dwordx4 v28, s[12:15], s41 offen lds
    s_waitcnt lgkmcnt(4)
    v_mfma_f32_32x32x16_bf16 v[96:111], v[12:15], a[96:99], v[96:111]
    ds_read_b64_tr_b16 v[8:9], v40 offset:32768
    ds_read_b64_tr_b16 v[10:11], v40 offset:33280
    v_rcp_f32 v47, v47
    v_rcp_f32 v48, v48
    v_mfma_f32_32x32x16_bf16 v[112:127], v[12:15], a[100:103], v[112:127]
    v_rcp_f32 v49, v49
    v_rcp_f32 v50, v50
    v_rcp_f32 v51, v51
    s_waitcnt lgkmcnt(4)
    v_mfma_f32_32x32x16_bf16 v[128:143], v[16:19], a[64:67], v[128:143]
    ds_read_b64_tr_b16 v[12:13], v41 offset:61440
    ds_read_b64_tr_b16 v[14:15], v41 offset:61952
    v_mul_f32 v44, v44, v212
    v_mul_f32 v45, v45, v213
    v_mul_f32 v46, v46, v214
    v_mul_f32 v47, v47, v215
    v_mul_f32 v48, v48, v220
    v_mfma_f32_32x32x16_bf16 v[144:159], v[16:19], a[68:71], v[144:159]
    v_mul_f32 v49, v49, v221
    v_mul_f32 v50, v50, v222
    v_mul_f32 v51, v51, v223
    v_cvt_pk_bf16_f32 v56, v44, v45
    v_cvt_pk_bf16_f32 v57, v46, v47
    v_cvt_pk_bf16_f32 v58, v48, v49
    s_waitcnt lgkmcnt(4)
    v_mfma_f32_32x32x16_bf16 v[160:175], v[20:23], a[32:35], v[160:175]
    ds_read_b64_tr_b16 v[16:17], v26 offset:61440
    ds_read_b64_tr_b16 v[18:19], v26 offset:61952
    v_cvt_pk_bf16_f32 v59, v50, v51
    s_add_u32 s42, s37, 334848
    v_mfma_f32_32x32x16_bf16 v[176:191], v[20:23], a[36:39], v[176:191]
    buffer_store_dwordx4 v[56:59], v39, s[16:19], s42 offen sc0 sc1
    s_waitcnt lgkmcnt(4)
    v_mfma_f32_32x32x16_bf16 v[224:239], v[8:11], a[136:139], v[224:239]
    ds_read_b64_tr_b16 v[20:21], v27 offset:28672
    ds_read_b64_tr_b16 v[22:23], v27 offset:29184
    s_add_u32 s35, s35, 1
    s_cmp_eq_u32 s35, 9
    s_cselect_b32 s35, 0, s35
    s_mov_b32 s40, 589824
    s_cselect_b32 s40, 4290248704, s40
    v_mfma_f32_32x32x16_bf16 v[240:255], v[8:11], a[140:143], v[240:255]
    s_add_u32 s36, s36, s40
    s_add_u32 m0, s39, 16384
    s_add_u32 s41, s36, 3072
    s_waitcnt lgkmcnt(4)
    v_mfma_f32_32x32x16_bf16 v[96:111], v[12:15], a[104:107], v[96:111]
    ds_read_b64_tr_b16 v[8:9], v40 offset:36864
    ds_read_b64_tr_b16 v[10:11], v40 offset:37376
    buffer_load_dwordx4 v28, s[12:15], s41 offen lds
    v_mfma_f32_32x32x16_bf16 v[112:127], v[12:15], a[108:111], v[112:127]
    s_waitcnt lgkmcnt(4)
    v_mfma_f32_32x32x16_bf16 v[128:143], v[16:19], a[72:75], v[128:143]
    ds_read_b64_tr_b16 v[12:13], v41 offset:45056
    ds_read_b64_tr_b16 v[14:15], v41 offset:45568
    v_mfma_f32_32x32x16_bf16 v[144:159], v[16:19], a[76:79], v[144:159]
    s_waitcnt lgkmcnt(4)
    v_mfma_f32_32x32x16_bf16 v[160:175], v[20:23], a[40:43], v[160:175]
    ds_read_b64_tr_b16 v[16:17], v26 offset:36864
    ds_read_b64_tr_b16 v[18:19], v26 offset:37376
    v_mfma_f32_32x32x16_bf16 v[176:191], v[20:23], a[44:47], v[176:191]
    s_waitcnt lgkmcnt(4)
    v_mfma_f32_32x32x16_bf16 v[224:239], v[8:11], a[144:147], v[224:239]
    ds_read_b64_tr_b16 v[20:21], v43 offset:24576
    ds_read_b64_tr_b16 v[22:23], v43 offset:25088
    s_add_u32 m0, s39, 20480
    s_add_u32 s41, s36, 150528
    v_mfma_f32_32x32x16_bf16 v[240:255], v[8:11], a[148:151], v[240:255]
    buffer_load_dwordx4 v28, s[12:15], s41 offen lds
    s_waitcnt lgkmcnt(4)
    v_mfma_f32_32x32x16_bf16 v[96:111], v[12:15], a[112:115], v[96:111]
    ds_read_b64_tr_b16 v[8:9], v40 offset:40960
    ds_read_b64_tr_b16 v[10:11], v40 offset:41472
    v_mfma_f32_32x32x16_bf16 v[112:127], v[12:15], a[116:119], v[112:127]
    s_waitcnt lgkmcnt(4)
    v_mfma_f32_32x32x16_bf16 v[128:143], v[16:19], a[80:83], v[128:143]
    ds_read_b64_tr_b16 v[12:13], v41 offset:49152
    ds_read_b64_tr_b16 v[14:15], v41 offset:49664
    v_mfma_f32_32x32x16_bf16 v[144:159], v[16:19], a[84:87], v[144:159]
    s_waitcnt lgkmcnt(4)
    v_mfma_f32_32x32x16_bf16 v[160:175], v[20:23], a[48:51], v[160:175]
    ds_read_b64_tr_b16 v[16:17], v26 offset:40960
    ds_read_b64_tr_b16 v[18:19], v26 offset:41472
    v_mfma_f32_32x32x16_bf16 v[176:191], v[20:23], a[52:55], v[176:191]
    s_waitcnt lgkmcnt(4)
    v_mfma_f32_32x32x16_bf16 v[224:239], v[8:11], a[152:155], v[224:239]
    ds_read_b64_tr_b16 v[20:21], v43 offset:28672
    ds_read_b64_tr_b16 v[22:23], v43 offset:29184
    s_add_u32 m0, s39, 53248
    s_add_u32 s41, s36, 297984
    v_mfma_f32_32x32x16_bf16 v[240:255], v[8:11], a[156:159], v[240:255]
    buffer_load_dwordx4 v28, s[12:15], s41 offen lds
    s_waitcnt lgkmcnt(4)
    v_mfma_f32_32x32x16_bf16 v[96:111], v[12:15], a[120:123], v[96:111]
    ds_read_b64_tr_b16 v[8:9], v40 offset:0
    ds_read_b64_tr_b16 v[10:11], v40 offset:512
    v_mfma_f32_32x32x16_bf16 v[112:127], v[12:15], a[124:127], v[112:127]
    s_waitcnt lgkmcnt(4)
    v_mfma_f32_32x32x16_bf16 v[128:143], v[16:19], a[88:91], v[128:143]
    ds_read_b64_tr_b16 v[12:13], v41 offset:53248
    ds_read_b64_tr_b16 v[14:15], v41 offset:53760
    v_mfma_f32_32x32x16_bf16 v[144:159], v[16:19], a[92:95], v[144:159]
    s_waitcnt lgkmcnt(4)
    v_mfma_f32_32x32x16_bf16 v[160:175], v[20:23], a[56:59], v[160:175]
    ds_read_b64_tr_b16 v[16:17], v42 offset:57344
    ds_read_b64_tr_b16 v[18:19], v42 offset:57856
    v_mfma_f32_32x32x16_bf16 v[176:191], v[20:23], a[60:63], v[176:191]
    s_waitcnt lgkmcnt(4)
    v_mfma_f32_32x32x16_bf16 v[224:239], v[8:11], a[160:163], v[224:239]
    s_waitcnt vmcnt(14)
    s_barrier
    ds_read_b64_tr_b16 v[20:21], v27 offset:32768
    ds_read_b64_tr_b16 v[22:23], v27 offset:33280
    s_add_u32 m0, s39, 90112
    s_add_u32 s41, s36, 445440
    v_mfma_f32_32x32x16_bf16 v[240:255], v[8:11], a[164:167], v[240:255]
    buffer_load_dwordx4 v28, s[12:15], s41 offen lds
    s_waitcnt lgkmcnt(4)
    v_mfma_f32_32x32x16_bf16 v[96:111], v[12:15], a[128:131], v[96:111]
    ds_read_b64_tr_b16 v[8:9], v40 offset:4096
    ds_read_b64_tr_b16 v[10:11], v40 offset:4608
    v_mfma_f32_32x32x16_bf16 v[112:127], v[12:15], a[132:135], v[112:127]
    s_waitcnt lgkmcnt(4)
    v_mfma_f32_32x32x16_bf16 v[128:143], v[16:19], a[96:99], v[128:143]
    ds_read_b64_tr_b16 v[12:13], v41 offset:32768
    ds_read_b64_tr_b16 v[14:15], v41 offset:33280
    v_mfma_f32_32x32x16_bf16 v[144:159], v[16:19], a[100:103], v[144:159]
    s_waitcnt lgkmcnt(4)
    v_mfma_f32_32x32x16_bf16 v[160:175], v[20:23], a[64:67], v[160:175]
    ds_read_b64_tr_b16 v[16:17], v42 offset:61440
    ds_read_b64_tr_b16 v[18:19], v42 offset:61952
    v_mfma_f32_32x32x16_bf16 v[176:191], v[20:23], a[68:71], v[176:191]
    s_waitcnt lgkmcnt(4)
    v_mfma_f32_32x32x16_bf16 v[224:239], v[8:11], a[168:171], v[224:239]
    ds_read_b64_tr_b16 v[20:21], v27 offset:61440
    ds_read_b64_tr_b16 v[22:23], v27 offset:61952
    s_add_u32 s35, s35, 1
    s_cmp_eq_u32 s35, 9
    s_cselect_b32 s35, 0, s35
    s_mov_b32 s40, 589824
    s_cselect_b32 s40, 4290248704, s40
    v_mfma_f32_32x32x16_bf16 v[240:255], v[8:11], a[172:175], v[240:255]
    s_add_u32 s36, s36, s40
    s_add_u32 m0, s39, 94208
    s_add_u32 s41, s36, 6144
    s_waitcnt lgkmcnt(4)
    v_mfma_f32_32x32x16_bf16 v[96:111], v[12:15], a[136:139], v[96:111]
    ds_read_b64_tr_b16 v[8:9], v40 offset:8192
    ds_read_b64_tr_b16 v[10:11], v40 offset:8704
    buffer_load_dwordx4 v28, s[12:15], s41 offen lds
    v_mfma_f32_32x32x16_bf16 v[112:127], v[12:15], a[140:143], v[112:127]
    s_mov_b32 s69, 200000
L_NG2293:
    v_readfirstlane_b32 s68, v60
    s_nop 3
    s_cmp_lg_u32 s68, 0
    s_cbranch_scc1 L_NG2293_D
    s_sub_u32 s69, s69, 1
    s_cmp_eq_u32 s69, 0
    s_cbranch_scc1 L_NG2293_D
    s_sleep 4
    buffer_load_dword v60, v61, s[20:23], 0 offen sc0 sc1
    s_waitcnt vmcnt(0)
    s_branch L_NG2293
L_NG2293_D:
    s_lshl_b32 s48, s33, 2
    s_add_u32 s48, s48, s43
    s_lshl_b32 s48, s48, 7
    s_add_u32 s48, s48, 22085632
    s_lshl_b32 s46, s45, 2
    s_waitcnt lgkmcnt(4)
    v_mfma_f32_32x32x16_bf16 v[128:143], v[16:19], a[104:107], v[128:143]
    ds_read_b64_tr_b16 v[12:13], v41 offset:36864
    ds_read_b64_tr_b16 v[14:15], v41 offset:37376
    s_add_u32 s50, s46, s48
    v_mfma_f32_32x32x16_bf16 v[144:159], v[16:19], a[108:111], v[144:159]
    s_waitcnt lgkmcnt(4)
    v_mfma_f32_32x32x16_bf16 v[160:175], v[20:23], a[72:75], v[160:175]
    ds_read_b64_tr_b16 v[16:17], v42 offset:45056
    ds_read_b64_tr_b16 v[18:19], v42 offset:45568
    v_mfma_f32_32x32x16_bf16 v[176:191], v[20:23], a[76:79], v[176:191]
    s_waitcnt lgkmcnt(4)
    v_mfma_f32_32x32x16_bf16 v[224:239], v[8:11], a[176:179], v[224:239]
    ds_read_b64_tr_b16 v[20:21], v27 offset:36864
    ds_read_b64_tr_b16 v[22:23], v27 offset:37376
    s_add_u32 m0, s39, 24576
    s_add_u32 s41, s36, 153600
    v_mfma_f32_32x32x16_bf16 v[240:255], v[8:11], a[180:183], v[240:255]
    buffer_load_dwordx4 v28, s[12:15], s41 offen lds
    s_waitcnt lgkmcnt(4)
    v_mfma_f32_32x32x16_bf16 v[96:111], v[12:15], a[144:147], v[96:111]
    ds_read_b64_tr_b16 v[8:9], v40 offset:12288
    ds_read_b64_tr_b16 v[10:11], v40 offset:12800
    v_mfma_f32_32x32x16_bf16 v[112:127], v[12:15], a[148:151], v[112:127]
    s_waitcnt lgkmcnt(4)
    v_mfma_f32_32x32x16_bf16 v[128:143], v[16:19], a[112:115], v[128:143]
    ds_read_b64_tr_b16 v[12:13], v41 offset:40960
    ds_read_b64_tr_b16 v[14:15], v41 offset:41472
    v_mfma_f32_32x32x16_bf16 v[144:159], v[16:19], a[116:119], v[144:159]
    s_waitcnt lgkmcnt(4)
    v_mfma_f32_32x32x16_bf16 v[160:175], v[20:23], a[80:83], v[160:175]
    ds_read_b64_tr_b16 v[16:17], v42 offset:49152
    ds_read_b64_tr_b16 v[18:19], v42 offset:49664
    v_mfma_f32_32x32x16_bf16 v[176:191], v[20:23], a[84:87], v[176:191]
    s_waitcnt lgkmcnt(4)
    v_mfma_f32_32x32x16_bf16 v[224:239], v[8:11], a[184:187], v[224:239]
    ds_read_b64_tr_b16 v[20:21], v27 offset:40960
    ds_read_b64_tr_b16 v[22:23], v27 offset:41472
    s_add_u32 m0, s39, 28672
    s_add_u32 s41, s36, 301056
    v_mfma_f32_32x32x16_bf16 v[240:255], v[8:11], a[188:191], v[240:255]
    buffer_load_dwordx4 v28, s[12:15], s41 offen lds
    s_waitcnt lgkmcnt(4)
    v_mfma_f32_32x32x16_bf16 v[96:111], v[12:15], a[152:155], v[96:111]
    ds_read_b64_tr_b16 v[8:9], v40 offset:16384
    ds_read_b64_tr_b16 v[10:11], v40 offset:16896
    v_mfma_f32_32x32x16_bf16 v[112:127], v[12:15], a[156:159], v[112:127]
    s_waitcnt lgkmcnt(4)
    v_mfma_f32_32x32x16_bf16 v[128:143], v[16:19], a[120:123], v[128:143]
    ds_read_b64_tr_b16 v[12:13], v41 offset:0
    ds_read_b64_tr_b16 v[14:15], v41 offset:512
    v_mfma_f32_32x32x16_bf16 v[144:159], v[16:19], a[124:127], v[144:159]
    s_waitcnt lgkmcnt(4)
    v_mfma_f32_32x32x16_bf16 v[160:175], v[20:23], a[88:91], v[160:175]
    ds_read_b64_tr_b16 v[16:17], v42 offset:53248
    ds_read_b64_tr_b16 v[18:19], v42 offset:53760
    v_mfma_f32_32x32x16_bf16 v[176:191], v[20:23], a[92:95], v[176:191]
    s_waitcnt lgkmcnt(4)
    v_mfma_f32_32x32x16_bf16 v[224:239], v[8:11], a[192:195], v[224:239]
    s_waitcnt vmcnt(12)
    s_waitcnt vmcnt(7)
    s_barrier
    v_mov_b32 v60, s68
    v_mov_b32 v61, 0
    s_mov_b64 exec, 1
    buffer_store_dword v60, v61, s[16:19], s50 offen offset:64 sc0 sc1
    s_mov_b64 exec, -1
    ds_read_b64_tr_b16 v[20:21], v43 offset:57344
    ds_read_b64_tr_b16 v[22:23], v43 offset:57856
    s_add_u32 m0, s39, 61440
    s_add_u32 s41, s36, 448512
    v_mfma_f32_32x32x16_bf16 v[240:255], v[8:11], a[196:199], v[240:255]
    buffer_load_dwordx4 v28, s[12:15], s41 offen lds
    s_waitcnt lgkmcnt(4)
    v_mfma_f32_32x32x16_bf16 v[96:111], v[12:15], a[160:163], v[96:111]
    ds_read_b64_tr_b16 v[8:9], v24 offset:0
    ds_read_b64_tr_b16 v[10:11], v24 offset:512
    v_mfma_f32_32x32x16_bf16 v[112:127], v[12:15], a[164:167], v[112:127]
    s_waitcnt lgkmcnt(4)
    v_mfma_f32_32x32x16_bf16 v[128:143], v[16:19], a[128:131], v[128:143]
    ds_read_b64_tr_b16 v[12:13], v41 offset:4096
    ds_read_b64_tr_b16 v[14:15], v41 offset:4608
    v_mfma_f32_32x32x16_bf16 v[144:159], v[16:19], a[132:135], v[144:159]
    s_waitcnt lgkmcnt(4)
    v_mfma_f32_32x32x16_bf16 v[160:175], v[20:23], a[96:99], v[160:175]
    ds_read_b64_tr_b16 v[16:17], v42 offset:32768
    ds_read_b64_tr_b16 v[18:19], v42 offset:33280
    v_mfma_f32_32x32x16_bf16 v[176:191], v[20:23], a[100:103], v[176:191]
    s_waitcnt lgkmcnt(4)
    v_mfma_f32_32x32x16_bf16 v[224:239], v[8:11], a[200:203], v[224:239]
    ds_read_b64_tr_b16 v[20:21], v43 offset:61440
    ds_read_b64_tr_b16 v[22:23], v43 offset:61952
    s_add_u32 s35, s35, 1
    s_cmp_eq_u32 s35, 9
    s_cselect_b32 s35, 0, s35
    s_mov_b32 s40, 589824
    s_cselect_b32 s40, 4290248704, s40
    v_mfma_f32_32x32x16_bf16 v[240:255], v[8:11], a[204:207], v[240:255]
    s_add_u32 s36, s36, s40
    s_add_u32 m0, s39, 32768
    s_add_u32 s41, s36, 6144
    s_waitcnt lgkmcnt(4)
    v_mfma_f32_32x32x16_bf16 v[96:111], v[12:15], a[168:171], v[96:111]
    ds_read_b64_tr_b16 v[8:9], v24 offset:4096
    ds_read_b64_tr_b16 v[10:11], v24 offset:4608
    buffer_load_dwordx4 v28, s[12:15], s41 offen lds
    v_mfma_f32_32x32x16_bf16 v[112:127], v[12:15], a[172:175], v[112:127]
    s_waitcnt lgkmcnt(4)
    v_mfma_f32_32x32x16_bf16 v[128:143], v[16:19], a[136:139], v[128:143]
    ds_read_b64_tr_b16 v[12:13], v41 offset:8192
    ds_read_b64_tr_b16 v[14:15], v41 offset:8704
    v_mfma_f32_32x32x16_bf16 v[144:159], v[16:19], a[140:143], v[144:159]
    s_waitcnt lgkmcnt(4)
    v_mfma_f32_32x32x16_bf16 v[160:175], v[20:23], a[104:107], v[160:175]
    ds_read_b64_tr_b16 v[16:17], v42 offset:36864
    ds_read_b64_tr_b16 v[18:19], v42 offset:37376
    v_mfma_f32_32x32x16_bf16 v[176:191], v[20:23], a[108:111], v[176:191]
    s_waitcnt lgkmcnt(4)
    v_mfma_f32_32x32x16_bf16 v[224:239], v[8:11], a[208:211], v[224:239]
    ds_read_b64_tr_b16 v[20:21], v43 offset:45056
    ds_read_b64_tr_b16 v[22:23], v43 offset:45568
    s_add_u32 m0, s39, 36864
    s_add_u32 s41, s36, 153600
    v_mfma_f32_32x32x16_bf16 v[240:255], v[8:11], a[212:215], v[240:255]
    buffer_load_dwordx4 v28, s[12:15], s41 offen lds
    s_and_b32 s46, s45, 1
    s_waitcnt lgkmcnt(4)
    v_mfma_f32_32x32x16_bf16 v[96:111], v[12:15], a[176:179], v[96:111]
    ds_read_b64_tr_b16 v[8:9], v24 offset:8192
    ds_read_b64_tr_b16 v[10:11], v24 offset:8704
    s_lshr_b32 s66, s45, 1
    s_mov_b32 s49, s43
    s_mov_b32 s60, s52
    s_mov_b32 s61, s53
    s_mov_b32 s62, 5308416
    v_mfma_f32_32x32x16_bf16 v[112:127], v[12:15], a[180:183], v[112:127]
    s_mov_b32 s63, 0x00020000
    s_lshl_b32 s65, s33, 1
    s_add_u32 s65, s65, s46
    s_mul_i32 s64, s32, 9216
    s_mul_i32 s46, s66, 384
    s_add_u32 s64, s64, s46
    s_waitcnt lgkmcnt(4)
    v_mfma_f32_32x32x16_bf16 v[128:143], v[16:19], a[144:147], v[128:143]
    ds_read_b64_tr_b16 v[12:13], v41 offset:12288
    ds_read_b64_tr_b16 v[14:15], v41 offset:12800
    s_mul_i32 s46, s49, 442368
    s_add_u32 s64, s64, s46
    s_mul_i32 s38, s32, 3072
    s_lshl_b32 s46, s65, 2
    s_add_u32 s46, s46, s32
    v_mfma_f32_32x32x16_bf16 v[144:159], v[16:19], a[148:151], v[144:159]
    s_mul_i32 s46, s46, 324
    s_mul_i32 s67, s49, 72
    s_add_u32 s46, s46, s67
    s_add_u32 s46, s46, 36
    s_lshl_b32 s67, s46, 10
    v_add_u32 v2, 0, v0
    s_waitcnt lgkmcnt(4)
    v_mfma_f32_32x32x16_bf16 v[160:175], v[20:23], a[112:115], v[160:175]
    ds_read_b64_tr_b16 v[16:17], v42 offset:40960
    ds_read_b64_tr_b16 v[18:19], v42 offset:41472
    v_mul_u32_u24 v3, 2731, v2
    v_lshrrev_b32 v3, 16, v3
    v_mul_u32_u24 v4, 24, v3
    v_sub_u32 v4, v2, v4
    v_bfe_u32 v5, v3, 1, 1
    v_mfma_f32_32x32x16_bf16 v[176:191], v[20:23], a[116:119], v[176:191]
    v_lshlrev_b32 v5, 2, v5
    v_xor_b32 v4, v4, v5
    s_mul_i32 s46, s49, 6
    v_add_u32 v4, s46, v4
    v_subrev_u32 v5, 24, v4
    v_min_u32 v4, v4, v5
    s_waitcnt lgkmcnt(4)
    v_mfma_f32_32x32x16_bf16 v[224:239], v[8:11], a[216:219], v[224:239]
    ds_read_b64_tr_b16 v[20:21], v43 offset:49152
    ds_read_b64_tr_b16 v[22:23], v43 offset:49664
    v_mul_u32_u24 v3, 1152, v3
    v_lshl_add_u32 v32, v4, 4, v3
    s_add_u32 m0, s39, 40960
    s_add_u32 s41, s36, 301056
    v_mfma_f32_32x32x16_bf16 v[240:255], v[8:11], a[220:223], v[240:255]
    buffer_load_dwordx4 v28, s[12:15], s41 offen lds
    v_add_u32 v2, 64, v0
    s_waitcnt lgkmcnt(4)
    v_mfma_f32_32x32x16_bf16 v[96:111], v[12:15], a[184:187], v[96:111]
    ds_read_b64_tr_b16 v[8:9], v24 offset:12288
    ds_read_b64_tr_b16 v[10:11], v24 offset:12800
    v_mul_u32_u24 v3, 2731, v2
    v_lshrrev_b32 v3, 16, v3
    v_mul_u32_u24 v4, 24, v3
    v_sub_u32 v4, v2, v4
    v_bfe_u32 v5, v3, 1, 1
    v_mfma_f32_32x32x16_bf16 v[112:127], v[12:15], a[188:191], v[112:127]
    v_lshlrev_b32 v5, 2, v5
    v_xor_b32 v4, v4, v5
    s_mul_i32 s46, s49, 6
    v_add_u32 v4, s46, v4
    v_subrev_u32 v5, 24, v4
    v_min_u32 v4, v4, v5
    s_waitcnt lgkmcnt(4)
    v_mfma_f32_32x32x16_bf16 v[128:143], v[16:19], a[152:155], v[128:143]
    ds_read_b64_tr_b16 v[12:13], v41 offset:16384
    ds_read_b64_tr_b16 v[14:15], v41 offset:16896
    v_mul_u32_u24 v3, 1152, v3
    v_lshl_add_u32 v33, v4, 4, v3
    v_subrev_u32 v33, 1024, v33
    v_add_u32 v2, 128, v0
    v_mul_u32_u24 v3, 2731, v2
    v_mfma_f32_32x32x16_bf16 v[144:159], v[16:19], a[156:159], v[144:159]
    v_lshrrev_b32 v3, 16, v3
    v_mul_u32_u24 v4, 24, v3
    v_sub_u32 v4, v2, v4
    v_bfe_u32 v5, v3, 1, 1
    v_lshlrev_b32 v5, 2, v5
    v_xor_b32 v4, v4, v5
    s_waitcnt lgkmcnt(4)
    v_mfma_f32_32x32x16_bf16 v[160:175], v[20:23], a[120:123], v[160:175]
    ds_read_b64_tr_b16 v[16:17], v42 offset:0
    ds_read_b64_tr_b16 v[18:19], v42 offset:512
    s_mul_i32 s46, s49, 6
    v_add_u32 v4, s46, v4
    v_subrev_u32 v5, 24, v4
    v_min_u32 v4, v4, v5
    v_mul_u32_u24 v3, 1152, v3
    v_mfma_f32_32x32x16_bf16 v[176:191], v[20:23], a[124:127], v[176:191]
    v_lshl_add_u32 v34, v4, 4, v3
    v_subrev_u32 v34, 2048, v34
    v_lshrrev_b32 v2, 4, v0
    v_bfe_u32 v3, v0, 2, 2
    v_and_b32 v4, 3, v0
    v_lshrrev_b32 v5, 1, v2
    s_waitcnt lgkmcnt(4)
    v_mfma_f32_32x32x16_bf16 v[224:239], v[8:11], a[224:227], v[224:239]
    s_waitcnt vmcnt(11)
    s_barrier
    ds_read_b64_tr_b16 v[20:21], v43 offset:53248
    ds_read_b64_tr_b16 v[22:23], v43 offset:53760
    v_lshl_add_u32 v5, v5, 3, v3
    s_add_u32 m0, s39, 122880
    v_mfma_f32_32x32x16_bf16 v[240:255], v[8:11], a[228:231], v[240:255]
    s_add_u32 s41, s36, 448512
    buffer_load_dwordx4 v28, s[12:15], s41 offen lds
    s_waitcnt lgkmcnt(4)
    v_mfma_f32_32x32x16_bf16 v[96:111], v[12:15], a[192:195], v[96:111]
    ds_read_b64_tr_b16 v[8:9], v24 offset:45056
    ds_read_b64_tr_b16 v[10:11], v24 offset:45568
    v_mul_u32_u24 v5, 384, v5
    v_and_b32 v6, 1, v2
    v_lshl_add_u32 v5, v6, 5, v5
    v_lshl_add_u32 v5, v4, 3, v5
    v_lshrrev_b32 v6, 1, v3
    v_mfma_f32_32x32x16_bf16 v[112:127], v[12:15], a[196:199], v[112:127]
    v_lshlrev_b32 v6, 6, v6
    v_add_u32 v5, 49152, v5
    v_add_u32 v35, v5, v6
    v_sub_u32 v36, v5, v6
    v_add_u32 v36, 64, v36
    v_add_u32 v37, 49152, v35
    s_waitcnt lgkmcnt(4)
    v_mfma_f32_32x32x16_bf16 v[128:143], v[16:19], a[160:163], v[128:143]
    ds_read_b64_tr_b16 v[12:13], v25 offset:0
    ds_read_b64_tr_b16 v[14:15], v25 offset:512
    v_add_u32 v38, 49152, v36
    v_add_u32 v31, 98304, v35
    v_add_u32 v30, 98304, v36
    v_mfma_f32_32x32x16_bf16 v[144:159], v[16:19], a[164:167], v[144:159]
    s_waitcnt lgkmcnt(4)
    v_mfma_f32_32x32x16_bf16 v[160:175], v[20:23], a[128:131], v[160:175]
    ds_read_b64_tr_b16 v[16:17], v42 offset:4096
    ds_read_b64_tr_b16 v[18:19], v42 offset:4608
    v_mfma_f32_32x32x16_bf16 v[176:191], v[20:23], a[132:135], v[176:191]
    s_waitcnt lgkmcnt(4)
    v_mfma_f32_32x32x16_bf16 v[224:239], v[8:11], a[232:235], v[224:239]
    ds_read_b64_tr_b16 v[20:21], v43 offset:32768
    ds_read_b64_tr_b16 v[22:23], v43 offset:33280
    s_add_u32 s35, s35, 1
    s_cmp_eq_u32 s35, 9
    s_cselect_b32 s35, 0, s35
    s_mov_b32 s40, 589824
    s_cselect_b32 s40, 4290248704, s40
    v_mfma_f32_32x32x16_bf16 v[240:255], v[8:11], a[236:239], v[240:255]
    s_add_u32 s36, s36, s40
    s_add_u32 m0, s39, 126976
    s_add_u32 s41, s36, 6144
    s_waitcnt lgkmcnt(4)
    v_mfma_f32_32x32x16_bf16 v[96:111], v[12:15], a[200:203], v[96:111]
    ds_read_b64_tr_b16 v[8:9], v24 offset:49152
    ds_read_b64_tr_b16 v[10:11], v24 offset:49664
    buffer_load_dwordx4 v28, s[12:15], s41 offen lds
    v_mfma_f32_32x32x16_bf16 v[112:127], v[12:15], a[204:207], v[112:127]
    s_waitcnt lgkmcnt(4)
    v_mfma_f32_32x32x16_bf16 v[128:143], v[16:19], a[168:171], v[128:143]
    ds_read_b64_tr_b16 v[12:13], v25 offset:4096
    ds_read_b64_tr_b16 v[14:15], v25 offset:4608
    v_mfma_f32_32x32x16_bf16 v[144:159], v[16:19], a[172:175], v[144:159]
    s_waitcnt lgkmcnt(4)
    v_mfma_f32_32x32x16_bf16 v[160:175], v[20:23], a[136:139], v[160:175]
    ds_read_b64_tr_b16 v[16:17], v42 offset:8192
    ds_read_b64_tr_b16 v[18:19], v42 offset:8704
    v_mfma_f32_32x32x16_bf16 v[176:191], v[20:23], a[140:143], v[176:191]
    s_waitcnt lgkmcnt(4)
    v_mfma_f32_32x32x16_bf16 v[224:239], v[8:11], a[240:243], v[224:239]
    ds_read_b64_tr_b16 v[20:21], v43 offset:36864
    ds_read_b64_tr_b16 v[22:23], v43 offset:37376
    s_add_u32 m0, s39, 110592
    s_add_u32 s41, s36, 153600
    v_mfma_f32_32x32x16_bf16 v[240:255], v[8:11], a[244:247], v[240:255]
    buffer_load_dwordx4 v28, s[12:15], s41 offen lds
    s_waitcnt lgkmcnt(4)
    v_mfma_f32_32x32x16_bf16 v[96:111], v[12:15], a[208:211], v[96:111]
    ds_read_b64_tr_b16 v[8:9], v40 offset:20480
    ds_read_b64_tr_b16 v[10:11], v40 offset:20992
    v_mfma_f32_32x32x16_bf16 v[112:127], v[12:15], a[212:215], v[112:127]
    s_waitcnt lgkmcnt(4)
    v_mfma_f32_32x32x16_bf16 v[128:143], v[16:19], a[176:179], v[128:143]
    ds_read_b64_tr_b16 v[12:13], v25 offset:8192
    ds_read_b64_tr_b16 v[14:15], v25 offset:8704
    v_mfma_f32_32x32x16_bf16 v[144:159], v[16:19], a[180:183], v[144:159]
    s_waitcnt lgkmcnt(4)
    v_mfma_f32_32x32x16_bf16 v[160:175], v[20:23], a[144:147], v[160:175]
    ds_read_b64_tr_b16 v[16:17], v42 offset:12288
    ds_read_b64_tr_b16 v[18:19], v42 offset:12800
    v_mfma_f32_32x32x16_bf16 v[176:191], v[20:23], a[148:151], v[176:191]
    s_waitcnt lgkmcnt(4)
    v_mfma_f32_32x32x16_bf16 v[224:239], v[8:11], a[248:251], v[224:239]
    ds_read_b64_tr_b16 v[20:21], v43 offset:40960
    ds_read_b64_tr_b16 v[22:23], v43 offset:41472
    s_add_u32 m0, s39, 114688
    s_add_u32 s41, s36, 301056
    v_mfma_f32_32x32x16_bf16 v[240:255], v[8:11], a[252:255], v[240:255]
    buffer_load_dwordx4 v28, s[12:15], s41 offen lds
    s_waitcnt lgkmcnt(4)
    v_mfma_f32_32x32x16_bf16 v[96:111], v[12:15], a[216:219], v[96:111]
    ds_read_b64_tr_b16 v[8:9], v24 offset:16384
    ds_read_b64_tr_b16 v[10:11], v24 offset:16896
    v_mfma_f32_32x32x16_bf16 v[112:127], v[12:15], a[220:223], v[112:127]
    s_waitcnt lgkmcnt(4)
    v_mfma_f32_32x32x16_bf16 v[128:143], v[16:19], a[184:187], v[128:143]
    ds_read_b64_tr_b16 v[12:13], v25 offset:12288
    ds_read_b64_tr_b16 v[14:15], v25 offset:12800
    v_mfma_f32_32x32x16_bf16 v[144:159], v[16:19], a[188:191], v[144:159]
    s_waitcnt lgkmcnt(4)
    v_mfma_f32_32x32x16_bf16 v[160:175], v[20:23], a[152:155], v[160:175]
    ds_read_b64_tr_b16 v[16:17], v42 offset:16384
    ds_read_b64_tr_b16 v[18:19], v42 offset:16896
    v_mfma_f32_32x32x16_bf16 v[176:191], v[20:23], a[156:159], v[176:191]
    s_waitcnt lgkmcnt(4)
    v_mfma_f32_32x32x16_bf16 v[224:239], v[8:11], v[64:67], v[224:239]
    s_waitcnt vmcnt(11)
    s_barrier
    ds_read_b64_tr_b16 v[20:21], v43 offset:0
    ds_read_b64_tr_b16 v[22:23], v43 offset:512
    s_add_u32 m0, s39, 118784
    s_add_u32 s41, s36, 448512
    v_mfma_f32_32x32x16_bf16 v[240:255], v[8:11], v[68:71], v[240:255]
    buffer_load_dwordx4 v28, s[12:15], s41 offen lds
    s_waitcnt lgkmcnt(4)
    v_mfma_f32_32x32x16_bf16 v[96:111], v[12:15], a[224:227], v[96:111]
    ds_read_b64_tr_b16 v[8:9], v24 offset:20480
    ds_read_b64_tr_b16 v[10:11], v24 offset:20992
    v_mfma_f32_32x32x16_bf16 v[112:127], v[12:15], a[228:231], v[112:127]
    s_waitcnt lgkmcnt(4)
    v_mfma_f32_32x32x16_bf16 v[128:143], v[16:19], a[192:195], v[128:143]
    ds_read_b64_tr_b16 v[12:13], v25 offset:45056
    ds_read_b64_tr_b16 v[14:15], v25 offset:45568
    v_mfma_f32_32x32x16_bf16 v[144:159], v[16:19], a[196:199], v[144:159]
    s_waitcnt lgkmcnt(4)
    v_mfma_f32_32x32x16_bf16 v[160:175], v[20:23], a[160:163], v[160:175]
    ds_read_b64_tr_b16 v[16:17], v26 offset:0
    ds_read_b64_tr_b16 v[18:19], v26 offset:512
    v_mfma_f32_32x32x16_bf16 v[176:191], v[20:23], a[164:167], v[176:191]
    s_waitcnt lgkmcnt(4)
    v_mfma_f32_32x32x16_bf16 v[224:239], v[8:11], v[72:75], v[224:239]
    ds_read_b64_tr_b16 v[20:21], v43 offset:4096
    ds_read_b64_tr_b16 v[22:23], v43 offset:4608
    s_add_u32 s35, s35, 1
    s_cmp_eq_u32 s35, 9
    s_cselect_b32 s35, 0, s35
    s_mov_b32 s40, 589824
    s_cselect_b32 s40, 4290248704, s40
    v_mfma_f32_32x32x16_bf16 v[240:255], v[8:11], v[76:79], v[240:255]
    s_add_u32 s36, s36, s40
    s_add_u32 m0, s39, 98304
    s_add_u32 s41, s36, 6144
    s_waitcnt lgkmcnt(4)
    v_mfma_f32_32x32x16_bf16 v[96:111], v[12:15], a[232:235], v[96:111]
    ds_read_b64_tr_b16 v[8:9], v24 offset:53248
    ds_read_b64_tr_b16 v[10:11], v24 offset:53760
    buffer_load_dwordx4 v28, s[12:15], s41 offen lds
    v_mfma_f32_32x32x16_bf16 v[112:127], v[12:15], a[236:239], v[112:127]
    s_waitcnt lgkmcnt(4)
    v_mfma_f32_32x32x16_bf16 v[128:143], v[16:19], a[200:203], v[128:143]
    ds_read_b64_tr_b16 v[12:13], v25 offset:49152
    ds_read_b64_tr_b16 v[14:15], v25 offset:49664
    v_mfma_f32_32x32x16_bf16 v[144:159], v[16:19], a[204:207], v[144:159]
    s_waitcnt lgkmcnt(4)
    v_mfma_f32_32x32x16_bf16 v[160:175], v[20:23], a[168:171], v[160:175]
    ds_read_b64_tr_b16 v[16:17], v26 offset:4096
    ds_read_b64_tr_b16 v[18:19], v26 offset:4608
    v_mfma_f32_32x32x16_bf16 v[176:191], v[20:23], a[172:175], v[176:191]
    s_waitcnt lgkmcnt(4)
    v_mfma_f32_32x32x16_bf16 v[224:239], v[8:11], v[80:83], v[224:239]
    ds_read_b64_tr_b16 v[20:21], v43 offset:8192
    ds_read_b64_tr_b16 v[22:23], v43 offset:8704
    s_add_u32 m0, s39, 102400
    s_add_u32 s41, s36, 153600
    v_mfma_f32_32x32x16_bf16 v[240:255], v[8:11], v[84:87], v[240:255]
    buffer_load_dwordx4 v28, s[12:15], s41 offen lds
    s_waitcnt lgkmcnt(4)
    v_mfma_f32_32x32x16_bf16 v[96:111], v[12:15], a[240:243], v[96:111]
    ds_read_b64_tr_b16 v[8:9], v40 offset:24576
    ds_read_b64_tr_b16 v[10:11], v40 offset:25088
    v_mfma_f32_32x32x16_bf16 v[112:127], v[12:15], a[244:247], v[112:127]
    s_waitcnt lgkmcnt(4)
    v_mfma_f32_32x32x16_bf16 v[128:143], v[16:19], a[208:211], v[128:143]
    ds_read_b64_tr_b16 v[12:13], v41 offset:20480
    ds_read_b64_tr_b16 v[14:15], v41 offset:20992
    v_mfma_f32_32x32x16_bf16 v[144:159], v[16:19], a[212:215], v[144:159]
    s_waitcnt lgkmcnt(4)
    v_mfma_f32_32x32x16_bf16 v[160:175], v[20:23], a[176:179], v[160:175]
    ds_read_b64_tr_b16 v[16:17], v26 offset:8192
    ds_read_b64_tr_b16 v[18:19], v26 offset:8704
    v_mfma_f32_32x32x16_bf16 v[176:191], v[20:23], a[180:183], v[176:191]
    s_waitcnt lgkmcnt(4)
    v_mfma_f32_32x32x16_bf16 v[224:239], v[8:11], v[88:91], v[224:239]
    ds_read_b64_tr_b16 v[20:21], v43 offset:12288
    ds_read_b64_tr_b16 v[22:23], v43 offset:12800
    s_add_u32 m0, s39, 106496
    s_add_u32 s41, s36, 301056
    v_mfma_f32_32x32x16_bf16 v[240:255], v[8:11], v[92:95], v[240:255]
    buffer_load_dwordx4 v28, s[12:15], s41 offen lds
    s_waitcnt lgkmcnt(4)
    v_mfma_f32_32x32x16_bf16 v[96:111], v[12:15], a[248:251], v[96:111]
    ds_read_b64_tr_b16 v[8:9], v40 offset:28672
    ds_read_b64_tr_b16 v[10:11], v40 offset:29184
    v_mfma_f32_32x32x16_bf16 v[112:127], v[12:15], a[252:255], v[112:127]
    s_waitcnt lgkmcnt(4)
    v_mfma_f32_32x32x16_bf16 v[128:143], v[16:19], a[216:219], v[128:143]
    ds_read_b64_tr_b16 v[12:13], v25 offset:16384
    ds_read_b64_tr_b16 v[14:15], v25 offset:16896
    v_mfma_f32_32x32x16_bf16 v[144:159], v[16:19], a[220:223], v[144:159]
    s_waitcnt lgkmcnt(4)
    v_mfma_f32_32x32x16_bf16 v[160:175], v[20:23], a[184:187], v[160:175]
    ds_read_b64_tr_b16 v[16:17], v26 offset:12288
    ds_read_b64_tr_b16 v[18:19], v26 offset:12800
    v_mul_f32 v44, 0xbfb8aa3b, v224
    v_mul_f32 v45, 0xbfb8aa3b, v225
    v_mul_f32 v46, 0xbfb8aa3b, v226
    v_mul_f32 v47, 0xbfb8aa3b, v227
    v_mul_f32 v48, 0xbfb8aa3b, v232
    v_mfma_f32_32x32x16_bf16 v[176:191], v[20:23], a[188:191], v[176:191]
    v_mul_f32 v49, 0xbfb8aa3b, v233
    v_mul_f32 v50, 0xbfb8aa3b, v234
    v_mul_f32 v51, 0xbfb8aa3b, v235
    v_exp_f32 v44, v44
    s_waitcnt lgkmcnt(4)
    v_mfma_f32_32x32x16_bf16 v[192:207], v[8:11], a[0:3], 0
    s_waitcnt vmcnt(10)
    s_barrier
    ds_read_b64_tr_b16 v[20:21], v43 offset:16384
    ds_read_b64_tr_b16 v[22:23], v43 offset:16896
    s_add_u32 m0, s39, 65536
    s_add_u32 s41, s36, 448512
    v_mfma_f32_32x32x16_bf16 v[208:223], v[8:11], a[4:7], 0
    buffer_load_dwordx4 v28, s[12:15], s41 offen lds
    s_waitcnt lgkmcnt(4)
    v_mfma_f32_32x32x16_bf16 v[96:111], v[12:15], v[64:67], v[96:111]
    ds_read_b64_tr_b16 v[8:9], v24 offset:24576
    ds_read_b64_tr_b16 v[10:11], v24 offset:25088
    v_exp_f32 v45, v45
    v_exp_f32 v46, v46
    v_mfma_f32_32x32x16_bf16 v[112:127], v[12:15], v[68:71], v[112:127]
    v_exp_f32 v47, v47
    v_exp_f32 v48, v48
    v_exp_f32 v49, v49
    s_waitcnt lgkmcnt(4)
    v_mfma_f32_32x32x16_bf16 v[128:143], v[16:19], a[224:227], v[128:143]
    ds_read_b64_tr_b16 v[12:13], v25 offset:20480
    ds_read_b64_tr_b16 v[14:15], v25 offset:20992
    v_exp_f32 v50, v50
    v_exp_f32 v51, v51
    v_add_f32 v44, 1.0, v44
    v_mfma_f32_32x32x16_bf16 v[144:159], v[16:19], a[228:231], v[144:159]
    v_add_f32 v45, 1.0, v45
    v_add_f32 v46, 1.0, v46
    v_add_f32 v47, 1.0, v47
    v_add_f32 v48, 1.0, v48
    v_add_f32 v49, 1.0, v49
    v_add_f32 v50, 1.0, v50
    s_waitcnt lgkmcnt(4)
    v_mfma_f32_32x32x16_bf16 v[160:175], v[20:23], a[192:195], v[160:175]
    ds_read_b64_tr_b16 v[16:17], v26 offset:45056
    ds_read_b64_tr_b16 v[18:19], v26 offset:45568
    v_add_f32 v51, 1.0, v51
    v_rcp_f32 v44, v44
    v_rcp_f32 v45, v45
    v_mfma_f32_32x32x16_bf16 v[176:191], v[20:23], a[196:199], v[176:191]
    v_rcp_f32 v46, v46
    v_rcp_f32 v47, v47
    v_rcp_f32 v48, v48
    s_waitcnt lgkmcnt(4)
    v_mfma_f32_32x32x16_bf16 v[192:207], v[8:11], a[8:11], v[192:207]
    ds_read_b64_tr_b16 v[20:21], v27 offset:0
    ds_read_b64_tr_b16 v[22:23], v27 offset:512
    s_add_u32 s35, s35, 1
    s_cmp_eq_u32 s35, 9
    s_cselect_b32 s35, 0, s35
    s_mov_b32 s40, 589824
    s_cselect_b32 s40, 4290248704, s40
    v_mfma_f32_32x32x16_bf16 v[208:223], v[8:11], a[12:15], v[208:223]
    s_add_u32 s36, s36, s40
    s_add_u32 m0, s39, 69632
    s_add_u32 s41, s36, 6144
    v_rcp_f32 v49, v49
    s_waitcnt lgkmcnt(4)
    v_mfma_f32_32x32x16_bf16 v[96:111], v[12:15], v[72:75], v[96:111]
    ds_read_b64_tr_b16 v[8:9], v24 offset:28672
    ds_read_b64_tr_b16 v[10:11], v24 offset:29184
    buffer_load_dwordx4 v28, s[12:15], s41 offen lds
    v_mfma_f32_32x32x16_bf16 v[112:127], v[12:15], v[76:79], v[112:127]
    v_rcp_f32 v50, v50
    v_rcp_f32 v51, v51
    v_mul_f32 v44, v44, v228
    v_mul_f32 v45, v45, v229
    s_waitcnt lgkmcnt(4)
    v_mfma_f32_32x32x16_bf16 v[128:143], v[16:19], a[232:235], v[128:143]
    ds_read_b64_tr_b16 v[12:13], v25 offset:53248
    ds_read_b64_tr_b16 v[14:15], v25 offset:53760
    v_mul_f32 v46, v46, v230
    v_mul_f32 v47, v47, v231
    v_mul_f32 v48, v48, v236
    v_mul_f32 v49, v49, v237
    v_mul_f32 v50, v50, v238
    v_mfma_f32_32x32x16_bf16 v[144:159], v[16:19], a[236:239], v[144:159]
    v_mul_f32 v51, v51, v239
    v_cvt_pk_bf16_f32 v52, v44, v45
    v_cvt_pk_bf16_f32 v53, v46, v47
    v_cvt_pk_bf16_f32 v54, v48, v49
    v_cvt_pk_bf16_f32 v55, v50, v51
    s_add_u32 s42, s37, 24576
    s_waitcnt lgkmcnt(4)
    v_mfma_f32_32x32x16_bf16 v[160:175], v[20:23], a[200:203], v[160:175]
    ds_read_b64_tr_b16 v[16:17], v26 offset:49152
    ds_read_b64_tr_b16 v[18:19], v26 offset:49664
    buffer_store_dwordx4 v[52:55], v39, s[16:19], s42 offen sc0 sc1
    v_mfma_f32_32x32x16_bf16 v[176:191], v[20:23], a[204:207], v[176:191]
    v_mul_f32 v44, 0xbfb8aa3b, v240
    v_mul_f32 v45, 0xbfb8aa3b, v241
    v_mul_f32 v46, 0xbfb8aa3b, v242
    v_mul_f32 v47, 0xbfb8aa3b, v243
    v_mul_f32 v48, 0xbfb8aa3b, v248
    v_mul_f32 v49, 0xbfb8aa3b, v249
    s_waitcnt lgkmcnt(4)
    v_mfma_f32_32x32x16_bf16 v[192:207], v[8:11], a[16:19], v[192:207]
    ds_read_b64_tr_b16 v[20:21], v27 offset:4096
    ds_read_b64_tr_b16 v[22:23], v27 offset:4608
    s_add_u32 m0, s39, 73728
    s_add_u32 s41, s36, 153600
    v_mul_f32 v50, 0xbfb8aa3b, v250
    v_mul_f32 v51, 0xbfb8aa3b, v251
    v_mfma_f32_32x32x16_bf16 v[208:223], v[8:11], a[20:23], v[208:223]
    buffer_load_dwordx4 v28, s[12:15], s41 offen lds
    s_waitcnt lgkmcnt(4)
    v_mfma_f32_32x32x16_bf16 v[96:111], v[12:15], v[80:83], v[96:111]
    ds_read_b64_tr_b16 v[8:9], v24 offset:61440
    ds_read_b64_tr_b16 v[10:11], v24 offset:61952
    v_exp_f32 v44, v44
    v_exp_f32 v45, v45
    v_mfma_f32_32x32x16_bf16 v[112:127], v[12:15], v[84:87], v[112:127]
    v_exp_f32 v46, v46
    v_exp_f32 v47, v47
    v_exp_f32 v48, v48
    s_waitcnt lgkmcnt(4)
    v_mfma_f32_32x32x16_bf16 v[128:143], v[16:19], a[240:243], v[128:143]
    ds_read_b64_tr_b16 v[12:13], v41 offset:24576
    ds_read_b64_tr_b16 v[14:15], v41 offset:25088
    v_exp_f32 v49, v49
    v_exp_f32 v50, v50
    v_mfma_f32_32x32x16_bf16 v[144:159], v[16:19], a[244:247], v[144:159]
    v_exp_f32 v51, v51
    v_add_f32 v44, 1.0, v44
    v_add_f32 v45, 1.0, v45
    v_add_f32 v46, 1.0, v46
    v_add_f32 v47, 1.0, v47
    s_waitcnt lgkmcnt(4)
    v_mfma_f32_32x32x16_bf16 v[160:175], v[20:23], a[208:211], v[160:175]
    ds_read_b64_tr_b16 v[16:17], v42 offset:20480
    ds_read_b64_tr_b16 v[18:19], v42 offset:20992
    v_add_f32 v48, 1.0, v48
    v_add_f32 v49, 1.0, v49
    v_add_f32 v50, 1.0, v50
    v_add_f32 v51, 1.0, v51
    v_mfma_f32_32x32x16_bf16 v[176:191], v[20:23], a[212:215], v[176:191]
    v_rcp_f32 v44, v44
    v_rcp_f32 v45, v45
    v_rcp_f32 v46, v46
    s_waitcnt lgkmcnt(4)
    v_mfma_f32_32x32x16_bf16 v[192:207], v[8:11], a[24:27], v[192:207]
    ds_read_b64_tr_b16 v[20:21], v27 offset:8192
    ds_read_b64_tr_b16 v[22:23], v27 offset:8704
    s_add_u32 m0, s39, 77824
    s_add_u32 s41, s36, 301056
    v_rcp_f32 v47, v47
    v_mfma_f32_32x32x16_bf16 v[208:223], v[8:11], a[28:31], v[208:223]
    buffer_load_dwordx4 v28, s[12:15], s41 offen lds
    s_waitcnt lgkmcnt(4)
    v_mfma_f32_32x32x16_bf16 v[96:111], v[12:15], v[88:91], v[96:111]
    ds_read_b64_tr_b16 v[8:9], v24 offset:32768
    ds_read_b64_tr_b16 v[10:11], v24 offset:33280
    v_rcp_f32 v48, v48
    v_rcp_f32 v49, v49
    v_mfma_f32_32x32x16_bf16 v[112:127], v[12:15], v[92:95], v[112:127]
    v_rcp_f32 v50, v50
    v_rcp_f32 v51, v51
    v_mul_f32 v44, v44, v244
    v_mul_f32 v45, v45, v245
    s_waitcnt lgkmcnt(4)
    v_mfma_f32_32x32x16_bf16 v[128:143], v[16:19], a[248:251], v[128:143]
    ds_read_b64_tr_b16 v[12:13], v41 offset:28672
    ds_read_b64_tr_b16 v[14:15], v41 offset:29184
    v_mul_f32 v46, v46, v246
    v_mul_f32 v47, v47, v247
    v_mul_f32 v48, v48, v252
    v_mul_f32 v49, v49, v253
    v_mul_f32 v50, v50, v254
    v_mfma_f32_32x32x16_bf16 v[144:159], v[16:19], a[252:255], v[144:159]
    v_mul_f32 v51, v51, v255
    v_cvt_pk_bf16_f32 v56, v44, v45
    v_cvt_pk_bf16_f32 v57, v46, v47
    v_cvt_pk_bf16_f32 v58, v48, v49
    v_cvt_pk_bf16_f32 v59, v50, v51
    s_add_u32 s42, s37, 356352
    s_waitcnt lgkmcnt(4)
    v_mfma_f32_32x32x16_bf16 v[160:175], v[20:23], a[216:219], v[160:175]
    ds_read_b64_tr_b16 v[16:17], v26 offset:16384
    ds_read_b64_tr_b16 v[18:19], v26 offset:16896
    buffer_store_dwordx4 v[56:59], v39, s[16:19], s42 offen sc0 sc1
    v_mfma_f32_32x32x16_bf16 v[176:191], v[20:23], a[220:223], v[176:191]
    v_mul_f32 v44, 0xbfb8aa3b, v96
    v_mul_f32 v45, 0xbfb8aa3b, v97
    v_mul_f32 v46, 0xbfb8aa3b, v98
    v_mul_f32 v47, 0xbfb8aa3b, v99
    v_mul_f32 v48, 0xbfb8aa3b, v104
    v_mul_f32 v49, 0xbfb8aa3b, v105
    s_waitcnt lgkmcnt(4)
    v_mfma_f32_32x32x16_bf16 v[192:207], v[8:11], a[32:35], v[192:207]
    s_waitcnt vmcnt(12)
    s_barrier
    ds_read_b64_tr_b16 v[20:21], v27 offset:12288
    ds_read_b64_tr_b16 v[22:23], v27 offset:12800
    s_add_u32 m0, s39, 81920
    s_add_u32 s41, s36, 448512
    v_mfma_f32_32x32x16_bf16 v[208:223], v[8:11], a[36:39], v[208:223]
    buffer_load_dwordx4 v28, s[12:15], s41 offen lds
    v_mul_f32 v50, 0xbfb8aa3b, v106
    s_waitcnt lgkmcnt(4)
    v_mfma_f32_32x32x16_bf16 v[224:239], v[12:15], a[0:3], 0
    ds_read_b64_tr_b16 v[8:9], v24 offset:36864
    ds_read_b64_tr_b16 v[10:11], v24 offset:37376
    v_mul_f32 v51, 0xbfb8aa3b, v107
    v_exp_f32 v44, v44
    v_exp_f32 v45, v45
    v_mfma_f32_32x32x16_bf16 v[240:255], v[12:15], a[4:7], 0
    v_exp_f32 v46, v46
    v_exp_f32 v47, v47
    v_exp_f32 v48, v48
    s_waitcnt lgkmcnt(4)
    v_mfma_f32_32x32x16_bf16 v[128:143], v[16:19], v[64:67], v[128:143]
    ds_read_b64_tr_b16 v[12:13], v25 offset:24576
    ds_read_b64_tr_b16 v[14:15], v25 offset:25088
    v_exp_f32 v49, v49
    v_exp_f32 v50, v50
    v_mfma_f32_32x32x16_bf16 v[144:159], v[16:19], v[68:71], v[144:159]
    v_exp_f32 v51, v51
    v_add_f32 v44, 1.0, v44
    v_add_f32 v45, 1.0, v45
    v_add_f32 v46, 1.0, v46
    v_add_f32 v47, 1.0, v47
    s_waitcnt lgkmcnt(4)
    v_mfma_f32_32x32x16_bf16 v[160:175], v[20:23], a[224:227], v[160:175]
    ds_read_b64_tr_b16 v[16:17], v26 offset:20480
    ds_read_b64_tr_b16 v[18:19], v26 offset:20992
    v_add_f32 v48, 1.0, v48
    v_add_f32 v49, 1.0, v49
    v_add_f32 v50, 1.0, v50
    v_add_f32 v51, 1.0, v51
    v_mfma_f32_32x32x16_bf16 v[176:191], v[20:23], a[228:231], v[176:191]
    v_rcp_f32 v44, v44
    v_rcp_f32 v45, v45
    v_rcp_f32 v46, v46
    s_waitcnt lgkmcnt(4)
    v_mfma_f32_32x32x16_bf16 v[192:207], v[8:11], a[40:43], v[192:207]
    ds_read_b64_tr_b16 v[20:21], v27 offset:45056
    ds_read_b64_tr_b16 v[22:23], v27 offset:45568
    s_add_u32 s35, s35, 1
    s_cmp_eq_u32 s35, 9
    s_cselect_b32 s35, 0, s35
    s_mov_b32 s40, 589824
    s_cselect_b32 s40, 4290248704, s40
    v_mfma_f32_32x32x16_bf16 v[208:223], v[8:11], a[44:47], v[208:223]
    s_add_u32 s36, s36, s40
    s_add_u32 m0, s39, 0
    s_add_u32 s41, s36, 6144
    v_rcp_f32 v47, v47
    s_waitcnt lgkmcnt(4)
    v_mfma_f32_32x32x16_bf16 v[224:239], v[12:15], a[8:11], v[224:239]
    ds_read_b64_tr_b16 v[8:9], v24 offset:40960
    ds_read_b64_tr_b16 v[10:11], v24 offset:41472
    buffer_load_dwordx4 v28, s[12:15], s41 offen lds
    v_mfma_f32_32x32x16_bf16 v[240:255], v[12:15], a[12:15], v[240:255]
    v_rcp_f32 v48, v48
    v_rcp_f32 v49, v49
    v_rcp_f32 v50, v50
    s_waitcnt lgkmcnt(4)
    v_mfma_f32_32x32x16_bf16 v[128:143], v[16:19], v[72:75], v[128:143]
    ds_read_b64_tr_b16 v[12:13], v25 offset:28672
    ds_read_b64_tr_b16 v[14:15], v25 offset:29184
    v_rcp_f32 v51, v51
    v_mul_f32 v44, v44, v100
    v_mul_f32 v45, v45, v101
    v_mul_f32 v46, v46, v102
    v_mfma_f32_32x32x16_bf16 v[144:159], v[16:19], v[76:79], v[144:159]
    v_mul_f32 v47, v47, v103
    v_mul_f32 v48, v48, v108
    v_mul_f32 v49, v49, v109
    v_mul_f32 v50, v50, v110
    v_mul_f32 v51, v51, v111
    v_cvt_pk_bf16_f32 v52, v44, v45
    s_waitcnt lgkmcnt(4)
    v_mfma_f32_32x32x16_bf16 v[160:175], v[20:23], a[232:235], v[160:175]
    ds_read_b64_tr_b16 v[16:17], v26 offset:53248
    ds_read_b64_tr_b16 v[18:19], v26 offset:53760
    v_cvt_pk_bf16_f32 v53, v46, v47
    v_cvt_pk_bf16_f32 v54, v48, v49
    v_cvt_pk_bf16_f32 v55, v50, v51
    s_add_u32 s42, s37, 25600
    v_mul_f32 v44, 0xbfb8aa3b, v112
    v_mfma_f32_32x32x16_bf16 v[176:191], v[20:23], a[236:239], v[176:191]
    buffer_store_dwordx4 v[52:55], v39, s[16:19], s42 offen sc0 sc1
    v_mul_f32 v45, 0xbfb8aa3b, v113
    s_waitcnt lgkmcnt(4)
    v_mfma_f32_32x32x16_bf16 v[192:207], v[8:11], a[48:51], v[192:207]
    ds_read_b64_tr_b16 v[20:21], v27 offset:49152
    ds_read_b64_tr_b16 v[22:23], v27 offset:49664
    s_add_u32 m0, s39, 4096
    s_add_u32 s41, s36, 153600
    v_mul_f32 v46, 0xbfb8aa3b, v114
    v_mul_f32 v47, 0xbfb8aa3b, v115
    v_mul_f32 v48, 0xbfb8aa3b, v120
    v_mfma_f32_32x32x16_bf16 v[208:223], v[8:11], a[52:55], v[208:223]
    buffer_load_dwordx4 v28, s[12:15], s41 offen lds
    v_mul_f32 v49, 0xbfb8aa3b, v121
    s_waitcnt lgkmcnt(4)
    v_mfma_f32_32x32x16_bf16 v[224:239], v[12:15], a[16:19], v[224:239]
    ds_read_b64_tr_b16 v[8:9], v40 offset:57344
    ds_read_b64_tr_b16 v[10:11], v40 offset:57856
    v_mul_f32 v50, 0xbfb8aa3b, v122
    v_mul_f32 v51, 0xbfb8aa3b, v123
    v_exp_f32 v44, v44
    v_mfma_f32_32x32x16_bf16 v[240:255], v[12:15], a[20:23], v[240:255]
    v_exp_f32 v45, v45
    v_exp_f32 v46, v46
    v_exp_f32 v47, v47
    s_waitcnt lgkmcnt(4)
    v_mfma_f32_32x32x16_bf16 v[128:143], v[16:19], v[80:83], v[128:143]
    ds_read_b64_tr_b16 v[12:13], v25 offset:61440
    ds_read_b64_tr_b16 v[14:15], v25 offset:61952
    v_exp_f32 v48, v48
    v_exp_f32 v49, v49
    v_mfma_f32_32x32x16_bf16 v[144:159], v[16:19], v[84:87], v[144:159]
    v_exp_f32 v50, v50
    v_exp_f32 v51, v51
    v_add_f32 v44, 1.0, v44
    v_add_f32 v45, 1.0, v45
    s_waitcnt lgkmcnt(4)
    v_mfma_f32_32x32x16_bf16 v[160:175], v[20:23], a[240:243], v[160:175]
    ds_read_b64_tr_b16 v[16:17], v42 offset:24576
    ds_read_b64_tr_b16 v[18:19], v42 offset:25088
    v_add_f32 v46, 1.0, v46
    v_add_f32 v47, 1.0, v47
    v_add_f32 v48, 1.0, v48
    v_add_f32 v49, 1.0, v49
    v_add_f32 v50, 1.0, v50
    v_mfma_f32_32x32x16_bf16 v[176:191], v[20:23], a[244:247], v[176:191]
    v_add_f32 v51, 1.0, v51
    v_rcp_f32 v44, v44
    v_rcp_f32 v45, v45
    s_waitcnt lgkmcnt(4)
    v_mfma_f32_32x32x16_bf16 v[192:207], v[8:11], a[56:59], v[192:207]
    ds_read_b64_tr_b16 v[20:21], v43 offset:20480
    ds_read_b64_tr_b16 v[22:23], v43 offset:20992
    s_add_u32 m0, s39, 8192
    s_add_u32 s41, s36, 301056
    v_rcp_f32 v46, v46
    v_mfma_f32_32x32x16_bf16 v[208:223], v[8:11], a[60:63], v[208:223]
    buffer_load_dwordx4 v28, s[12:15], s41 offen lds
    s_waitcnt lgkmcnt(4)
    v_mfma_f32_32x32x16_bf16 v[224:239], v[12:15], a[24:27], v[224:239]
    ds_read_b64_tr_b16 v[8:9], v40 offset:61440
    ds_read_b64_tr_b16 v[10:11], v40 offset:61952
    v_rcp_f32 v47, v47
    v_rcp_f32 v48, v48
    v_mfma_f32_32x32x16_bf16 v[240:255], v[12:15], a[28:31], v[240:255]
    v_rcp_f32 v49, v49
    v_rcp_f32 v50, v50
    v_rcp_f32 v51, v51
    s_waitcnt lgkmcnt(4)
    v_mfma_f32_32x32x16_bf16 v[128:143], v[16:19], v[88:91], v[128:143]
    ds_read_b64_tr_b16 v[12:13], v25 offset:32768
    ds_read_b64_tr_b16 v[14:15], v25 offset:33280
    v_mul_f32 v44, v44, v116
    v_mul_f32 v45, v45, v117
    v_mul_f32 v46, v46, v118
    v_mul_f32 v47, v47, v119
    v_mul_f32 v48, v48, v124
    v_mfma_f32_32x32x16_bf16 v[144:159], v[16:19], v[92:95], v[144:159]
    v_mul_f32 v49, v49, v125
    v_mul_f32 v50, v50, v126
    v_mul_f32 v51, v51, v127
    v_cvt_pk_bf16_f32 v56, v44, v45
    v_cvt_pk_bf16_f32 v57, v46, v47
    v_cvt_pk_bf16_f32 v58, v48, v49
    s_waitcnt lgkmcnt(4)
    v_mfma_f32_32x32x16_bf16 v[160:175], v[20:23], a[248:251], v[160:175]
    ds_read_b64_tr_b16 v[16:17], v42 offset:28672
    ds_read_b64_tr_b16 v[18:19], v42 offset:29184
    v_cvt_pk_bf16_f32 v59, v50, v51
    s_add_u32 s42, s37, 357376
    v_mfma_f32_32x32x16_bf16 v[176:191], v[20:23], a[252:255], v[176:191]
    buffer_store_dwordx4 v[56:59], v39, s[16:19], s42 offen sc0 sc1
    s_waitcnt lgkmcnt(4)
    v_mfma_f32_32x32x16_bf16 v[192:207], v[8:11], a[64:67], v[192:207]
    s_waitcnt vmcnt(14)
    s_barrier
    ds_read_b64_tr_b16 v[20:21], v27 offset:16384
    ds_read_b64_tr_b16 v[22:23], v27 offset:16896
    s_add_u32 m0, s39, 86016
    s_add_u32 s41, s36, 448512
    v_mfma_f32_32x32x16_bf16 v[208:223], v[8:11], a[68:71], v[208:223]
    buffer_load_dwordx4 v28, s[12:15], s41 offen lds
    v_mul_f32 v44, 0xbfb8aa3b, v128
    s_waitcnt lgkmcnt(4)
    v_mfma_f32_32x32x16_bf16 v[224:239], v[12:15], a[32:35], v[224:239]
    ds_read_b64_tr_b16 v[8:9], v40 offset:45056
    ds_read_b64_tr_b16 v[10:11], v40 offset:45568
    v_mul_f32 v45, 0xbfb8aa3b, v129
    v_mul_f32 v46, 0xbfb8aa3b, v130
    v_mul_f32 v47, 0xbfb8aa3b, v131
    v_mul_f32 v48, 0xbfb8aa3b, v136
    v_mul_f32 v49, 0xbfb8aa3b, v137
    v_mfma_f32_32x32x16_bf16 v[240:255], v[12:15], a[36:39], v[240:255]
    v_mul_f32 v50, 0xbfb8aa3b, v138
    v_mul_f32 v51, 0xbfb8aa3b, v139
    v_exp_f32 v44, v44
    v_exp_f32 v45, v45
    s_waitcnt lgkmcnt(4)
    v_mfma_f32_32x32x16_bf16 v[96:111], v[16:19], a[0:3], 0
    ds_read_b64_tr_b16 v[12:13], v25 offset:36864
    ds_read_b64_tr_b16 v[14:15], v25 offset:37376
    v_exp_f32 v46, v46
    v_exp_f32 v47, v47
    v_mfma_f32_32x32x16_bf16 v[112:127], v[16:19], a[4:7], 0
    v_exp_f32 v48, v48
    v_exp_f32 v49, v49
    v_exp_f32 v50, v50
    s_waitcnt lgkmcnt(4)
    v_mfma_f32_32x32x16_bf16 v[160:175], v[20:23], v[64:67], v[160:175]
    ds_read_b64_tr_b16 v[16:17], v26 offset:24576
    ds_read_b64_tr_b16 v[18:19], v26 offset:25088
    v_exp_f32 v51, v51
    v_add_f32 v44, 1.0, v44
    v_add_f32 v45, 1.0, v45
    v_add_f32 v46, 1.0, v46
    v_mfma_f32_32x32x16_bf16 v[176:191], v[20:23], v[68:71], v[176:191]
    v_add_f32 v47, 1.0, v47
    v_add_f32 v48, 1.0, v48
    v_add_f32 v49, 1.0, v49
    v_add_f32 v50, 1.0, v50
    v_add_f32 v51, 1.0, v51
    s_waitcnt lgkmcnt(4)
    v_mfma_f32_32x32x16_bf16 v[192:207], v[8:11], a[72:75], v[192:207]
    ds_read_b64_tr_b16 v[20:21], v27 offset:20480
    ds_read_b64_tr_b16 v[22:23], v27 offset:20992
    s_add_u32 s35, s35, 1
    s_cmp_eq_u32 s35, 9
    s_cselect_b32 s35, 0, s35
    s_mov_b32 s40, 589824
    s_cselect_b32 s40, 4290248704, s40
    v_mfma_f32_32x32x16_bf16 v[208:223], v[8:11], a[76:79], v[208:223]
    s_add_u32 s36, s36, s40
    s_add_u32 m0, s39, 12288
    s_add_u32 s41, s36, 6144
    v_rcp_f32 v44, v44
    s_waitcnt lgkmcnt(4)
    v_mfma_f32_32x32x16_bf16 v[224:239], v[12:15], a[40:43], v[224:239]
    ds_read_b64_tr_b16 v[8:9], v40 offset:49152
    ds_read_b64_tr_b16 v[10:11], v40 offset:49664
    buffer_load_dwordx4 v28, s[12:15], s41 offen lds
    v_mfma_f32_32x32x16_bf16 v[240:255], v[12:15], a[44:47], v[240:255]
    v_rcp_f32 v45, v45
    v_rcp_f32 v46, v46
    v_rcp_f32 v47, v47
    s_waitcnt lgkmcnt(4)
    v_mfma_f32_32x32x16_bf16 v[96:111], v[16:19], a[8:11], v[96:111]
    ds_read_b64_tr_b16 v[12:13], v25 offset:40960
    ds_read_b64_tr_b16 v[14:15], v25 offset:41472
    v_rcp_f32 v48, v48
    v_rcp_f32 v49, v49
    v_mfma_f32_32x32x16_bf16 v[112:127], v[16:19], a[12:15], v[112:127]
    v_rcp_f32 v50, v50
    v_rcp_f32 v51, v51
    v_mul_f32 v44, v44, v132
    v_mul_f32 v45, v45, v133
    s_waitcnt lgkmcnt(4)
    v_mfma_f32_32x32x16_bf16 v[160:175], v[20:23], v[72:75], v[160:175]
    ds_read_b64_tr_b16 v[16:17], v26 offset:28672
    ds_read_b64_tr_b16 v[18:19], v26 offset:29184
    v_mul_f32 v46, v46, v134
    v_mul_f32 v47, v47, v135
    v_mul_f32 v48, v48, v140
    v_mul_f32 v49, v49, v141
    v_mul_f32 v50, v50, v142
    v_mfma_f32_32x32x16_bf16 v[176:191], v[20:23], v[76:79], v[176:191]
    v_mul_f32 v51, v51, v143
    v_cvt_pk_bf16_f32 v52, v44, v45
    v_cvt_pk_bf16_f32 v53, v46, v47
    v_cvt_pk_bf16_f32 v54, v48, v49
    v_cvt_pk_bf16_f32 v55, v50, v51
    s_add_u32 s42, s37, 26624
    s_waitcnt lgkmcnt(4)
    v_mfma_f32_32x32x16_bf16 v[192:207], v[8:11], a[80:83], v[192:207]
    ds_read_b64_tr_b16 v[20:21], v27 offset:53248
    ds_read_b64_tr_b16 v[22:23], v27 offset:53760
    buffer_store_dwordx4 v[52:55], v39, s[16:19], s42 offen sc0 sc1
    v_mfma_f32_32x32x16_bf16 v[208:223], v[8:11], a[84:87], v[208:223]
    s_add_u32 m0, s39, 45056
    s_add_u32 s41, s36, 153600
    v_mul_f32 v44, 0xbfb8aa3b, v144
    v_mul_f32 v45, 0xbfb8aa3b, v145
    v_mul_f32 v46, 0xbfb8aa3b, v146
    v_mul_f32 v47, 0xbfb8aa3b, v147
    s_waitcnt lgkmcnt(4)
    v_mfma_f32_32x32x16_bf16 v[224:239], v[12:15], a[48:51], v[224:239]
    ds_read_b64_tr_b16 v[8:9], v40 offset:53248
    ds_read_b64_tr_b16 v[10:11], v40 offset:53760
    buffer_load_dwordx4 v28, s[12:15], s41 offen lds
    v_mfma_f32_32x32x16_bf16 v[240:255], v[12:15], a[52:55], v[240:255]
    v_mul_f32 v48, 0xbfb8aa3b, v152
    v_mul_f32 v49, 0xbfb8aa3b, v153
    v_mul_f32 v50, 0xbfb8aa3b, v154
    v_mul_f32 v51, 0xbfb8aa3b, v155
    v_exp_f32 v44, v44
    s_waitcnt lgkmcnt(4)
    v_mfma_f32_32x32x16_bf16 v[96:111], v[16:19], a[16:19], v[96:111]
    ds_read_b64_tr_b16 v[12:13], v41 offset:57344
    ds_read_b64_tr_b16 v[14:15], v41 offset:57856
    v_exp_f32 v45, v45
    v_exp_f32 v46, v46
    v_mfma_f32_32x32x16_bf16 v[112:127], v[16:19], a[20:23], v[112:127]
    v_exp_f32 v47, v47
    v_exp_f32 v48, v48
    v_exp_f32 v49, v49
    s_waitcnt lgkmcnt(4)
    v_mfma_f32_32x32x16_bf16 v[160:175], v[20:23], v[80:83], v[160:175]
    ds_read_b64_tr_b16 v[16:17], v26 offset:61440
    ds_read_b64_tr_b16 v[18:19], v26 offset:61952
    v_exp_f32 v50, v50
    v_exp_f32 v51, v51
    v_add_f32 v44, 1.0, v44
    v_mfma_f32_32x32x16_bf16 v[176:191], v[20:23], v[84:87], v[176:191]
    v_add_f32 v45, 1.0, v45
    v_add_f32 v46, 1.0, v46
    v_add_f32 v47, 1.0, v47
    v_add_f32 v48, 1.0, v48
    v_add_f32 v49, 1.0, v49
    v_add_f32 v50, 1.0, v50
    s_waitcnt lgkmcnt(4)
    v_mfma_f32_32x32x16_bf16 v[192:207], v[8:11], a[88:91], v[192:207]
    ds_read_b64_tr_b16 v[20:21], v43 offset:24576
    ds_read_b64_tr_b16 v[22:23], v43 offset:25088
    s_add_u32 m0, s39, 49152
    s_add_u32 s41, s36, 301056
    v_add_f32 v51, 1.0, v51
    v_rcp_f32 v44, v44
    v_mfma_f32_32x32x16_bf16 v[208:223], v[8:11], a[92:95], v[208:223]
    buffer_load_dwordx4 v28, s[12:15], s41 offen lds
    s_waitcnt lgkmcnt(4)
    v_mfma_f32_32x32x16_bf16 v[224:239], v[12:15], a[56:59], v[224:239]
    ds_read_b64_tr_b16 v[8:9], v40 offset:32768
    ds_read_b64_tr_b16 v[10:11], v40 offset:33280
    v_rcp_f32 v45, v45
    v_rcp_f32 v46, v46
    v_mfma_f32_32x32x16_bf16 v[240:255], v[12:15], a[60:63], v[240:255]
    v_rcp_f32 v47, v47
    v_rcp_f32 v48, v48
    v_rcp_f32 v49, v49
    s_waitcnt lgkmcnt(4)
    v_mfma_f32_32x32x16_bf16 v[96:111], v[16:19], a[24:27], v[96:111]
    ds_read_b64_tr_b16 v[12:13], v41 offset:61440
    ds_read_b64_tr_b16 v[14:15], v41 offset:61952
    v_rcp_f32 v50, v50
    v_rcp_f32 v51, v51
    v_mul_f32 v44, v44, v148
    v_mfma_f32_32x32x16_bf16 v[112:127], v[16:19], a[28:31], v[112:127]
    v_mul_f32 v45, v45, v149
    v_mul_f32 v46, v46, v150
    v_mul_f32 v47, v47, v151
    v_mul_f32 v48, v48, v156
    v_mul_f32 v49, v49, v157
    v_mul_f32 v50, v50, v158
    s_waitcnt lgkmcnt(4)
    v_mfma_f32_32x32x16_bf16 v[160:175], v[20:23], v[88:91], v[160:175]
    ds_read_b64_tr_b16 v[16:17], v26 offset:32768
    ds_read_b64_tr_b16 v[18:19], v26 offset:33280
    v_mul_f32 v51, v51, v159
    v_cvt_pk_bf16_f32 v56, v44, v45
    v_cvt_pk_bf16_f32 v57, v46, v47
    v_cvt_pk_bf16_f32 v58, v48, v49
    v_cvt_pk_bf16_f32 v59, v50, v51
    v_mfma_f32_32x32x16_bf16 v[176:191], v[20:23], v[92:95], v[176:191]
    s_add_u32 s42, s37, 358400
    buffer_store_dwordx4 v[56:59], v39, s[16:19], s42 offen sc0 sc1
    s_waitcnt lgkmcnt(4)
    v_mfma_f32_32x32x16_bf16 v[192:207], v[8:11], a[96:99], v[192:207]
    s_waitcnt vmcnt(16)
    s_barrier
    ds_read_b64_tr_b16 v[20:21], v43 offset:28672
    ds_read_b64_tr_b16 v[22:23], v43 offset:29184
    s_add_u32 m0, s39, 16384
    s_add_u32 s41, s36, 448512
    v_mfma_f32_32x32x16_bf16 v[208:223], v[8:11], a[100:103], v[208:223]
    buffer_load_dwordx4 v28, s[12:15], s41 offen lds
    s_waitcnt lgkmcnt(4)
    v_mfma_f32_32x32x16_bf16 v[224:239], v[12:15], a[64:67], v[224:239]
    ds_read_b64_tr_b16 v[8:9], v40 offset:36864
    ds_read_b64_tr_b16 v[10:11], v40 offset:37376
    v_mul_f32 v44, 0xbfb8aa3b, v160
    v_mul_f32 v45, 0xbfb8aa3b, v161
    v_mul_f32 v46, 0xbfb8aa3b, v162
    v_mul_f32 v47, 0xbfb8aa3b, v163
    v_mul_f32 v48, 0xbfb8aa3b, v168
    v_mfma_f32_32x32x16_bf16 v[240:255], v[12:15], a[68:71], v[240:255]
    v_mul_f32 v49, 0xbfb8aa3b, v169
    v_mul_f32 v50, 0xbfb8aa3b, v170
    v_mul_f32 v51, 0xbfb8aa3b, v171
    v_exp_f32 v44, v44
    s_waitcnt lgkmcnt(4)
    v_mfma_f32_32x32x16_bf16 v[96:111], v[16:19], a[32:35], v[96:111]
    ds_read_b64_tr_b16 v[12:13], v41 offset:45056
    ds_read_b64_tr_b16 v[14:15], v41 offset:45568
    v_exp_f32 v45, v45
    v_exp_f32 v46, v46
    v_mfma_f32_32x32x16_bf16 v[112:127], v[16:19], a[36:39], v[112:127]
    v_exp_f32 v47, v47
    v_exp_f32 v48, v48
    v_exp_f32 v49, v49
    s_waitcnt lgkmcnt(4)
    v_mfma_f32_32x32x16_bf16 v[128:143], v[20:23], a[0:3], 0
    ds_read_b64_tr_b16 v[16:17], v26 offset:36864
    ds_read_b64_tr_b16 v[18:19], v26 offset:37376
    v_exp_f32 v50, v50
    v_exp_f32 v51, v51
    v_add_f32 v44, 1.0, v44
    v_mfma_f32_32x32x16_bf16 v[144:159], v[20:23], a[4:7], 0
    v_add_f32 v45, 1.0, v45
    v_add_f32 v46, 1.0, v46
    v_add_f32 v47, 1.0, v47
    v_add_f32 v48, 1.0, v48
    v_add_f32 v49, 1.0, v49
    v_add_f32 v50, 1.0, v50
    s_waitcnt lgkmcnt(4)
    v_mfma_f32_32x32x16_bf16 v[192:207], v[8:11], a[104:107], v[192:207]
    ds_read_b64_tr_b16 v[20:21], v27 offset:24576
    ds_read_b64_tr_b16 v[22:23], v27 offset:25088
    s_add_u32 s35, s35, 1
    s_cmp_eq_u32 s35, 9
    s_cselect_b32 s35, 0, s35
    s_mov_b32 s40, 589824
    s_cselect_b32 s40, 4290248704, s40
    v_mfma_f32_32x32x16_bf16 v[208:223], v[8:11], a[108:111], v[208:223]
    s_add_u32 s36, s36, s40
    s_add_u32 m0, s39, 20480
    s_add_u32 s41, s36, 6144
    v_add_f32 v51, 1.0, v51
    v_rcp_f32 v44, v44
    s_waitcnt lgkmcnt(4)
    v_mfma_f32_32x32x16_bf16 v[224:239], v[12:15], a[72:75], v[224:239]
    ds_read_b64_tr_b16 v[8:9], v40 offset:40960
    ds_read_b64_tr_b16 v[10:11], v40 offset:41472
    buffer_load_dwordx4 v28, s[12:15], s41 offen lds
    v_mfma_f32_32x32x16_bf16 v[240:255], v[12:15], a[76:79], v[240:255]
    v_rcp_f32 v45, v45
    v_rcp_f32 v46, v46
    v_rcp_f32 v47, v47
    s_waitcnt lgkmcnt(4)
    v_mfma_f32_32x32x16_bf16 v[96:111], v[16:19], a[40:43], v[96:111]
    ds_read_b64_tr_b16 v[12:13], v41 offset:49152
    ds_read_b64_tr_b16 v[14:15], v41 offset:49664
    v_rcp_f32 v48, v48
    v_rcp_f32 v49, v49
    v_mfma_f32_32x32x16_bf16 v[112:127], v[16:19], a[44:47], v[112:127]
    v_rcp_f32 v50, v50
    v_rcp_f32 v51, v51
    v_mul_f32 v44, v44, v164
    v_mul_f32 v45, v45, v165
    s_waitcnt lgkmcnt(4)
    v_mfma_f32_32x32x16_bf16 v[128:143], v[20:23], a[8:11], v[128:143]
    ds_read_b64_tr_b16 v[16:17], v26 offset:40960
    ds_read_b64_tr_b16 v[18:19], v26 offset:41472
    v_mul_f32 v46, v46, v166
    v_mul_f32 v47, v47, v167
    v_mul_f32 v48, v48, v172
    v_mul_f32 v49, v49, v173
    v_mul_f32 v50, v50, v174
    v_mfma_f32_32x32x16_bf16 v[144:159], v[20:23], a[12:15], v[144:159]
    v_mul_f32 v51, v51, v175
    v_cvt_pk_bf16_f32 v52, v44, v45
    v_cvt_pk_bf16_f32 v53, v46, v47
    v_cvt_pk_bf16_f32 v54, v48, v49
    v_cvt_pk_bf16_f32 v55, v50, v51
    s_add_u32 s42, s37, 27648
    s_waitcnt lgkmcnt(4)
    v_mfma_f32_32x32x16_bf16 v[192:207], v[8:11], a[112:115], v[192:207]
    ds_read_b64_tr_b16 v[20:21], v27 offset:28672
    ds_read_b64_tr_b16 v[22:23], v27 offset:29184
    buffer_store_dwordx4 v[52:55], v39, s[16:19], s42 offen sc0 sc1
    v_mfma_f32_32x32x16_bf16 v[208:223], v[8:11], a[116:119], v[208:223]
    s_add_u32 m0, s39, 53248
    s_add_u32 s41, s36, 153600
    v_mul_f32 v44, 0xbfb8aa3b, v176
    v_mul_f32 v45, 0xbfb8aa3b, v177
    v_mul_f32 v46, 0xbfb8aa3b, v178
    v_mul_f32 v47, 0xbfb8aa3b, v179
    s_waitcnt lgkmcnt(4)
    v_mfma_f32_32x32x16_bf16 v[224:239], v[12:15], a[80:83], v[224:239]
    ds_read_b64_tr_b16 v[8:9], v40 offset:0
    ds_read_b64_tr_b16 v[10:11], v40 offset:512
    buffer_load_dwordx4 v28, s[12:15], s41 offen lds
    v_mfma_f32_32x32x16_bf16 v[240:255], v[12:15], a[84:87], v[240:255]
    v_mul_f32 v48, 0xbfb8aa3b, v184
    v_mul_f32 v49, 0xbfb8aa3b, v185
    v_mul_f32 v50, 0xbfb8aa3b, v186
    v_mul_f32 v51, 0xbfb8aa3b, v187
    v_exp_f32 v44, v44
    s_waitcnt lgkmcnt(4)
    v_mfma_f32_32x32x16_bf16 v[96:111], v[16:19], a[48:51], v[96:111]
    ds_read_b64_tr_b16 v[12:13], v41 offset:53248
    ds_read_b64_tr_b16 v[14:15], v41 offset:53760
    v_exp_f32 v45, v45
    v_exp_f32 v46, v46
    v_mfma_f32_32x32x16_bf16 v[112:127], v[16:19], a[52:55], v[112:127]
    v_exp_f32 v47, v47
    v_exp_f32 v48, v48
    v_exp_f32 v49, v49
    s_waitcnt lgkmcnt(4)
    v_mfma_f32_32x32x16_bf16 v[128:143], v[20:23], a[16:19], v[128:143]
    ds_read_b64_tr_b16 v[16:17], v42 offset:57344
    ds_read_b64_tr_b16 v[18:19], v42 offset:57856
    v_exp_f32 v50, v50
    v_exp_f32 v51, v51
    v_add_f32 v44, 1.0, v44
    v_mfma_f32_32x32x16_bf16 v[144:159], v[20:23], a[20:23], v[144:159]
    v_add_f32 v45, 1.0, v45
    v_add_f32 v46, 1.0, v46
    v_add_f32 v47, 1.0, v47
    v_add_f32 v48, 1.0, v48
    v_add_f32 v49, 1.0, v49
    v_add_f32 v50, 1.0, v50
    s_waitcnt lgkmcnt(4)
    v_mfma_f32_32x32x16_bf16 v[192:207], v[8:11], a[120:123], v[192:207]
    ds_read_b64_tr_b16 v[20:21], v27 offset:61440
    ds_read_b64_tr_b16 v[22:23], v27 offset:61952
    s_add_u32 m0, s39, 57344
    s_add_u32 s41, s36, 301056
    v_add_f32 v51, 1.0, v51
    v_rcp_f32 v44, v44
    v_mfma_f32_32x32x16_bf16 v[208:223], v[8:11], a[124:127], v[208:223]
    buffer_load_dwordx4 v28, s[12:15], s41 offen lds
    s_waitcnt lgkmcnt(4)
    v_mfma_f32_32x32x16_bf16 v[224:239], v[12:15], a[88:91], v[224:239]
    ds_read_b64_tr_b16 v[8:9], v40 offset:4096
    ds_read_b64_tr_b16 v[10:11], v40 offset:4608
    v_rcp_f32 v45, v45
    v_rcp_f32 v46, v46
    v_mfma_f32_32x32x16_bf16 v[240:255], v[12:15], a[92:95], v[240:255]
    v_rcp_f32 v47, v47
    v_rcp_f32 v48, v48
    v_rcp_f32 v49, v49
    s_waitcnt lgkmcnt(4)
    v_mfma_f32_32x32x16_bf16 v[96:111], v[16:19], a[56:59], v[96:111]
    ds_read_b64_tr_b16 v[12:13], v41 offset:32768
    ds_read_b64_tr_b16 v[14:15], v41 offset:33280
    v_rcp_f32 v50, v50
    v_rcp_f32 v51, v51
    v_mul_f32 v44, v44, v180
    v_mfma_f32_32x32x16_bf16 v[112:127], v[16:19], a[60:63], v[112:127]
    v_mul_f32 v45, v45, v181
    v_mul_f32 v46, v46, v182
    v_mul_f32 v47, v47, v183
    v_mul_f32 v48, v48, v188
    v_mul_f32 v49, v49, v189
    v_mul_f32 v50, v50, v190
    s_waitcnt lgkmcnt(4)
    v_mfma_f32_32x32x16_bf16 v[128:143], v[20:23], a[24:27], v[128:143]
    ds_read_b64_tr_b16 v[16:17], v42 offset:61440
    ds_read_b64_tr_b16 v[18:19], v42 offset:61952
    v_mul_f32 v51, v51, v191
    v_cvt_pk_bf16_f32 v56, v44, v45
    v_cvt_pk_bf16_f32 v57, v46, v47
    v_cvt_pk_bf16_f32 v58, v48, v49
    v_cvt_pk_bf16_f32 v59, v50, v51
    v_mfma_f32_32x32x16_bf16 v[144:159], v[20:23], a[28:31], v[144:159]
    s_add_u32 s42, s37, 359424
    buffer_store_dwordx4 v[56:59], v39, s[16:19], s42 offen sc0 sc1
    s_waitcnt lgkmcnt(4)
    v_mfma_f32_32x32x16_bf16 v[192:207], v[8:11], a[128:131], v[192:207]
    s_waitcnt vmcnt(16)
    s_barrier
    ds_read_b64_tr_b16 v[20:21], v27 offset:32768
    ds_read_b64_tr_b16 v[22:23], v27 offset:33280
    s_add_u32 m0, s39, 61440
    s_add_u32 s41, s36, 448512
    v_mfma_f32_32x32x16_bf16 v[208:223], v[8:11], a[132:135], v[208:223]
    buffer_load_dwordx4 v28, s[12:15], s41 offen lds
    s_add_u32 m0, s38, 147456
    s_waitcnt lgkmcnt(4)
    v_mfma_f32_32x32x16_bf16 v[224:239], v[12:15], a[96:99], v[224:239]
    ds_read_b64_tr_b16 v[8:9], v40 offset:8192
    ds_read_b64_tr_b16 v[10:11], v40 offset:8704
    s_add_u32 s41, s64, 0
    v_mfma_f32_32x32x16_bf16 v[240:255], v[12:15], a[100:103], v[240:255]
    buffer_load_dwordx4 v32, s[60:63], s41 offen offset:0 lds
    s_add_u32 m0, s38, 147456
    s_waitcnt lgkmcnt(4)
    v_mfma_f32_32x32x16_bf16 v[96:111], v[16:19], a[64:67], v[96:111]
    ds_read_b64_tr_b16 v[12:13], v41 offset:36864
    ds_read_b64_tr_b16 v[14:15], v41 offset:37376
    s_add_u32 s41, s64, 0
    v_mfma_f32_32x32x16_bf16 v[112:127], v[16:19], a[68:71], v[112:127]
    buffer_load_dwordx4 v33, s[60:63], s41 offen offset:1024 lds
    s_add_u32 m0, s38, 147456
    s_waitcnt lgkmcnt(4)
    v_mfma_f32_32x32x16_bf16 v[128:143], v[20:23], a[32:35], v[128:143]
    ds_read_b64_tr_b16 v[16:17], v42 offset:45056
    ds_read_b64_tr_b16 v[18:19], v42 offset:45568
    s_add_u32 s41, s64, 0
    v_mfma_f32_32x32x16_bf16 v[144:159], v[20:23], a[36:39], v[144:159]
    buffer_load_dwordx4 v34, s[60:63], s41 offen offset:2048 lds
    s_waitcnt lgkmcnt(4)
    v_mfma_f32_32x32x16_bf16 v[192:207], v[8:11], a[136:139], v[192:207]
    ds_read_b64_tr_b16 v[20:21], v27 offset:36864
    ds_read_b64_tr_b16 v[22:23], v27 offset:37376
    s_add_u32 s35, s35, 1
    s_cmp_eq_u32 s35, 9
    s_cselect_b32 s35, 0, s35
    s_mov_b32 s40, 589824
    s_cselect_b32 s40, 4290248704, s40
    v_mfma_f32_32x32x16_bf16 v[208:223], v[8:11], a[140:143], v[208:223]
    s_add_u32 s36, s36, s40
    s_add_u32 m0, s39, 24576
    s_add_u32 s41, s36, 6144
    s_waitcnt lgkmcnt(4)
    v_mfma_f32_32x32x16_bf16 v[224:239], v[12:15], a[104:107], v[224:239]
    ds_read_b64_tr_b16 v[8:9], v40 offset:12288
    ds_read_b64_tr_b16 v[10:11], v40 offset:12800
    buffer_load_dwordx4 v28, s[12:15], s41 offen lds
    v_mfma_f32_32x32x16_bf16 v[240:255], v[12:15], a[108:111], v[240:255]
    s_waitcnt lgkmcnt(4)
    v_mfma_f32_32x32x16_bf16 v[96:111], v[16:19], a[72:75], v[96:111]
    ds_read_b64_tr_b16 v[12:13], v41 offset:40960
    ds_read_b64_tr_b16 v[14:15], v41 offset:41472
    v_mfma_f32_32x32x16_bf16 v[112:127], v[16:19], a[76:79], v[112:127]
    s_waitcnt lgkmcnt(4)
    v_mfma_f32_32x32x16_bf16 v[128:143], v[20:23], a[40:43], v[128:143]
    ds_read_b64_tr_b16 v[16:17], v42 offset:49152
    ds_read_b64_tr_b16 v[18:19], v42 offset:49664
    v_mfma_f32_32x32x16_bf16 v[144:159], v[20:23], a[44:47], v[144:159]
    s_waitcnt lgkmcnt(4)
    v_mfma_f32_32x32x16_bf16 v[192:207], v[8:11], a[144:147], v[192:207]
    ds_read_b64_tr_b16 v[20:21], v27 offset:40960
    ds_read_b64_tr_b16 v[22:23], v27 offset:41472
    s_add_u32 m0, s39, 28672
    s_add_u32 s41, s36, 153600
    v_mfma_f32_32x32x16_bf16 v[208:223], v[8:11], a[148:151], v[208:223]
    buffer_load_dwordx4 v28, s[12:15], s41 offen lds
    v_and_b32 v62, 15, v0
    s_waitcnt lgkmcnt(4)
    v_mfma_f32_32x32x16_bf16 v[224:239], v[12:15], a[112:115], v[224:239]
    ds_read_b64_tr_b16 v[8:9], v40 offset:16384
    ds_read_b64_tr_b16 v[10:11], v40 offset:16896
    v_lshlrev_b32 v62, 2, v62
    v_mfma_f32_32x32x16_bf16 v[240:255], v[12:15], a[116:119], v[240:255]
    buffer_load_dword v63, v62, s[16:19], s48 offen offset:64 sc0 sc1
    s_waitcnt lgkmcnt(4)
    v_mfma_f32_32x32x16_bf16 v[96:111], v[16:19], a[80:83], v[96:111]
    ds_read_b64_tr_b16 v[12:13], v41 offset:0
    ds_read_b64_tr_b16 v[14:15], v41 offset:512
    v_mfma_f32_32x32x16_bf16 v[112:127], v[16:19], a[84:87], v[112:127]
    s_waitcnt lgkmcnt(4)
    v_mfma_f32_32x32x16_bf16 v[128:143], v[20:23], a[48:51], v[128:143]
    ds_read_b64_tr_b16 v[16:17], v42 offset:53248
    ds_read_b64_tr_b16 v[18:19], v42 offset:53760
    v_mfma_f32_32x32x16_bf16 v[144:159], v[20:23], a[52:55], v[144:159]
    s_waitcnt lgkmcnt(4)
    v_mfma_f32_32x32x16_bf16 v[192:207], v[8:11], a[152:155], v[192:207]
    ds_read_b64_tr_b16 v[20:21], v43 offset:57344
    ds_read_b64_tr_b16 v[22:23], v43 offset:57856
    v_mfma_f32_32x32x16_bf16 v[208:223], v[8:11], a[156:159], v[208:223]
    s_waitcnt lgkmcnt(4)
    v_mfma_f32_32x32x16_bf16 v[224:239], v[12:15], a[120:123], v[224:239]
    ds_read_b64_tr_b16 v[8:9], v24 offset:0
    ds_read_b64_tr_b16 v[10:11], v24 offset:512
    v_mfma_f32_32x32x16_bf16 v[240:255], v[12:15], a[124:127], v[240:255]
    s_waitcnt lgkmcnt(4)
    v_mfma_f32_32x32x16_bf16 v[96:111], v[16:19], a[88:91], v[96:111]
    ds_read_b64_tr_b16 v[12:13], v41 offset:4096
    ds_read_b64_tr_b16 v[14:15], v41 offset:4608
    v_mfma_f32_32x32x16_bf16 v[112:127], v[16:19], a[92:95], v[112:127]
    s_waitcnt lgkmcnt(4)
    v_mfma_f32_32x32x16_bf16 v[128:143], v[20:23], a[56:59], v[128:143]
    ds_read_b64_tr_b16 v[16:17], v42 offset:32768
    ds_read_b64_tr_b16 v[18:19], v42 offset:33280
    v_mfma_f32_32x32x16_bf16 v[144:159], v[20:23], a[60:63], v[144:159]
    s_waitcnt lgkmcnt(4)
    v_mfma_f32_32x32x16_bf16 v[192:207], v[8:11], a[160:163], v[192:207]
    s_waitcnt vmcnt(17)
    s_barrier
    ds_read_b64_tr_b16 v[20:21], v43 offset:61440
    ds_read_b64_tr_b16 v[22:23], v43 offset:61952
    s_add_u32 m0, s39, 32768
    s_add_u32 s41, s36, 301056
    v_mfma_f32_32x32x16_bf16 v[208:223], v[8:11], a[164:167], v[208:223]
    buffer_load_dwordx4 v28, s[12:15], s41 offen lds
    s_add_u32 m0, s39, 36864
    s_waitcnt lgkmcnt(4)
    v_mfma_f32_32x32x16_bf16 v[224:239], v[12:15], a[128:131], v[224:239]
    ds_read_b64_tr_b16 v[8:9], v24 offset:4096
    ds_read_b64_tr_b16 v[10:11], v24 offset:4608
    s_add_u32 s41, s36, 448512
    v_mfma_f32_32x32x16_bf16 v[240:255], v[12:15], a[132:135], v[240:255]
    buffer_load_dwordx4 v28, s[12:15], s41 offen lds
    s_add_u32 m0, s38, 135168
    s_waitcnt lgkmcnt(4)
    v_mfma_f32_32x32x16_bf16 v[96:111], v[16:19], a[96:99], v[96:111]
    ds_read_b64_tr_b16 v[12:13], v41 offset:8192
    ds_read_b64_tr_b16 v[14:15], v41 offset:8704
    s_add_u32 s41, s64, 36864
    v_mfma_f32_32x32x16_bf16 v[112:127], v[16:19], a[100:103], v[112:127]
    buffer_load_dwordx4 v32, s[60:63], s41 offen offset:0 lds
    s_add_u32 m0, s38, 135168
    s_waitcnt lgkmcnt(4)
    v_mfma_f32_32x32x16_bf16 v[128:143], v[20:23], a[64:67], v[128:143]
    ds_read_b64_tr_b16 v[16:17], v42 offset:36864
    ds_read_b64_tr_b16 v[18:19], v42 offset:37376
    s_add_u32 s41, s64, 36864
    v_mfma_f32_32x32x16_bf16 v[144:159], v[20:23], a[68:71], v[144:159]
    buffer_load_dwordx4 v33, s[60:63], s41 offen offset:1024 lds
    s_add_u32 m0, s38, 135168
    s_waitcnt lgkmcnt(4)
    v_mfma_f32_32x32x16_bf16 v[192:207], v[8:11], a[168:171], v[192:207]
    ds_read_b64_tr_b16 v[20:21], v43 offset:45056
    ds_read_b64_tr_b16 v[22:23], v43 offset:45568
    s_add_u32 s41, s64, 36864
    v_mfma_f32_32x32x16_bf16 v[208:223], v[8:11], a[172:175], v[208:223]
    buffer_load_dwordx4 v34, s[60:63], s41 offen offset:2048 lds
    s_waitcnt lgkmcnt(4)
    v_mfma_f32_32x32x16_bf16 v[224:239], v[12:15], a[136:139], v[224:239]
    ds_read_b64_tr_b16 v[8:9], v24 offset:8192
    ds_read_b64_tr_b16 v[10:11], v24 offset:8704
    v_mfma_f32_32x32x16_bf16 v[240:255], v[12:15], a[140:143], v[240:255]
    s_waitcnt lgkmcnt(4)
    v_mfma_f32_32x32x16_bf16 v[96:111], v[16:19], a[104:107], v[96:111]
    ds_read_b64_tr_b16 v[12:13], v41 offset:12288
    ds_read_b64_tr_b16 v[14:15], v41 offset:12800
    v_mfma_f32_32x32x16_bf16 v[112:127], v[16:19], a[108:111], v[112:127]
    s_waitcnt lgkmcnt(4)
    v_mfma_f32_32x32x16_bf16 v[128:143], v[20:23], a[72:75], v[128:143]
    ds_read_b64_tr_b16 v[16:17], v42 offset:40960
    ds_read_b64_tr_b16 v[18:19], v42 offset:41472
    v_mfma_f32_32x32x16_bf16 v[144:159], v[20:23], a[76:79], v[144:159]
    s_waitcnt lgkmcnt(4)
    v_mfma_f32_32x32x16_bf16 v[192:207], v[8:11], a[176:179], v[192:207]
    ds_read_b64_tr_b16 v[20:21], v43 offset:49152
    ds_read_b64_tr_b16 v[22:23], v43 offset:49664
    v_mfma_f32_32x32x16_bf16 v[208:223], v[8:11], a[180:183], v[208:223]
    s_waitcnt lgkmcnt(4)
    v_mfma_f32_32x32x16_bf16 v[224:239], v[12:15], a[144:147], v[224:239]
    ds_read_b64_tr_b16 v[8:9], v40 offset:20480
    ds_read_b64_tr_b16 v[10:11], v40 offset:20992
    v_mfma_f32_32x32x16_bf16 v[240:255], v[12:15], a[148:151], v[240:255]
    s_waitcnt lgkmcnt(4)
    v_mfma_f32_32x32x16_bf16 v[96:111], v[16:19], a[112:115], v[96:111]
    ds_read_b64_tr_b16 v[12:13], v41 offset:16384
    ds_read_b64_tr_b16 v[14:15], v41 offset:16896
    v_mfma_f32_32x32x16_bf16 v[112:127], v[16:19], a[116:119], v[112:127]
    s_waitcnt lgkmcnt(4)
    v_mfma_f32_32x32x16_bf16 v[128:143], v[20:23], a[80:83], v[128:143]
    ds_read_b64_tr_b16 v[16:17], v42 offset:0
    ds_read_b64_tr_b16 v[18:19], v42 offset:512
    v_mfma_f32_32x32x16_bf16 v[144:159], v[20:23], a[84:87], v[144:159]
    s_waitcnt lgkmcnt(4)
    v_mfma_f32_32x32x16_bf16 v[192:207], v[8:11], a[184:187], v[192:207]
    ds_read_b64_tr_b16 v[20:21], v43 offset:53248
    ds_read_b64_tr_b16 v[22:23], v43 offset:53760
    v_mfma_f32_32x32x16_bf16 v[208:223], v[8:11], a[188:191], v[208:223]
    s_waitcnt lgkmcnt(4)
    v_mfma_f32_32x32x16_bf16 v[224:239], v[12:15], a[152:155], v[224:239]
    ds_read_b64_tr_b16 v[8:9], v24 offset:12288
    ds_read_b64_tr_b16 v[10:11], v24 offset:12800
    v_mfma_f32_32x32x16_bf16 v[240:255], v[12:15], a[156:159], v[240:255]
    s_waitcnt lgkmcnt(4)
    v_mfma_f32_32x32x16_bf16 v[96:111], v[16:19], a[120:123], v[96:111]
    ds_read_b64_tr_b16 v[12:13], v25 offset:0
    ds_read_b64_tr_b16 v[14:15], v25 offset:512
    v_mfma_f32_32x32x16_bf16 v[112:127], v[16:19], a[124:127], v[112:127]
    s_waitcnt lgkmcnt(4)
    v_mfma_f32_32x32x16_bf16 v[128:143], v[20:23], a[88:91], v[128:143]
    ds_read_b64_tr_b16 v[16:17], v42 offset:4096
    ds_read_b64_tr_b16 v[18:19], v42 offset:4608
    v_mfma_f32_32x32x16_bf16 v[144:159], v[20:23], a[92:95], v[144:159]
    s_waitcnt lgkmcnt(4)
    v_mfma_f32_32x32x16_bf16 v[192:207], v[8:11], a[192:195], v[192:207]
    s_waitcnt vmcnt(16)
    s_waitcnt vmcnt(12)
    s_barrier
    v_mov_b32 v60, s68
    v_mov_b32 v61, 0
    s_mov_b64 exec, 1
    buffer_store_dword v60, v61, s[16:19], s50 offen offset:32 sc0 sc1
    s_mov_b64 exec, -1
    ds_read_b64_tr_b16 v[20:21], v43 offset:32768
    ds_read_b64_tr_b16 v[22:23], v43 offset:33280
    s_add_u32 m0, s38, 122880
    s_add_u32 s41, s64, 73728
    v_mfma_f32_32x32x16_bf16 v[208:223], v[8:11], a[196:199], v[208:223]
    buffer_load_dwordx4 v32, s[60:63], s41 offen offset:0 lds
    s_add_u32 m0, s38, 122880
    s_waitcnt lgkmcnt(4)
    v_mfma_f32_32x32x16_bf16 v[224:239], v[12:15], a[160:163], v[224:239]
    ds_read_b64_tr_b16 v[8:9], v24 offset:45056
    ds_read_b64_tr_b16 v[10:11], v24 offset:45568
    s_add_u32 s41, s64, 73728
    v_mfma_f32_32x32x16_bf16 v[240:255], v[12:15], a[164:167], v[240:255]
    buffer_load_dwordx4 v33, s[60:63], s41 offen offset:1024 lds
    s_add_u32 m0, s38, 122880
    s_waitcnt lgkmcnt(4)
    v_mfma_f32_32x32x16_bf16 v[96:111], v[16:19], a[128:131], v[96:111]
    ds_read_b64_tr_b16 v[12:13], v25 offset:4096
    ds_read_b64_tr_b16 v[14:15], v25 offset:4608
    s_add_u32 s41, s64, 73728
    v_mfma_f32_32x32x16_bf16 v[112:127], v[16:19], a[132:135], v[112:127]
    buffer_load_dwordx4 v34, s[60:63], s41 offen offset:2048 lds
    s_waitcnt lgkmcnt(4)
    v_mfma_f32_32x32x16_bf16 v[128:143], v[20:23], a[96:99], v[128:143]
    ds_read_b64_tr_b16 v[16:17], v42 offset:8192
    ds_read_b64_tr_b16 v[18:19], v42 offset:8704
    v_mfma_f32_32x32x16_bf16 v[144:159], v[20:23], a[100:103], v[144:159]
    s_waitcnt lgkmcnt(4)
    v_mfma_f32_32x32x16_bf16 v[192:207], v[8:11], a[200:203], v[192:207]
    ds_read_b64_tr_b16 v[20:21], v43 offset:36864
    ds_read_b64_tr_b16 v[22:23], v43 offset:37376
    v_mfma_f32_32x32x16_bf16 v[208:223], v[8:11], a[204:207], v[208:223]
    s_waitcnt lgkmcnt(4)
    v_mfma_f32_32x32x16_bf16 v[224:239], v[12:15], a[168:171], v[224:239]
    ds_read_b64_tr_b16 v[8:9], v24 offset:49152
    ds_read_b64_tr_b16 v[10:11], v24 offset:49664
    v_mfma_f32_32x32x16_bf16 v[240:255], v[12:15], a[172:175], v[240:255]
    s_waitcnt lgkmcnt(4)
    v_mfma_f32_32x32x16_bf16 v[96:111], v[16:19], a[136:139], v[96:111]
    ds_read_b64_tr_b16 v[12:13], v25 offset:8192
    ds_read_b64_tr_b16 v[14:15], v25 offset:8704
    v_mfma_f32_32x32x16_bf16 v[112:127], v[16:19], a[140:143], v[112:127]
    s_waitcnt lgkmcnt(4)
    v_mfma_f32_32x32x16_bf16 v[128:143], v[20:23], a[104:107], v[128:143]
    ds_read_b64_tr_b16 v[16:17], v42 offset:12288
    ds_read_b64_tr_b16 v[18:19], v42 offset:12800
    v_mfma_f32_32x32x16_bf16 v[144:159], v[20:23], a[108:111], v[144:159]
    s_waitcnt lgkmcnt(4)
    v_mfma_f32_32x32x16_bf16 v[192:207], v[8:11], a[208:211], v[192:207]
    ds_read_b64_tr_b16 v[20:21], v43 offset:40960
    ds_read_b64_tr_b16 v[22:23], v43 offset:41472
    v_mfma_f32_32x32x16_bf16 v[208:223], v[8:11], a[212:215], v[208:223]
    s_waitcnt lgkmcnt(4)
    v_mfma_f32_32x32x16_bf16 v[224:239], v[12:15], a[176:179], v[224:239]
    ds_read_b64_tr_b16 v[8:9], v24 offset:16384
    ds_read_b64_tr_b16 v[10:11], v24 offset:16896
    v_mfma_f32_32x32x16_bf16 v[240:255], v[12:15], a[180:183], v[240:255]
    s_waitcnt lgkmcnt(4)
    v_mfma_f32_32x32x16_bf16 v[96:111], v[16:19], a[144:147], v[96:111]
    ds_read_b64_tr_b16 v[12:13], v41 offset:20480
    ds_read_b64_tr_b16 v[14:15], v41 offset:20992
    v_mfma_f32_32x32x16_bf16 v[112:127], v[16:19], a[148:151], v[112:127]
    s_waitcnt lgkmcnt(4)
    v_mfma_f32_32x32x16_bf16 v[128:143], v[20:23], a[112:115], v[128:143]
    ds_read_b64_tr_b16 v[16:17], v42 offset:16384
    ds_read_b64_tr_b16 v[18:19], v42 offset:16896
    v_mfma_f32_32x32x16_bf16 v[144:159], v[20:23], a[116:119], v[144:159]
    s_waitcnt lgkmcnt(4)
    v_mfma_f32_32x32x16_bf16 v[192:207], v[8:11], a[216:219], v[192:207]
    ds_read_b64_tr_b16 v[20:21], v43 offset:0
    ds_read_b64_tr_b16 v[22:23], v43 offset:512
    v_mfma_f32_32x32x16_bf16 v[208:223], v[8:11], a[220:223], v[208:223]
    s_waitcnt lgkmcnt(4)
    v_mfma_f32_32x32x16_bf16 v[224:239], v[12:15], a[184:187], v[224:239]
    ds_read_b64_tr_b16 v[8:9], v24 offset:20480
    ds_read_b64_tr_b16 v[10:11], v24 offset:20992
    v_mfma_f32_32x32x16_bf16 v[240:255], v[12:15], a[188:191], v[240:255]
    s_waitcnt lgkmcnt(4)
    v_mfma_f32_32x32x16_bf16 v[96:111], v[16:19], a[152:155], v[96:111]
    ds_read_b64_tr_b16 v[12:13], v25 offset:12288
    ds_read_b64_tr_b16 v[14:15], v25 offset:12800
    v_mfma_f32_32x32x16_bf16 v[112:127], v[16:19], a[156:159], v[112:127]
    s_waitcnt lgkmcnt(4)
    v_mfma_f32_32x32x16_bf16 v[128:143], v[20:23], a[120:123], v[128:143]
    ds_read_b64_tr_b16 v[16:17], v26 offset:0
    ds_read_b64_tr_b16 v[18:19], v26 offset:512
    v_mfma_f32_32x32x16_bf16 v[144:159], v[20:23], a[124:127], v[144:159]
    s_waitcnt lgkmcnt(4)
    v_mfma_f32_32x32x16_bf16 v[192:207], v[8:11], a[224:227], v[192:207]
    s_waitcnt vmcnt(11)
    s_barrier
    ds_read_b64_tr_b16 v[20:21], v43 offset:4096
    ds_read_b64_tr_b16 v[22:23], v43 offset:4608
    s_add_u32 m0, s38, 110592
    s_add_u32 s41, s64, 110592
    v_mfma_f32_32x32x16_bf16 v[208:223], v[8:11], a[228:231], v[208:223]
    buffer_load_dwordx4 v32, s[60:63], s41 offen offset:0 lds
    s_add_u32 m0, s38, 110592
    s_waitcnt lgkmcnt(4)
    v_mfma_f32_32x32x16_bf16 v[224:239], v[12:15], a[192:195], v[224:239]
    ds_read_b64_tr_b16 v[8:9], v24 offset:53248
    ds_read_b64_tr_b16 v[10:11], v24 offset:53760
    s_add_u32 s41, s64, 110592
    v_mfma_f32_32x32x16_bf16 v[240:255], v[12:15], a[196:199], v[240:255]
    buffer_load_dwordx4 v33, s[60:63], s41 offen offset:1024 lds
    s_add_u32 m0, s38, 110592
    s_waitcnt lgkmcnt(4)
    v_mfma_f32_32x32x16_bf16 v[96:111], v[16:19], a[160:163], v[96:111]
    ds_read_b64_tr_b16 v[12:13], v25 offset:45056
    ds_read_b64_tr_b16 v[14:15], v25 offset:45568
    s_add_u32 s41, s64, 110592
    v_mfma_f32_32x32x16_bf16 v[112:127], v[16:19], a[164:167], v[112:127]
    buffer_load_dwordx4 v34, s[60:63], s41 offen offset:2048 lds
    s_waitcnt lgkmcnt(4)
    v_mfma_f32_32x32x16_bf16 v[128:143], v[20:23], a[128:131], v[128:143]
    ds_read_b64_tr_b16 v[16:17], v26 offset:4096
    ds_read_b64_tr_b16 v[18:19], v26 offset:4608
    v_mfma_f32_32x32x16_bf16 v[144:159], v[20:23], a[132:135], v[144:159]
    s_waitcnt lgkmcnt(4)
    v_mfma_f32_32x32x16_bf16 v[192:207], v[8:11], a[232:235], v[192:207]
    ds_read_b64_tr_b16 v[20:21], v43 offset:8192
    ds_read_b64_tr_b16 v[22:23], v43 offset:8704
    v_mfma_f32_32x32x16_bf16 v[208:223], v[8:11], a[236:239], v[208:223]
    s_waitcnt lgkmcnt(4)
    v_mfma_f32_32x32x16_bf16 v[224:239], v[12:15], a[200:203], v[224:239]
    ds_read_b64_tr_b16 v[8:9], v24 offset:57344
    ds_read_b64_tr_b16 v[10:11], v24 offset:57856
    v_mfma_f32_32x32x16_bf16 v[240:255], v[12:15], a[204:207], v[240:255]
    s_waitcnt lgkmcnt(4)
    v_mfma_f32_32x32x16_bf16 v[96:111], v[16:19], a[168:171], v[96:111]
    ds_read_b64_tr_b16 v[12:13], v25 offset:49152
    ds_read_b64_tr_b16 v[14:15], v25 offset:49664
    v_mfma_f32_32x32x16_bf16 v[112:127], v[16:19], a[172:175], v[112:127]
    s_waitcnt lgkmcnt(4)
    v_mfma_f32_32x32x16_bf16 v[128:143], v[20:23], a[136:139], v[128:143]
    ds_read_b64_tr_b16 v[16:17], v26 offset:8192
    ds_read_b64_tr_b16 v[18:19], v26 offset:8704
    v_mfma_f32_32x32x16_bf16 v[144:159], v[20:23], a[140:143], v[144:159]
    s_waitcnt lgkmcnt(4)
    v_mfma_f32_32x32x16_bf16 v[192:207], v[8:11], a[240:243], v[192:207]
    ds_read_b64_tr_b16 v[20:21], v43 offset:12288
    ds_read_b64_tr_b16 v[22:23], v43 offset:12800
    v_mfma_f32_32x32x16_bf16 v[208:223], v[8:11], a[244:247], v[208:223]
    s_waitcnt lgkmcnt(4)
    v_mfma_f32_32x32x16_bf16 v[224:239], v[12:15], a[208:211], v[224:239]
    ds_read_b64_tr_b16 v[8:9], v24 offset:61440
    ds_read_b64_tr_b16 v[10:11], v24 offset:61952
    v_mfma_f32_32x32x16_bf16 v[240:255], v[12:15], a[212:215], v[240:255]
    s_waitcnt lgkmcnt(4)
    v_mfma_f32_32x32x16_bf16 v[96:111], v[16:19], a[176:179], v[96:111]
    ds_read_b64_tr_b16 v[12:13], v25 offset:16384
    ds_read_b64_tr_b16 v[14:15], v25 offset:16896
    v_mfma_f32_32x32x16_bf16 v[112:127], v[16:19], a[180:183], v[112:127]
    s_waitcnt lgkmcnt(4)
    v_mfma_f32_32x32x16_bf16 v[128:143], v[20:23], a[144:147], v[128:143]
    ds_read_b64_tr_b16 v[16:17], v42 offset:20480
    ds_read_b64_tr_b16 v[18:19], v42 offset:20992
    v_mfma_f32_32x32x16_bf16 v[144:159], v[20:23], a[148:151], v[144:159]
    s_waitcnt lgkmcnt(4)
    v_mfma_f32_32x32x16_bf16 v[192:207], v[8:11], a[248:251], v[192:207]
    ds_read_b64_tr_b16 v[20:21], v43 offset:16384
    ds_read_b64_tr_b16 v[22:23], v43 offset:16896
    v_mfma_f32_32x32x16_bf16 v[208:223], v[8:11], a[252:255], v[208:223]
    s_waitcnt lgkmcnt(4)
    v_mfma_f32_32x32x16_bf16 v[224:239], v[12:15], a[216:219], v[224:239]
    ds_read_b64_tr_b16 v[8:9], v24 offset:24576
    ds_read_b64_tr_b16 v[10:11], v24 offset:25088
    v_mfma_f32_32x32x16_bf16 v[240:255], v[12:15], a[220:223], v[240:255]
    s_waitcnt lgkmcnt(4)
    v_mfma_f32_32x32x16_bf16 v[96:111], v[16:19], a[184:187], v[96:111]
    ds_read_b64_tr_b16 v[12:13], v25 offset:20480
    ds_read_b64_tr_b16 v[14:15], v25 offset:20992
    v_mfma_f32_32x32x16_bf16 v[112:127], v[16:19], a[188:191], v[112:127]
    s_waitcnt lgkmcnt(4)
    v_mfma_f32_32x32x16_bf16 v[128:143], v[20:23], a[152:155], v[128:143]
    ds_read_b64_tr_b16 v[16:17], v26 offset:12288
    ds_read_b64_tr_b16 v[18:19], v26 offset:12800
    v_mfma_f32_32x32x16_bf16 v[144:159], v[20:23], a[156:159], v[144:159]
    s_waitcnt lgkmcnt(4)
    v_mfma_f32_32x32x16_bf16 v[192:207], v[8:11], v[64:67], v[192:207]
    s_waitcnt vmcnt(10)
    s_barrier
    ds_read_b64_tr_b16 v[20:21], v27 offset:0
    ds_read_b64_tr_b16 v[22:23], v27 offset:512
    s_add_u32 m0, s38, 98304
    s_add_u32 s41, s64, 147456
    v_mfma_f32_32x32x16_bf16 v[208:223], v[8:11], v[68:71], v[208:223]
    buffer_load_dwordx4 v32, s[60:63], s41 offen offset:0 lds
    s_add_u32 m0, s38, 98304
    s_waitcnt lgkmcnt(4)
    v_mfma_f32_32x32x16_bf16 v[224:239], v[12:15], a[224:227], v[224:239]
    ds_read_b64_tr_b16 v[8:9], v24 offset:28672
    ds_read_b64_tr_b16 v[10:11], v24 offset:29184
    s_add_u32 s41, s64, 147456
    v_mfma_f32_32x32x16_bf16 v[240:255], v[12:15], a[228:231], v[240:255]
    buffer_load_dwordx4 v33, s[60:63], s41 offen offset:1024 lds
    s_add_u32 m0, s38, 98304
    s_waitcnt lgkmcnt(4)
    v_mfma_f32_32x32x16_bf16 v[96:111], v[16:19], a[192:195], v[96:111]
    ds_read_b64_tr_b16 v[12:13], v25 offset:53248
    ds_read_b64_tr_b16 v[14:15], v25 offset:53760
    s_add_u32 s41, s64, 147456
    v_mfma_f32_32x32x16_bf16 v[112:127], v[16:19], a[196:199], v[112:127]
    buffer_load_dwordx4 v34, s[60:63], s41 offen offset:2048 lds
    s_waitcnt lgkmcnt(4)
    v_mfma_f32_32x32x16_bf16 v[128:143], v[20:23], a[160:163], v[128:143]
    ds_read_b64_tr_b16 v[16:17], v26 offset:45056
    ds_read_b64_tr_b16 v[18:19], v26 offset:45568
    v_mfma_f32_32x32x16_bf16 v[144:159], v[20:23], a[164:167], v[144:159]
    s_mov_b32 s69, 200000
    s_mov_b64 exec, 63
L_FC3951:
    v_cmp_ne_u32 vcc, s68, v63
    s_sub_u32 s69, s69, 1
    s_nop 4
    s_cbranch_vccz L_FC3951_D
    s_cmp_eq_u32 s69, 0
    s_cbranch_scc1 L_FC3951_D
    s_sleep 2
    buffer_load_dword v63, v62, s[16:19], s48 offen offset:64 sc0 sc1
    s_waitcnt vmcnt(0)
    s_branch L_FC3951
L_FC3951_D:
    s_mov_b64 exec, -1
    s_nop 3
    s_waitcnt lgkmcnt(4)
    v_mfma_f32_32x32x16_bf16 v[192:207], v[8:11], v[72:75], v[192:207]
    ds_read_b64_tr_b16 v[20:21], v27 offset:4096
    ds_read_b64_tr_b16 v[22:23], v27 offset:4608
    s_add_u32 s40, s67, 0
    v_mfma_f32_32x32x16_bf16 v[208:223], v[8:11], v[76:79], v[208:223]
    buffer_load_dwordx4 a[0:3], v39, s[16:19], s40 offen offset:0 sc0 sc1
    s_add_u32 s40, s67, 0
    s_waitcnt lgkmcnt(4)
    v_mfma_f32_32x32x16_bf16 v[224:239], v[12:15], a[232:235], v[224:239]
    ds_read_b64_tr_b16 v[8:9], v24 offset:32768
    ds_read_b64_tr_b16 v[10:11], v24 offset:33280
    buffer_load_dwordx4 a[4:7], v39, s[16:19], s40 offen offset:1024 sc0 sc1
    v_mfma_f32_32x32x16_bf16 v[240:255], v[12:15], a[236:239], v[240:255]
    s_add_u32 s40, s67, 2048
    buffer_load_dwordx4 a[8:11], v39, s[16:19], s40 offen offset:0 sc0 sc1
    s_waitcnt lgkmcnt(4)
    v_mfma_f32_32x32x16_bf16 v[96:111], v[16:19], a[200:203], v[96:111]
    ds_read_b64_tr_b16 v[12:13], v25 offset:57344
    ds_read_b64_tr_b16 v[14:15], v25 offset:57856
    s_add_u32 s40, s67, 2048
    v_mfma_f32_32x32x16_bf16 v[112:127], v[16:19], a[204:207], v[112:127]
    buffer_load_dwordx4 a[12:15], v39, s[16:19], s40 offen offset:1024 sc0 sc1
    s_add_u32 s40, s67, 4096
    s_waitcnt lgkmcnt(4)
    v_mfma_f32_32x32x16_bf16 v[128:143], v[20:23], a[168:171], v[128:143]
    ds_read_b64_tr_b16 v[16:17], v26 offset:49152
    ds_read_b64_tr_b16 v[18:19], v26 offset:49664
    buffer_load_dwordx4 a[16:19], v39, s[16:19], s40 offen offset:0 sc0 sc1
    v_mfma_f32_32x32x16_bf16 v[144:159], v[20:23], a[172:175], v[144:159]
    s_add_u32 s40, s67, 4096
    buffer_load_dwordx4 a[20:23], v39, s[16:19], s40 offen offset:1024 sc0 sc1
    s_waitcnt lgkmcnt(4)
    v_mfma_f32_32x32x16_bf16 v[192:207], v[8:11], v[80:83], v[192:207]
    ds_read_b64_tr_b16 v[20:21], v27 offset:8192
    ds_read_b64_tr_b16 v[22:23], v27 offset:8704
    s_add_u32 s40, s67, 6144
    v_mfma_f32_32x32x16_bf16 v[208:223], v[8:11], v[84:87], v[208:223]
    buffer_load_dwordx4 a[24:27], v39, s[16:19], s40 offen offset:0 sc0 sc1
    s_waitcnt lgkmcnt(4)
    v_mfma_f32_32x32x16_bf16 v[224:239], v[12:15], a[240:243], v[224:239]
    ds_read_b64_tr_b16 v[8:9], v24 offset:36864
    ds_read_b64_tr_b16 v[10:11], v24 offset:37376
    s_add_u32 s40, s67, 6144
    v_mfma_f32_32x32x16_bf16 v[240:255], v[12:15], a[244:247], v[240:255]
    buffer_load_dwordx4 a[28:31], v39, s[16:19], s40 offen offset:1024 sc0 sc1
    s_waitcnt lgkmcnt(4)
    v_mfma_f32_32x32x16_bf16 v[96:111], v[16:19], a[208:211], v[96:111]
    ds_read_b64_tr_b16 v[12:13], v25 offset:61440
    ds_read_b64_tr_b16 v[14:15], v25 offset:61952
    v_mfma_f32_32x32x16_bf16 v[112:127], v[16:19], a[212:215], v[112:127]
    s_waitcnt lgkmcnt(4)
    v_mfma_f32_32x32x16_bf16 v[128:143], v[20:23], a[176:179], v[128:143]
    ds_read_b64_tr_b16 v[16:17], v26 offset:16384
    ds_read_b64_tr_b16 v[18:19], v26 offset:16896
    v_mfma_f32_32x32x16_bf16 v[144:159], v[20:23], a[180:183], v[144:159]
    s_waitcnt lgkmcnt(4)
    v_mfma_f32_32x32x16_bf16 v[192:207], v[8:11], v[88:91], v[192:207]
    ds_read_b64_tr_b16 v[20:21], v43 offset:20480
    ds_read_b64_tr_b16 v[22:23], v43 offset:20992
    v_mfma_f32_32x32x16_bf16 v[208:223], v[8:11], v[92:95], v[208:223]
    s_waitcnt lgkmcnt(4)
    v_mfma_f32_32x32x16_bf16 v[224:239], v[12:15], a[248:251], v[224:239]
    ds_read_b64_tr_b16 v[8:9], v25 offset:24576
    ds_read_b64_tr_b16 v[10:11], v25 offset:25088
    v_mfma_f32_32x32x16_bf16 v[240:255], v[12:15], a[252:255], v[240:255]
    s_waitcnt lgkmcnt(4)
    v_mfma_f32_32x32x16_bf16 v[96:111], v[16:19], a[216:219], v[96:111]
    ds_read_b64_tr_b16 v[12:13], v26 offset:20480
    ds_read_b64_tr_b16 v[14:15], v26 offset:20992
    v_mfma_f32_32x32x16_bf16 v[112:127], v[16:19], a[220:223], v[112:127]
    s_waitcnt lgkmcnt(4)
    v_mfma_f32_32x32x16_bf16 v[128:143], v[20:23], a[184:187], v[128:143]
    ds_read_b64_tr_b16 v[16:17], v27 offset:12288
    ds_read_b64_tr_b16 v[18:19], v27 offset:12800
    v_mul_f32 v44, 0xbfb8aa3b, v192
    v_mul_f32 v45, 0xbfb8aa3b, v193
    v_mul_f32 v46, 0xbfb8aa3b, v194
    v_mul_f32 v47, 0xbfb8aa3b, v195
    v_mul_f32 v48, 0xbfb8aa3b, v200
    v_mfma_f32_32x32x16_bf16 v[144:159], v[20:23], a[188:191], v[144:159]
    v_mul_f32 v49, 0xbfb8aa3b, v201
    v_mul_f32 v50, 0xbfb8aa3b, v202
    v_mul_f32 v51, 0xbfb8aa3b, v203
    v_exp_f32 v44, v44
    s_waitcnt lgkmcnt(4)
    v_mfma_f32_32x32x16_bf16 v[224:239], v[8:11], v[64:67], v[224:239]
    s_barrier
    ds_read_b64_tr_b16 v[20:21], v25 offset:28672
    ds_read_b64_tr_b16 v[22:23], v25 offset:29184
    s_add_u32 m0, s38, 86016
    s_add_u32 s41, s64, 184320
    v_mfma_f32_32x32x16_bf16 v[240:255], v[8:11], v[68:71], v[240:255]
    buffer_load_dwordx4 v32, s[60:63], s41 offen offset:0 lds
    s_add_u32 m0, s38, 86016
    s_waitcnt lgkmcnt(4)
    v_mfma_f32_32x32x16_bf16 v[96:111], v[12:15], a[224:227], v[96:111]
    ds_read_b64_tr_b16 v[8:9], v26 offset:53248
    ds_read_b64_tr_b16 v[10:11], v26 offset:53760
    s_add_u32 s41, s64, 184320
    v_exp_f32 v45, v45
    v_exp_f32 v46, v46
    v_mfma_f32_32x32x16_bf16 v[112:127], v[12:15], a[228:231], v[112:127]
    buffer_load_dwordx4 v33, s[60:63], s41 offen offset:1024 lds
    s_add_u32 m0, s38, 86016
    s_waitcnt lgkmcnt(4)
    v_mfma_f32_32x32x16_bf16 v[128:143], v[16:19], a[192:195], v[128:143]
    ds_read_b64_tr_b16 v[12:13], v27 offset:45056
    ds_read_b64_tr_b16 v[14:15], v27 offset:45568
    s_add_u32 s41, s64, 184320
    v_exp_f32 v47, v47
    v_exp_f32 v48, v48
    v_mfma_f32_32x32x16_bf16 v[144:159], v[16:19], a[196:199], v[144:159]
    buffer_load_dwordx4 v34, s[60:63], s41 offen offset:2048 lds
    s_waitcnt lgkmcnt(4)
    v_mfma_f32_32x32x16_bf16 v[224:239], v[20:23], v[72:75], v[224:239]
    ds_read_b64_tr_b16 v[16:17], v25 offset:32768
    ds_read_b64_tr_b16 v[18:19], v25 offset:33280
    v_exp_f32 v49, v49
    v_exp_f32 v50, v50
    v_mfma_f32_32x32x16_bf16 v[240:255], v[20:23], v[76:79], v[240:255]
    v_exp_f32 v51, v51
    v_add_f32 v44, 1.0, v44
    v_add_f32 v45, 1.0, v45
    v_add_f32 v46, 1.0, v46
    v_add_f32 v47, 1.0, v47
    s_waitcnt lgkmcnt(4)
    v_mfma_f32_32x32x16_bf16 v[96:111], v[8:11], a[232:235], v[96:111]
    ds_read_b64_tr_b16 v[20:21], v26 offset:57344
    ds_read_b64_tr_b16 v[22:23], v26 offset:57856
    v_add_f32 v48, 1.0, v48
    v_add_f32 v49, 1.0, v49
    v_add_f32 v50, 1.0, v50
    v_add_f32 v51, 1.0, v51
    v_mfma_f32_32x32x16_bf16 v[112:127], v[8:11], a[236:239], v[112:127]
    v_rcp_f32 v44, v44
    v_rcp_f32 v45, v45
    v_rcp_f32 v46, v46
    s_waitcnt lgkmcnt(4)
    v_mfma_f32_32x32x16_bf16 v[128:143], v[12:15], a[200:203], v[128:143]
    ds_read_b64_tr_b16 v[8:9], v27 offset:49152
    ds_read_b64_tr_b16 v[10:11], v27 offset:49664
    v_rcp_f32 v47, v47
    v_rcp_f32 v48, v48
    v_mfma_f32_32x32x16_bf16 v[144:159], v[12:15], a[204:207], v[144:159]
    v_rcp_f32 v49, v49
    v_rcp_f32 v50, v50
    v_rcp_f32 v51, v51
    s_waitcnt lgkmcnt(4)
    v_mfma_f32_32x32x16_bf16 v[224:239], v[16:19], v[80:83], v[224:239]
    ds_read_b64_tr_b16 v[12:13], v25 offset:36864
    ds_read_b64_tr_b16 v[14:15], v25 offset:37376
    v_mul_f32 v44, v44, v196
    v_mul_f32 v45, v45, v197
    v_mul_f32 v46, v46, v198
    v_mul_f32 v47, v47, v199
    v_mul_f32 v48, v48, v204
    v_mfma_f32_32x32x16_bf16 v[240:255], v[16:19], v[84:87], v[240:255]
    v_mul_f32 v49, v49, v205
    v_mul_f32 v50, v50, v206
    v_mul_f32 v51, v51, v207
    v_cvt_pk_bf16_f32 v52, v44, v45
    v_cvt_pk_bf16_f32 v53, v46, v47
    v_cvt_pk_bf16_f32 v54, v48, v49
    s_waitcnt lgkmcnt(4)
    v_mfma_f32_32x32x16_bf16 v[96:111], v[20:23], a[240:243], v[96:111]
    ds_read_b64_tr_b16 v[16:17], v26 offset:61440
    ds_read_b64_tr_b16 v[18:19], v26 offset:61952
    v_cvt_pk_bf16_f32 v55, v50, v51
    s_add_u32 s42, s37, 49152
    v_mul_f32 v44, 0xbfb8aa3b, v208
    v_mul_f32 v45, 0xbfb8aa3b, v209
    v_mul_f32 v46, 0xbfb8aa3b, v210
    v_mfma_f32_32x32x16_bf16 v[112:127], v[20:23], a[244:247], v[112:127]
    buffer_store_dwordx4 v[52:55], v39, s[16:19], s42 offen sc0 sc1
    v_mul_f32 v47, 0xbfb8aa3b, v211
    s_waitcnt lgkmcnt(4)
    v_mfma_f32_32x32x16_bf16 v[128:143], v[8:11], a[208:211], v[128:143]
    ds_read_b64_tr_b16 v[20:21], v27 offset:16384
    ds_read_b64_tr_b16 v[22:23], v27 offset:16896
    v_mul_f32 v48, 0xbfb8aa3b, v216
    v_mul_f32 v49, 0xbfb8aa3b, v217
    v_mul_f32 v50, 0xbfb8aa3b, v218
    v_mul_f32 v51, 0xbfb8aa3b, v219
    v_mfma_f32_32x32x16_bf16 v[144:159], v[8:11], a[212:215], v[144:159]
    v_exp_f32 v44, v44
    v_exp_f32 v45, v45
    v_exp_f32 v46, v46
    s_waitcnt lgkmcnt(4)
    v_mfma_f32_32x32x16_bf16 v[224:239], v[12:15], v[88:91], v[224:239]
    ds_read_b64_tr_b16 v[8:9], v26 offset:24576
    ds_read_b64_tr_b16 v[10:11], v26 offset:25088
    v_exp_f32 v47, v47
    v_exp_f32 v48, v48
    v_mfma_f32_32x32x16_bf16 v[240:255], v[12:15], v[92:95], v[240:255]
    v_exp_f32 v49, v49
    v_exp_f32 v50, v50
    v_exp_f32 v51, v51
    s_waitcnt lgkmcnt(4)
    v_mfma_f32_32x32x16_bf16 v[96:111], v[16:19], a[248:251], v[96:111]
    ds_read_b64_tr_b16 v[12:13], v27 offset:20480
    ds_read_b64_tr_b16 v[14:15], v27 offset:20992
    v_add_f32 v44, 1.0, v44
    v_add_f32 v45, 1.0, v45
    v_add_f32 v46, 1.0, v46
    v_add_f32 v47, 1.0, v47
    v_add_f32 v48, 1.0, v48
    v_mfma_f32_32x32x16_bf16 v[112:127], v[16:19], a[252:255], v[112:127]
    v_add_f32 v49, 1.0, v49
    v_add_f32 v50, 1.0, v50
    v_add_f32 v51, 1.0, v51
    v_rcp_f32 v44, v44
    s_waitcnt lgkmcnt(4)
    v_mfma_f32_32x32x16_bf16 v[128:143], v[20:23], a[216:219], v[128:143]
    ds_read_b64_tr_b16 v[16:17], v26 offset:28672
    ds_read_b64_tr_b16 v[18:19], v26 offset:29184
    v_rcp_f32 v45, v45
    v_rcp_f32 v46, v46
    v_mfma_f32_32x32x16_bf16 v[144:159], v[20:23], a[220:223], v[144:159]
    v_rcp_f32 v47, v47
    v_rcp_f32 v48, v48
    v_rcp_f32 v49, v49
    s_waitcnt lgkmcnt(4)
    v_mfma_f32_32x32x16_bf16 v[96:111], v[8:11], v[64:67], v[96:111]
    s_barrier
    ds_read_b64_tr_b16 v[20:21], v27 offset:53248
    ds_read_b64_tr_b16 v[22:23], v27 offset:53760
    v_rcp_f32 v50, v50
    v_mfma_f32_32x32x16_bf16 v[112:127], v[8:11], v[68:71], v[112:127]
    v_rcp_f32 v51, v51
    v_mul_f32 v44, v44, v212
    v_mul_f32 v45, v45, v213
    v_mul_f32 v46, v46, v214
    v_mul_f32 v47, v47, v215
    s_waitcnt lgkmcnt(4)
    v_mfma_f32_32x32x16_bf16 v[128:143], v[12:15], a[224:227], v[128:143]
    ds_read_b64_tr_b16 v[8:9], v26 offset:32768
    ds_read_b64_tr_b16 v[10:11], v26 offset:33280
    v_mul_f32 v48, v48, v220
    v_mul_f32 v49, v49, v221
    v_mul_f32 v50, v50, v222
    v_mul_f32 v51, v51, v223
    v_cvt_pk_bf16_f32 v56, v44, v45
    v_mfma_f32_32x32x16_bf16 v[144:159], v[12:15], a[228:231], v[144:159]
    v_cvt_pk_bf16_f32 v57, v46, v47
    v_cvt_pk_bf16_f32 v58, v48, v49
    v_cvt_pk_bf16_f32 v59, v50, v51
    s_add_u32 s42, s37, 380928
    v_mul_f32 v44, 0xbfb8aa3b, v224
    v_mul_f32 v45, 0xbfb8aa3b, v225
    s_waitcnt lgkmcnt(4)
    v_mfma_f32_32x32x16_bf16 v[96:111], v[16:19], v[72:75], v[96:111]
    ds_read_b64_tr_b16 v[12:13], v27 offset:57344
    ds_read_b64_tr_b16 v[14:15], v27 offset:57856
    buffer_store_dwordx4 v[56:59], v39, s[16:19], s42 offen sc0 sc1
    v_mfma_f32_32x32x16_bf16 v[112:127], v[16:19], v[76:79], v[112:127]
    v_mul_f32 v46, 0xbfb8aa3b, v226
    v_mul_f32 v47, 0xbfb8aa3b, v227
    v_mul_f32 v48, 0xbfb8aa3b, v232
    v_mul_f32 v49, 0xbfb8aa3b, v233
    v_mul_f32 v50, 0xbfb8aa3b, v234
    v_mul_f32 v51, 0xbfb8aa3b, v235
    s_waitcnt lgkmcnt(4)
    v_mfma_f32_32x32x16_bf16 v[128:143], v[20:23], a[232:235], v[128:143]
    ds_read_b64_tr_b16 v[16:17], v26 offset:36864
    ds_read_b64_tr_b16 v[18:19], v26 offset:37376
    v_exp_f32 v44, v44
    v_exp_f32 v45, v45
    v_mfma_f32_32x32x16_bf16 v[144:159], v[20:23], a[236:239], v[144:159]
    v_exp_f32 v46, v46
    v_exp_f32 v47, v47
    v_exp_f32 v48, v48
    s_waitcnt lgkmcnt(4)
    v_mfma_f32_32x32x16_bf16 v[96:111], v[8:11], v[80:83], v[96:111]
    ds_read_b64_tr_b16 v[20:21], v27 offset:61440
    ds_read_b64_tr_b16 v[22:23], v27 offset:61952
    v_exp_f32 v49, v49
    v_exp_f32 v50, v50
    v_mfma_f32_32x32x16_bf16 v[112:127], v[8:11], v[84:87], v[112:127]
    v_exp_f32 v51, v51
    v_add_f32 v44, 1.0, v44
    v_add_f32 v45, 1.0, v45
    v_add_f32 v46, 1.0, v46
    v_add_f32 v47, 1.0, v47
    s_waitcnt lgkmcnt(4)
    v_mfma_f32_32x32x16_bf16 v[128:143], v[12:15], a[240:243], v[128:143]
    ds_read_b64_tr_b16 v[8:9], v27 offset:24576
    ds_read_b64_tr_b16 v[10:11], v27 offset:25088
    v_add_f32 v48, 1.0, v48
    v_add_f32 v49, 1.0, v49
    v_add_f32 v50, 1.0, v50
    v_add_f32 v51, 1.0, v51
    v_mfma_f32_32x32x16_bf16 v[144:159], v[12:15], a[244:247], v[144:159]
    v_rcp_f32 v44, v44
    v_rcp_f32 v45, v45
    v_rcp_f32 v46, v46
    s_waitcnt lgkmcnt(4)
    v_mfma_f32_32x32x16_bf16 v[96:111], v[16:19], v[88:91], v[96:111]
    ds_read_b64_tr_b16 v[12:13], v27 offset:28672
    ds_read_b64_tr_b16 v[14:15], v27 offset:29184
    v_rcp_f32 v47, v47
    v_rcp_f32 v48, v48
    v_mfma_f32_32x32x16_bf16 v[112:127], v[16:19], v[92:95], v[112:127]
    v_rcp_f32 v49, v49
    v_rcp_f32 v50, v50
    v_rcp_f32 v51, v51
    s_waitcnt lgkmcnt(4)
    v_mfma_f32_32x32x16_bf16 v[128:143], v[20:23], a[248:251], v[128:143]
    ds_read_b64_tr_b16 v[16:17], v27 offset:32768
    ds_read_b64_tr_b16 v[18:19], v27 offset:33280
    v_mul_f32 v44, v44, v228
    v_mul_f32 v45, v45, v229
    v_mul_f32 v46, v46, v230
    v_mul_f32 v47, v47, v231
    v_mul_f32 v48, v48, v236
    v_mfma_f32_32x32x16_bf16 v[144:159], v[20:23], a[252:255], v[144:159]
    v_mul_f32 v49, v49, v237
    v_mul_f32 v50, v50, v238
    v_mul_f32 v51, v51, v239
    v_cvt_pk_bf16_f32 v52, v44, v45
    v_cvt_pk_bf16_f32 v53, v46, v47
    v_cvt_pk_bf16_f32 v54, v48, v49
    s_waitcnt lgkmcnt(4)
    v_mfma_f32_32x32x16_bf16 v[128:143], v[8:11], v[64:67], v[128:143]
    s_waitcnt vmcnt(19)
    s_barrier
    ds_read_b64_tr_b16 v[20:21], v27 offset:36864
    ds_read_b64_tr_b16 v[22:23], v27 offset:37376
    v_cvt_pk_bf16_f32 v55, v50, v51
    s_add_u32 s42, s37, 50176
    v_mfma_f32_32x32x16_bf16 v[144:159], v[8:11], v[68:71], v[144:159]
    buffer_store_dwordx4 v[52:55], v39, s[16:19], s42 offen sc0 sc1
    v_mul_f32 v44, 0xbfb8aa3b, v240
    s_waitcnt lgkmcnt(4)
    v_mfma_f32_32x32x16_bf16 v[128:143], v[12:15], v[72:75], v[128:143]
    v_mul_f32 v45, 0xbfb8aa3b, v241
    v_mul_f32 v46, 0xbfb8aa3b, v242
    v_mul_f32 v47, 0xbfb8aa3b, v243
    v_mul_f32 v48, 0xbfb8aa3b, v248
    v_mul_f32 v49, 0xbfb8aa3b, v249
    v_mul_f32 v50, 0xbfb8aa3b, v250
    v_mul_f32 v51, 0xbfb8aa3b, v251
    v_mfma_f32_32x32x16_bf16 v[144:159], v[12:15], v[76:79], v[144:159]
    v_exp_f32 v44, v44
    v_exp_f32 v45, v45
    v_exp_f32 v46, v46
    s_waitcnt lgkmcnt(2)
    v_mfma_f32_32x32x16_bf16 v[128:143], v[16:19], v[80:83], v[128:143]
    v_exp_f32 v47, v47
    v_exp_f32 v48, v48
    v_exp_f32 v49, v49
    v_mfma_f32_32x32x16_bf16 v[144:159], v[16:19], v[84:87], v[144:159]
    v_exp_f32 v50, v50
    v_exp_f32 v51, v51
    v_add_f32 v44, 1.0, v44
    v_add_f32 v45, 1.0, v45
    s_waitcnt lgkmcnt(0)
    v_mfma_f32_32x32x16_bf16 v[128:143], v[20:23], v[88:91], v[128:143]
    v_add_f32 v46, 1.0, v46
    v_add_f32 v47, 1.0, v47
    v_add_f32 v48, 1.0, v48
    v_add_f32 v49, 1.0, v49
    v_add_f32 v50, 1.0, v50
    v_add_f32 v51, 1.0, v51
    v_mfma_f32_32x32x16_bf16 v[144:159], v[20:23], v[92:95], v[144:159]
    v_rcp_f32 v44, v44
    v_rcp_f32 v45, v45
    v_rcp_f32 v46, v46
    v_rcp_f32 v47, v47
    v_rcp_f32 v48, v48
    v_rcp_f32 v49, v49
    v_rcp_f32 v50, v50
    v_rcp_f32 v51, v51
    v_mul_f32 v44, v44, v244
    v_mul_f32 v45, v45, v245
    v_mul_f32 v46, v46, v246
    v_mul_f32 v47, v47, v247
    v_mul_f32 v48, v48, v252
    v_mul_f32 v49, v49, v253
    v_mul_f32 v50, v50, v254
    v_mul_f32 v51, v51, v255
    v_cvt_pk_bf16_f32 v56, v44, v45
    v_cvt_pk_bf16_f32 v57, v46, v47
    v_cvt_pk_bf16_f32 v58, v48, v49
    v_cvt_pk_bf16_f32 v59, v50, v51
    s_add_u32 s42, s37, 381952
    buffer_store_dwordx4 v[56:59], v39, s[16:19], s42 offen sc0 sc1
    ds_read_b64_tr_b16 v[64:65], v31 offset:0
    ds_read_b64_tr_b16 v[66:67], v31 offset:1536
    s_waitcnt vmcnt(14)
    s_waitcnt lgkmcnt(0)
    v_mfma_f32_32x32x16_bf16 v[160:175], v[64:67], a[0:3], 0
    ds_read_b64_tr_b16 v[68:69], v30 offset:0
    ds_read_b64_tr_b16 v[70:71], v30 offset:1536
    ds_read_b64_tr_b16 v[72:73], v31 offset:128
    ds_read_b64_tr_b16 v[74:75], v31 offset:1664
    ds_read_b64_tr_b16 v[76:77], v30 offset:128
    ds_read_b64_tr_b16 v[78:79], v30 offset:1664
    ds_read_b64_tr_b16 v[80:81], v31 offset:256
    ds_read_b64_tr_b16 v[82:83], v31 offset:1792
    ds_read_b64_tr_b16 v[84:85], v30 offset:256
    ds_read_b64_tr_b16 v[86:87], v30 offset:1792
    s_waitcnt lgkmcnt(8)
    v_mfma_f32_32x32x16_bf16 v[176:191], v[68:71], a[0:3], 0
    s_add_u32 s40, s67, 8192
    buffer_load_dwordx4 a[32:35], v39, s[16:19], s40 offen offset:0 sc0 sc1
    s_waitcnt lgkmcnt(4)
    v_mfma_f32_32x32x16_bf16 v[192:207], v[72:75], a[0:3], 0
    ds_read_b64_tr_b16 v[88:89], v31 offset:6144
    ds_read_b64_tr_b16 v[90:91], v31 offset:7680
    ds_read_b64_tr_b16 v[92:93], v30 offset:6144
    ds_read_b64_tr_b16 v[94:95], v30 offset:7680
    v_mul_f32 v44, 0xbfb8aa3b, v96
    v_mul_f32 v45, 0xbfb8aa3b, v97
    v_mul_f32 v46, 0xbfb8aa3b, v98
    v_mfma_f32_32x32x16_bf16 v[208:223], v[76:79], a[0:3], 0
    buffer_load_dwordx4 a[36:39], v39, s[16:19], s40 offen offset:1024 sc0 sc1
    s_add_u32 m0, s38, 73728
    s_waitcnt lgkmcnt(4)
    v_mfma_f32_32x32x16_bf16 v[224:239], v[80:83], a[0:3], 0
    ds_read_b64_tr_b16 v[64:65], v31 offset:6272
    ds_read_b64_tr_b16 v[66:67], v31 offset:7808
    ds_read_b64_tr_b16 v[68:69], v30 offset:6272
    ds_read_b64_tr_b16 v[70:71], v30 offset:7808
    s_add_u32 s41, s64, 221184
    v_mul_f32 v47, 0xbfb8aa3b, v99
    v_mul_f32 v48, 0xbfb8aa3b, v104
    v_mfma_f32_32x32x16_bf16 v[240:255], v[84:87], a[0:3], 0
    buffer_load_dwordx4 v32, s[60:63], s41 offen offset:0 lds
    v_mul_f32 v49, 0xbfb8aa3b, v105
    s_waitcnt vmcnt(16)
    s_waitcnt lgkmcnt(4)
    v_mfma_f32_32x32x16_bf16 v[160:175], v[88:91], a[4:7], v[160:175]
    ds_read_b64_tr_b16 v[72:73], v31 offset:6400
    ds_read_b64_tr_b16 v[74:75], v31 offset:7936
    ds_read_b64_tr_b16 v[76:77], v30 offset:6400
    ds_read_b64_tr_b16 v[78:79], v30 offset:7936
    v_mul_f32 v50, 0xbfb8aa3b, v106
    v_mul_f32 v51, 0xbfb8aa3b, v107
    v_mfma_f32_32x32x16_bf16 v[176:191], v[92:95], a[4:7], v[176:191]
    buffer_load_dwordx4 v33, s[60:63], s41 offen offset:1024 lds
    s_waitcnt lgkmcnt(4)
    v_mfma_f32_32x32x16_bf16 v[192:207], v[64:67], a[4:7], v[192:207]
    ds_read_b64_tr_b16 v[80:81], v37 offset:36864
    ds_read_b64_tr_b16 v[82:83], v37 offset:38400
    ds_read_b64_tr_b16 v[84:85], v38 offset:36864
    ds_read_b64_tr_b16 v[86:87], v38 offset:38400
    v_exp_f32 v44, v44
    v_mfma_f32_32x32x16_bf16 v[208:223], v[68:71], a[4:7], v[208:223]
    buffer_load_dwordx4 v34, s[60:63], s41 offen offset:2048 lds
    s_waitcnt lgkmcnt(4)
    v_mfma_f32_32x32x16_bf16 v[224:239], v[72:75], a[4:7], v[224:239]
    ds_read_b64_tr_b16 v[88:89], v37 offset:36992
    ds_read_b64_tr_b16 v[90:91], v37 offset:38528
    ds_read_b64_tr_b16 v[92:93], v38 offset:36992
    ds_read_b64_tr_b16 v[94:95], v38 offset:38528
    v_exp_f32 v45, v45
    v_mfma_f32_32x32x16_bf16 v[240:255], v[76:79], a[4:7], v[240:255]
    v_exp_f32 v46, v46
    v_exp_f32 v47, v47
    v_exp_f32 v48, v48
    s_waitcnt vmcnt(17)
    s_waitcnt lgkmcnt(4)
    v_mfma_f32_32x32x16_bf16 v[160:175], v[80:83], a[8:11], v[160:175]
    ds_read_b64_tr_b16 v[64:65], v37 offset:37120
    ds_read_b64_tr_b16 v[66:67], v37 offset:38656
    ds_read_b64_tr_b16 v[68:69], v38 offset:37120
    ds_read_b64_tr_b16 v[70:71], v38 offset:38656
    s_add_u32 s40, s67, 10240
    v_exp_f32 v49, v49
    v_mfma_f32_32x32x16_bf16 v[176:191], v[84:87], a[8:11], v[176:191]
    buffer_load_dwordx4 a[0:3], v39, s[16:19], s40 offen offset:0 sc0 sc1
    s_waitcnt lgkmcnt(4)
    v_mfma_f32_32x32x16_bf16 v[192:207], v[88:91], a[8:11], v[192:207]
    ds_read_b64_tr_b16 v[72:73], v37 offset:43008
    ds_read_b64_tr_b16 v[74:75], v37 offset:44544
    ds_read_b64_tr_b16 v[76:77], v38 offset:43008
    ds_read_b64_tr_b16 v[78:79], v38 offset:44544
    v_exp_f32 v50, v50
    v_mfma_f32_32x32x16_bf16 v[208:223], v[92:95], a[8:11], v[208:223]
    buffer_load_dwordx4 a[4:7], v39, s[16:19], s40 offen offset:1024 sc0 sc1
    s_add_u32 m0, s38, 61440
    s_waitcnt lgkmcnt(4)
    v_mfma_f32_32x32x16_bf16 v[224:239], v[64:67], a[8:11], v[224:239]
    ds_read_b64_tr_b16 v[80:81], v37 offset:43136
    ds_read_b64_tr_b16 v[82:83], v37 offset:44672
    ds_read_b64_tr_b16 v[84:85], v38 offset:43136
    ds_read_b64_tr_b16 v[86:87], v38 offset:44672
    s_add_u32 s41, s64, 258048
    v_exp_f32 v51, v51
    v_mfma_f32_32x32x16_bf16 v[240:255], v[68:71], a[8:11], v[240:255]
    buffer_load_dwordx4 v32, s[60:63], s41 offen offset:0 lds
    v_add_f32 v44, 1.0, v44
    s_waitcnt vmcnt(19)
    s_waitcnt lgkmcnt(4)
    v_mfma_f32_32x32x16_bf16 v[160:175], v[72:75], a[12:15], v[160:175]
    ds_read_b64_tr_b16 v[88:89], v37 offset:43264
    ds_read_b64_tr_b16 v[90:91], v37 offset:44800
    ds_read_b64_tr_b16 v[92:93], v38 offset:43264
    ds_read_b64_tr_b16 v[94:95], v38 offset:44800
    v_add_f32 v45, 1.0, v45
    v_add_f32 v46, 1.0, v46
    v_add_f32 v47, 1.0, v47
    v_mfma_f32_32x32x16_bf16 v[176:191], v[76:79], a[12:15], v[176:191]
    buffer_load_dwordx4 v33, s[60:63], s41 offen offset:1024 lds
    v_add_f32 v48, 1.0, v48
    s_waitcnt lgkmcnt(4)
    v_mfma_f32_32x32x16_bf16 v[192:207], v[80:83], a[12:15], v[192:207]
    ds_read_b64_tr_b16 v[64:65], v37 offset:24576
    ds_read_b64_tr_b16 v[66:67], v37 offset:26112
    ds_read_b64_tr_b16 v[68:69], v38 offset:24576
    ds_read_b64_tr_b16 v[70:71], v38 offset:26112
    v_add_f32 v49, 1.0, v49
    v_add_f32 v50, 1.0, v50
    v_add_f32 v51, 1.0, v51
    v_mfma_f32_32x32x16_bf16 v[208:223], v[84:87], a[12:15], v[208:223]
    buffer_load_dwordx4 v34, s[60:63], s41 offen offset:2048 lds
    s_waitcnt lgkmcnt(4)
    v_mfma_f32_32x32x16_bf16 v[224:239], v[88:91], a[12:15], v[224:239]
    ds_read_b64_tr_b16 v[72:73], v37 offset:24704
    ds_read_b64_tr_b16 v[74:75], v37 offset:26240
    ds_read_b64_tr_b16 v[76:77], v38 offset:24704
    ds_read_b64_tr_b16 v[78:79], v38 offset:26240
    v_rcp_f32 v44, v44
    v_mfma_f32_32x32x16_bf16 v[240:255], v[92:95], a[12:15], v[240:255]
    v_rcp_f32 v45, v45
    v_rcp_f32 v46, v46
    v_rcp_f32 v47, v47
    s_waitcnt vmcnt(20)
    s_waitcnt lgkmcnt(4)
    v_mfma_f32_32x32x16_bf16 v[160:175], v[64:67], a[16:19], v[160:175]
    s_barrier
    ds_read_b64_tr_b16 v[80:81], v37 offset:24832
    ds_read_b64_tr_b16 v[82:83], v37 offset:26368
    ds_read_b64_tr_b16 v[84:85], v38 offset:24832
    ds_read_b64_tr_b16 v[86:87], v38 offset:26368
    s_add_u32 s40, s67, 12288
    v_mfma_f32_32x32x16_bf16 v[176:191], v[68:71], a[16:19], v[176:191]
    buffer_load_dwordx4 a[8:11], v39, s[16:19], s40 offen offset:0 sc0 sc1
    s_waitcnt lgkmcnt(4)
    v_mfma_f32_32x32x16_bf16 v[192:207], v[72:75], a[16:19], v[192:207]
    ds_read_b64_tr_b16 v[88:89], v37 offset:30720
    ds_read_b64_tr_b16 v[90:91], v37 offset:32256
    ds_read_b64_tr_b16 v[92:93], v38 offset:30720
    ds_read_b64_tr_b16 v[94:95], v38 offset:32256
    v_rcp_f32 v48, v48
    v_mfma_f32_32x32x16_bf16 v[208:223], v[76:79], a[16:19], v[208:223]
    buffer_load_dwordx4 a[12:15], v39, s[16:19], s40 offen offset:1024 sc0 sc1
    s_add_u32 m0, s38, 49152
    s_waitcnt lgkmcnt(4)
    v_mfma_f32_32x32x16_bf16 v[224:239], v[80:83], a[16:19], v[224:239]
    ds_read_b64_tr_b16 v[64:65], v37 offset:30848
    ds_read_b64_tr_b16 v[66:67], v37 offset:32384
    ds_read_b64_tr_b16 v[68:69], v38 offset:30848
    ds_read_b64_tr_b16 v[70:71], v38 offset:32384
    s_add_u32 s41, s64, 294912
    v_rcp_f32 v49, v49
    v_mfma_f32_32x32x16_bf16 v[240:255], v[84:87], a[16:19], v[240:255]
    buffer_load_dwordx4 v32, s[60:63], s41 offen offset:0 lds
    s_waitcnt vmcnt(22)
    s_waitcnt lgkmcnt(4)
    v_mfma_f32_32x32x16_bf16 v[160:175], v[88:91], a[20:23], v[160:175]
    ds_read_b64_tr_b16 v[72:73], v37 offset:30976
    ds_read_b64_tr_b16 v[74:75], v37 offset:32512
    ds_read_b64_tr_b16 v[76:77], v38 offset:30976
    ds_read_b64_tr_b16 v[78:79], v38 offset:32512
    v_rcp_f32 v50, v50
    v_mfma_f32_32x32x16_bf16 v[176:191], v[92:95], a[20:23], v[176:191]
    buffer_load_dwordx4 v33, s[60:63], s41 offen offset:1024 lds
    s_waitcnt lgkmcnt(4)
    v_mfma_f32_32x32x16_bf16 v[192:207], v[64:67], a[20:23], v[192:207]
    ds_read_b64_tr_b16 v[80:81], v37 offset:12288
    ds_read_b64_tr_b16 v[82:83], v37 offset:13824
    ds_read_b64_tr_b16 v[84:85], v38 offset:12288
    ds_read_b64_tr_b16 v[86:87], v38 offset:13824
    v_rcp_f32 v51, v51
    v_mul_f32 v44, v44, v100
    v_mfma_f32_32x32x16_bf16 v[208:223], v[68:71], a[20:23], v[208:223]
    buffer_load_dwordx4 v34, s[60:63], s41 offen offset:2048 lds
    v_mul_f32 v45, v45, v101
    s_waitcnt lgkmcnt(4)
    v_mfma_f32_32x32x16_bf16 v[224:239], v[72:75], a[20:23], v[224:239]
    ds_read_b64_tr_b16 v[88:89], v37 offset:12416
    ds_read_b64_tr_b16 v[90:91], v37 offset:13952
    ds_read_b64_tr_b16 v[92:93], v38 offset:12416
    ds_read_b64_tr_b16 v[94:95], v38 offset:13952
    v_mul_f32 v46, v46, v102
    v_mul_f32 v47, v47, v103
    v_mul_f32 v48, v48, v108
    v_mfma_f32_32x32x16_bf16 v[240:255], v[76:79], a[20:23], v[240:255]
    v_mul_f32 v49, v49, v109
    v_mul_f32 v50, v50, v110
    v_mul_f32 v51, v51, v111
    v_cvt_pk_bf16_f32 v52, v44, v45
    v_cvt_pk_bf16_f32 v53, v46, v47
    v_cvt_pk_bf16_f32 v54, v48, v49
    s_waitcnt vmcnt(23)
    s_waitcnt lgkmcnt(4)
    v_mfma_f32_32x32x16_bf16 v[160:175], v[80:83], a[24:27], v[160:175]
    ds_read_b64_tr_b16 v[64:65], v37 offset:12544
    ds_read_b64_tr_b16 v[66:67], v37 offset:14080
    ds_read_b64_tr_b16 v[68:69], v38 offset:12544
    ds_read_b64_tr_b16 v[70:71], v38 offset:14080
    s_add_u32 s40, s67, 14336
    v_cvt_pk_bf16_f32 v55, v50, v51
    v_mfma_f32_32x32x16_bf16 v[176:191], v[84:87], a[24:27], v[176:191]
    buffer_load_dwordx4 a[16:19], v39, s[16:19], s40 offen offset:0 sc0 sc1
    s_waitcnt lgkmcnt(4)
    v_mfma_f32_32x32x16_bf16 v[192:207], v[88:91], a[24:27], v[192:207]
    ds_read_b64_tr_b16 v[72:73], v37 offset:18432
    ds_read_b64_tr_b16 v[74:75], v37 offset:19968
    ds_read_b64_tr_b16 v[76:77], v38 offset:18432
    ds_read_b64_tr_b16 v[78:79], v38 offset:19968
    v_mfma_f32_32x32x16_bf16 v[208:223], v[92:95], a[24:27], v[208:223]
    buffer_load_dwordx4 a[20:23], v39, s[16:19], s40 offen offset:1024 sc0 sc1
    s_add_u32 m0, s38, 147456
    s_waitcnt lgkmcnt(4)
    v_mfma_f32_32x32x16_bf16 v[224:239], v[64:67], a[24:27], v[224:239]
    ds_read_b64_tr_b16 v[80:81], v37 offset:18560
    ds_read_b64_tr_b16 v[82:83], v37 offset:20096
    ds_read_b64_tr_b16 v[84:85], v38 offset:18560
    ds_read_b64_tr_b16 v[86:87], v38 offset:20096
    s_add_u32 s41, s64, 331776
    v_mfma_f32_32x32x16_bf16 v[240:255], v[68:71], a[24:27], v[240:255]
    buffer_load_dwordx4 v32, s[60:63], s41 offen offset:0 lds
    s_waitcnt vmcnt(25)
    s_waitcnt lgkmcnt(4)
    v_mfma_f32_32x32x16_bf16 v[160:175], v[72:75], a[28:31], v[160:175]
    ds_read_b64_tr_b16 v[88:89], v37 offset:18688
    ds_read_b64_tr_b16 v[90:91], v37 offset:20224
    ds_read_b64_tr_b16 v[92:93], v38 offset:18688
    ds_read_b64_tr_b16 v[94:95], v38 offset:20224
    v_mfma_f32_32x32x16_bf16 v[176:191], v[76:79], a[28:31], v[176:191]
    buffer_load_dwordx4 v33, s[60:63], s41 offen offset:1024 lds
    s_waitcnt lgkmcnt(4)
    v_mfma_f32_32x32x16_bf16 v[192:207], v[80:83], a[28:31], v[192:207]
    ds_read_b64_tr_b16 v[64:65], v37 offset:0
    ds_read_b64_tr_b16 v[66:67], v37 offset:1536
    ds_read_b64_tr_b16 v[68:69], v38 offset:0
    ds_read_b64_tr_b16 v[70:71], v38 offset:1536
    v_mfma_f32_32x32x16_bf16 v[208:223], v[84:87], a[28:31], v[208:223]
    buffer_load_dwordx4 v34, s[60:63], s41 offen offset:2048 lds
    s_add_u32 s42, s37, 51200
    s_waitcnt lgkmcnt(4)
    v_mfma_f32_32x32x16_bf16 v[224:239], v[88:91], a[28:31], v[224:239]
    ds_read_b64_tr_b16 v[72:73], v37 offset:128
    ds_read_b64_tr_b16 v[74:75], v37 offset:1664
    ds_read_b64_tr_b16 v[76:77], v38 offset:128
    ds_read_b64_tr_b16 v[78:79], v38 offset:1664
    v_mul_f32 v44, 0xbfb8aa3b, v112
    v_mul_f32 v45, 0xbfb8aa3b, v113
    v_mul_f32 v46, 0xbfb8aa3b, v114
    v_mfma_f32_32x32x16_bf16 v[240:255], v[92:95], a[28:31], v[240:255]
    buffer_store_dwordx4 v[52:55], v39, s[16:19], s42 offen sc0 sc1
    v_mul_f32 v47, 0xbfb8aa3b, v115
    s_waitcnt vmcnt(20)
    s_waitcnt lgkmcnt(4)
    v_mfma_f32_32x32x16_bf16 v[160:175], v[64:67], a[32:35], v[160:175]
    s_waitcnt vmcnt(16)
    s_barrier
    ds_read_b64_tr_b16 v[80:81], v37 offset:256
    ds_read_b64_tr_b16 v[82:83], v37 offset:1792
    ds_read_b64_tr_b16 v[84:85], v38 offset:256
    ds_read_b64_tr_b16 v[86:87], v38 offset:1792
    s_add_u32 s40, s67, 16384
    v_mfma_f32_32x32x16_bf16 v[176:191], v[68:71], a[32:35], v[176:191]
    buffer_load_dwordx4 a[24:27], v39, s[16:19], s40 offen offset:0 sc0 sc1
    v_mul_f32 v48, 0xbfb8aa3b, v120
    s_waitcnt lgkmcnt(4)
    v_mfma_f32_32x32x16_bf16 v[192:207], v[72:75], a[32:35], v[192:207]
    ds_read_b64_tr_b16 v[88:89], v37 offset:6144
    ds_read_b64_tr_b16 v[90:91], v37 offset:7680
    ds_read_b64_tr_b16 v[92:93], v38 offset:6144
    ds_read_b64_tr_b16 v[94:95], v38 offset:7680
    v_mul_f32 v49, 0xbfb8aa3b, v121
    v_mul_f32 v50, 0xbfb8aa3b, v122
    v_mul_f32 v51, 0xbfb8aa3b, v123
    v_mfma_f32_32x32x16_bf16 v[208:223], v[76:79], a[32:35], v[208:223]
    buffer_load_dwordx4 a[28:31], v39, s[16:19], s40 offen offset:1024 sc0 sc1
    s_add_u32 m0, s38, 135168
    s_waitcnt lgkmcnt(4)
    v_mfma_f32_32x32x16_bf16 v[224:239], v[80:83], a[32:35], v[224:239]
    ds_read_b64_tr_b16 v[64:65], v37 offset:6272
    ds_read_b64_tr_b16 v[66:67], v37 offset:7808
    ds_read_b64_tr_b16 v[68:69], v38 offset:6272
    ds_read_b64_tr_b16 v[70:71], v38 offset:7808
    s_add_u32 s41, s64, 368640
    v_exp_f32 v44, v44
    v_mfma_f32_32x32x16_bf16 v[240:255], v[84:87], a[32:35], v[240:255]
    buffer_load_dwordx4 v32, s[60:63], s41 offen offset:0 lds
    s_waitcnt lgkmcnt(4)
    v_mfma_f32_32x32x16_bf16 v[160:175], v[88:91], a[36:39], v[160:175]
    ds_read_b64_tr_b16 v[72:73], v37 offset:6400
    ds_read_b64_tr_b16 v[74:75], v37 offset:7936
    ds_read_b64_tr_b16 v[76:77], v38 offset:6400
    ds_read_b64_tr_b16 v[78:79], v38 offset:7936
    v_exp_f32 v45, v45
    v_mfma_f32_32x32x16_bf16 v[176:191], v[92:95], a[36:39], v[176:191]
    buffer_load_dwordx4 v33, s[60:63], s41 offen offset:1024 lds
    s_waitcnt lgkmcnt(4)
    v_mfma_f32_32x32x16_bf16 v[192:207], v[64:67], a[36:39], v[192:207]
    ds_read_b64_tr_b16 v[80:81], v35 offset:36864
    ds_read_b64_tr_b16 v[82:83], v35 offset:38400
    ds_read_b64_tr_b16 v[84:85], v36 offset:36864
    ds_read_b64_tr_b16 v[86:87], v36 offset:38400
    v_exp_f32 v46, v46
    v_mfma_f32_32x32x16_bf16 v[208:223], v[68:71], a[36:39], v[208:223]
    buffer_load_dwordx4 v34, s[60:63], s41 offen offset:2048 lds
    s_waitcnt lgkmcnt(4)
    v_mfma_f32_32x32x16_bf16 v[224:239], v[72:75], a[36:39], v[224:239]
    ds_read_b64_tr_b16 v[88:89], v35 offset:36992
    ds_read_b64_tr_b16 v[90:91], v35 offset:38528
    ds_read_b64_tr_b16 v[92:93], v36 offset:36992
    ds_read_b64_tr_b16 v[94:95], v36 offset:38528
    v_exp_f32 v47, v47
    v_mfma_f32_32x32x16_bf16 v[240:255], v[76:79], a[36:39], v[240:255]
    v_exp_f32 v48, v48
    v_exp_f32 v49, v49
    v_exp_f32 v50, v50
    s_waitcnt vmcnt(20)
    s_waitcnt lgkmcnt(4)
    v_mfma_f32_32x32x16_bf16 v[160:175], v[80:83], a[0:3], v[160:175]
    ds_read_b64_tr_b16 v[64:65], v35 offset:37120
    ds_read_b64_tr_b16 v[66:67], v35 offset:38656
    ds_read_b64_tr_b16 v[68:69], v36 offset:37120
    ds_read_b64_tr_b16 v[70:71], v36 offset:38656
    s_add_u32 s40, s67, 18432
    v_exp_f32 v51, v51
    v_mfma_f32_32x32x16_bf16 v[176:191], v[84:87], a[0:3], v[176:191]
    buffer_load_dwordx4 a[32:35], v39, s[16:19], s40 offen offset:0 sc0 sc1
    v_add_f32 v44, 1.0, v44
    s_waitcnt lgkmcnt(4)
    v_mfma_f32_32x32x16_bf16 v[192:207], v[88:91], a[0:3], v[192:207]
    ds_read_b64_tr_b16 v[72:73], v35 offset:43008
    ds_read_b64_tr_b16 v[74:75], v35 offset:44544
    ds_read_b64_tr_b16 v[76:77], v36 offset:43008
    ds_read_b64_tr_b16 v[78:79], v36 offset:44544
    v_add_f32 v45, 1.0, v45
    v_add_f32 v46, 1.0, v46
    v_add_f32 v47, 1.0, v47
    v_mfma_f32_32x32x16_bf16 v[208:223], v[92:95], a[0:3], v[208:223]
    buffer_load_dwordx4 a[36:39], v39, s[16:19], s40 offen offset:1024 sc0 sc1
    s_add_u32 m0, s38, 122880
    s_waitcnt lgkmcnt(4)
    v_mfma_f32_32x32x16_bf16 v[224:239], v[64:67], a[0:3], v[224:239]
    ds_read_b64_tr_b16 v[80:81], v35 offset:43136
    ds_read_b64_tr_b16 v[82:83], v35 offset:44672
    ds_read_b64_tr_b16 v[84:85], v36 offset:43136
    ds_read_b64_tr_b16 v[86:87], v36 offset:44672
    s_add_u32 s41, s64, 405504
    v_add_f32 v48, 1.0, v48
    v_add_f32 v49, 1.0, v49
    v_mfma_f32_32x32x16_bf16 v[240:255], v[68:71], a[0:3], v[240:255]
    buffer_load_dwordx4 v32, s[60:63], s41 offen offset:0 lds
    v_add_f32 v50, 1.0, v50
    s_waitcnt vmcnt(22)
    s_waitcnt lgkmcnt(4)
    v_mfma_f32_32x32x16_bf16 v[160:175], v[72:75], a[4:7], v[160:175]
    ds_read_b64_tr_b16 v[88:89], v35 offset:43264
    ds_read_b64_tr_b16 v[90:91], v35 offset:44800
    ds_read_b64_tr_b16 v[92:93], v36 offset:43264
    ds_read_b64_tr_b16 v[94:95], v36 offset:44800
    v_add_f32 v51, 1.0, v51
    v_rcp_f32 v44, v44
    v_mfma_f32_32x32x16_bf16 v[176:191], v[76:79], a[4:7], v[176:191]
    buffer_load_dwordx4 v33, s[60:63], s41 offen offset:1024 lds
    s_waitcnt lgkmcnt(4)
    v_mfma_f32_32x32x16_bf16 v[192:207], v[80:83], a[4:7], v[192:207]
    ds_read_b64_tr_b16 v[64:65], v35 offset:24576
    ds_read_b64_tr_b16 v[66:67], v35 offset:26112
    ds_read_b64_tr_b16 v[68:69], v36 offset:24576
    ds_read_b64_tr_b16 v[70:71], v36 offset:26112
    v_rcp_f32 v45, v45
    v_mfma_f32_32x32x16_bf16 v[208:223], v[84:87], a[4:7], v[208:223]
    buffer_load_dwordx4 v34, s[60:63], s41 offen offset:2048 lds
    s_waitcnt lgkmcnt(4)
    v_mfma_f32_32x32x16_bf16 v[224:239], v[88:91], a[4:7], v[224:239]
    ds_read_b64_tr_b16 v[72:73], v35 offset:24704
    ds_read_b64_tr_b16 v[74:75], v35 offset:26240
    ds_read_b64_tr_b16 v[76:77], v36 offset:24704
    ds_read_b64_tr_b16 v[78:79], v36 offset:26240
    v_rcp_f32 v46, v46
    v_mfma_f32_32x32x16_bf16 v[240:255], v[92:95], a[4:7], v[240:255]
    v_rcp_f32 v47, v47
    v_rcp_f32 v48, v48
    v_rcp_f32 v49, v49
    s_waitcnt vmcnt(20)
    s_waitcnt lgkmcnt(4)
    v_mfma_f32_32x32x16_bf16 v[160:175], v[64:67], a[8:11], v[160:175]
    s_waitcnt vmcnt(16)
    s_barrier
    ds_read_b64_tr_b16 v[80:81], v35 offset:24832
    ds_read_b64_tr_b16 v[82:83], v35 offset:26368
    ds_read_b64_tr_b16 v[84:85], v36 offset:24832
    ds_read_b64_tr_b16 v[86:87], v36 offset:26368
    v_and_b32 v2, 15, v0
    v_mfma_f32_32x32x16_bf16 v[176:191], v[68:71], a[8:11], v[176:191]
    v_lshlrev_b32 v2, 2, v2
    buffer_load_dword v3, v2, s[16:19], s48 offen offset:32 sc0 sc1
    s_waitcnt lgkmcnt(4)
    v_mfma_f32_32x32x16_bf16 v[192:207], v[72:75], a[8:11], v[192:207]
    ds_read_b64_tr_b16 v[88:89], v35 offset:30720
    ds_read_b64_tr_b16 v[90:91], v35 offset:32256
    ds_read_b64_tr_b16 v[92:93], v36 offset:30720
    ds_read_b64_tr_b16 v[94:95], v36 offset:32256
    s_add_u32 s40, s67, 20480
    v_rcp_f32 v50, v50
    v_mfma_f32_32x32x16_bf16 v[208:223], v[76:79], a[8:11], v[208:223]
    buffer_load_dwordx4 a[0:3], v39, s[16:19], s40 offen offset:0 sc0 sc1
    s_waitcnt lgkmcnt(4)
    v_mfma_f32_32x32x16_bf16 v[224:239], v[80:83], a[8:11], v[224:239]
    ds_read_b64_tr_b16 v[64:65], v35 offset:30848
    ds_read_b64_tr_b16 v[66:67], v35 offset:32384
    ds_read_b64_tr_b16 v[68:69], v36 offset:30848
    ds_read_b64_tr_b16 v[70:71], v36 offset:32384
    v_rcp_f32 v51, v51
    v_mul_f32 v44, v44, v116
    v_mfma_f32_32x32x16_bf16 v[240:255], v[84:87], a[8:11], v[240:255]
    buffer_load_dwordx4 a[4:7], v39, s[16:19], s40 offen offset:1024 sc0 sc1
    s_add_u32 m0, s38, 110592
    s_waitcnt lgkmcnt(4)
    v_mfma_f32_32x32x16_bf16 v[160:175], v[88:91], a[12:15], v[160:175]
    ds_read_b64_tr_b16 v[72:73], v35 offset:30976
    ds_read_b64_tr_b16 v[74:75], v35 offset:32512
    ds_read_b64_tr_b16 v[76:77], v36 offset:30976
    ds_read_b64_tr_b16 v[78:79], v36 offset:32512
    s_add_u32 s41, s64, 1769472
    v_mul_f32 v45, v45, v117
    v_mul_f32 v46, v46, v118
    v_mfma_f32_32x32x16_bf16 v[176:191], v[92:95], a[12:15], v[176:191]
    buffer_load_dwordx4 v32, s[60:63], s41 offen offset:0 lds
    v_mul_f32 v47, v47, v119
    s_waitcnt lgkmcnt(4)
    v_mfma_f32_32x32x16_bf16 v[192:207], v[64:67], a[12:15], v[192:207]
    ds_read_b64_tr_b16 v[80:81], v35 offset:12288
    ds_read_b64_tr_b16 v[82:83], v35 offset:13824
    ds_read_b64_tr_b16 v[84:85], v36 offset:12288
    ds_read_b64_tr_b16 v[86:87], v36 offset:13824
    v_mul_f32 v48, v48, v124
    v_mul_f32 v49, v49, v125
    v_mul_f32 v50, v50, v126
    v_mfma_f32_32x32x16_bf16 v[208:223], v[68:71], a[12:15], v[208:223]
    buffer_load_dwordx4 v33, s[60:63], s41 offen offset:1024 lds
    v_mul_f32 v51, v51, v127
    s_waitcnt lgkmcnt(4)
    v_mfma_f32_32x32x16_bf16 v[224:239], v[72:75], a[12:15], v[224:239]
    ds_read_b64_tr_b16 v[88:89], v35 offset:12416
    ds_read_b64_tr_b16 v[90:91], v35 offset:13952
    ds_read_b64_tr_b16 v[92:93], v36 offset:12416
    ds_read_b64_tr_b16 v[94:95], v36 offset:13952
    v_cvt_pk_bf16_f32 v56, v44, v45
    v_cvt_pk_bf16_f32 v57, v46, v47
    v_cvt_pk_bf16_f32 v58, v48, v49
    v_mfma_f32_32x32x16_bf16 v[240:255], v[76:79], a[12:15], v[240:255]
    buffer_load_dwordx4 v34, s[60:63], s41 offen offset:2048 lds
    v_cvt_pk_bf16_f32 v59, v50, v51
    s_waitcnt vmcnt(21)
    s_waitcnt lgkmcnt(4)
    v_mfma_f32_32x32x16_bf16 v[160:175], v[80:83], a[16:19], v[160:175]
    ds_read_b64_tr_b16 v[64:65], v35 offset:12544
    ds_read_b64_tr_b16 v[66:67], v35 offset:14080
    ds_read_b64_tr_b16 v[68:69], v36 offset:12544
    ds_read_b64_tr_b16 v[70:71], v36 offset:14080
    s_add_u32 s40, s67, 22528
    v_mfma_f32_32x32x16_bf16 v[176:191], v[84:87], a[16:19], v[176:191]
    buffer_load_dwordx4 a[8:11], v39, s[16:19], s40 offen offset:0 sc0 sc1
    s_waitcnt lgkmcnt(4)
    v_mfma_f32_32x32x16_bf16 v[192:207], v[88:91], a[16:19], v[192:207]
    ds_read_b64_tr_b16 v[72:73], v35 offset:18432
    ds_read_b64_tr_b16 v[74:75], v35 offset:19968
    ds_read_b64_tr_b16 v[76:77], v36 offset:18432
    ds_read_b64_tr_b16 v[78:79], v36 offset:19968
    v_mfma_f32_32x32x16_bf16 v[208:223], v[92:95], a[16:19], v[208:223]
    buffer_load_dwordx4 a[12:15], v39, s[16:19], s40 offen offset:1024 sc0 sc1
    s_add_u32 m0, s38, 98304
    s_waitcnt lgkmcnt(4)
    v_mfma_f32_32x32x16_bf16 v[224:239], v[64:67], a[16:19], v[224:239]
    ds_read_b64_tr_b16 v[80:81], v35 offset:18560
    ds_read_b64_tr_b16 v[82:83], v35 offset:20096
    ds_read_b64_tr_b16 v[84:85], v36 offset:18560
    ds_read_b64_tr_b16 v[86:87], v36 offset:20096
    s_add_u32 s41, s64, 1806336
    v_mfma_f32_32x32x16_bf16 v[240:255], v[68:71], a[16:19], v[240:255]
    buffer_load_dwordx4 v32, s[60:63], s41 offen offset:0 lds
    s_waitcnt vmcnt(23)
    s_waitcnt lgkmcnt(4)
    v_mfma_f32_32x32x16_bf16 v[160:175], v[72:75], a[20:23], v[160:175]
    ds_read_b64_tr_b16 v[88:89], v35 offset:18688
    ds_read_b64_tr_b16 v[90:91], v35 offset:20224
    ds_read_b64_tr_b16 v[92:93], v36 offset:18688
    ds_read_b64_tr_b16 v[94:95], v36 offset:20224
    v_mfma_f32_32x32x16_bf16 v[176:191], v[76:79], a[20:23], v[176:191]
    buffer_load_dwordx4 v33, s[60:63], s41 offen offset:1024 lds
    s_waitcnt lgkmcnt(4)
    v_mfma_f32_32x32x16_bf16 v[192:207], v[80:83], a[20:23], v[192:207]
    ds_read_b64_tr_b16 v[64:65], v35 offset:0
    ds_read_b64_tr_b16 v[66:67], v35 offset:1536
    ds_read_b64_tr_b16 v[68:69], v36 offset:0
    ds_read_b64_tr_b16 v[70:71], v36 offset:1536
    v_mfma_f32_32x32x16_bf16 v[208:223], v[84:87], a[20:23], v[208:223]
    buffer_load_dwordx4 v34, s[60:63], s41 offen offset:2048 lds
    s_add_u32 s42, s37, 382976
    s_waitcnt lgkmcnt(4)
    v_mfma_f32_32x32x16_bf16 v[224:239], v[88:91], a[20:23], v[224:239]
    ds_read_b64_tr_b16 v[72:73], v35 offset:128
    ds_read_b64_tr_b16 v[74:75], v35 offset:1664
    ds_read_b64_tr_b16 v[76:77], v36 offset:128
    ds_read_b64_tr_b16 v[78:79], v36 offset:1664
    v_mul_f32 v44, 0xbfb8aa3b, v128
    v_mul_f32 v45, 0xbfb8aa3b, v129
    v_mul_f32 v46, 0xbfb8aa3b, v130
    v_mfma_f32_32x32x16_bf16 v[240:255], v[92:95], a[20:23], v[240:255]
    buffer_store_dwordx4 v[56:59], v39, s[16:19], s42 offen sc0 sc1
    v_mul_f32 v47, 0xbfb8aa3b, v131
    s_waitcnt vmcnt(21)
    s_waitcnt lgkmcnt(4)
    v_mfma_f32_32x32x16_bf16 v[160:175], v[64:67], a[24:27], v[160:175]
    s_waitcnt vmcnt(17)
    s_barrier
    s_waitcnt vmcnt(11)
    s_mov_b32 s69, 200000
    s_mov_b64 exec, 63
L_FC4884:
    v_cmp_ne_u32 vcc, s68, v3
    s_sub_u32 s69, s69, 1
    s_nop 4
    s_cbranch_vccz L_FC4884_D
    s_cmp_eq_u32 s69, 0
    s_cbranch_scc1 L_FC4884_D
    s_sleep 2
    buffer_load_dword v3, v2, s[16:19], s48 offen offset:32 sc0 sc1
    s_waitcnt vmcnt(0)
    s_branch L_FC4884
L_FC4884_D:
    s_mov_b64 exec, -1
    s_nop 3
    ds_read_b64_tr_b16 v[80:81], v35 offset:256
    ds_read_b64_tr_b16 v[82:83], v35 offset:1792
    ds_read_b64_tr_b16 v[84:85], v36 offset:256
    ds_read_b64_tr_b16 v[86:87], v36 offset:1792
    v_mfma_f32_32x32x16_bf16 v[176:191], v[68:71], a[24:27], v[176:191]
    s_add_u32 s40, s67, 24576
    buffer_load_dwordx4 a[16:19], v39, s[16:19], s40 offen offset:0 sc0 sc1
    s_waitcnt lgkmcnt(4)
    v_mfma_f32_32x32x16_bf16 v[192:207], v[72:75], a[24:27], v[192:207]
    ds_read_b64_tr_b16 v[88:89], v35 offset:6144
    ds_read_b64_tr_b16 v[90:91], v35 offset:7680
    ds_read_b64_tr_b16 v[92:93], v36 offset:6144
    ds_read_b64_tr_b16 v[94:95], v36 offset:7680
    v_mul_f32 v48, 0xbfb8aa3b, v136
    v_mul_f32 v49, 0xbfb8aa3b, v137
    v_mul_f32 v50, 0xbfb8aa3b, v138
    v_mfma_f32_32x32x16_bf16 v[208:223], v[76:79], a[24:27], v[208:223]
    buffer_load_dwordx4 a[20:23], v39, s[16:19], s40 offen offset:1024 sc0 sc1
    s_add_u32 m0, s38, 86016
    s_waitcnt lgkmcnt(4)
    v_mfma_f32_32x32x16_bf16 v[224:239], v[80:83], a[24:27], v[224:239]
    ds_read_b64_tr_b16 v[64:65], v35 offset:6272
    ds_read_b64_tr_b16 v[66:67], v35 offset:7808
    ds_read_b64_tr_b16 v[68:69], v36 offset:6272
    ds_read_b64_tr_b16 v[70:71], v36 offset:7808
    s_add_u32 s41, s64, 1843200
    v_mul_f32 v51, 0xbfb8aa3b, v139
    v_mfma_f32_32x32x16_bf16 v[240:255], v[84:87], a[24:27], v[240:255]
    buffer_load_dwordx4 v32, s[60:63], s41 offen offset:0 lds
    s_waitcnt lgkmcnt(4)
    v_mfma_f32_32x32x16_bf16 v[160:175], v[88:91], a[28:31], v[160:175]
    ds_read_b64_tr_b16 v[72:73], v35 offset:6400
    ds_read_b64_tr_b16 v[74:75], v35 offset:7936
    ds_read_b64_tr_b16 v[76:77], v36 offset:6400
    ds_read_b64_tr_b16 v[78:79], v36 offset:7936
    v_exp_f32 v44, v44
    v_mfma_f32_32x32x16_bf16 v[176:191], v[92:95], a[28:31], v[176:191]
    buffer_load_dwordx4 v33, s[60:63], s41 offen offset:1024 lds
    s_waitcnt lgkmcnt(4)
    v_mfma_f32_32x32x16_bf16 v[192:207], v[64:67], a[28:31], v[192:207]
    ds_read_b64_tr_b16 v[80:81], v31 offset:0
    ds_read_b64_tr_b16 v[82:83], v31 offset:1536
    ds_read_b64_tr_b16 v[84:85], v30 offset:0
    ds_read_b64_tr_b16 v[86:87], v30 offset:1536
    v_exp_f32 v45, v45
    v_mfma_f32_32x32x16_bf16 v[208:223], v[68:71], a[28:31], v[208:223]
    buffer_load_dwordx4 v34, s[60:63], s41 offen offset:2048 lds
    s_waitcnt lgkmcnt(4)
    v_mfma_f32_32x32x16_bf16 v[224:239], v[72:75], a[28:31], v[224:239]
    ds_read_b64_tr_b16 v[88:89], v31 offset:128
    ds_read_b64_tr_b16 v[90:91], v31 offset:1664
    ds_read_b64_tr_b16 v[92:93], v30 offset:128
    ds_read_b64_tr_b16 v[94:95], v30 offset:1664
    v_exp_f32 v46, v46
    v_mfma_f32_32x32x16_bf16 v[240:255], v[76:79], a[28:31], v[240:255]
    v_exp_f32 v47, v47
    v_exp_f32 v48, v48
    v_exp_f32 v49, v49
    s_waitcnt lgkmcnt(4)
    v_mfma_f32_32x32x16_bf16 v[160:175], v[80:83], a[32:35], v[160:175]
    ds_read_b64_tr_b16 v[64:65], v31 offset:256
    ds_read_b64_tr_b16 v[66:67], v31 offset:1792
    ds_read_b64_tr_b16 v[68:69], v30 offset:256
    ds_read_b64_tr_b16 v[70:71], v30 offset:1792
    s_add_u32 s40, s67, 26624
    v_exp_f32 v50, v50
    v_mfma_f32_32x32x16_bf16 v[176:191], v[84:87], a[32:35], v[176:191]
    buffer_load_dwordx4 a[24:27], v39, s[16:19], s40 offen offset:0 sc0 sc1
    s_waitcnt lgkmcnt(4)
    v_mfma_f32_32x32x16_bf16 v[192:207], v[88:91], a[32:35], v[192:207]
    ds_read_b64_tr_b16 v[72:73], v31 offset:6144
    ds_read_b64_tr_b16 v[74:75], v31 offset:7680
    ds_read_b64_tr_b16 v[76:77], v30 offset:6144
    ds_read_b64_tr_b16 v[78:79], v30 offset:7680
    v_exp_f32 v51, v51
    v_add_f32 v44, 1.0, v44
    v_mfma_f32_32x32x16_bf16 v[208:223], v[92:95], a[32:35], v[208:223]
    buffer_load_dwordx4 a[28:31], v39, s[16:19], s40 offen offset:1024 sc0 sc1
    s_add_u32 m0, s38, 73728
    s_waitcnt lgkmcnt(4)
    v_mfma_f32_32x32x16_bf16 v[224:239], v[64:67], a[32:35], v[224:239]
    ds_read_b64_tr_b16 v[80:81], v31 offset:6272
    ds_read_b64_tr_b16 v[82:83], v31 offset:7808
    ds_read_b64_tr_b16 v[84:85], v30 offset:6272
    ds_read_b64_tr_b16 v[86:87], v30 offset:7808
    s_add_u32 s41, s64, 1880064
    v_add_f32 v45, 1.0, v45
    v_add_f32 v46, 1.0, v46
    v_mfma_f32_32x32x16_bf16 v[240:255], v[68:71], a[32:35], v[240:255]
    buffer_load_dwordx4 v32, s[60:63], s41 offen offset:0 lds
    v_add_f32 v47, 1.0, v47
    s_waitcnt lgkmcnt(4)
    v_mfma_f32_32x32x16_bf16 v[160:175], v[72:75], a[36:39], v[160:175]
    ds_read_b64_tr_b16 v[88:89], v31 offset:6400
    ds_read_b64_tr_b16 v[90:91], v31 offset:7936
    ds_read_b64_tr_b16 v[92:93], v30 offset:6400
    ds_read_b64_tr_b16 v[94:95], v30 offset:7936
    v_add_f32 v48, 1.0, v48
    v_add_f32 v49, 1.0, v49
    v_add_f32 v50, 1.0, v50
    v_mfma_f32_32x32x16_bf16 v[176:191], v[76:79], a[36:39], v[176:191]
    buffer_load_dwordx4 v33, s[60:63], s41 offen offset:1024 lds
    v_add_f32 v51, 1.0, v51
    s_waitcnt lgkmcnt(4)
    v_mfma_f32_32x32x16_bf16 v[192:207], v[80:83], a[36:39], v[192:207]
    ds_read_b64_tr_b16 v[64:65], v37 offset:36864
    ds_read_b64_tr_b16 v[66:67], v37 offset:38400
    ds_read_b64_tr_b16 v[68:69], v38 offset:36864
    ds_read_b64_tr_b16 v[70:71], v38 offset:38400
    v_rcp_f32 v44, v44
    v_mfma_f32_32x32x16_bf16 v[208:223], v[84:87], a[36:39], v[208:223]
    buffer_load_dwordx4 v34, s[60:63], s41 offen offset:2048 lds
    s_waitcnt lgkmcnt(4)
    v_mfma_f32_32x32x16_bf16 v[224:239], v[88:91], a[36:39], v[224:239]
    ds_read_b64_tr_b16 v[72:73], v37 offset:36992
    ds_read_b64_tr_b16 v[74:75], v37 offset:38528
    ds_read_b64_tr_b16 v[76:77], v38 offset:36992
    ds_read_b64_tr_b16 v[78:79], v38 offset:38528
    v_rcp_f32 v45, v45
    v_mfma_f32_32x32x16_bf16 v[240:255], v[92:95], a[36:39], v[240:255]
    v_rcp_f32 v46, v46
    v_rcp_f32 v47, v47
    v_rcp_f32 v48, v48
    s_waitcnt vmcnt(20)
    s_waitcnt lgkmcnt(4)
    v_mfma_f32_32x32x16_bf16 v[160:175], v[64:67], a[0:3], v[160:175]
    s_waitcnt vmcnt(16)
    s_barrier
    v_rcp_f32 v49, v49
    v_rcp_f32 v50, v50
    v_rcp_f32 v51, v51
    v_mul_f32 v44, v44, v132
    v_mul_f32 v45, v45, v133
    v_mul_f32 v46, v46, v134
    v_mul_f32 v47, v47, v135
    v_mul_f32 v48, v48, v140
    v_mul_f32 v49, v49, v141
    v_mul_f32 v50, v50, v142
    v_mul_f32 v51, v51, v143
    v_cvt_pk_bf16_f32 v52, v44, v45
    v_cvt_pk_bf16_f32 v53, v46, v47
    v_cvt_pk_bf16_f32 v54, v48, v49
    v_cvt_pk_bf16_f32 v55, v50, v51
    s_add_u32 s42, s37, 52224
    buffer_store_dwordx4 v[52:55], v39, s[16:19], s42 offen sc0 sc1
    v_mul_f32 v44, 0xbfb8aa3b, v144
    v_mul_f32 v45, 0xbfb8aa3b, v145
    v_mul_f32 v46, 0xbfb8aa3b, v146
    v_mul_f32 v47, 0xbfb8aa3b, v147
    v_mul_f32 v48, 0xbfb8aa3b, v152
    v_mul_f32 v49, 0xbfb8aa3b, v153
    v_mul_f32 v50, 0xbfb8aa3b, v154
    v_mul_f32 v51, 0xbfb8aa3b, v155
    v_exp_f32 v44, v44
    v_exp_f32 v45, v45
    v_exp_f32 v46, v46
    v_exp_f32 v47, v47
    v_exp_f32 v48, v48
    v_exp_f32 v49, v49
    v_exp_f32 v50, v50
    v_exp_f32 v51, v51
    v_add_f32 v44, 1.0, v44
    v_add_f32 v45, 1.0, v45
    v_add_f32 v46, 1.0, v46
    v_add_f32 v47, 1.0, v47
    v_add_f32 v48, 1.0, v48
    v_add_f32 v49, 1.0, v49
    v_add_f32 v50, 1.0, v50
    v_add_f32 v51, 1.0, v51
    v_rcp_f32 v44, v44
    v_rcp_f32 v45, v45
    v_rcp_f32 v46, v46
    v_rcp_f32 v47, v47
    v_rcp_f32 v48, v48
    v_rcp_f32 v49, v49
    v_rcp_f32 v50, v50
    v_rcp_f32 v51, v51
    v_mul_f32 v44, v44, v148
    v_mul_f32 v45, v45, v149
    v_mul_f32 v46, v46, v150
    v_mul_f32 v47, v47, v151
    v_mul_f32 v48, v48, v156
    v_mul_f32 v49, v49, v157
    v_mul_f32 v50, v50, v158
    v_mul_f32 v51, v51, v159
    v_cvt_pk_bf16_f32 v56, v44, v45
    v_cvt_pk_bf16_f32 v57, v46, v47
    v_cvt_pk_bf16_f32 v58, v48, v49
    v_cvt_pk_bf16_f32 v59, v50, v51
    s_add_u32 s42, s37, 384000
    buffer_store_dwordx4 v[56:59], v39, s[16:19], s42 offen sc0 sc1
    ds_read_b64_tr_b16 v[80:81], v37 offset:37120
    ds_read_b64_tr_b16 v[82:83], v37 offset:38656
    ds_read_b64_tr_b16 v[84:85], v38 offset:37120
    ds_read_b64_tr_b16 v[86:87], v38 offset:38656
    v_mfma_f32_32x32x16_bf16 v[176:191], v[68:71], a[0:3], v[176:191]
    s_add_u32 s40, s67, 28672
    buffer_load_dwordx4 a[32:35], v39, s[16:19], s40 offen offset:0 sc0 sc1
    s_waitcnt lgkmcnt(4)
    v_mfma_f32_32x32x16_bf16 v[192:207], v[72:75], a[0:3], v[192:207]
    ds_read_b64_tr_b16 v[88:89], v37 offset:43008
    ds_read_b64_tr_b16 v[90:91], v37 offset:44544
    ds_read_b64_tr_b16 v[92:93], v38 offset:43008
    ds_read_b64_tr_b16 v[94:95], v38 offset:44544
    v_mfma_f32_32x32x16_bf16 v[208:223], v[76:79], a[0:3], v[208:223]
    buffer_load_dwordx4 a[36:39], v39, s[16:19], s40 offen offset:1024 sc0 sc1
    s_add_u32 m0, s38, 61440
    s_waitcnt lgkmcnt(4)
    v_mfma_f32_32x32x16_bf16 v[224:239], v[80:83], a[0:3], v[224:239]
    ds_read_b64_tr_b16 v[64:65], v37 offset:43136
    ds_read_b64_tr_b16 v[66:67], v37 offset:44672
    ds_read_b64_tr_b16 v[68:69], v38 offset:43136
    ds_read_b64_tr_b16 v[70:71], v38 offset:44672
    s_add_u32 s41, s64, 1916928
    v_mfma_f32_32x32x16_bf16 v[240:255], v[84:87], a[0:3], v[240:255]
    buffer_load_dwordx4 v32, s[60:63], s41 offen offset:0 lds
    s_waitcnt lgkmcnt(4)
    v_mfma_f32_32x32x16_bf16 v[160:175], v[88:91], a[4:7], v[160:175]
    ds_read_b64_tr_b16 v[72:73], v37 offset:43264
    ds_read_b64_tr_b16 v[74:75], v37 offset:44800
    ds_read_b64_tr_b16 v[76:77], v38 offset:43264
    ds_read_b64_tr_b16 v[78:79], v38 offset:44800
    v_mfma_f32_32x32x16_bf16 v[176:191], v[92:95], a[4:7], v[176:191]
    buffer_load_dwordx4 v33, s[60:63], s41 offen offset:1024 lds
    s_waitcnt lgkmcnt(4)
    v_mfma_f32_32x32x16_bf16 v[192:207], v[64:67], a[4:7], v[192:207]
    ds_read_b64_tr_b16 v[80:81], v37 offset:24576
    ds_read_b64_tr_b16 v[82:83], v37 offset:26112
    ds_read_b64_tr_b16 v[84:85], v38 offset:24576
    ds_read_b64_tr_b16 v[86:87], v38 offset:26112
    v_mfma_f32_32x32x16_bf16 v[208:223], v[68:71], a[4:7], v[208:223]
    buffer_load_dwordx4 v34, s[60:63], s41 offen offset:2048 lds
    s_waitcnt lgkmcnt(4)
    v_mfma_f32_32x32x16_bf16 v[224:239], v[72:75], a[4:7], v[224:239]
    ds_read_b64_tr_b16 v[88:89], v37 offset:24704
    ds_read_b64_tr_b16 v[90:91], v37 offset:26240
    ds_read_b64_tr_b16 v[92:93], v38 offset:24704
    ds_read_b64_tr_b16 v[94:95], v38 offset:26240
    v_mfma_f32_32x32x16_bf16 v[240:255], v[76:79], a[4:7], v[240:255]
    s_waitcnt vmcnt(22)
    s_waitcnt lgkmcnt(4)
    v_mfma_f32_32x32x16_bf16 v[160:175], v[80:83], a[8:11], v[160:175]
    ds_read_b64_tr_b16 v[64:65], v37 offset:24832
    ds_read_b64_tr_b16 v[66:67], v37 offset:26368
    ds_read_b64_tr_b16 v[68:69], v38 offset:24832
    ds_read_b64_tr_b16 v[70:71], v38 offset:26368
    s_add_u32 s40, s67, 30720
    v_mfma_f32_32x32x16_bf16 v[176:191], v[84:87], a[8:11], v[176:191]
    buffer_load_dwordx4 a[0:3], v39, s[16:19], s40 offen offset:0 sc0 sc1
    s_waitcnt lgkmcnt(4)
    v_mfma_f32_32x32x16_bf16 v[192:207], v[88:91], a[8:11], v[192:207]
    ds_read_b64_tr_b16 v[72:73], v37 offset:30720
    ds_read_b64_tr_b16 v[74:75], v37 offset:32256
    ds_read_b64_tr_b16 v[76:77], v38 offset:30720
    ds_read_b64_tr_b16 v[78:79], v38 offset:32256
    v_mfma_f32_32x32x16_bf16 v[208:223], v[92:95], a[8:11], v[208:223]
    buffer_load_dwordx4 a[4:7], v39, s[16:19], s40 offen offset:1024 sc0 sc1
    s_add_u32 m0, s38, 49152
    s_waitcnt lgkmcnt(4)
    v_mfma_f32_32x32x16_bf16 v[224:239], v[64:67], a[8:11], v[224:239]
    ds_read_b64_tr_b16 v[80:81], v37 offset:30848
    ds_read_b64_tr_b16 v[82:83], v37 offset:32384
    ds_read_b64_tr_b16 v[84:85], v38 offset:30848
    ds_read_b64_tr_b16 v[86:87], v38 offset:32384
    s_add_u32 s41, s64, 1953792
    v_mfma_f32_32x32x16_bf16 v[240:255], v[68:71], a[8:11], v[240:255]
    buffer_load_dwordx4 v32, s[60:63], s41 offen offset:0 lds
    s_waitcnt vmcnt(24)
    s_waitcnt lgkmcnt(4)
    v_mfma_f32_32x32x16_bf16 v[160:175], v[72:75], a[12:15], v[160:175]
    ds_read_b64_tr_b16 v[88:89], v37 offset:30976
    ds_read_b64_tr_b16 v[90:91], v37 offset:32512
    ds_read_b64_tr_b16 v[92:93], v38 offset:30976
    ds_read_b64_tr_b16 v[94:95], v38 offset:32512
    v_mfma_f32_32x32x16_bf16 v[176:191], v[76:79], a[12:15], v[176:191]
    buffer_load_dwordx4 v33, s[60:63], s41 offen offset:1024 lds
    s_waitcnt lgkmcnt(4)
    v_mfma_f32_32x32x16_bf16 v[192:207], v[80:83], a[12:15], v[192:207]
    ds_read_b64_tr_b16 v[64:65], v37 offset:12288
    ds_read_b64_tr_b16 v[66:67], v37 offset:13824
    ds_read_b64_tr_b16 v[68:69], v38 offset:12288
    ds_read_b64_tr_b16 v[70:71], v38 offset:13824
    v_mfma_f32_32x32x16_bf16 v[208:223], v[84:87], a[12:15], v[208:223]
    buffer_load_dwordx4 v34, s[60:63], s41 offen offset:2048 lds
    s_waitcnt lgkmcnt(4)
    v_mfma_f32_32x32x16_bf16 v[224:239], v[88:91], a[12:15], v[224:239]
    ds_read_b64_tr_b16 v[72:73], v37 offset:12416
    ds_read_b64_tr_b16 v[74:75], v37 offset:13952
    ds_read_b64_tr_b16 v[76:77], v38 offset:12416
    ds_read_b64_tr_b16 v[78:79], v38 offset:13952
    v_mfma_f32_32x32x16_bf16 v[240:255], v[92:95], a[12:15], v[240:255]
    s_waitcnt vmcnt(21)
    s_waitcnt lgkmcnt(4)
    v_mfma_f32_32x32x16_bf16 v[160:175], v[64:67], a[16:19], v[160:175]
    s_waitcnt vmcnt(17)
    s_barrier
    ds_read_b64_tr_b16 v[80:81], v37 offset:12544
    ds_read_b64_tr_b16 v[82:83], v37 offset:14080
    ds_read_b64_tr_b16 v[84:85], v38 offset:12544
    ds_read_b64_tr_b16 v[86:87], v38 offset:14080
    s_add_u32 s40, s67, 32768
    v_mfma_f32_32x32x16_bf16 v[176:191], v[68:71], a[16:19], v[176:191]
    buffer_load_dwordx4 a[8:11], v39, s[16:19], s40 offen offset:0 sc0 sc1
    s_waitcnt lgkmcnt(4)
    v_mfma_f32_32x32x16_bf16 v[192:207], v[72:75], a[16:19], v[192:207]
    ds_read_b64_tr_b16 v[88:89], v37 offset:18432
    ds_read_b64_tr_b16 v[90:91], v37 offset:19968
    ds_read_b64_tr_b16 v[92:93], v38 offset:18432
    ds_read_b64_tr_b16 v[94:95], v38 offset:19968
    v_mfma_f32_32x32x16_bf16 v[208:223], v[76:79], a[16:19], v[208:223]
    buffer_load_dwordx4 a[12:15], v39, s[16:19], s40 offen offset:1024 sc0 sc1
    s_add_u32 m0, s38, 147456
    s_waitcnt lgkmcnt(4)
    v_mfma_f32_32x32x16_bf16 v[224:239], v[80:83], a[16:19], v[224:239]
    ds_read_b64_tr_b16 v[64:65], v37 offset:18560
    ds_read_b64_tr_b16 v[66:67], v37 offset:20096
    ds_read_b64_tr_b16 v[68:69], v38 offset:18560
    ds_read_b64_tr_b16 v[70:71], v38 offset:20096
    s_add_u32 s41, s64, 1990656
    v_mfma_f32_32x32x16_bf16 v[240:255], v[84:87], a[16:19], v[240:255]
    buffer_load_dwordx4 v32, s[60:63], s41 offen offset:0 lds
    s_waitcnt lgkmcnt(4)
    v_mfma_f32_32x32x16_bf16 v[160:175], v[88:91], a[20:23], v[160:175]
    ds_read_b64_tr_b16 v[72:73], v37 offset:18688
    ds_read_b64_tr_b16 v[74:75], v37 offset:20224
    ds_read_b64_tr_b16 v[76:77], v38 offset:18688
    ds_read_b64_tr_b16 v[78:79], v38 offset:20224
    v_mfma_f32_32x32x16_bf16 v[176:191], v[92:95], a[20:23], v[176:191]
    buffer_load_dwordx4 v33, s[60:63], s41 offen offset:1024 lds
    s_waitcnt lgkmcnt(4)
    v_mfma_f32_32x32x16_bf16 v[192:207], v[64:67], a[20:23], v[192:207]
    ds_read_b64_tr_b16 v[80:81], v37 offset:0
    ds_read_b64_tr_b16 v[82:83], v37 offset:1536
    ds_read_b64_tr_b16 v[84:85], v38 offset:0
    ds_read_b64_tr_b16 v[86:87], v38 offset:1536
    v_mfma_f32_32x32x16_bf16 v[208:223], v[68:71], a[20:23], v[208:223]
    buffer_load_dwordx4 v34, s[60:63], s41 offen offset:2048 lds
    s_waitcnt lgkmcnt(4)
    v_mfma_f32_32x32x16_bf16 v[224:239], v[72:75], a[20:23], v[224:239]
    ds_read_b64_tr_b16 v[88:89], v37 offset:128
    ds_read_b64_tr_b16 v[90:91], v37 offset:1664
    ds_read_b64_tr_b16 v[92:93], v38 offset:128
    ds_read_b64_tr_b16 v[94:95], v38 offset:1664
    v_mfma_f32_32x32x16_bf16 v[240:255], v[76:79], a[20:23], v[240:255]
    s_waitcnt vmcnt(21)
    s_waitcnt lgkmcnt(4)
    v_mfma_f32_32x32x16_bf16 v[160:175], v[80:83], a[24:27], v[160:175]
    ds_read_b64_tr_b16 v[64:65], v37 offset:256
    ds_read_b64_tr_b16 v[66:67], v37 offset:1792
    ds_read_b64_tr_b16 v[68:69], v38 offset:256
    ds_read_b64_tr_b16 v[70:71], v38 offset:1792
    s_add_u32 s40, s67, 34816
    v_mfma_f32_32x32x16_bf16 v[176:191], v[84:87], a[24:27], v[176:191]
    buffer_load_dwordx4 a[16:19], v39, s[16:19], s40 offen offset:0 sc0 sc1
    s_waitcnt lgkmcnt(4)
    v_mfma_f32_32x32x16_bf16 v[192:207], v[88:91], a[24:27], v[192:207]
    ds_read_b64_tr_b16 v[72:73], v37 offset:6144
    ds_read_b64_tr_b16 v[74:75], v37 offset:7680
    ds_read_b64_tr_b16 v[76:77], v38 offset:6144
    ds_read_b64_tr_b16 v[78:79], v38 offset:7680
    v_mfma_f32_32x32x16_bf16 v[208:223], v[92:95], a[24:27], v[208:223]
    buffer_load_dwordx4 a[20:23], v39, s[16:19], s40 offen offset:1024 sc0 sc1
    s_add_u32 m0, s38, 135168
    s_waitcnt lgkmcnt(4)
    v_mfma_f32_32x32x16_bf16 v[224:239], v[64:67], a[24:27], v[224:239]
    ds_read_b64_tr_b16 v[80:81], v37 offset:6272
    ds_read_b64_tr_b16 v[82:83], v37 offset:7808
    ds_read_b64_tr_b16 v[84:85], v38 offset:6272
    ds_read_b64_tr_b16 v[86:87], v38 offset:7808
    s_add_u32 s41, s64, 2027520
    v_mfma_f32_32x32x16_bf16 v[240:255], v[68:71], a[24:27], v[240:255]
    buffer_load_dwordx4 v32, s[60:63], s41 offen offset:0 lds
    s_waitcnt vmcnt(23)
    s_waitcnt lgkmcnt(4)
    v_mfma_f32_32x32x16_bf16 v[160:175], v[72:75], a[28:31], v[160:175]
    ds_read_b64_tr_b16 v[88:89], v37 offset:6400
    ds_read_b64_tr_b16 v[90:91], v37 offset:7936
    ds_read_b64_tr_b16 v[92:93], v38 offset:6400
    ds_read_b64_tr_b16 v[94:95], v38 offset:7936
    v_mfma_f32_32x32x16_bf16 v[176:191], v[76:79], a[28:31], v[176:191]
    buffer_load_dwordx4 v33, s[60:63], s41 offen offset:1024 lds
    s_waitcnt lgkmcnt(4)
    v_mfma_f32_32x32x16_bf16 v[192:207], v[80:83], a[28:31], v[192:207]
    ds_read_b64_tr_b16 v[64:65], v35 offset:36864
    ds_read_b64_tr_b16 v[66:67], v35 offset:38400
    ds_read_b64_tr_b16 v[68:69], v36 offset:36864
    ds_read_b64_tr_b16 v[70:71], v36 offset:38400
    v_mfma_f32_32x32x16_bf16 v[208:223], v[84:87], a[28:31], v[208:223]
    buffer_load_dwordx4 v34, s[60:63], s41 offen offset:2048 lds
    s_waitcnt lgkmcnt(4)
    v_mfma_f32_32x32x16_bf16 v[224:239], v[88:91], a[28:31], v[224:239]
    ds_read_b64_tr_b16 v[72:73], v35 offset:36992
    ds_read_b64_tr_b16 v[74:75], v35 offset:38528
    ds_read_b64_tr_b16 v[76:77], v36 offset:36992
    ds_read_b64_tr_b16 v[78:79], v36 offset:38528
    v_mfma_f32_32x32x16_bf16 v[240:255], v[92:95], a[28:31], v[240:255]
    s_waitcnt vmcnt(19)
    s_waitcnt lgkmcnt(4)
    v_mfma_f32_32x32x16_bf16 v[160:175], v[64:67], a[32:35], v[160:175]
    s_waitcnt vmcnt(15)
    s_barrier
    v_mov_b32 v60, s68
    v_mov_b32 v61, 0
    s_mov_b64 exec, 1
    buffer_store_dword v60, v61, s[16:19], s50 offen offset:0 sc0 sc1
    s_mov_b64 exec, -1
    ds_read_b64_tr_b16 v[80:81], v35 offset:37120
    ds_read_b64_tr_b16 v[82:83], v35 offset:38656
    ds_read_b64_tr_b16 v[84:85], v36 offset:37120
    ds_read_b64_tr_b16 v[86:87], v36 offset:38656
    v_mfma_f32_32x32x16_bf16 v[176:191], v[68:71], a[32:35], v[176:191]
    s_add_u32 s40, s67, 36864
    buffer_load_dwordx4 a[24:27], v39, s[16:19], s40 offen offset:0 sc0 sc1
    s_waitcnt lgkmcnt(4)
    v_mfma_f32_32x32x16_bf16 v[192:207], v[72:75], a[32:35], v[192:207]
    ds_read_b64_tr_b16 v[88:89], v35 offset:43008
    ds_read_b64_tr_b16 v[90:91], v35 offset:44544
    ds_read_b64_tr_b16 v[92:93], v36 offset:43008
    ds_read_b64_tr_b16 v[94:95], v36 offset:44544
    v_mfma_f32_32x32x16_bf16 v[208:223], v[76:79], a[32:35], v[208:223]
    buffer_load_dwordx4 a[28:31], v39, s[16:19], s40 offen offset:1024 sc0 sc1
    s_add_u32 m0, s38, 122880
    s_waitcnt lgkmcnt(4)
    v_mfma_f32_32x32x16_bf16 v[224:239], v[80:83], a[32:35], v[224:239]
    ds_read_b64_tr_b16 v[64:65], v35 offset:43136
    ds_read_b64_tr_b16 v[66:67], v35 offset:44672
    ds_read_b64_tr_b16 v[68:69], v36 offset:43136
    ds_read_b64_tr_b16 v[70:71], v36 offset:44672
    s_add_u32 s41, s64, 2064384
    v_mfma_f32_32x32x16_bf16 v[240:255], v[84:87], a[32:35], v[240:255]
    buffer_load_dwordx4 v32, s[60:63], s41 offen offset:0 lds
    s_waitcnt lgkmcnt(4)
    v_mfma_f32_32x32x16_bf16 v[160:175], v[88:91], a[36:39], v[160:175]
    ds_read_b64_tr_b16 v[72:73], v35 offset:43264
    ds_read_b64_tr_b16 v[74:75], v35 offset:44800
    ds_read_b64_tr_b16 v[76:77], v36 offset:43264
    ds_read_b64_tr_b16 v[78:79], v36 offset:44800
    v_mfma_f32_32x32x16_bf16 v[176:191], v[92:95], a[36:39], v[176:191]
    buffer_load_dwordx4 v33, s[60:63], s41 offen offset:1024 lds
    s_waitcnt lgkmcnt(4)
    v_mfma_f32_32x32x16_bf16 v[192:207], v[64:67], a[36:39], v[192:207]
    ds_read_b64_tr_b16 v[80:81], v35 offset:24576
    ds_read_b64_tr_b16 v[82:83], v35 offset:26112
    ds_read_b64_tr_b16 v[84:85], v36 offset:24576
    ds_read_b64_tr_b16 v[86:87], v36 offset:26112
    v_mfma_f32_32x32x16_bf16 v[208:223], v[68:71], a[36:39], v[208:223]
    buffer_load_dwordx4 v34, s[60:63], s41 offen offset:2048 lds
    s_waitcnt lgkmcnt(4)
    v_mfma_f32_32x32x16_bf16 v[224:239], v[72:75], a[36:39], v[224:239]
    ds_read_b64_tr_b16 v[88:89], v35 offset:24704
    ds_read_b64_tr_b16 v[90:91], v35 offset:26240
    ds_read_b64_tr_b16 v[92:93], v36 offset:24704
    ds_read_b64_tr_b16 v[94:95], v36 offset:26240
    v_mfma_f32_32x32x16_bf16 v[240:255], v[76:79], a[36:39], v[240:255]
    s_waitcnt vmcnt(20)
    s_waitcnt lgkmcnt(4)
    v_mfma_f32_32x32x16_bf16 v[160:175], v[80:83], a[0:3], v[160:175]
    ds_read_b64_tr_b16 v[64:65], v35 offset:24832
    ds_read_b64_tr_b16 v[66:67], v35 offset:26368
    ds_read_b64_tr_b16 v[68:69], v36 offset:24832
    ds_read_b64_tr_b16 v[70:71], v36 offset:26368
    s_add_u32 s40, s67, 38912
    v_mfma_f32_32x32x16_bf16 v[176:191], v[84:87], a[0:3], v[176:191]
    buffer_load_dwordx4 a[32:35], v39, s[16:19], s40 offen offset:0 sc0 sc1
    s_waitcnt lgkmcnt(4)
    v_mfma_f32_32x32x16_bf16 v[192:207], v[88:91], a[0:3], v[192:207]
    ds_read_b64_tr_b16 v[72:73], v35 offset:30720
    ds_read_b64_tr_b16 v[74:75], v35 offset:32256
    ds_read_b64_tr_b16 v[76:77], v36 offset:30720
    ds_read_b64_tr_b16 v[78:79], v36 offset:32256
    v_mfma_f32_32x32x16_bf16 v[208:223], v[92:95], a[0:3], v[208:223]
    buffer_load_dwordx4 a[36:39], v39, s[16:19], s40 offen offset:1024 sc0 sc1
    s_add_u32 m0, s38, 110592
    s_waitcnt lgkmcnt(4)
    v_mfma_f32_32x32x16_bf16 v[224:239], v[64:67], a[0:3], v[224:239]
    ds_read_b64_tr_b16 v[80:81], v35 offset:30848
    ds_read_b64_tr_b16 v[82:83], v35 offset:32384
    ds_read_b64_tr_b16 v[84:85], v36 offset:30848
    ds_read_b64_tr_b16 v[86:87], v36 offset:32384
    s_add_u32 s41, s64, 2101248
    v_mfma_f32_32x32x16_bf16 v[240:255], v[68:71], a[0:3], v[240:255]
    buffer_load_dwordx4 v32, s[60:63], s41 offen offset:0 lds
    s_waitcnt vmcnt(22)
    s_waitcnt lgkmcnt(4)
    v_mfma_f32_32x32x16_bf16 v[160:175], v[72:75], a[4:7], v[160:175]
    ds_read_b64_tr_b16 v[88:89], v35 offset:30976
    ds_read_b64_tr_b16 v[90:91], v35 offset:32512
    ds_read_b64_tr_b16 v[92:93], v36 offset:30976
    ds_read_b64_tr_b16 v[94:95], v36 offset:32512
    v_mfma_f32_32x32x16_bf16 v[176:191], v[76:79], a[4:7], v[176:191]
    buffer_load_dwordx4 v33, s[60:63], s41 offen offset:1024 lds
    s_waitcnt lgkmcnt(4)
    v_mfma_f32_32x32x16_bf16 v[192:207], v[80:83], a[4:7], v[192:207]
    ds_read_b64_tr_b16 v[64:65], v35 offset:12288
    ds_read_b64_tr_b16 v[66:67], v35 offset:13824
    ds_read_b64_tr_b16 v[68:69], v36 offset:12288
    ds_read_b64_tr_b16 v[70:71], v36 offset:13824
    v_mfma_f32_32x32x16_bf16 v[208:223], v[84:87], a[4:7], v[208:223]
    buffer_load_dwordx4 v34, s[60:63], s41 offen offset:2048 lds
    s_waitcnt lgkmcnt(4)
    v_mfma_f32_32x32x16_bf16 v[224:239], v[88:91], a[4:7], v[224:239]
    ds_read_b64_tr_b16 v[72:73], v35 offset:12416
    ds_read_b64_tr_b16 v[74:75], v35 offset:13952
    ds_read_b64_tr_b16 v[76:77], v36 offset:12416
    ds_read_b64_tr_b16 v[78:79], v36 offset:13952
    v_mfma_f32_32x32x16_bf16 v[240:255], v[92:95], a[4:7], v[240:255]
    s_waitcnt vmcnt(20)
    s_waitcnt lgkmcnt(4)
    v_mfma_f32_32x32x16_bf16 v[160:175], v[64:67], a[8:11], v[160:175]
    s_waitcnt vmcnt(16)
    s_barrier
    ds_read_b64_tr_b16 v[80:81], v35 offset:12544
    ds_read_b64_tr_b16 v[82:83], v35 offset:14080
    ds_read_b64_tr_b16 v[84:85], v36 offset:12544
    ds_read_b64_tr_b16 v[86:87], v36 offset:14080
    s_add_u32 s40, s67, 40960
    v_mfma_f32_32x32x16_bf16 v[176:191], v[68:71], a[8:11], v[176:191]
    buffer_load_dwordx4 a[0:3], v39, s[16:19], s40 offen offset:0 sc0 sc1
    s_waitcnt lgkmcnt(4)
    v_mfma_f32_32x32x16_bf16 v[192:207], v[72:75], a[8:11], v[192:207]
    ds_read_b64_tr_b16 v[88:89], v35 offset:18432
    ds_read_b64_tr_b16 v[90:91], v35 offset:19968
    ds_read_b64_tr_b16 v[92:93], v36 offset:18432
    ds_read_b64_tr_b16 v[94:95], v36 offset:19968
    v_mfma_f32_32x32x16_bf16 v[208:223], v[76:79], a[8:11], v[208:223]
    buffer_load_dwordx4 a[4:7], v39, s[16:19], s40 offen offset:1024 sc0 sc1
    s_add_u32 m0, s38, 98304
    s_waitcnt lgkmcnt(4)
    v_mfma_f32_32x32x16_bf16 v[224:239], v[80:83], a[8:11], v[224:239]
    ds_read_b64_tr_b16 v[64:65], v35 offset:18560
    ds_read_b64_tr_b16 v[66:67], v35 offset:20096
    ds_read_b64_tr_b16 v[68:69], v36 offset:18560
    ds_read_b64_tr_b16 v[70:71], v36 offset:20096
    s_add_u32 s41, s64, 2138112
    v_mfma_f32_32x32x16_bf16 v[240:255], v[84:87], a[8:11], v[240:255]
    buffer_load_dwordx4 v32, s[60:63], s41 offen offset:0 lds
    s_waitcnt lgkmcnt(4)
    v_mfma_f32_32x32x16_bf16 v[160:175], v[88:91], a[12:15], v[160:175]
    ds_read_b64_tr_b16 v[72:73], v35 offset:18688
    ds_read_b64_tr_b16 v[74:75], v35 offset:20224
    ds_read_b64_tr_b16 v[76:77], v36 offset:18688
    ds_read_b64_tr_b16 v[78:79], v36 offset:20224
    v_mfma_f32_32x32x16_bf16 v[176:191], v[92:95], a[12:15], v[176:191]
    buffer_load_dwordx4 v33, s[60:63], s41 offen offset:1024 lds
    s_waitcnt lgkmcnt(4)
    v_mfma_f32_32x32x16_bf16 v[192:207], v[64:67], a[12:15], v[192:207]
    ds_read_b64_tr_b16 v[80:81], v35 offset:0
    ds_read_b64_tr_b16 v[82:83], v35 offset:1536
    ds_read_b64_tr_b16 v[84:85], v36 offset:0
    ds_read_b64_tr_b16 v[86:87], v36 offset:1536
    v_mfma_f32_32x32x16_bf16 v[208:223], v[68:71], a[12:15], v[208:223]
    buffer_load_dwordx4 v34, s[60:63], s41 offen offset:2048 lds
    s_waitcnt lgkmcnt(4)
    v_mfma_f32_32x32x16_bf16 v[224:239], v[72:75], a[12:15], v[224:239]
    ds_read_b64_tr_b16 v[88:89], v35 offset:128
    ds_read_b64_tr_b16 v[90:91], v35 offset:1664
    ds_read_b64_tr_b16 v[92:93], v36 offset:128
    ds_read_b64_tr_b16 v[94:95], v36 offset:1664
    v_mfma_f32_32x32x16_bf16 v[240:255], v[76:79], a[12:15], v[240:255]
    s_waitcnt vmcnt(20)
    s_waitcnt lgkmcnt(4)
    v_mfma_f32_32x32x16_bf16 v[160:175], v[80:83], a[16:19], v[160:175]
    ds_read_b64_tr_b16 v[64:65], v35 offset:256
    ds_read_b64_tr_b16 v[66:67], v35 offset:1792
    ds_read_b64_tr_b16 v[68:69], v36 offset:256
    ds_read_b64_tr_b16 v[70:71], v36 offset:1792
    s_add_u32 s40, s67, 43008
    v_mfma_f32_32x32x16_bf16 v[176:191], v[84:87], a[16:19], v[176:191]
    buffer_load_dwordx4 a[8:11], v39, s[16:19], s40 offen offset:0 sc0 sc1
    s_waitcnt lgkmcnt(4)
    v_mfma_f32_32x32x16_bf16 v[192:207], v[88:91], a[16:19], v[192:207]
    ds_read_b64_tr_b16 v[72:73], v35 offset:6144
    ds_read_b64_tr_b16 v[74:75], v35 offset:7680
    ds_read_b64_tr_b16 v[76:77], v36 offset:6144
    ds_read_b64_tr_b16 v[78:79], v36 offset:7680
    v_mfma_f32_32x32x16_bf16 v[208:223], v[92:95], a[16:19], v[208:223]
    buffer_load_dwordx4 a[12:15], v39, s[16:19], s40 offen offset:1024 sc0 sc1
    s_add_u32 m0, s38, 86016
    s_waitcnt lgkmcnt(4)
    v_mfma_f32_32x32x16_bf16 v[224:239], v[64:67], a[16:19], v[224:239]
    ds_read_b64_tr_b16 v[80:81], v35 offset:6272
    ds_read_b64_tr_b16 v[82:83], v35 offset:7808
    ds_read_b64_tr_b16 v[84:85], v36 offset:6272
    ds_read_b64_tr_b16 v[86:87], v36 offset:7808
    s_add_u32 s41, s64, 2174976
    v_mfma_f32_32x32x16_bf16 v[240:255], v[68:71], a[16:19], v[240:255]
    buffer_load_dwordx4 v32, s[60:63], s41 offen offset:0 lds
    s_waitcnt vmcnt(22)
    s_waitcnt lgkmcnt(4)
    v_mfma_f32_32x32x16_bf16 v[160:175], v[72:75], a[20:23], v[160:175]
    ds_read_b64_tr_b16 v[88:89], v35 offset:6400
    ds_read_b64_tr_b16 v[90:91], v35 offset:7936
    ds_read_b64_tr_b16 v[92:93], v36 offset:6400
    ds_read_b64_tr_b16 v[94:95], v36 offset:7936
    v_mfma_f32_32x32x16_bf16 v[176:191], v[76:79], a[20:23], v[176:191]
    buffer_load_dwordx4 v33, s[60:63], s41 offen offset:1024 lds
    s_waitcnt lgkmcnt(4)
    v_mfma_f32_32x32x16_bf16 v[192:207], v[80:83], a[20:23], v[192:207]
    ds_read_b64_tr_b16 v[64:65], v31 offset:0
    ds_read_b64_tr_b16 v[66:67], v31 offset:1536
    ds_read_b64_tr_b16 v[68:69], v30 offset:0
    ds_read_b64_tr_b16 v[70:71], v30 offset:1536
    v_mfma_f32_32x32x16_bf16 v[208:223], v[84:87], a[20:23], v[208:223]
    buffer_load_dwordx4 v34, s[60:63], s41 offen offset:2048 lds
    s_waitcnt lgkmcnt(4)
    v_mfma_f32_32x32x16_bf16 v[224:239], v[88:91], a[20:23], v[224:239]
    ds_read_b64_tr_b16 v[72:73], v31 offset:128
    ds_read_b64_tr_b16 v[74:75], v31 offset:1664
    ds_read_b64_tr_b16 v[76:77], v30 offset:128
    ds_read_b64_tr_b16 v[78:79], v30 offset:1664
    v_mfma_f32_32x32x16_bf16 v[240:255], v[92:95], a[20:23], v[240:255]
    s_waitcnt vmcnt(19)
    s_waitcnt lgkmcnt(4)
    v_mfma_f32_32x32x16_bf16 v[160:175], v[64:67], a[24:27], v[160:175]
    s_waitcnt vmcnt(15)
    s_barrier
    ds_read_b64_tr_b16 v[80:81], v31 offset:256
    ds_read_b64_tr_b16 v[82:83], v31 offset:1792
    ds_read_b64_tr_b16 v[84:85], v30 offset:256
    ds_read_b64_tr_b16 v[86:87], v30 offset:1792
    v_and_b32 v2, 15, v0
    v_mfma_f32_32x32x16_bf16 v[176:191], v[68:71], a[24:27], v[176:191]
    v_lshlrev_b32 v2, 2, v2
    buffer_load_dword v3, v2, s[16:19], s48 offen offset:0 sc0 sc1
    s_waitcnt lgkmcnt(4)
    v_mfma_f32_32x32x16_bf16 v[192:207], v[72:75], a[24:27], v[192:207]
    ds_read_b64_tr_b16 v[88:89], v31 offset:6144
    ds_read_b64_tr_b16 v[90:91], v31 offset:7680
    ds_read_b64_tr_b16 v[92:93], v30 offset:6144
    ds_read_b64_tr_b16 v[94:95], v30 offset:7680
    s_add_u32 s40, s67, 45056
    v_mfma_f32_32x32x16_bf16 v[208:223], v[76:79], a[24:27], v[208:223]
    buffer_load_dwordx4 a[16:19], v39, s[16:19], s40 offen offset:0 sc0 sc1
    s_waitcnt lgkmcnt(4)
    v_mfma_f32_32x32x16_bf16 v[224:239], v[80:83], a[24:27], v[224:239]
    ds_read_b64_tr_b16 v[64:65], v31 offset:6272
    ds_read_b64_tr_b16 v[66:67], v31 offset:7808
    ds_read_b64_tr_b16 v[68:69], v30 offset:6272
    ds_read_b64_tr_b16 v[70:71], v30 offset:7808
    v_mfma_f32_32x32x16_bf16 v[240:255], v[84:87], a[24:27], v[240:255]
    buffer_load_dwordx4 a[20:23], v39, s[16:19], s40 offen offset:1024 sc0 sc1
    s_add_u32 m0, s38, 73728
    s_waitcnt lgkmcnt(4)
    v_mfma_f32_32x32x16_bf16 v[160:175], v[88:91], a[28:31], v[160:175]
    ds_read_b64_tr_b16 v[72:73], v31 offset:6400
    ds_read_b64_tr_b16 v[74:75], v31 offset:7936
    ds_read_b64_tr_b16 v[76:77], v30 offset:6400
    ds_read_b64_tr_b16 v[78:79], v30 offset:7936
    s_add_u32 s41, s64, 3538944
    v_mfma_f32_32x32x16_bf16 v[176:191], v[92:95], a[28:31], v[176:191]
    buffer_load_dwordx4 v32, s[60:63], s41 offen offset:0 lds
    s_waitcnt lgkmcnt(4)
    v_mfma_f32_32x32x16_bf16 v[192:207], v[64:67], a[28:31], v[192:207]
    ds_read_b64_tr_b16 v[80:81], v37 offset:36864
    ds_read_b64_tr_b16 v[82:83], v37 offset:38400
    ds_read_b64_tr_b16 v[84:85], v38 offset:36864
    ds_read_b64_tr_b16 v[86:87], v38 offset:38400
    v_mfma_f32_32x32x16_bf16 v[208:223], v[68:71], a[28:31], v[208:223]
    buffer_load_dwordx4 v33, s[60:63], s41 offen offset:1024 lds
    s_waitcnt lgkmcnt(4)
    v_mfma_f32_32x32x16_bf16 v[224:239], v[72:75], a[28:31], v[224:239]
    ds_read_b64_tr_b16 v[88:89], v37 offset:36992
    ds_read_b64_tr_b16 v[90:91], v37 offset:38528
    ds_read_b64_tr_b16 v[92:93], v38 offset:36992
    ds_read_b64_tr_b16 v[94:95], v38 offset:38528
    v_mfma_f32_32x32x16_bf16 v[240:255], v[76:79], a[28:31], v[240:255]
    buffer_load_dwordx4 v34, s[60:63], s41 offen offset:2048 lds
    s_waitcnt vmcnt(20)
    s_waitcnt lgkmcnt(4)
    v_mfma_f32_32x32x16_bf16 v[160:175], v[80:83], a[32:35], v[160:175]
    ds_read_b64_tr_b16 v[64:65], v37 offset:37120
    ds_read_b64_tr_b16 v[66:67], v37 offset:38656
    ds_read_b64_tr_b16 v[68:69], v38 offset:37120
    ds_read_b64_tr_b16 v[70:71], v38 offset:38656
    s_add_u32 s40, s67, 47104
    v_mfma_f32_32x32x16_bf16 v[176:191], v[84:87], a[32:35], v[176:191]
    buffer_load_dwordx4 a[24:27], v39, s[16:19], s40 offen offset:0 sc0 sc1
    s_waitcnt lgkmcnt(4)
    v_mfma_f32_32x32x16_bf16 v[192:207], v[88:91], a[32:35], v[192:207]
    ds_read_b64_tr_b16 v[72:73], v37 offset:43008
    ds_read_b64_tr_b16 v[74:75], v37 offset:44544
    ds_read_b64_tr_b16 v[76:77], v38 offset:43008
    ds_read_b64_tr_b16 v[78:79], v38 offset:44544
    v_mfma_f32_32x32x16_bf16 v[208:223], v[92:95], a[32:35], v[208:223]
    buffer_load_dwordx4 a[28:31], v39, s[16:19], s40 offen offset:1024 sc0 sc1
    s_add_u32 m0, s38, 61440
    s_waitcnt lgkmcnt(4)
    v_mfma_f32_32x32x16_bf16 v[224:239], v[64:67], a[32:35], v[224:239]
    ds_read_b64_tr_b16 v[80:81], v37 offset:43136
    ds_read_b64_tr_b16 v[82:83], v37 offset:44672
    ds_read_b64_tr_b16 v[84:85], v38 offset:43136
    ds_read_b64_tr_b16 v[86:87], v38 offset:44672
    s_add_u32 s41, s64, 3575808
    v_mfma_f32_32x32x16_bf16 v[240:255], v[68:71], a[32:35], v[240:255]
    buffer_load_dwordx4 v32, s[60:63], s41 offen offset:0 lds
    s_waitcnt vmcnt(22)
    s_waitcnt lgkmcnt(4)
    v_mfma_f32_32x32x16_bf16 v[160:175], v[72:75], a[36:39], v[160:175]
    ds_read_b64_tr_b16 v[88:89], v37 offset:43264
    ds_read_b64_tr_b16 v[90:91], v37 offset:44800
    ds_read_b64_tr_b16 v[92:93], v38 offset:43264
    ds_read_b64_tr_b16 v[94:95], v38 offset:44800
    v_mfma_f32_32x32x16_bf16 v[176:191], v[76:79], a[36:39], v[176:191]
    buffer_load_dwordx4 v33, s[60:63], s41 offen offset:1024 lds
    s_waitcnt lgkmcnt(4)
    v_mfma_f32_32x32x16_bf16 v[192:207], v[80:83], a[36:39], v[192:207]
    ds_read_b64_tr_b16 v[64:65], v37 offset:24576
    ds_read_b64_tr_b16 v[66:67], v37 offset:26112
    ds_read_b64_tr_b16 v[68:69], v38 offset:24576
    ds_read_b64_tr_b16 v[70:71], v38 offset:26112
    v_mfma_f32_32x32x16_bf16 v[208:223], v[84:87], a[36:39], v[208:223]
    buffer_load_dwordx4 v34, s[60:63], s41 offen offset:2048 lds
    s_waitcnt lgkmcnt(4)
    v_mfma_f32_32x32x16_bf16 v[224:239], v[88:91], a[36:39], v[224:239]
    ds_read_b64_tr_b16 v[72:73], v37 offset:24704
    ds_read_b64_tr_b16 v[74:75], v37 offset:26240
    ds_read_b64_tr_b16 v[76:77], v38 offset:24704
    ds_read_b64_tr_b16 v[78:79], v38 offset:26240
    v_mfma_f32_32x32x16_bf16 v[240:255], v[92:95], a[36:39], v[240:255]
    s_waitcnt vmcnt(20)
    s_waitcnt lgkmcnt(4)
    v_mfma_f32_32x32x16_bf16 v[160:175], v[64:67], a[0:3], v[160:175]
    s_waitcnt vmcnt(16)
    s_barrier
    s_waitcnt vmcnt(10)
    s_mov_b32 s69, 200000
    s_mov_b64 exec, 63
L_FC5623:
    v_cmp_ne_u32 vcc, s68, v3
    s_sub_u32 s69, s69, 1
    s_nop 4
    s_cbranch_vccz L_FC5623_D
    s_cmp_eq_u32 s69, 0
    s_cbranch_scc1 L_FC5623_D
    s_sleep 2
    buffer_load_dword v3, v2, s[16:19], s48 offen offset:0 sc0 sc1
    s_waitcnt vmcnt(0)
    s_branch L_FC5623
L_FC5623_D:
    s_mov_b64 exec, -1
    s_nop 3
    ds_read_b64_tr_b16 v[80:81], v37 offset:24832
    ds_read_b64_tr_b16 v[82:83], v37 offset:26368
    ds_read_b64_tr_b16 v[84:85], v38 offset:24832
    ds_read_b64_tr_b16 v[86:87], v38 offset:26368
    v_mfma_f32_32x32x16_bf16 v[176:191], v[68:71], a[0:3], v[176:191]
    s_add_u32 s40, s67, 49152
    buffer_load_dwordx4 a[32:35], v39, s[16:19], s40 offen offset:0 sc0 sc1
    s_waitcnt lgkmcnt(4)
    v_mfma_f32_32x32x16_bf16 v[192:207], v[72:75], a[0:3], v[192:207]
    ds_read_b64_tr_b16 v[88:89], v37 offset:30720
    ds_read_b64_tr_b16 v[90:91], v37 offset:32256
    ds_read_b64_tr_b16 v[92:93], v38 offset:30720
    ds_read_b64_tr_b16 v[94:95], v38 offset:32256
    v_mfma_f32_32x32x16_bf16 v[208:223], v[76:79], a[0:3], v[208:223]
    buffer_load_dwordx4 a[36:39], v39, s[16:19], s40 offen offset:1024 sc0 sc1
    s_add_u32 m0, s38, 49152
    s_waitcnt lgkmcnt(4)
    v_mfma_f32_32x32x16_bf16 v[224:239], v[80:83], a[0:3], v[224:239]
    ds_read_b64_tr_b16 v[64:65], v37 offset:30848
    ds_read_b64_tr_b16 v[66:67], v37 offset:32384
    ds_read_b64_tr_b16 v[68:69], v38 offset:30848
    ds_read_b64_tr_b16 v[70:71], v38 offset:32384
    s_add_u32 s41, s64, 3612672
    v_mfma_f32_32x32x16_bf16 v[240:255], v[84:87], a[0:3], v[240:255]
    buffer_load_dwordx4 v32, s[60:63], s41 offen offset:0 lds
    s_waitcnt lgkmcnt(4)
    v_mfma_f32_32x32x16_bf16 v[160:175], v[88:91], a[4:7], v[160:175]
    ds_read_b64_tr_b16 v[72:73], v37 offset:30976
    ds_read_b64_tr_b16 v[74:75], v37 offset:32512
    ds_read_b64_tr_b16 v[76:77], v38 offset:30976
    ds_read_b64_tr_b16 v[78:79], v38 offset:32512
    v_mfma_f32_32x32x16_bf16 v[176:191], v[92:95], a[4:7], v[176:191]
    buffer_load_dwordx4 v33, s[60:63], s41 offen offset:1024 lds
    s_waitcnt lgkmcnt(4)
    v_mfma_f32_32x32x16_bf16 v[192:207], v[64:67], a[4:7], v[192:207]
    ds_read_b64_tr_b16 v[80:81], v37 offset:12288
    ds_read_b64_tr_b16 v[82:83], v37 offset:13824
    ds_read_b64_tr_b16 v[84:85], v38 offset:12288
    ds_read_b64_tr_b16 v[86:87], v38 offset:13824
    v_mfma_f32_32x32x16_bf16 v[208:223], v[68:71], a[4:7], v[208:223]
    buffer_load_dwordx4 v34, s[60:63], s41 offen offset:2048 lds
    s_waitcnt lgkmcnt(4)
    v_mfma_f32_32x32x16_bf16 v[224:239], v[72:75], a[4:7], v[224:239]
    ds_read_b64_tr_b16 v[88:89], v37 offset:12416
    ds_read_b64_tr_b16 v[90:91], v37 offset:13952
    ds_read_b64_tr_b16 v[92:93], v38 offset:12416
    ds_read_b64_tr_b16 v[94:95], v38 offset:13952
    v_mfma_f32_32x32x16_bf16 v[240:255], v[76:79], a[4:7], v[240:255]
    s_waitcnt lgkmcnt(4)
    v_mfma_f32_32x32x16_bf16 v[160:175], v[80:83], a[8:11], v[160:175]
    ds_read_b64_tr_b16 v[64:65], v37 offset:12544
    ds_read_b64_tr_b16 v[66:67], v37 offset:14080
    ds_read_b64_tr_b16 v[68:69], v38 offset:12544
    ds_read_b64_tr_b16 v[70:71], v38 offset:14080
    s_add_u32 s40, s67, 51200
    v_mfma_f32_32x32x16_bf16 v[176:191], v[84:87], a[8:11], v[176:191]
    buffer_load_dwordx4 a[0:3], v39, s[16:19], s40 offen offset:0 sc0 sc1
    s_waitcnt lgkmcnt(4)
    v_mfma_f32_32x32x16_bf16 v[192:207], v[88:91], a[8:11], v[192:207]
    ds_read_b64_tr_b16 v[72:73], v37 offset:18432
    ds_read_b64_tr_b16 v[74:75], v37 offset:19968
    ds_read_b64_tr_b16 v[76:77], v38 offset:18432
    ds_read_b64_tr_b16 v[78:79], v38 offset:19968
    v_mfma_f32_32x32x16_bf16 v[208:223], v[92:95], a[8:11], v[208:223]
    buffer_load_dwordx4 a[4:7], v39, s[16:19], s40 offen offset:1024 sc0 sc1
    s_add_u32 m0, s38, 147456
    s_waitcnt lgkmcnt(4)
    v_mfma_f32_32x32x16_bf16 v[224:239], v[64:67], a[8:11], v[224:239]
    ds_read_b64_tr_b16 v[80:81], v37 offset:18560
    ds_read_b64_tr_b16 v[82:83], v37 offset:20096
    ds_read_b64_tr_b16 v[84:85], v38 offset:18560
    ds_read_b64_tr_b16 v[86:87], v38 offset:20096
    s_add_u32 s41, s64, 3649536
    v_mfma_f32_32x32x16_bf16 v[240:255], v[68:71], a[8:11], v[240:255]
    buffer_load_dwordx4 v32, s[60:63], s41 offen offset:0 lds
    s_waitcnt lgkmcnt(4)
    v_mfma_f32_32x32x16_bf16 v[160:175], v[72:75], a[12:15], v[160:175]
    ds_read_b64_tr_b16 v[88:89], v37 offset:18688
    ds_read_b64_tr_b16 v[90:91], v37 offset:20224
    ds_read_b64_tr_b16 v[92:93], v38 offset:18688
    ds_read_b64_tr_b16 v[94:95], v38 offset:20224
    v_mfma_f32_32x32x16_bf16 v[176:191], v[76:79], a[12:15], v[176:191]
    buffer_load_dwordx4 v33, s[60:63], s41 offen offset:1024 lds
    s_waitcnt lgkmcnt(4)
    v_mfma_f32_32x32x16_bf16 v[192:207], v[80:83], a[12:15], v[192:207]
    ds_read_b64_tr_b16 v[64:65], v37 offset:0
    ds_read_b64_tr_b16 v[66:67], v37 offset:1536
    ds_read_b64_tr_b16 v[68:69], v38 offset:0
    ds_read_b64_tr_b16 v[70:71], v38 offset:1536
    v_mfma_f32_32x32x16_bf16 v[208:223], v[84:87], a[12:15], v[208:223]
    buffer_load_dwordx4 v34, s[60:63], s41 offen offset:2048 lds
    s_waitcnt lgkmcnt(4)
    v_mfma_f32_32x32x16_bf16 v[224:239], v[88:91], a[12:15], v[224:239]
    ds_read_b64_tr_b16 v[72:73], v37 offset:128
    ds_read_b64_tr_b16 v[74:75], v37 offset:1664
    ds_read_b64_tr_b16 v[76:77], v38 offset:128
    ds_read_b64_tr_b16 v[78:79], v38 offset:1664
    v_mfma_f32_32x32x16_bf16 v[240:255], v[92:95], a[12:15], v[240:255]
    s_waitcnt vmcnt(19)
    s_waitcnt lgkmcnt(4)
    v_mfma_f32_32x32x16_bf16 v[160:175], v[64:67], a[16:19], v[160:175]
    s_waitcnt vmcnt(15)
    s_barrier
    ds_read_b64_tr_b16 v[80:81], v37 offset:256
    ds_read_b64_tr_b16 v[82:83], v37 offset:1792
    ds_read_b64_tr_b16 v[84:85], v38 offset:256
    ds_read_b64_tr_b16 v[86:87], v38 offset:1792
    s_add_u32 s40, s67, 53248
    v_mfma_f32_32x32x16_bf16 v[176:191], v[68:71], a[16:19], v[176:191]
    buffer_load_dwordx4 a[8:11], v39, s[16:19], s40 offen offset:0 sc0 sc1
    s_waitcnt lgkmcnt(4)
    v_mfma_f32_32x32x16_bf16 v[192:207], v[72:75], a[16:19], v[192:207]
    ds_read_b64_tr_b16 v[88:89], v37 offset:6144
    ds_read_b64_tr_b16 v[90:91], v37 offset:7680
    ds_read_b64_tr_b16 v[92:93], v38 offset:6144
    ds_read_b64_tr_b16 v[94:95], v38 offset:7680
    v_mfma_f32_32x32x16_bf16 v[208:223], v[76:79], a[16:19], v[208:223]
    buffer_load_dwordx4 a[12:15], v39, s[16:19], s40 offen offset:1024 sc0 sc1
    s_add_u32 m0, s38, 135168
    s_waitcnt lgkmcnt(4)
    v_mfma_f32_32x32x16_bf16 v[224:239], v[80:83], a[16:19], v[224:239]
    ds_read_b64_tr_b16 v[64:65], v37 offset:6272
    ds_read_b64_tr_b16 v[66:67], v37 offset:7808
    ds_read_b64_tr_b16 v[68:69], v38 offset:6272
    ds_read_b64_tr_b16 v[70:71], v38 offset:7808
    s_add_u32 s41, s64, 3686400
    v_mfma_f32_32x32x16_bf16 v[240:255], v[84:87], a[16:19], v[240:255]
    buffer_load_dwordx4 v32, s[60:63], s41 offen offset:0 lds
    s_waitcnt lgkmcnt(4)
    v_mfma_f32_32x32x16_bf16 v[160:175], v[88:91], a[20:23], v[160:175]
    ds_read_b64_tr_b16 v[72:73], v37 offset:6400
    ds_read_b64_tr_b16 v[74:75], v37 offset:7936
    ds_read_b64_tr_b16 v[76:77], v38 offset:6400
    ds_read_b64_tr_b16 v[78:79], v38 offset:7936
    v_mfma_f32_32x32x16_bf16 v[176:191], v[92:95], a[20:23], v[176:191]
    buffer_load_dwordx4 v33, s[60:63], s41 offen offset:1024 lds
    s_waitcnt lgkmcnt(4)
    v_mfma_f32_32x32x16_bf16 v[192:207], v[64:67], a[20:23], v[192:207]
    ds_read_b64_tr_b16 v[80:81], v35 offset:36864
    ds_read_b64_tr_b16 v[82:83], v35 offset:38400
    ds_read_b64_tr_b16 v[84:85], v36 offset:36864
    ds_read_b64_tr_b16 v[86:87], v36 offset:38400
    v_mfma_f32_32x32x16_bf16 v[208:223], v[68:71], a[20:23], v[208:223]
    buffer_load_dwordx4 v34, s[60:63], s41 offen offset:2048 lds
    s_waitcnt lgkmcnt(4)
    v_mfma_f32_32x32x16_bf16 v[224:239], v[72:75], a[20:23], v[224:239]
    ds_read_b64_tr_b16 v[88:89], v35 offset:36992
    ds_read_b64_tr_b16 v[90:91], v35 offset:38528
    ds_read_b64_tr_b16 v[92:93], v36 offset:36992
    ds_read_b64_tr_b16 v[94:95], v36 offset:38528
    v_mfma_f32_32x32x16_bf16 v[240:255], v[76:79], a[20:23], v[240:255]
    s_waitcnt vmcnt(19)
    s_waitcnt lgkmcnt(4)
    v_mfma_f32_32x32x16_bf16 v[160:175], v[80:83], a[24:27], v[160:175]
    ds_read_b64_tr_b16 v[64:65], v35 offset:37120
    ds_read_b64_tr_b16 v[66:67], v35 offset:38656
    ds_read_b64_tr_b16 v[68:69], v36 offset:37120
    ds_read_b64_tr_b16 v[70:71], v36 offset:38656
    s_add_u32 s40, s67, 55296
    v_mfma_f32_32x32x16_bf16 v[176:191], v[84:87], a[24:27], v[176:191]
    buffer_load_dwordx4 a[16:19], v39, s[16:19], s40 offen offset:0 sc0 sc1
    s_waitcnt lgkmcnt(4)
    v_mfma_f32_32x32x16_bf16 v[192:207], v[88:91], a[24:27], v[192:207]
    ds_read_b64_tr_b16 v[72:73], v35 offset:43008
    ds_read_b64_tr_b16 v[74:75], v35 offset:44544
    ds_read_b64_tr_b16 v[76:77], v36 offset:43008
    ds_read_b64_tr_b16 v[78:79], v36 offset:44544
    v_mfma_f32_32x32x16_bf16 v[208:223], v[92:95], a[24:27], v[208:223]
    buffer_load_dwordx4 a[20:23], v39, s[16:19], s40 offen offset:1024 sc0 sc1
    s_add_u32 m0, s38, 122880
    s_waitcnt lgkmcnt(4)
    v_mfma_f32_32x32x16_bf16 v[224:239], v[64:67], a[24:27], v[224:239]
    ds_read_b64_tr_b16 v[80:81], v35 offset:43136
    ds_read_b64_tr_b16 v[82:83], v35 offset:44672
    ds_read_b64_tr_b16 v[84:85], v36 offset:43136
    ds_read_b64_tr_b16 v[86:87], v36 offset:44672
    s_add_u32 s41, s64, 3723264
    v_mfma_f32_32x32x16_bf16 v[240:255], v[68:71], a[24:27], v[240:255]
    buffer_load_dwordx4 v32, s[60:63], s41 offen offset:0 lds
    s_waitcnt vmcnt(21)
    s_waitcnt lgkmcnt(4)
    v_mfma_f32_32x32x16_bf16 v[160:175], v[72:75], a[28:31], v[160:175]
    ds_read_b64_tr_b16 v[88:89], v35 offset:43264
    ds_read_b64_tr_b16 v[90:91], v35 offset:44800
    ds_read_b64_tr_b16 v[92:93], v36 offset:43264
    ds_read_b64_tr_b16 v[94:95], v36 offset:44800
    v_mfma_f32_32x32x16_bf16 v[176:191], v[76:79], a[28:31], v[176:191]
    buffer_load_dwordx4 v33, s[60:63], s41 offen offset:1024 lds
    s_waitcnt lgkmcnt(4)
    v_mfma_f32_32x32x16_bf16 v[192:207], v[80:83], a[28:31], v[192:207]
    ds_read_b64_tr_b16 v[64:65], v35 offset:24576
    ds_read_b64_tr_b16 v[66:67], v35 offset:26112
    ds_read_b64_tr_b16 v[68:69], v36 offset:24576
    ds_read_b64_tr_b16 v[70:71], v36 offset:26112
    v_mfma_f32_32x32x16_bf16 v[208:223], v[84:87], a[28:31], v[208:223]
    buffer_load_dwordx4 v34, s[60:63], s41 offen offset:2048 lds
    s_waitcnt lgkmcnt(4)
    v_mfma_f32_32x32x16_bf16 v[224:239], v[88:91], a[28:31], v[224:239]
    ds_read_b64_tr_b16 v[72:73], v35 offset:24704
    ds_read_b64_tr_b16 v[74:75], v35 offset:26240
    ds_read_b64_tr_b16 v[76:77], v36 offset:24704
    ds_read_b64_tr_b16 v[78:79], v36 offset:26240
    v_mfma_f32_32x32x16_bf16 v[240:255], v[92:95], a[28:31], v[240:255]
    s_waitcnt vmcnt(19)
    s_waitcnt lgkmcnt(4)
    v_mfma_f32_32x32x16_bf16 v[160:175], v[64:67], a[32:35], v[160:175]
    s_waitcnt vmcnt(15)
    s_barrier
    ds_read_b64_tr_b16 v[80:81], v35 offset:24832
    ds_read_b64_tr_b16 v[82:83], v35 offset:26368
    ds_read_b64_tr_b16 v[84:85], v36 offset:24832
    ds_read_b64_tr_b16 v[86:87], v36 offset:26368
    s_add_u32 s40, s67, 57344
    v_mfma_f32_32x32x16_bf16 v[176:191], v[68:71], a[32:35], v[176:191]
    buffer_load_dwordx4 a[24:27], v39, s[16:19], s40 offen offset:0 sc0 sc1
    s_waitcnt lgkmcnt(4)
    v_mfma_f32_32x32x16_bf16 v[192:207], v[72:75], a[32:35], v[192:207]
    ds_read_b64_tr_b16 v[88:89], v35 offset:30720
    ds_read_b64_tr_b16 v[90:91], v35 offset:32256
    ds_read_b64_tr_b16 v[92:93], v36 offset:30720
    ds_read_b64_tr_b16 v[94:95], v36 offset:32256
    v_mfma_f32_32x32x16_bf16 v[208:223], v[76:79], a[32:35], v[208:223]
    buffer_load_dwordx4 a[28:31], v39, s[16:19], s40 offen offset:1024 sc0 sc1
    s_add_u32 m0, s38, 110592
    s_waitcnt lgkmcnt(4)
    v_mfma_f32_32x32x16_bf16 v[224:239], v[80:83], a[32:35], v[224:239]
    ds_read_b64_tr_b16 v[64:65], v35 offset:30848
    ds_read_b64_tr_b16 v[66:67], v35 offset:32384
    ds_read_b64_tr_b16 v[68:69], v36 offset:30848
    ds_read_b64_tr_b16 v[70:71], v36 offset:32384
    s_add_u32 s41, s64, 3760128
    v_mfma_f32_32x32x16_bf16 v[240:255], v[84:87], a[32:35], v[240:255]
    buffer_load_dwordx4 v32, s[60:63], s41 offen offset:0 lds
    s_waitcnt lgkmcnt(4)
    v_mfma_f32_32x32x16_bf16 v[160:175], v[88:91], a[36:39], v[160:175]
    ds_read_b64_tr_b16 v[72:73], v35 offset:30976
    ds_read_b64_tr_b16 v[74:75], v35 offset:32512
    ds_read_b64_tr_b16 v[76:77], v36 offset:30976
    ds_read_b64_tr_b16 v[78:79], v36 offset:32512
    v_mfma_f32_32x32x16_bf16 v[176:191], v[92:95], a[36:39], v[176:191]
    buffer_load_dwordx4 v33, s[60:63], s41 offen offset:1024 lds
    s_waitcnt lgkmcnt(4)
    v_mfma_f32_32x32x16_bf16 v[192:207], v[64:67], a[36:39], v[192:207]
    ds_read_b64_tr_b16 v[80:81], v35 offset:12288
    ds_read_b64_tr_b16 v[82:83], v35 offset:13824
    ds_read_b64_tr_b16 v[84:85], v36 offset:12288
    ds_read_b64_tr_b16 v[86:87], v36 offset:13824
    v_mfma_f32_32x32x16_bf16 v[208:223], v[68:71], a[36:39], v[208:223]
    buffer_load_dwordx4 v34, s[60:63], s41 offen offset:2048 lds
    s_waitcnt lgkmcnt(4)
    v_mfma_f32_32x32x16_bf16 v[224:239], v[72:75], a[36:39], v[224:239]
    ds_read_b64_tr_b16 v[88:89], v35 offset:12416
    ds_read_b64_tr_b16 v[90:91], v35 offset:13952
    ds_read_b64_tr_b16 v[92:93], v36 offset:12416
    ds_read_b64_tr_b16 v[94:95], v36 offset:13952
    v_mfma_f32_32x32x16_bf16 v[240:255], v[76:79], a[36:39], v[240:255]
    s_waitcnt vmcnt(19)
    s_waitcnt lgkmcnt(4)
    v_mfma_f32_32x32x16_bf16 v[160:175], v[80:83], a[0:3], v[160:175]
    ds_read_b64_tr_b16 v[64:65], v35 offset:12544
    ds_read_b64_tr_b16 v[66:67], v35 offset:14080
    ds_read_b64_tr_b16 v[68:69], v36 offset:12544
    ds_read_b64_tr_b16 v[70:71], v36 offset:14080
    s_add_u32 s40, s67, 59392
    v_mfma_f32_32x32x16_bf16 v[176:191], v[84:87], a[0:3], v[176:191]
    buffer_load_dwordx4 a[32:35], v39, s[16:19], s40 offen offset:0 sc0 sc1
    s_waitcnt lgkmcnt(4)
    v_mfma_f32_32x32x16_bf16 v[192:207], v[88:91], a[0:3], v[192:207]
    ds_read_b64_tr_b16 v[72:73], v35 offset:18432
    ds_read_b64_tr_b16 v[74:75], v35 offset:19968
    ds_read_b64_tr_b16 v[76:77], v36 offset:18432
    ds_read_b64_tr_b16 v[78:79], v36 offset:19968
    v_mfma_f32_32x32x16_bf16 v[208:223], v[92:95], a[0:3], v[208:223]
    buffer_load_dwordx4 a[36:39], v39, s[16:19], s40 offen offset:1024 sc0 sc1
    s_add_u32 m0, s38, 98304
    s_waitcnt lgkmcnt(4)
    v_mfma_f32_32x32x16_bf16 v[224:239], v[64:67], a[0:3], v[224:239]
    ds_read_b64_tr_b16 v[80:81], v35 offset:18560
    ds_read_b64_tr_b16 v[82:83], v35 offset:20096
    ds_read_b64_tr_b16 v[84:85], v36 offset:18560
    ds_read_b64_tr_b16 v[86:87], v36 offset:20096
    s_add_u32 s41, s64, 3796992
    v_mfma_f32_32x32x16_bf16 v[240:255], v[68:71], a[0:3], v[240:255]
    buffer_load_dwordx4 v32, s[60:63], s41 offen offset:0 lds
    s_waitcnt vmcnt(21)
    s_waitcnt lgkmcnt(4)
    v_mfma_f32_32x32x16_bf16 v[160:175], v[72:75], a[4:7], v[160:175]
    ds_read_b64_tr_b16 v[88:89], v35 offset:18688
    ds_read_b64_tr_b16 v[90:91], v35 offset:20224
    ds_read_b64_tr_b16 v[92:93], v36 offset:18688
    ds_read_b64_tr_b16 v[94:95], v36 offset:20224
    v_mfma_f32_32x32x16_bf16 v[176:191], v[76:79], a[4:7], v[176:191]
    buffer_load_dwordx4 v33, s[60:63], s41 offen offset:1024 lds
    s_waitcnt lgkmcnt(4)
    v_mfma_f32_32x32x16_bf16 v[192:207], v[80:83], a[4:7], v[192:207]
    ds_read_b64_tr_b16 v[64:65], v35 offset:0
    ds_read_b64_tr_b16 v[66:67], v35 offset:1536
    ds_read_b64_tr_b16 v[68:69], v36 offset:0
    ds_read_b64_tr_b16 v[70:71], v36 offset:1536
    v_mfma_f32_32x32x16_bf16 v[208:223], v[84:87], a[4:7], v[208:223]
    buffer_load_dwordx4 v34, s[60:63], s41 offen offset:2048 lds
    s_waitcnt lgkmcnt(4)
    v_mfma_f32_32x32x16_bf16 v[224:239], v[88:91], a[4:7], v[224:239]
    ds_read_b64_tr_b16 v[72:73], v35 offset:128
    ds_read_b64_tr_b16 v[74:75], v35 offset:1664
    ds_read_b64_tr_b16 v[76:77], v36 offset:128
    ds_read_b64_tr_b16 v[78:79], v36 offset:1664
    v_mfma_f32_32x32x16_bf16 v[240:255], v[92:95], a[4:7], v[240:255]
    s_waitcnt vmcnt(19)
    s_waitcnt lgkmcnt(4)
    v_mfma_f32_32x32x16_bf16 v[160:175], v[64:67], a[8:11], v[160:175]
    s_waitcnt vmcnt(15)
    s_barrier
    ds_read_b64_tr_b16 v[80:81], v35 offset:256
    ds_read_b64_tr_b16 v[82:83], v35 offset:1792
    ds_read_b64_tr_b16 v[84:85], v36 offset:256
    ds_read_b64_tr_b16 v[86:87], v36 offset:1792
    s_add_u32 s40, s67, 61440
    v_mfma_f32_32x32x16_bf16 v[176:191], v[68:71], a[8:11], v[176:191]
    buffer_load_dwordx4 a[0:3], v39, s[16:19], s40 offen offset:0 sc0 sc1
    s_waitcnt lgkmcnt(4)
    v_mfma_f32_32x32x16_bf16 v[192:207], v[72:75], a[8:11], v[192:207]
    ds_read_b64_tr_b16 v[88:89], v35 offset:6144
    ds_read_b64_tr_b16 v[90:91], v35 offset:7680
    ds_read_b64_tr_b16 v[92:93], v36 offset:6144
    ds_read_b64_tr_b16 v[94:95], v36 offset:7680
    v_mfma_f32_32x32x16_bf16 v[208:223], v[76:79], a[8:11], v[208:223]
    buffer_load_dwordx4 a[4:7], v39, s[16:19], s40 offen offset:1024 sc0 sc1
    s_add_u32 m0, s38, 86016
    s_waitcnt lgkmcnt(4)
    v_mfma_f32_32x32x16_bf16 v[224:239], v[80:83], a[8:11], v[224:239]
    ds_read_b64_tr_b16 v[64:65], v35 offset:6272
    ds_read_b64_tr_b16 v[66:67], v35 offset:7808
    ds_read_b64_tr_b16 v[68:69], v36 offset:6272
    ds_read_b64_tr_b16 v[70:71], v36 offset:7808
    s_add_u32 s41, s64, 3833856
    v_mfma_f32_32x32x16_bf16 v[240:255], v[84:87], a[8:11], v[240:255]
    buffer_load_dwordx4 v32, s[60:63], s41 offen offset:0 lds
    s_waitcnt lgkmcnt(4)
    v_mfma_f32_32x32x16_bf16 v[160:175], v[88:91], a[12:15], v[160:175]
    ds_read_b64_tr_b16 v[72:73], v35 offset:6400
    ds_read_b64_tr_b16 v[74:75], v35 offset:7936
    ds_read_b64_tr_b16 v[76:77], v36 offset:6400
    ds_read_b64_tr_b16 v[78:79], v36 offset:7936
    v_mfma_f32_32x32x16_bf16 v[176:191], v[92:95], a[12:15], v[176:191]
    buffer_load_dwordx4 v33, s[60:63], s41 offen offset:1024 lds
    s_waitcnt lgkmcnt(4)
    v_mfma_f32_32x32x16_bf16 v[192:207], v[64:67], a[12:15], v[192:207]
    ds_read_b64_tr_b16 v[80:81], v31 offset:0
    ds_read_b64_tr_b16 v[82:83], v31 offset:1536
    ds_read_b64_tr_b16 v[84:85], v30 offset:0
    ds_read_b64_tr_b16 v[86:87], v30 offset:1536
    v_mfma_f32_32x32x16_bf16 v[208:223], v[68:71], a[12:15], v[208:223]
    buffer_load_dwordx4 v34, s[60:63], s41 offen offset:2048 lds
    s_waitcnt lgkmcnt(4)
    v_mfma_f32_32x32x16_bf16 v[224:239], v[72:75], a[12:15], v[224:239]
    ds_read_b64_tr_b16 v[88:89], v31 offset:128
    ds_read_b64_tr_b16 v[90:91], v31 offset:1664
    ds_read_b64_tr_b16 v[92:93], v30 offset:128
    ds_read_b64_tr_b16 v[94:95], v30 offset:1664
    v_mfma_f32_32x32x16_bf16 v[240:255], v[76:79], a[12:15], v[240:255]
    s_waitcnt vmcnt(19)
    s_waitcnt lgkmcnt(4)
    v_mfma_f32_32x32x16_bf16 v[160:175], v[80:83], a[16:19], v[160:175]
    ds_read_b64_tr_b16 v[64:65], v31 offset:256
    ds_read_b64_tr_b16 v[66:67], v31 offset:1792
    ds_read_b64_tr_b16 v[68:69], v30 offset:256
    ds_read_b64_tr_b16 v[70:71], v30 offset:1792
    s_add_u32 s40, s67, 63488
    v_mfma_f32_32x32x16_bf16 v[176:191], v[84:87], a[16:19], v[176:191]
    buffer_load_dwordx4 a[8:11], v39, s[16:19], s40 offen offset:0 sc0 sc1
    s_waitcnt lgkmcnt(4)
    v_mfma_f32_32x32x16_bf16 v[192:207], v[88:91], a[16:19], v[192:207]
    ds_read_b64_tr_b16 v[72:73], v31 offset:6144
    ds_read_b64_tr_b16 v[74:75], v31 offset:7680
    ds_read_b64_tr_b16 v[76:77], v30 offset:6144
    ds_read_b64_tr_b16 v[78:79], v30 offset:7680
    v_mfma_f32_32x32x16_bf16 v[208:223], v[92:95], a[16:19], v[208:223]
    buffer_load_dwordx4 a[12:15], v39, s[16:19], s40 offen offset:1024 sc0 sc1
    s_add_u32 m0, s38, 73728
    s_waitcnt lgkmcnt(4)
    v_mfma_f32_32x32x16_bf16 v[224:239], v[64:67], a[16:19], v[224:239]
    ds_read_b64_tr_b16 v[80:81], v31 offset:6272
    ds_read_b64_tr_b16 v[82:83], v31 offset:7808
    ds_read_b64_tr_b16 v[84:85], v30 offset:6272
    ds_read_b64_tr_b16 v[86:87], v30 offset:7808
    s_add_u32 s41, s64, 3870720
    v_mfma_f32_32x32x16_bf16 v[240:255], v[68:71], a[16:19], v[240:255]
    buffer_load_dwordx4 v32, s[60:63], s41 offen offset:0 lds
    s_waitcnt vmcnt(21)
    s_waitcnt lgkmcnt(4)
    v_mfma_f32_32x32x16_bf16 v[160:175], v[72:75], a[20:23], v[160:175]
    ds_read_b64_tr_b16 v[88:89], v31 offset:6400
    ds_read_b64_tr_b16 v[90:91], v31 offset:7936
    ds_read_b64_tr_b16 v[92:93], v30 offset:6400
    ds_read_b64_tr_b16 v[94:95], v30 offset:7936
    v_mfma_f32_32x32x16_bf16 v[176:191], v[76:79], a[20:23], v[176:191]
    buffer_load_dwordx4 v33, s[60:63], s41 offen offset:1024 lds
    s_waitcnt lgkmcnt(4)
    v_mfma_f32_32x32x16_bf16 v[192:207], v[80:83], a[20:23], v[192:207]
    ds_read_b64_tr_b16 v[64:65], v37 offset:36864
    ds_read_b64_tr_b16 v[66:67], v37 offset:38400
    ds_read_b64_tr_b16 v[68:69], v38 offset:36864
    ds_read_b64_tr_b16 v[70:71], v38 offset:38400
    v_mfma_f32_32x32x16_bf16 v[208:223], v[84:87], a[20:23], v[208:223]
    buffer_load_dwordx4 v34, s[60:63], s41 offen offset:2048 lds
    s_waitcnt lgkmcnt(4)
    v_mfma_f32_32x32x16_bf16 v[224:239], v[88:91], a[20:23], v[224:239]
    ds_read_b64_tr_b16 v[72:73], v37 offset:36992
    ds_read_b64_tr_b16 v[74:75], v37 offset:38528
    ds_read_b64_tr_b16 v[76:77], v38 offset:36992
    ds_read_b64_tr_b16 v[78:79], v38 offset:38528
    v_mfma_f32_32x32x16_bf16 v[240:255], v[92:95], a[20:23], v[240:255]
    s_waitcnt vmcnt(19)
    s_waitcnt lgkmcnt(4)
    v_mfma_f32_32x32x16_bf16 v[160:175], v[64:67], a[24:27], v[160:175]
    s_waitcnt vmcnt(15)
    s_barrier
    ds_read_b64_tr_b16 v[80:81], v37 offset:37120
    ds_read_b64_tr_b16 v[82:83], v37 offset:38656
    ds_read_b64_tr_b16 v[84:85], v38 offset:37120
    ds_read_b64_tr_b16 v[86:87], v38 offset:38656
    s_add_u32 s40, s67, 65536
    v_mfma_f32_32x32x16_bf16 v[176:191], v[68:71], a[24:27], v[176:191]
    buffer_load_dwordx4 a[16:19], v39, s[16:19], s40 offen offset:0 sc0 sc1
    s_waitcnt lgkmcnt(4)
    v_mfma_f32_32x32x16_bf16 v[192:207], v[72:75], a[24:27], v[192:207]
    ds_read_b64_tr_b16 v[88:89], v37 offset:43008
    ds_read_b64_tr_b16 v[90:91], v37 offset:44544
    ds_read_b64_tr_b16 v[92:93], v38 offset:43008
    ds_read_b64_tr_b16 v[94:95], v38 offset:44544
    v_mfma_f32_32x32x16_bf16 v[208:223], v[76:79], a[24:27], v[208:223]
    buffer_load_dwordx4 a[20:23], v39, s[16:19], s40 offen offset:1024 sc0 sc1
    s_add_u32 m0, s38, 61440
    s_waitcnt lgkmcnt(4)
    v_mfma_f32_32x32x16_bf16 v[224:239], v[80:83], a[24:27], v[224:239]
    ds_read_b64_tr_b16 v[64:65], v37 offset:43136
    ds_read_b64_tr_b16 v[66:67], v37 offset:44672
    ds_read_b64_tr_b16 v[68:69], v38 offset:43136
    ds_read_b64_tr_b16 v[70:71], v38 offset:44672
    s_add_u32 s41, s64, 3907584
    v_mfma_f32_32x32x16_bf16 v[240:255], v[84:87], a[24:27], v[240:255]
    buffer_load_dwordx4 v32, s[60:63], s41 offen offset:0 lds
    s_waitcnt lgkmcnt(4)
    v_mfma_f32_32x32x16_bf16 v[160:175], v[88:91], a[28:31], v[160:175]
    ds_read_b64_tr_b16 v[72:73], v37 offset:43264
    ds_read_b64_tr_b16 v[74:75], v37 offset:44800
    ds_read_b64_tr_b16 v[76:77], v38 offset:43264
    ds_read_b64_tr_b16 v[78:79], v38 offset:44800
    v_mfma_f32_32x32x16_bf16 v[176:191], v[92:95], a[28:31], v[176:191]
    buffer_load_dwordx4 v33, s[60:63], s41 offen offset:1024 lds
    s_waitcnt lgkmcnt(4)
    v_mfma_f32_32x32x16_bf16 v[192:207], v[64:67], a[28:31], v[192:207]
    ds_read_b64_tr_b16 v[80:81], v37 offset:24576
    ds_read_b64_tr_b16 v[82:83], v37 offset:26112
    ds_read_b64_tr_b16 v[84:85], v38 offset:24576
    ds_read_b64_tr_b16 v[86:87], v38 offset:26112
    v_mfma_f32_32x32x16_bf16 v[208:223], v[68:71], a[28:31], v[208:223]
    buffer_load_dwordx4 v34, s[60:63], s41 offen offset:2048 lds
    s_waitcnt lgkmcnt(4)
    v_mfma_f32_32x32x16_bf16 v[224:239], v[72:75], a[28:31], v[224:239]
    ds_read_b64_tr_b16 v[88:89], v37 offset:24704
    ds_read_b64_tr_b16 v[90:91], v37 offset:26240
    ds_read_b64_tr_b16 v[92:93], v38 offset:24704
    ds_read_b64_tr_b16 v[94:95], v38 offset:26240
    v_mfma_f32_32x32x16_bf16 v[240:255], v[76:79], a[28:31], v[240:255]
    s_waitcnt vmcnt(19)
    s_waitcnt lgkmcnt(4)
    v_mfma_f32_32x32x16_bf16 v[160:175], v[80:83], a[32:35], v[160:175]
    ds_read_b64_tr_b16 v[64:65], v37 offset:24832
    ds_read_b64_tr_b16 v[66:67], v37 offset:26368
    ds_read_b64_tr_b16 v[68:69], v38 offset:24832
    ds_read_b64_tr_b16 v[70:71], v38 offset:26368
    s_add_u32 s40, s67, 67584
    v_mfma_f32_32x32x16_bf16 v[176:191], v[84:87], a[32:35], v[176:191]
    buffer_load_dwordx4 a[24:27], v39, s[16:19], s40 offen offset:0 sc0 sc1
    s_waitcnt lgkmcnt(4)
    v_mfma_f32_32x32x16_bf16 v[192:207], v[88:91], a[32:35], v[192:207]
    ds_read_b64_tr_b16 v[72:73], v37 offset:30720
    ds_read_b64_tr_b16 v[74:75], v37 offset:32256
    ds_read_b64_tr_b16 v[76:77], v38 offset:30720
    ds_read_b64_tr_b16 v[78:79], v38 offset:32256
    v_mfma_f32_32x32x16_bf16 v[208:223], v[92:95], a[32:35], v[208:223]
    buffer_load_dwordx4 a[28:31], v39, s[16:19], s40 offen offset:1024 sc0 sc1
    s_add_u32 m0, s38, 49152
    s_waitcnt lgkmcnt(4)
    v_mfma_f32_32x32x16_bf16 v[224:239], v[64:67], a[32:35], v[224:239]
    ds_read_b64_tr_b16 v[80:81], v37 offset:30848
    ds_read_b64_tr_b16 v[82:83], v37 offset:32384
    ds_read_b64_tr_b16 v[84:85], v38 offset:30848
    ds_read_b64_tr_b16 v[86:87], v38 offset:32384
    s_add_u32 s41, s64, 3944448
    v_mfma_f32_32x32x16_bf16 v[240:255], v[68:71], a[32:35], v[240:255]
    buffer_load_dwordx4 v32, s[60:63], s41 offen offset:0 lds
    s_waitcnt vmcnt(21)
    s_waitcnt lgkmcnt(4)
    v_mfma_f32_32x32x16_bf16 v[160:175], v[72:75], a[36:39], v[160:175]
    ds_read_b64_tr_b16 v[88:89], v37 offset:30976
    ds_read_b64_tr_b16 v[90:91], v37 offset:32512
    ds_read_b64_tr_b16 v[92:93], v38 offset:30976
    ds_read_b64_tr_b16 v[94:95], v38 offset:32512
    v_mfma_f32_32x32x16_bf16 v[176:191], v[76:79], a[36:39], v[176:191]
    buffer_load_dwordx4 v33, s[60:63], s41 offen offset:1024 lds
    s_waitcnt lgkmcnt(4)
    v_mfma_f32_32x32x16_bf16 v[192:207], v[80:83], a[36:39], v[192:207]
    ds_read_b64_tr_b16 v[64:65], v37 offset:12288
    ds_read_b64_tr_b16 v[66:67], v37 offset:13824
    ds_read_b64_tr_b16 v[68:69], v38 offset:12288
    ds_read_b64_tr_b16 v[70:71], v38 offset:13824
    v_mfma_f32_32x32x16_bf16 v[208:223], v[84:87], a[36:39], v[208:223]
    buffer_load_dwordx4 v34, s[60:63], s41 offen offset:2048 lds
    s_mul_i32 s46, s65, 3
    s_waitcnt lgkmcnt(4)
    v_mfma_f32_32x32x16_bf16 v[224:239], v[88:91], a[36:39], v[224:239]
    ds_read_b64_tr_b16 v[72:73], v37 offset:12416
    ds_read_b64_tr_b16 v[74:75], v37 offset:13952
    ds_read_b64_tr_b16 v[76:77], v38 offset:12416
    ds_read_b64_tr_b16 v[78:79], v38 offset:13952
    s_add_u32 s46, s46, s66
    s_add_u32 s35, s46, 40
    s_lshl_b32 s35, s35, 7
    v_mfma_f32_32x32x16_bf16 v[240:255], v[92:95], a[36:39], v[240:255]
    s_add_u32 s35, s35, 22085632
    s_mul_i32 s46, s46, 20
    s_add_u32 s46, s46, s32
    s_mul_i32 s36, s46, 12288
    s_add_u32 s36, s36, 23068672
    s_mul_i32 s46, s49, 49152
    s_waitcnt vmcnt(19)
    s_waitcnt lgkmcnt(4)
    v_mfma_f32_32x32x16_bf16 v[160:175], v[64:67], a[0:3], v[160:175]
    s_waitcnt vmcnt(15)
    s_barrier
    ds_read_b64_tr_b16 v[80:81], v37 offset:12544
    ds_read_b64_tr_b16 v[82:83], v37 offset:14080
    ds_read_b64_tr_b16 v[84:85], v38 offset:12544
    ds_read_b64_tr_b16 v[86:87], v38 offset:14080
    s_add_u32 s47, s36, s46
    v_mfma_f32_32x32x16_bf16 v[176:191], v[68:71], a[0:3], v[176:191]
    s_add_u32 s46, s49, 0
    s_and_b32 s46, s46, 3
    s_mul_i32 s46, s46, 3072
    s_add_u32 s24, s47, s46
    s_add_u32 s46, s49, 1
    s_and_b32 s46, s46, 3
    s_waitcnt lgkmcnt(4)
    v_mfma_f32_32x32x16_bf16 v[192:207], v[72:75], a[0:3], v[192:207]
    ds_read_b64_tr_b16 v[88:89], v37 offset:18432
    ds_read_b64_tr_b16 v[90:91], v37 offset:19968
    ds_read_b64_tr_b16 v[92:93], v38 offset:18432
    ds_read_b64_tr_b16 v[94:95], v38 offset:19968
    s_mul_i32 s46, s46, 3072
    s_add_u32 s25, s47, s46
    s_add_u32 s46, s49, 2
    v_mfma_f32_32x32x16_bf16 v[208:223], v[76:79], a[0:3], v[208:223]
    s_and_b32 s46, s46, 3
    s_mul_i32 s46, s46, 3072
    s_add_u32 s26, s47, s46
    s_add_u32 s46, s49, 3
    s_and_b32 s46, s46, 3
    s_mul_i32 s46, s46, 3072
    s_waitcnt lgkmcnt(4)
    v_mfma_f32_32x32x16_bf16 v[224:239], v[80:83], a[0:3], v[224:239]
    ds_read_b64_tr_b16 v[64:65], v37 offset:18560
    ds_read_b64_tr_b16 v[66:67], v37 offset:20096
    ds_read_b64_tr_b16 v[68:69], v38 offset:18560
    ds_read_b64_tr_b16 v[70:71], v38 offset:20096
    s_add_u32 s27, s47, s46
    s_lshl_b32 s46, s49, 2
    s_add_u32 s50, s46, s35
    v_mfma_f32_32x32x16_bf16 v[240:255], v[84:87], a[0:3], v[240:255]
    s_add_u32 s40, s67, 69632
    buffer_load_dwordx4 a[32:35], v39, s[16:19], s40 offen offset:0 sc0 sc1
    s_waitcnt lgkmcnt(4)
    v_mfma_f32_32x32x16_bf16 v[160:175], v[88:91], a[4:7], v[160:175]
    ds_read_b64_tr_b16 v[72:73], v37 offset:18688
    ds_read_b64_tr_b16 v[74:75], v37 offset:20224
    ds_read_b64_tr_b16 v[76:77], v38 offset:18688
    ds_read_b64_tr_b16 v[78:79], v38 offset:20224
    v_mfma_f32_32x32x16_bf16 v[176:191], v[92:95], a[4:7], v[176:191]
    buffer_load_dwordx4 a[36:39], v39, s[16:19], s40 offen offset:1024 sc0 sc1
    s_mul_i32 s46, s49, 3072
    s_waitcnt lgkmcnt(4)
    v_mfma_f32_32x32x16_bf16 v[192:207], v[64:67], a[4:7], v[192:207]
    ds_read_b64_tr_b16 v[80:81], v37 offset:0
    ds_read_b64_tr_b16 v[82:83], v37 offset:1536
    ds_read_b64_tr_b16 v[84:85], v38 offset:0
    ds_read_b64_tr_b16 v[86:87], v38 offset:1536
    s_add_u32 s36, s36, s46
    s_lshl_b32 s46, s65, 2
    s_add_u32 s46, s46, s32
    v_mfma_f32_32x32x16_bf16 v[208:223], v[68:71], a[4:7], v[208:223]
    s_lshl_b32 s39, s46, 7
    s_add_u32 s39, s39, 22020096
    s_mul_i32 s3, s46, 36864
    s_mul_i32 s46, s66, 384
    s_add_u32 s3, s3, s46
    s_mul_i32 s46, s49, 96
    s_waitcnt lgkmcnt(4)
    v_mfma_f32_32x32x16_bf16 v[224:239], v[72:75], a[4:7], v[224:239]
    ds_read_b64_tr_b16 v[88:89], v37 offset:128
    ds_read_b64_tr_b16 v[90:91], v37 offset:1664
    ds_read_b64_tr_b16 v[92:93], v38 offset:128
    ds_read_b64_tr_b16 v[94:95], v38 offset:1664
    s_add_u32 s3, s3, s46
    s_mov_b32 s8, s28
    s_mov_b32 s9, s29
    v_mfma_f32_32x32x16_bf16 v[240:255], v[76:79], a[4:7], v[240:255]
    s_mov_b32 s10, 2359296
    s_mov_b32 s11, 0x00020000
    v_and_b32 v12, 31, v0
    v_mul_u32_u24 v13, 1152, v12
    v_lshlrev_b32 v12, 2, v12
    v_lshrrev_b32 v14, 5, v0
    s_waitcnt vmcnt(16)
    s_waitcnt lgkmcnt(4)
    v_mfma_f32_32x32x16_bf16 v[160:175], v[80:83], a[8:11], v[160:175]
    ds_read_b64_tr_b16 v[64:65], v37 offset:256
    ds_read_b64_tr_b16 v[66:67], v37 offset:1792
    ds_read_b64_tr_b16 v[68:69], v38 offset:256
    ds_read_b64_tr_b16 v[70:71], v38 offset:1792
    v_lshl_add_u32 v13, v14, 4, v13
    s_add_u32 s40, s67, 71680
    v_mfma_f32_32x32x16_bf16 v[176:191], v[84:87], a[8:11], v[176:191]
    buffer_load_dwordx4 a[0:3], v39, s[16:19], s40 offen offset:0 sc0 sc1
    s_waitcnt lgkmcnt(4)
    v_mfma_f32_32x32x16_bf16 v[192:207], v[88:91], a[8:11], v[192:207]
    ds_read_b64_tr_b16 v[72:73], v37 offset:6144
    ds_read_b64_tr_b16 v[74:75], v37 offset:7680
    ds_read_b64_tr_b16 v[76:77], v38 offset:6144
    ds_read_b64_tr_b16 v[78:79], v38 offset:7680
    v_mfma_f32_32x32x16_bf16 v[208:223], v[92:95], a[8:11], v[208:223]
    buffer_load_dwordx4 a[4:7], v39, s[16:19], s40 offen offset:1024 sc0 sc1
    s_waitcnt lgkmcnt(4)
    v_mfma_f32_32x32x16_bf16 v[224:239], v[64:67], a[8:11], v[224:239]
    ds_read_b64_tr_b16 v[80:81], v37 offset:6272
    ds_read_b64_tr_b16 v[82:83], v37 offset:7808
    ds_read_b64_tr_b16 v[84:85], v38 offset:6272
    ds_read_b64_tr_b16 v[86:87], v38 offset:7808
    v_mfma_f32_32x32x16_bf16 v[240:255], v[68:71], a[8:11], v[240:255]
    s_waitcnt vmcnt(17)
    s_waitcnt lgkmcnt(4)
    v_mfma_f32_32x32x16_bf16 v[160:175], v[72:75], a[12:15], v[160:175]
    ds_read_b64_tr_b16 v[88:89], v37 offset:6400
    ds_read_b64_tr_b16 v[90:91], v37 offset:7936
    ds_read_b64_tr_b16 v[92:93], v38 offset:6400
    ds_read_b64_tr_b16 v[94:95], v38 offset:7936
    v_mfma_f32_32x32x16_bf16 v[176:191], v[76:79], a[12:15], v[176:191]
    s_waitcnt lgkmcnt(4)
    v_mfma_f32_32x32x16_bf16 v[192:207], v[80:83], a[12:15], v[192:207]
    ds_read_b64_tr_b16 v[64:65], v35 offset:36864
    ds_read_b64_tr_b16 v[66:67], v35 offset:38400
    ds_read_b64_tr_b16 v[68:69], v36 offset:36864
    ds_read_b64_tr_b16 v[70:71], v36 offset:38400
    v_mfma_f32_32x32x16_bf16 v[208:223], v[84:87], a[12:15], v[208:223]
    s_waitcnt lgkmcnt(4)
    v_mfma_f32_32x32x16_bf16 v[224:239], v[88:91], a[12:15], v[224:239]
    ds_read_b64_tr_b16 v[72:73], v35 offset:36992
    ds_read_b64_tr_b16 v[74:75], v35 offset:38528
    ds_read_b64_tr_b16 v[76:77], v36 offset:36992
    ds_read_b64_tr_b16 v[78:79], v36 offset:38528
    v_mfma_f32_32x32x16_bf16 v[240:255], v[92:95], a[12:15], v[240:255]
    s_waitcnt vmcnt(13)
    s_waitcnt lgkmcnt(4)
    v_mfma_f32_32x32x16_bf16 v[160:175], v[64:67], a[16:19], v[160:175]
    s_waitcnt vmcnt(9)
    s_barrier
    ds_read_b64_tr_b16 v[80:81], v35 offset:37120
    ds_read_b64_tr_b16 v[82:83], v35 offset:38656
    ds_read_b64_tr_b16 v[84:85], v36 offset:37120
    ds_read_b64_tr_b16 v[86:87], v36 offset:38656
    v_and_b32 v2, 15, v0
    v_mfma_f32_32x32x16_bf16 v[176:191], v[68:71], a[16:19], v[176:191]
    v_lshlrev_b32 v2, 2, v2
    buffer_load_dword v3, v2, s[16:19], s35 offen offset:16 sc0 sc1
    s_waitcnt lgkmcnt(4)
    v_mfma_f32_32x32x16_bf16 v[192:207], v[72:75], a[16:19], v[192:207]
    ds_read_b64_tr_b16 v[88:89], v35 offset:43008
    ds_read_b64_tr_b16 v[90:91], v35 offset:44544
    ds_read_b64_tr_b16 v[92:93], v36 offset:43008
    ds_read_b64_tr_b16 v[94:95], v36 offset:44544
    v_mfma_f32_32x32x16_bf16 v[208:223], v[76:79], a[16:19], v[208:223]
    s_waitcnt lgkmcnt(4)
    v_mfma_f32_32x32x16_bf16 v[224:239], v[80:83], a[16:19], v[224:239]
    ds_read_b64_tr_b16 v[64:65], v35 offset:43136
    ds_read_b64_tr_b16 v[66:67], v35 offset:44672
    ds_read_b64_tr_b16 v[68:69], v36 offset:43136
    ds_read_b64_tr_b16 v[70:71], v36 offset:44672
    v_mfma_f32_32x32x16_bf16 v[240:255], v[84:87], a[16:19], v[240:255]
    s_waitcnt lgkmcnt(4)
    v_mfma_f32_32x32x16_bf16 v[160:175], v[88:91], a[20:23], v[160:175]
    ds_read_b64_tr_b16 v[72:73], v35 offset:43264
    ds_read_b64_tr_b16 v[74:75], v35 offset:44800
    ds_read_b64_tr_b16 v[76:77], v36 offset:43264
    ds_read_b64_tr_b16 v[78:79], v36 offset:44800
    v_mfma_f32_32x32x16_bf16 v[176:191], v[92:95], a[20:23], v[176:191]
    s_waitcnt lgkmcnt(4)
    v_mfma_f32_32x32x16_bf16 v[192:207], v[64:67], a[20:23], v[192:207]
    ds_read_b64_tr_b16 v[80:81], v35 offset:24576
    ds_read_b64_tr_b16 v[82:83], v35 offset:26112
    ds_read_b64_tr_b16 v[84:85], v36 offset:24576
    ds_read_b64_tr_b16 v[86:87], v36 offset:26112
    v_mfma_f32_32x32x16_bf16 v[208:223], v[68:71], a[20:23], v[208:223]
    s_waitcnt lgkmcnt(4)
    v_mfma_f32_32x32x16_bf16 v[224:239], v[72:75], a[20:23], v[224:239]
    ds_read_b64_tr_b16 v[88:89], v35 offset:24704
    ds_read_b64_tr_b16 v[90:91], v35 offset:26240
    ds_read_b64_tr_b16 v[92:93], v36 offset:24704
    ds_read_b64_tr_b16 v[94:95], v36 offset:26240
    v_mfma_f32_32x32x16_bf16 v[240:255], v[76:79], a[20:23], v[240:255]
    s_waitcnt vmcnt(9)
    s_waitcnt lgkmcnt(4)
    v_mfma_f32_32x32x16_bf16 v[160:175], v[80:83], a[24:27], v[160:175]
    ds_read_b64_tr_b16 v[64:65], v35 offset:24832
    ds_read_b64_tr_b16 v[66:67], v35 offset:26368
    ds_read_b64_tr_b16 v[68:69], v36 offset:24832
    ds_read_b64_tr_b16 v[70:71], v36 offset:26368
    v_mfma_f32_32x32x16_bf16 v[176:191], v[84:87], a[24:27], v[176:191]
    s_waitcnt lgkmcnt(4)
    v_mfma_f32_32x32x16_bf16 v[192:207], v[88:91], a[24:27], v[192:207]
    ds_read_b64_tr_b16 v[72:73], v35 offset:30720
    ds_read_b64_tr_b16 v[74:75], v35 offset:32256
    ds_read_b64_tr_b16 v[76:77], v36 offset:30720
    ds_read_b64_tr_b16 v[78:79], v36 offset:32256
    v_mfma_f32_32x32x16_bf16 v[208:223], v[92:95], a[24:27], v[208:223]
    s_waitcnt lgkmcnt(4)
    v_mfma_f32_32x32x16_bf16 v[224:239], v[64:67], a[24:27], v[224:239]
    ds_read_b64_tr_b16 v[80:81], v35 offset:30848
    ds_read_b64_tr_b16 v[82:83], v35 offset:32384
    ds_read_b64_tr_b16 v[84:85], v36 offset:30848
    ds_read_b64_tr_b16 v[86:87], v36 offset:32384
    v_mfma_f32_32x32x16_bf16 v[240:255], v[68:71], a[24:27], v[240:255]
    s_waitcnt vmcnt(8)
    s_waitcnt lgkmcnt(4)
    v_mfma_f32_32x32x16_bf16 v[160:175], v[72:75], a[28:31], v[160:175]
    ds_read_b64_tr_b16 v[88:89], v35 offset:30976
    ds_read_b64_tr_b16 v[90:91], v35 offset:32512
    ds_read_b64_tr_b16 v[92:93], v36 offset:30976
    ds_read_b64_tr_b16 v[94:95], v36 offset:32512
    v_mfma_f32_32x32x16_bf16 v[176:191], v[76:79], a[28:31], v[176:191]
    s_waitcnt lgkmcnt(4)
    v_mfma_f32_32x32x16_bf16 v[192:207], v[80:83], a[28:31], v[192:207]
    ds_read_b64_tr_b16 v[64:65], v35 offset:12288
    ds_read_b64_tr_b16 v[66:67], v35 offset:13824
    ds_read_b64_tr_b16 v[68:69], v36 offset:12288
    ds_read_b64_tr_b16 v[70:71], v36 offset:13824
    v_mfma_f32_32x32x16_bf16 v[208:223], v[84:87], a[28:31], v[208:223]
    s_waitcnt lgkmcnt(4)
    v_mfma_f32_32x32x16_bf16 v[224:239], v[88:91], a[28:31], v[224:239]
    ds_read_b64_tr_b16 v[72:73], v35 offset:12416
    ds_read_b64_tr_b16 v[74:75], v35 offset:13952
    ds_read_b64_tr_b16 v[76:77], v36 offset:12416
    ds_read_b64_tr_b16 v[78:79], v36 offset:13952
    v_mfma_f32_32x32x16_bf16 v[240:255], v[92:95], a[28:31], v[240:255]
    s_waitcnt vmcnt(4)
    s_waitcnt lgkmcnt(4)
    v_mfma_f32_32x32x16_bf16 v[160:175], v[64:67], a[32:35], v[160:175]
    s_barrier
    s_waitcnt vmcnt(0)
    s_mov_b32 s69, 200000
    s_mov_b64 exec, 3
L_FC6396:
    v_cmp_ne_u32 vcc, s68, v3
    s_sub_u32 s69, s69, 1
    s_nop 4
    s_cbranch_vccz L_FC6396_D
    s_cmp_eq_u32 s69, 0
    s_cbranch_scc1 L_FC6396_D
    s_sleep 2
    buffer_load_dword v3, v2, s[16:19], s35 offen offset:16 sc0 sc1
    s_waitcnt vmcnt(0)
    s_branch L_FC6396
L_FC6396_D:
    s_mov_b64 exec, -1
    s_nop 3
    ds_read_b64_tr_b16 v[80:81], v35 offset:12544
    ds_read_b64_tr_b16 v[82:83], v35 offset:14080
    ds_read_b64_tr_b16 v[84:85], v36 offset:12544
    ds_read_b64_tr_b16 v[86:87], v36 offset:14080
    v_mfma_f32_32x32x16_bf16 v[176:191], v[68:71], a[32:35], v[176:191]
    buffer_load_dword v8, v12, s[16:19], s39 offen sc0 sc1
    s_add_u32 s42, s36, 196608
    s_waitcnt lgkmcnt(4)
    v_mfma_f32_32x32x16_bf16 v[192:207], v[72:75], a[32:35], v[192:207]
    ds_read_b64_tr_b16 v[88:89], v35 offset:18432
    ds_read_b64_tr_b16 v[90:91], v35 offset:19968
    ds_read_b64_tr_b16 v[92:93], v36 offset:18432
    ds_read_b64_tr_b16 v[94:95], v36 offset:19968
    v_mfma_f32_32x32x16_bf16 v[208:223], v[76:79], a[32:35], v[208:223]
    buffer_load_dwordx4 v[144:147], v39, s[16:19], s42 offen offset:0 sc0 sc1
    s_add_u32 s42, s36, 196608
    s_waitcnt lgkmcnt(4)
    v_mfma_f32_32x32x16_bf16 v[224:239], v[80:83], a[32:35], v[224:239]
    ds_read_b64_tr_b16 v[64:65], v35 offset:18560
    ds_read_b64_tr_b16 v[66:67], v35 offset:20096
    ds_read_b64_tr_b16 v[68:69], v36 offset:18560
    ds_read_b64_tr_b16 v[70:71], v36 offset:20096
    v_mfma_f32_32x32x16_bf16 v[240:255], v[84:87], a[32:35], v[240:255]
    buffer_load_dwordx4 v[148:151], v39, s[16:19], s42 offen offset:1024 sc0 sc1
    s_add_u32 s42, s36, 196608
    s_waitcnt lgkmcnt(4)
    v_mfma_f32_32x32x16_bf16 v[160:175], v[88:91], a[36:39], v[160:175]
    ds_read_b64_tr_b16 v[72:73], v35 offset:18688
    ds_read_b64_tr_b16 v[74:75], v35 offset:20224
    ds_read_b64_tr_b16 v[76:77], v36 offset:18688
    ds_read_b64_tr_b16 v[78:79], v36 offset:20224
    v_mfma_f32_32x32x16_bf16 v[176:191], v[92:95], a[36:39], v[176:191]
    buffer_load_dwordx4 v[152:155], v39, s[16:19], s42 offen offset:2048 sc0 sc1
    s_waitcnt lgkmcnt(4)
    v_mfma_f32_32x32x16_bf16 v[192:207], v[64:67], a[36:39], v[192:207]
    ds_read_b64_tr_b16 v[80:81], v35 offset:128
    ds_read_b64_tr_b16 v[82:83], v35 offset:1664
    ds_read_b64_tr_b16 v[84:85], v35 offset:6272
    ds_read_b64_tr_b16 v[86:87], v35 offset:7808
    v_mfma_f32_32x32x16_bf16 v[208:223], v[68:71], a[36:39], v[208:223]
    s_waitcnt lgkmcnt(4)
    v_mfma_f32_32x32x16_bf16 v[224:239], v[72:75], a[36:39], v[224:239]
    ds_read_b64_tr_b16 v[88:89], v36 offset:128
    ds_read_b64_tr_b16 v[90:91], v36 offset:1664
    ds_read_b64_tr_b16 v[92:93], v36 offset:6272
    ds_read_b64_tr_b16 v[94:95], v36 offset:7808
    v_mfma_f32_32x32x16_bf16 v[240:255], v[76:79], a[36:39], v[240:255]
    s_waitcnt lgkmcnt(4)
    v_mfma_f32_32x32x16_bf16 v[192:207], v[80:83], a[0:3], v[192:207]
    ds_read_b64_tr_b16 v[64:65], v35 offset:256
    ds_read_b64_tr_b16 v[66:67], v35 offset:1792
    ds_read_b64_tr_b16 v[68:69], v35 offset:6400
    ds_read_b64_tr_b16 v[70:71], v35 offset:7936
    v_mfma_f32_32x32x16_bf16 v[192:207], v[84:87], a[4:7], v[192:207]
    s_waitcnt lgkmcnt(4)
    v_mfma_f32_32x32x16_bf16 v[208:223], v[88:91], a[0:3], v[208:223]
    ds_read_b64_tr_b16 v[72:73], v36 offset:256
    ds_read_b64_tr_b16 v[74:75], v36 offset:1792
    ds_read_b64_tr_b16 v[76:77], v36 offset:6400
    ds_read_b64_tr_b16 v[78:79], v36 offset:7936
    v_mfma_f32_32x32x16_bf16 v[208:223], v[92:95], a[4:7], v[208:223]
    s_waitcnt lgkmcnt(4)
    v_mfma_f32_32x32x16_bf16 v[224:239], v[64:67], a[0:3], v[224:239]
    ds_read_b64_tr_b16 v[80:81], v36 offset:0
    ds_read_b64_tr_b16 v[82:83], v36 offset:1536
    ds_read_b64_tr_b16 v[84:85], v36 offset:6144
    ds_read_b64_tr_b16 v[86:87], v36 offset:7680
    v_cvt_pk_bf16_f32 v112, v192, v193
    v_cvt_pk_bf16_f32 v113, v194, v195
    v_cvt_pk_bf16_f32 v114, v196, v197
    v_mfma_f32_32x32x16_bf16 v[224:239], v[68:71], a[4:7], v[224:239]
    v_cvt_pk_bf16_f32 v115, v198, v199
    s_nop 0
    v_cvt_pk_bf16_f32 v116, v200, v201
    v_cvt_pk_bf16_f32 v117, v202, v203
    v_cvt_pk_bf16_f32 v118, v204, v205
    v_cvt_pk_bf16_f32 v119, v206, v207
    s_waitcnt lgkmcnt(4)
    v_mfma_f32_32x32x16_bf16 v[240:255], v[72:75], a[0:3], v[240:255]
    ds_read_b64_tr_b16 v[88:89], v35 offset:0
    ds_read_b64_tr_b16 v[90:91], v35 offset:1536
    ds_read_b64_tr_b16 v[92:93], v35 offset:6144
    ds_read_b64_tr_b16 v[94:95], v35 offset:7680
    v_mfma_f32_32x32x16_bf16 v[240:255], v[76:79], a[4:7], v[240:255]
    buffer_store_dwordx4 v[112:115], v39, s[16:19], s25 offen offset:1024 sc0 sc1
    s_nop 0
    s_waitcnt lgkmcnt(4)
    v_mfma_f32_32x32x16_bf16 v[176:191], v[80:83], a[0:3], v[176:191]
    buffer_store_dwordx4 v[116:119], v39, s[16:19], s25 offen offset:2048 sc0 sc1
    v_cvt_pk_bf16_f32 v120, v208, v209
    v_cvt_pk_bf16_f32 v121, v210, v211
    v_mfma_f32_32x32x16_bf16 v[176:191], v[84:87], a[4:7], v[176:191]
    v_cvt_pk_bf16_f32 v122, v212, v213
    v_cvt_pk_bf16_f32 v123, v214, v215
    s_nop 0
    v_cvt_pk_bf16_f32 v124, v216, v217
    v_cvt_pk_bf16_f32 v125, v218, v219
    v_cvt_pk_bf16_f32 v126, v220, v221
    s_waitcnt lgkmcnt(0)
    v_mfma_f32_32x32x16_bf16 v[160:175], v[88:91], a[0:3], v[160:175]
    buffer_store_dwordx4 v[120:123], v39, s[16:19], s26 offen offset:0 sc0 sc1
    v_cvt_pk_bf16_f32 v127, v222, v223
    s_nop 0
    v_mfma_f32_32x32x16_bf16 v[160:175], v[92:95], a[4:7], v[160:175]
    buffer_store_dwordx4 v[124:127], v39, s[16:19], s26 offen offset:1024 sc0 sc1
    v_cvt_pk_bf16_f32 v128, v224, v225
    v_cvt_pk_bf16_f32 v129, v226, v227
    v_cvt_pk_bf16_f32 v130, v228, v229
    v_cvt_pk_bf16_f32 v131, v230, v231
    s_nop 0
    buffer_store_dwordx4 v[128:131], v39, s[16:19], s26 offen offset:2048 sc0 sc1
    v_cvt_pk_bf16_f32 v132, v232, v233
    v_cvt_pk_bf16_f32 v133, v234, v235
    v_cvt_pk_bf16_f32 v134, v236, v237
    v_cvt_pk_bf16_f32 v135, v238, v239
    s_nop 0
    buffer_store_dwordx4 v[132:135], v39, s[16:19], s27 offen offset:0 sc0 sc1
    v_cvt_pk_bf16_f32 v136, v240, v241
    v_cvt_pk_bf16_f32 v137, v242, v243
    v_cvt_pk_bf16_f32 v138, v244, v245
    v_cvt_pk_bf16_f32 v139, v246, v247
    s_nop 0
    buffer_store_dwordx4 v[136:139], v39, s[16:19], s27 offen offset:1024 sc0 sc1
    v_cvt_pk_bf16_f32 v140, v248, v249
    v_cvt_pk_bf16_f32 v141, v250, v251
    v_cvt_pk_bf16_f32 v142, v252, v253
    v_cvt_pk_bf16_f32 v143, v254, v255
    s_nop 0
    buffer_store_dwordx4 v[140:143], v39, s[16:19], s27 offen offset:2048 sc0 sc1
    v_cvt_pk_bf16_f32 v108, v184, v185
    v_cvt_pk_bf16_f32 v109, v186, v187
    v_cvt_pk_bf16_f32 v110, v188, v189
    v_cvt_pk_bf16_f32 v111, v190, v191
    s_nop 0
    buffer_store_dwordx4 v[108:111], v39, s[16:19], s25 offen offset:0 sc0 sc1
    s_waitcnt vmcnt(9)
    v_lshlrev_b32 v64, 16, v144
    v_and_b32 v65, 0xffff0000, v144
    v_lshlrev_b32 v66, 16, v145
    v_and_b32 v67, 0xffff0000, v145
    v_lshlrev_b32 v68, 16, v146
    v_and_b32 v69, 0xffff0000, v146
    v_lshlrev_b32 v70, 16, v147
    v_and_b32 v71, 0xffff0000, v147
    v_lshlrev_b32 v72, 16, v148
    v_and_b32 v73, 0xffff0000, v148
    v_lshlrev_b32 v74, 16, v149
    v_and_b32 v75, 0xffff0000, v149
    v_lshlrev_b32 v76, 16, v150
    v_and_b32 v77, 0xffff0000, v150
    v_lshlrev_b32 v78, 16, v151
    v_and_b32 v79, 0xffff0000, v151
    v_lshlrev_b32 v80, 16, v152
    v_and_b32 v81, 0xffff0000, v152
    v_lshlrev_b32 v82, 16, v153
    v_and_b32 v83, 0xffff0000, v153
    v_lshlrev_b32 v84, 16, v154
    v_and_b32 v85, 0xffff0000, v154
    v_lshlrev_b32 v86, 16, v155
    v_and_b32 v87, 0xffff0000, v155
    v_mul_f32 v64, v8, v64
    v_mul_f32 v65, v8, v65
    v_mul_f32 v66, v8, v66
    v_mul_f32 v67, v8, v67
    v_mul_f32 v68, v8, v68
    v_mul_f32 v69, v8, v69
    v_mul_f32 v70, v8, v70
    v_mul_f32 v71, v8, v71
    v_mul_f32 v72, v8, v72
    v_mul_f32 v73, v8, v73
    v_mul_f32 v74, v8, v74
    v_mul_f32 v75, v8, v75
    v_mul_f32 v76, v8, v76
    v_mul_f32 v77, v8, v77
    v_mul_f32 v78, v8, v78
    v_mul_f32 v79, v8, v79
    v_mul_f32 v80, v8, v80
    v_mul_f32 v81, v8, v81
    v_mul_f32 v82, v8, v82
    v_mul_f32 v83, v8, v83
    v_mul_f32 v84, v8, v84
    v_mul_f32 v85, v8, v85
    v_mul_f32 v86, v8, v86
    v_mul_f32 v87, v8, v87
    v_sub_f32 v8, 1.0, v8
    s_waitcnt vmcnt(0)
    s_barrier
    s_cmp_lg_u32 s32, 0
    s_cbranch_scc1 L_PUB6596
    v_mov_b32 v10, s68
    v_mov_b32 v11, 0
    s_mov_b64 exec, 1
    buffer_store_dword v10, v11, s[16:19], s50 offen sc0 sc1
    s_mov_b64 exec, -1
L_PUB6596:
    v_lshlrev_b32 v10, 2, v0
    s_mov_b32 s69, 200000
    s_mov_b64 exec, 15
L_POLL6605:
    buffer_load_dword v11, v10, s[16:19], s35 offen sc0 sc1
    s_waitcnt vmcnt(0)
    v_cmp_ne_u32 vcc, s68, v11
    s_sub_u32 s69, s69, 1
    s_nop 4
    s_cbranch_vccz L_POLL6605_D
    s_cmp_eq_u32 s69, 0
    s_cbranch_scc1 L_POLL6605_D
    s_sleep 1
    s_branch L_POLL6605
L_POLL6605_D:
    s_mov_b64 exec, -1
    s_add_u32 s46, s49, 1
    s_and_b32 s46, s46, 3
    s_mul_i32 s46, s46, 49152
    s_add_u32 s40, s36, s46
    buffer_load_dwordx4 v[96:99], v39, s[16:19], s40 offen offset:0 sc0 sc1
    buffer_load_dwordx4 v[100:103], v39, s[16:19], s40 offen offset:1024 sc0 sc1
    buffer_load_dwordx4 v[104:107], v39, s[16:19], s40 offen offset:2048 sc0 sc1
    s_add_u32 s46, s49, 2
    s_and_b32 s46, s46, 3
    s_mul_i32 s46, s46, 49152
    s_add_u32 s40, s36, s46
    buffer_load_dwordx4 v[108:111], v39, s[16:19], s40 offen offset:0 sc0 sc1
    buffer_load_dwordx4 v[112:115], v39, s[16:19], s40 offen offset:1024 sc0 sc1
    buffer_load_dwordx4 v[116:119], v39, s[16:19], s40 offen offset:2048 sc0 sc1
    s_add_u32 s46, s49, 3
    s_and_b32 s46, s46, 3
    s_mul_i32 s46, s46, 49152
    s_add_u32 s40, s36, s46
    buffer_load_dwordx4 v[120:123], v39, s[16:19], s40 offen offset:0 sc0 sc1
    buffer_load_dwordx4 v[124:127], v39, s[16:19], s40 offen offset:1024 sc0 sc1
    buffer_load_dwordx4 v[128:131], v39, s[16:19], s40 offen offset:2048 sc0 sc1
    s_waitcnt vmcnt(6)
    v_lshlrev_b32 v192, 16, v96
    v_and_b32 v193, 0xffff0000, v96
    v_lshlrev_b32 v194, 16, v97
    v_and_b32 v195, 0xffff0000, v97
    v_lshlrev_b32 v196, 16, v98
    v_and_b32 v197, 0xffff0000, v98
    v_lshlrev_b32 v198, 16, v99
    v_and_b32 v199, 0xffff0000, v99
    v_lshlrev_b32 v200, 16, v100
    v_and_b32 v201, 0xffff0000, v100
    v_lshlrev_b32 v202, 16, v101
    v_and_b32 v203, 0xffff0000, v101
    v_lshlrev_b32 v204, 16, v102
    v_and_b32 v205, 0xffff0000, v102
    v_lshlrev_b32 v206, 16, v103
    v_and_b32 v207, 0xffff0000, v103
    v_lshlrev_b32 v208, 16, v104
    v_and_b32 v209, 0xffff0000, v104
    v_lshlrev_b32 v210, 16, v105
    v_and_b32 v211, 0xffff0000, v105
    v_lshlrev_b32 v212, 16, v106
    v_and_b32 v213, 0xffff0000, v106
    v_lshlrev_b32 v214, 16, v107
    v_and_b32 v215, 0xffff0000, v107
    v_pk_add_f32 v[160:161], v[160:161], v[192:193]
    v_pk_add_f32 v[162:163], v[162:163], v[194:195]
    v_pk_add_f32 v[164:165], v[164:165], v[196:197]
    v_pk_add_f32 v[166:167], v[166:167], v[198:199]
    v_pk_add_f32 v[168:169], v[168:169], v[200:201]
    v_pk_add_f32 v[170:171], v[170:171], v[202:203]
    v_pk_add_f32 v[172:173], v[172:173], v[204:205]
    v_pk_add_f32 v[174:175], v[174:175], v[206:207]
    v_pk_add_f32 v[176:177], v[176:177], v[208:209]
    v_pk_add_f32 v[178:179], v[178:179], v[210:211]
    v_pk_add_f32 v[180:181], v[180:181], v[212:213]
    v_pk_add_f32 v[182:183], v[182:183], v[214:215]
    s_waitcnt vmcnt(3)
    v_lshlrev_b32 v192, 16, v108
    v_and_b32 v193, 0xffff0000, v108
    v_lshlrev_b32 v194, 16, v109
    v_and_b32 v195, 0xffff0000, v109
    v_lshlrev_b32 v196, 16, v110
    v_and_b32 v197, 0xffff0000, v110
    v_lshlrev_b32 v198, 16, v111
    v_and_b32 v199, 0xffff0000, v111
    v_lshlrev_b32 v200, 16, v112
    v_and_b32 v201, 0xffff0000, v112
    v_lshlrev_b32 v202, 16, v113
    v_and_b32 v203, 0xffff0000, v113
    v_lshlrev_b32 v204, 16, v114
    v_and_b32 v205, 0xffff0000, v114
    v_lshlrev_b32 v206, 16, v115
    v_and_b32 v207, 0xffff0000, v115
    v_lshlrev_b32 v208, 16, v116
    v_and_b32 v209, 0xffff0000, v116
    v_lshlrev_b32 v210, 16, v117
    v_and_b32 v211, 0xffff0000, v117
    v_lshlrev_b32 v212, 16, v118
    v_and_b32 v213, 0xffff0000, v118
    v_lshlrev_b32 v214, 16, v119
    v_and_b32 v215, 0xffff0000, v119
    v_pk_add_f32 v[160:161], v[160:161], v[192:193]
    v_pk_add_f32 v[162:163], v[162:163], v[194:195]
    v_pk_add_f32 v[164:165], v[164:165], v[196:197]
    v_pk_add_f32 v[166:167], v[166:167], v[198:199]
    v_pk_add_f32 v[168:169], v[168:169], v[200:201]
    v_pk_add_f32 v[170:171], v[170:171], v[202:203]
    v_pk_add_f32 v[172:173], v[172:173], v[204:205]
    v_pk_add_f32 v[174:175], v[174:175], v[206:207]
    v_pk_add_f32 v[176:177], v[176:177], v[208:209]
    v_pk_add_f32 v[178:179], v[178:179], v[210:211]
    v_pk_add_f32 v[180:181], v[180:181], v[212:213]
    v_pk_add_f32 v[182:183], v[182:183], v[214:215]
    s_waitcnt vmcnt(0)
    v_lshlrev_b32 v192, 16, v120
    v_and_b32 v193, 0xffff0000, v120
    v_lshlrev_b32 v194, 16, v121
    v_and_b32 v195, 0xffff0000, v121
    v_lshlrev_b32 v196, 16, v122
    v_and_b32 v197, 0xffff0000, v122
    v_lshlrev_b32 v198, 16, v123
    v_and_b32 v199, 0xffff0000, v123
    v_lshlrev_b32 v200, 16, v124
    v_and_b32 v201, 0xffff0000, v124
    v_lshlrev_b32 v202, 16, v125
    v_and_b32 v203, 0xffff0000, v125
    v_lshlrev_b32 v204, 16, v126
    v_and_b32 v205, 0xffff0000, v126
    v_lshlrev_b32 v206, 16, v127
    v_and_b32 v207, 0xffff0000, v127
    v_lshlrev_b32 v208, 16, v128
    v_and_b32 v209, 0xffff0000, v128
    v_lshlrev_b32 v210, 16, v129
    v_and_b32 v211, 0xffff0000, v129
    v_lshlrev_b32 v212, 16, v130
    v_and_b32 v213, 0xffff0000, v130
    v_lshlrev_b32 v214, 16, v131
    v_and_b32 v215, 0xffff0000, v131
    v_pk_add_f32 v[160:161], v[160:161], v[192:193]
    v_pk_add_f32 v[162:163], v[162:163], v[194:195]
    v_pk_add_f32 v[164:165], v[164:165], v[196:197]
    v_pk_add_f32 v[166:167], v[166:167], v[198:199]
    v_pk_add_f32 v[168:169], v[168:169], v[200:201]
    v_pk_add_f32 v[170:171], v[170:171], v[202:203]
    v_pk_add_f32 v[172:173], v[172:173], v[204:205]
    v_pk_add_f32 v[174:175], v[174:175], v[206:207]
    v_pk_add_f32 v[176:177], v[176:177], v[208:209]
    v_pk_add_f32 v[178:179], v[178:179], v[210:211]
    v_pk_add_f32 v[180:181], v[180:181], v[212:213]
    v_pk_add_f32 v[182:183], v[182:183], v[214:215]
    v_fma_f32 v160, v8, v160, v64
    v_fma_f32 v161, v8, v161, v65
    v_fma_f32 v162, v8, v162, v66
    v_fma_f32 v163, v8, v163, v67
    v_fma_f32 v164, v8, v164, v68
    v_fma_f32 v165, v8, v165, v69
    v_fma_f32 v166, v8, v166, v70
    v_fma_f32 v167, v8, v167, v71
    v_fma_f32 v168, v8, v168, v72
    v_fma_f32 v169, v8, v169, v73
    v_fma_f32 v170, v8, v170, v74
    v_fma_f32 v171, v8, v171, v75
    v_fma_f32 v172, v8, v172, v76
    v_fma_f32 v173, v8, v173, v77
    v_fma_f32 v174, v8, v174, v78
    v_fma_f32 v175, v8, v175, v79
    v_fma_f32 v176, v8, v176, v80
    v_fma_f32 v177, v8, v177, v81
    v_fma_f32 v178, v8, v178, v82
    v_fma_f32 v179, v8, v179, v83
    v_fma_f32 v180, v8, v180, v84
    v_fma_f32 v181, v8, v181, v85
    v_fma_f32 v182, v8, v182, v86
    v_fma_f32 v183, v8, v183, v87
    v_cvt_pk_bf16_f32 v192, v160, v161
    v_cvt_pk_bf16_f32 v193, v162, v163
    v_cvt_pk_bf16_f32 v194, v164, v165
    v_cvt_pk_bf16_f32 v195, v166, v167
    v_cvt_pk_bf16_f32 v196, v168, v169
    v_cvt_pk_bf16_f32 v197, v170, v171
    v_cvt_pk_bf16_f32 v198, v172, v173
    v_cvt_pk_bf16_f32 v199, v174, v175
    v_cvt_pk_bf16_f32 v200, v176, v177
    v_cvt_pk_bf16_f32 v201, v178, v179
    v_cvt_pk_bf16_f32 v202, v180, v181
    v_cvt_pk_bf16_f32 v203, v182, v183
    s_nop 1
    v_permlane32_swap_b32 v192, v194
    v_permlane32_swap_b32 v193, v195
    v_permlane32_swap_b32 v196, v198
    v_permlane32_swap_b32 v197, v199
    v_permlane32_swap_b32 v200, v202
    v_permlane32_swap_b32 v201, v203
    s_nop 1
    buffer_store_dwordx4 v[192:195], v13, s[8:11], s3 offen offset:0 nt
    buffer_store_dwordx4 v[196:199], v13, s[8:11], s3 offen offset:32 nt
    buffer_store_dwordx4 v[200:203], v13, s[8:11], s3 offen offset:64 nt
    s_branch L_END
L_QKV:
    s_lshl_b32 s34, s43, 1
    s_add_u32 s34, s34, s45
    s_sub_u32 s34, s34, 6
    s_mov_b32 s12, s6
    s_mov_b32 s13, s7
    s_mov_b32 s14, 1990656
    s_mov_b32 s15, 0x00020000
    s_mul_i32 s46, s32, 448
    s_mul_i32 s47, s34, 144
    s_mov_b32 s48, 3456
    s_mul_i32 s39, s32, 7168
    s_mul_i32 s36, s35, 221184
    s_lshl_b32 s37, s35, 7
    v_add_u32 v2, s46, v0
    v_add_u32 v2, 0, v2
    v_mul_u32_u24 v3, 2341, v2
    v_lshrrev_b32 v3, 16, v3
    v_mul_u32_u24 v4, 28, v3
    v_sub_u32 v4, v2, v4
    v_mul_u32_u24 v5, 57, v4
    v_lshrrev_b32 v5, 9, v5
    v_mul_u32_u24 v6, 9, v5
    v_sub_u32 v6, v4, v6
    v_mul_lo_u32 v7, v3, s48
    v_mul_u32_u24 v5, 1152, v5
    v_add3_u32 v7, v7, v5, s47
    v_lshl_add_u32 v40, v6, 4, v7
    v_cmp_eq_u32 vcc, 27, v4
    v_mov_b32 v4, 0x7ff00000
    s_nop 0
    v_cndmask_b32 v40, v40, v4, vcc
    s_add_u32 m0, s39, 0
    s_nop 0
    buffer_load_dwordx4 v40, s[12:15], s36 offen lds
    v_add_u32 v2, s46, v0
    v_add_u32 v2, 64, v2
    v_mul_u32_u24 v3, 2341, v2
    v_lshrrev_b32 v3, 16, v3
    v_mul_u32_u24 v4, 28, v3
    v_sub_u32 v4, v2, v4
    v_mul_u32_u24 v5, 57, v4
    v_lshrrev_b32 v5, 9, v5
    v_mul_u32_u24 v6, 9, v5
    v_sub_u32 v6, v4, v6
    v_mul_lo_u32 v7, v3, s48
    v_mul_u32_u24 v5, 1152, v5
    v_add3_u32 v7, v7, v5, s47
    v_lshl_add_u32 v41, v6, 4, v7
    v_cmp_eq_u32 vcc, 27, v4
    v_mov_b32 v4, 0x7ff00000
    s_nop 0
    v_cndmask_b32 v41, v41, v4, vcc
    s_add_u32 m0, s39, 1024
    s_nop 0
    buffer_load_dwordx4 v41, s[12:15], s36 offen lds
    v_add_u32 v2, s46, v0
    v_add_u32 v2, 128, v2
    v_mul_u32_u24 v3, 2341, v2
    v_lshrrev_b32 v3, 16, v3
    v_mul_u32_u24 v4, 28, v3
    v_sub_u32 v4, v2, v4
    v_mul_u32_u24 v5, 57, v4
    v_lshrrev_b32 v5, 9, v5
    v_mul_u32_u24 v6, 9, v5
    v_sub_u32 v6, v4, v6
    v_mul_lo_u32 v7, v3, s48
    v_mul_u32_u24 v5, 1152, v5
    v_add3_u32 v7, v7, v5, s47
    v_lshl_add_u32 v42, v6, 4, v7
    v_cmp_eq_u32 vcc, 27, v4
    v_mov_b32 v4, 0x7ff00000
    s_nop 0
    v_cndmask_b32 v42, v42, v4, vcc
    s_add_u32 m0, s39, 2048
    s_nop 0
    buffer_load_dwordx4 v42, s[12:15], s36 offen lds
    v_add_u32 v2, s46, v0
    v_add_u32 v2, 192, v2
    v_mul_u32_u24 v3, 2341, v2
    v_lshrrev_b32 v3, 16, v3
    v_mul_u32_u24 v4, 28, v3
    v_sub_u32 v4, v2, v4
    v_mul_u32_u24 v5, 57, v4
    v_lshrrev_b32 v5, 9, v5
    v_mul_u32_u24 v6, 9, v5
    v_sub_u32 v6, v4, v6
    v_mul_lo_u32 v7, v3, s48
    v_mul_u32_u24 v5, 1152, v5
    v_add3_u32 v7, v7, v5, s47
    v_lshl_add_u32 v43, v6, 4, v7
    v_cmp_eq_u32 vcc, 27, v4
    v_mov_b32 v4, 0x7ff00000
    s_nop 0
    v_cndmask_b32 v43, v43, v4, vcc
    s_add_u32 m0, s39, 3072
    s_nop 0
    buffer_load_dwordx4 v43, s[12:15], s36 offen lds
    v_add_u32 v2, s46, v0
    v_add_u32 v2, 256, v2
    v_mul_u32_u24 v3, 2341, v2
    v_lshrrev_b32 v3, 16, v3
    v_mul_u32_u24 v4, 28, v3
    v_sub_u32 v4, v2, v4
    v_mul_u32_u24 v5, 57, v4
    v_lshrrev_b32 v5, 9, v5
    v_mul_u32_u24 v6, 9, v5
    v_sub_u32 v6, v4, v6
    v_mul_lo_u32 v7, v3, s48
    v_mul_u32_u24 v5, 1152, v5
    v_add3_u32 v7, v7, v5, s47
    v_lshl_add_u32 v44, v6, 4, v7
    v_cmp_eq_u32 vcc, 27, v4
    v_mov_b32 v4, 0x7ff00000
    s_nop 0
    v_cndmask_b32 v44, v44, v4, vcc
    s_add_u32 m0, s39, 4096
    s_nop 0
    buffer_load_dwordx4 v44, s[12:15], s36 offen lds
    v_add_u32 v2, s46, v0
    v_add_u32 v2, 320, v2
    v_mul_u32_u24 v3, 2341, v2
    v_lshrrev_b32 v3, 16, v3
    v_mul_u32_u24 v4, 28, v3
    v_sub_u32 v4, v2, v4
    v_mul_u32_u24 v5, 57, v4
    v_lshrrev_b32 v5, 9, v5
    v_mul_u32_u24 v6, 9, v5
    v_sub_u32 v6, v4, v6
    v_mul_lo_u32 v7, v3, s48
    v_mul_u32_u24 v5, 1152, v5
    v_add3_u32 v7, v7, v5, s47
    v_lshl_add_u32 v45, v6, 4, v7
    v_cmp_eq_u32 vcc, 27, v4
    v_mov_b32 v4, 0x7ff00000
    s_nop 0
    v_cndmask_b32 v45, v45, v4, vcc
    s_add_u32 m0, s39, 5120
    s_nop 0
    buffer_load_dwordx4 v45, s[12:15], s36 offen lds
    v_add_u32 v2, s46, v0
    v_add_u32 v2, 384, v2
    v_mul_u32_u24 v3, 2341, v2
    v_lshrrev_b32 v3, 16, v3
    v_mul_u32_u24 v4, 28, v3
    v_sub_u32 v4, v2, v4
    v_mul_u32_u24 v5, 57, v4
    v_lshrrev_b32 v5, 9, v5
    v_mul_u32_u24 v6, 9, v5
    v_sub_u32 v6, v4, v6
    v_mul_lo_u32 v7, v3, s48
    v_mul_u32_u24 v5, 1152, v5
    v_add3_u32 v7, v7, v5, s47
    v_lshl_add_u32 v46, v6, 4, v7
    v_cmp_eq_u32 vcc, 27, v4
    v_mov_b32 v4, 0x7ff00000
    s_nop 0
    v_cndmask_b32 v46, v46, v4, vcc
    s_add_u32 m0, s39, 6144
    s_nop 0
    buffer_load_dwordx4 v46, s[12:15], s36 offen lds
    s_and_b32 s46, s32, 1
    v_lshrrev_b32 v2, 3, v0
    v_and_b32 v3, 7, v0
    v_lshrrev_b32 v4, 1, v2
    s_lshl_b32 s47, s46, 2
    v_or_b32 v4, s47, v4
    v_xor_b32 v3, v3, v4
    v_mul_u32_u24 v7, 1152, v2
    v_lshl_add_u32 v7, v3, 4, v7
    s_lshl_b32 s47, s33, 8
    s_lshl_b32 s48, s46, 3
    s_add_u32 s47, s47, s48
    s_sub_u32 s47, s47, 16
    s_mul_i32 s47, s47, 1152
    v_add_u32 v63, s47, v7
    s_lshl_b32 s49, s46, 10
    s_add_u32 s49, s49, 86016
    v_lshlrev_b32 v39, 4, v0
    s_add_u32 m0, s49, 0
    s_nop 0
    buffer_load_dwordx4 v63, s[8:11], s37 offen lds
    s_add_u32 s3, s3, 1
    s_cmp_eq_u32 s3, 9
    s_cselect_b32 s3, 0, s3
    s_mov_b32 s40, 128
    s_cselect_b32 s40, 4294966272, s40
    s_add_u32 s64, s64, s40
    s_add_u32 s65, s65, s40
    s_add_u32 s66, s66, s40
    s_add_u32 s67, s67, s40
    s_add_u32 m0, s38, 8192
    s_nop 0
    buffer_load_dwordx4 v38, s[8:11], s64 offen lds
    s_add_u32 m0, s38, 9216
    s_nop 0
    buffer_load_dwordx4 v31, s[8:11], s64 offen lds
    s_add_u32 m0, s38, 10240
    s_nop 0
    buffer_load_dwordx4 v38, s[8:11], s65 offen lds
    s_add_u32 m0, s38, 11264
    s_nop 0
    buffer_load_dwordx4 v31, s[8:11], s65 offen lds
    s_add_u32 m0, s38, 12288
    s_nop 0
    buffer_load_dwordx4 v38, s[8:11], s66 offen lds
    s_add_u32 m0, s38, 13312
    s_nop 0
    buffer_load_dwordx4 v31, s[8:11], s66 offen lds
    s_add_u32 m0, s38, 14336
    s_nop 0
    buffer_load_dwordx4 v38, s[8:11], s67 offen lds
    s_add_u32 m0, s38, 15360
    s_nop 0
    buffer_load_dwordx4 v31, s[8:11], s67 offen lds
    s_add_u32 s35, s35, 1
    s_cmp_eq_u32 s35, 9
    s_cselect_b32 s35, 0, s35
    s_mov_b32 s40, 128
    s_cselect_b32 s40, 4294966272, s40
    s_mov_b32 s41, s40
    s_mov_b32 s40, 221184
    s_cselect_b32 s40, 4293197824, s40
    s_mov_b32 s42, s40
    s_add_u32 s36, s36, s42
    s_add_u32 s37, s37, s41
    s_add_u32 m0, s39, 28672
    s_nop 0
    buffer_load_dwordx4 v40, s[12:15], s36 offen lds
    s_add_u32 m0, s39, 29696
    s_nop 0
    buffer_load_dwordx4 v41, s[12:15], s36 offen lds
    s_add_u32 m0, s39, 30720
    s_nop 0
    buffer_load_dwordx4 v42, s[12:15], s36 offen lds
    s_add_u32 m0, s39, 31744
    s_nop 0
    buffer_load_dwordx4 v43, s[12:15], s36 offen lds
    s_add_u32 m0, s39, 32768
    s_nop 0
    buffer_load_dwordx4 v44, s[12:15], s36 offen lds
    s_add_u32 m0, s39, 33792
    s_nop 0
    buffer_load_dwordx4 v45, s[12:15], s36 offen lds
    s_add_u32 m0, s39, 34816
    s_nop 0
    buffer_load_dwordx4 v46, s[12:15], s36 offen lds
    s_add_u32 m0, s49, 2048
    s_nop 0
    buffer_load_dwordx4 v63, s[8:11], s37 offen lds
    s_mov_b32 s16, s58
    s_mov_b32 s17, s59
    s_mov_b32 s18, 268435456
    s_mov_b32 s19, 0x00020000
    v_and_b32 v2, 31, v0
    v_lshrrev_b32 v3, 5, v0
    v_bfe_u32 v4, v2, 1, 3
    v_lshlrev_b32 v5, 7, v2
    v_add_u32 v5, s38, v5
    v_add_u32 v6, 0, v3
    v_xor_b32 v6, v6, v4
    v_lshl_add_u32 v32, v6, 4, v5
    v_add_u32 v6, 2, v3
    v_xor_b32 v6, v6, v4
    v_lshl_add_u32 v33, v6, 4, v5
    v_add_u32 v6, 4, v3
    v_xor_b32 v6, v6, v4
    v_lshl_add_u32 v34, v6, 4, v5
    v_add_u32 v6, 6, v3
    v_xor_b32 v6, v6, v4
    v_lshl_add_u32 v35, v6, 4, v5
    v_lshlrev_b32 v39, 4, v0
    v_lshrrev_b32 v2, 4, v0
    v_bfe_u32 v3, v0, 2, 2
    v_and_b32 v4, 3, v0
    v_lshrrev_b32 v5, 1, v2
    v_lshl_add_u32 v5, v5, 3, v3
    v_mul_u32_u24 v5, 448, v5
    v_and_b32 v6, 1, v2
    v_lshl_add_u32 v5, v6, 5, v5
    v_lshl_add_u32 v47, v4, 3, v5
    v_add_u32 v84, 57344, v47
    v_lshl_add_u32 v5, v2, 3, v3
    v_mul_u32_u24 v5, 448, v5
    v_lshl_add_u32 v5, v4, 3, v5
    v_and_b32 v10, 15, v0
    v_mul_u32_u24 v10, 592, v10
    v_lshl_add_u32 v10, v2, 4, v10
    s_mul_i32 s46, s32, 3
    s_add_u32 s46, s46, 0
    s_min_u32 s46, s46, 8
    s_lshl_b32 s47, s46, 5
    s_add_u32 s47, s47, 144
    v_add_u32 v54, s47, v5
    v_add_u32 v91, 57344, v54
    s_lshl_b32 s47, s46, 6
    v_add_u32 v60, s47, v10
    s_mul_i32 s46, s32, 3
    s_add_u32 s46, s46, 1
    s_min_u32 s46, s46, 8
    s_lshl_b32 s47, s46, 5
    s_add_u32 s47, s47, 144
    v_add_u32 v55, s47, v5
    v_add_u32 v92, 57344, v55
    s_lshl_b32 s47, s46, 6
    v_add_u32 v61, s47, v10
    s_mul_i32 s46, s32, 3
    s_add_u32 s46, s46, 2
    s_min_u32 s46, s46, 8
    s_lshl_b32 s47, s46, 5
    s_add_u32 s47, s47, 144
    v_add_u32 v56, s47, v5
    v_add_u32 v93, 57344, v56
    s_lshl_b32 s47, s46, 6
    v_add_u32 v62, s47, v10
    v_and_b32 v5, 15, v0
    v_bfe_u32 v6, v5, 1, 3
    v_add_u32 v7, 0, v2
    v_xor_b32 v7, v7, v6
    v_lshlrev_b32 v7, 4, v7
    v_lshl_add_u32 v7, v5, 7, v7
    v_add_u32 v57, 86016, v7
    v_add_u32 v7, 4, v2
    v_xor_b32 v7, v7, v6
    v_lshlrev_b32 v7, 4, v7
    v_lshl_add_u32 v7, v5, 7, v7
    v_add_u32 v58, 86016, v7
    s_waitcnt vmcnt(24)
    ds_read_b128 v[96:99], v32 offset:0
    ds_read_b128 v[100:103], v32 offset:4096
    ds_read_b128 v[104:107], v33 offset:0
    ds_read_b128 v[108:111], v33 offset:4096
    ds_read_b128 v[112:115], v34 offset:0
    ds_read_b128 v[116:119], v34 offset:4096
    ds_read_b128 v[120:123], v35 offset:0
    ds_read_b128 v[124:127], v35 offset:4096
    s_waitcnt vmcnt(16)
    s_barrier
    ds_read_b128 v[244:247], v57 offset:0
    ds_read_b64_tr_b16 v[68:69], v47 offset:0
    ds_read_b64_tr_b16 v[70:71], v47 offset:1792
    s_waitcnt lgkmcnt(0)
    v_mfma_f32_32x32x16_bf16 a[0:15], v[68:71], v[96:99], 0
    ds_read_b64_tr_b16 v[72:73], v47 offset:64
    ds_read_b64_tr_b16 v[74:75], v47 offset:1856
    ds_read_b64_tr_b16 v[76:77], v47 offset:128
    ds_read_b64_tr_b16 v[78:79], v47 offset:1920
    ds_read_b64_tr_b16 v[80:81], v47 offset:192
    ds_read_b64_tr_b16 v[82:83], v47 offset:1984
    v_mfma_f32_32x32x16_bf16 a[16:31], v[68:71], v[100:103], 0
    s_add_u32 s3, s3, 1
    s_cmp_eq_u32 s3, 9
    s_cselect_b32 s3, 0, s3
    s_mov_b32 s40, 128
    s_cselect_b32 s40, 4294966272, s40
    s_add_u32 s64, s64, s40
    s_waitcnt lgkmcnt(4)
    v_mfma_f32_32x32x16_bf16 a[32:47], v[72:75], v[96:99], 0
    ds_read_b64_tr_b16 v[68:69], v47 offset:256
    ds_read_b64_tr_b16 v[70:71], v47 offset:2048
    ds_read_b64_tr_b16 v[232:233], v54 offset:0
    ds_read_b64_tr_b16 v[234:235], v54 offset:1792
    s_add_u32 s65, s65, s40
    s_add_u32 s66, s66, s40
    s_add_u32 s67, s67, s40
    v_mfma_f32_32x32x16_bf16 a[48:63], v[72:75], v[100:103], 0
    s_add_u32 m0, s38, 0
    s_nop 0
    s_waitcnt lgkmcnt(6)
    v_mfma_f32_32x32x16_bf16 a[64:79], v[76:79], v[96:99], 0
    ds_read_b64_tr_b16 v[72:73], v47 offset:320
    ds_read_b64_tr_b16 v[74:75], v47 offset:2112
    ds_read_b64_tr_b16 v[236:237], v55 offset:0
    ds_read_b64_tr_b16 v[238:239], v55 offset:1792
    v_mfma_f32_32x32x16_bf16 a[80:95], v[76:79], v[100:103], 0
    buffer_load_dwordx4 v38, s[8:11], s64 offen lds
    s_add_u32 s35, s35, 1
    s_waitcnt lgkmcnt(8)
    v_mfma_f32_32x32x16_bf16 a[96:111], v[80:83], v[96:99], 0
    ds_read_b64_tr_b16 v[76:77], v47 offset:384
    ds_read_b64_tr_b16 v[78:79], v47 offset:2176
    ds_read_b64_tr_b16 v[240:241], v56 offset:0
    ds_read_b64_tr_b16 v[242:243], v56 offset:1792
    s_cmp_eq_u32 s35, 9
    s_cselect_b32 s35, 0, s35
    s_mov_b32 s40, 128
    v_mfma_f32_32x32x16_bf16 a[112:127], v[80:83], v[100:103], 0
    s_cselect_b32 s40, 4294966272, s40
    s_mov_b32 s41, s40
    s_mov_b32 s40, 221184
    s_cselect_b32 s40, 4293197824, s40
    s_mov_b32 s42, s40
    s_add_u32 s36, s36, s42
    s_waitcnt lgkmcnt(10)
    v_mfma_f32_32x32x16_bf16 a[128:143], v[68:71], v[96:99], 0
    ds_read_b64_tr_b16 v[80:81], v47 offset:7168
    ds_read_b64_tr_b16 v[82:83], v47 offset:8960
    s_add_u32 s37, s37, s41
    s_add_u32 m0, s39, 57344
    s_nop 0
    v_mfma_f32_32x32x16_bf16 a[144:159], v[68:71], v[100:103], 0
    buffer_load_dwordx4 v40, s[12:15], s36 offen lds
    s_add_u32 m0, s38, 1024
    s_waitcnt lgkmcnt(10)
    v_mfma_f32_16x16x32_bf16 a[224:227], v[232:235], v[244:247], 0
    s_waitcnt lgkmcnt(8)
    v_mfma_f32_32x32x16_bf16 a[160:175], v[72:75], v[96:99], 0
    ds_read_b64_tr_b16 v[68:69], v47 offset:7232
    ds_read_b64_tr_b16 v[70:71], v47 offset:9024
    s_nop 0
    v_mfma_f32_32x32x16_bf16 a[176:191], v[72:75], v[100:103], 0
    buffer_load_dwordx4 v31, s[8:11], s64 offen lds
    s_add_u32 m0, s39, 58368
    s_waitcnt lgkmcnt(8)
    v_mfma_f32_16x16x32_bf16 a[228:231], v[236:239], v[244:247], 0
    s_waitcnt lgkmcnt(6)
    v_mfma_f32_32x32x16_bf16 a[192:207], v[76:79], v[96:99], 0
    ds_read_b64_tr_b16 v[72:73], v47 offset:7296
    ds_read_b64_tr_b16 v[74:75], v47 offset:9088
    s_nop 0
    v_mfma_f32_32x32x16_bf16 a[208:223], v[76:79], v[100:103], 0
    buffer_load_dwordx4 v41, s[12:15], s36 offen lds
    s_add_u32 m0, s38, 2048
    s_waitcnt lgkmcnt(6)
    v_mfma_f32_16x16x32_bf16 a[232:235], v[240:243], v[244:247], 0
    s_waitcnt lgkmcnt(4)
    v_mfma_f32_32x32x16_bf16 a[0:15], v[80:83], v[104:107], a[0:15]
    ds_read_b64_tr_b16 v[76:77], v47 offset:7360
    ds_read_b64_tr_b16 v[78:79], v47 offset:9152
    s_nop 0
    v_mfma_f32_32x32x16_bf16 a[16:31], v[80:83], v[108:111], a[16:31]
    buffer_load_dwordx4 v38, s[8:11], s65 offen lds
    s_add_u32 m0, s39, 59392
    s_waitcnt lgkmcnt(4)
    v_mfma_f32_32x32x16_bf16 a[32:47], v[68:71], v[104:107], a[32:47]
    ds_read_b64_tr_b16 v[80:81], v47 offset:7424
    ds_read_b64_tr_b16 v[82:83], v47 offset:9216
    s_nop 0
    v_mfma_f32_32x32x16_bf16 a[48:63], v[68:71], v[108:111], a[48:63]
    buffer_load_dwordx4 v42, s[12:15], s36 offen lds
    s_add_u32 m0, s38, 3072
    s_waitcnt lgkmcnt(4)
    v_mfma_f32_32x32x16_bf16 a[64:79], v[72:75], v[104:107], a[64:79]
    ds_read_b64_tr_b16 v[68:69], v47 offset:7488
    ds_read_b64_tr_b16 v[70:71], v47 offset:9280
    s_nop 0
    v_mfma_f32_32x32x16_bf16 a[80:95], v[72:75], v[108:111], a[80:95]
    buffer_load_dwordx4 v31, s[8:11], s65 offen lds
    s_waitcnt lgkmcnt(4)
    v_mfma_f32_32x32x16_bf16 a[96:111], v[76:79], v[104:107], a[96:111]
    ds_read_b64_tr_b16 v[72:73], v47 offset:7552
    ds_read_b64_tr_b16 v[74:75], v47 offset:9344
    s_add_u32 m0, s39, 60416
    s_nop 0
    v_mfma_f32_32x32x16_bf16 a[112:127], v[76:79], v[108:111], a[112:127]
    buffer_load_dwordx4 v43, s[12:15], s36 offen lds
    s_waitcnt lgkmcnt(4)
    v_mfma_f32_32x32x16_bf16 a[128:143], v[80:83], v[104:107], a[128:143]
    ds_read_b64_tr_b16 v[76:77], v47 offset:14336
    ds_read_b64_tr_b16 v[78:79], v47 offset:16128
    s_add_u32 m0, s38, 4096
    s_nop 0
    v_mfma_f32_32x32x16_bf16 a[144:159], v[80:83], v[108:111], a[144:159]
    buffer_load_dwordx4 v38, s[8:11], s66 offen lds
    s_waitcnt lgkmcnt(4)
    v_mfma_f32_32x32x16_bf16 a[160:175], v[68:71], v[104:107], a[160:175]
    ds_read_b64_tr_b16 v[80:81], v47 offset:14400
    ds_read_b64_tr_b16 v[82:83], v47 offset:16192
    v_mfma_f32_32x32x16_bf16 a[176:191], v[68:71], v[108:111], a[176:191]
    s_add_u32 m0, s39, 61440
    s_nop 0
    s_waitcnt lgkmcnt(4)
    v_mfma_f32_32x32x16_bf16 a[192:207], v[72:75], v[104:107], a[192:207]
    ds_read_b64_tr_b16 v[68:69], v47 offset:14464
    ds_read_b64_tr_b16 v[70:71], v47 offset:16256
    buffer_load_dwordx4 v44, s[12:15], s36 offen lds
    v_mfma_f32_32x32x16_bf16 a[208:223], v[72:75], v[108:111], a[208:223]
    s_add_u32 m0, s38, 5120
    s_nop 0
    ds_read_b128 v[248:251], v58 offset:0
    s_waitcnt lgkmcnt(5)
    v_mfma_f32_32x32x16_bf16 a[0:15], v[76:79], v[112:115], a[0:15]
    ds_read_b64_tr_b16 v[72:73], v47 offset:14528
    ds_read_b64_tr_b16 v[74:75], v47 offset:16320
    buffer_load_dwordx4 v31, s[8:11], s66 offen lds
    v_mfma_f32_32x32x16_bf16 a[16:31], v[76:79], v[116:119], a[16:31]
    s_waitcnt lgkmcnt(5)
    v_mfma_f32_32x32x16_bf16 a[32:47], v[80:83], v[112:115], a[32:47]
    ds_read_b64_tr_b16 v[76:77], v47 offset:14592
    ds_read_b64_tr_b16 v[78:79], v47 offset:16384
    ds_read_b64_tr_b16 v[232:233], v54 offset:14336
    ds_read_b64_tr_b16 v[234:235], v54 offset:16128
    v_mfma_f32_32x32x16_bf16 a[48:63], v[80:83], v[116:119], a[48:63]
    s_add_u32 m0, s39, 62464
    s_nop 0
    s_waitcnt lgkmcnt(7)
    v_mfma_f32_32x32x16_bf16 a[64:79], v[68:71], v[112:115], a[64:79]
    ds_read_b64_tr_b16 v[80:81], v47 offset:14656
    ds_read_b64_tr_b16 v[82:83], v47 offset:16448
    ds_read_b64_tr_b16 v[236:237], v55 offset:14336
    ds_read_b64_tr_b16 v[238:239], v55 offset:16128
    v_mfma_f32_32x32x16_bf16 a[80:95], v[68:71], v[116:119], a[80:95]
    buffer_load_dwordx4 v45, s[12:15], s36 offen lds
    s_add_u32 m0, s38, 6144
    s_waitcnt lgkmcnt(8)
    v_mfma_f32_32x32x16_bf16 a[96:111], v[72:75], v[112:115], a[96:111]
    ds_read_b64_tr_b16 v[68:69], v47 offset:14720
    ds_read_b64_tr_b16 v[70:71], v47 offset:16512
    ds_read_b64_tr_b16 v[240:241], v56 offset:14336
    ds_read_b64_tr_b16 v[242:243], v56 offset:16128
    s_nop 0
    v_mfma_f32_32x32x16_bf16 a[112:127], v[72:75], v[116:119], a[112:127]
    buffer_load_dwordx4 v38, s[8:11], s67 offen lds
    s_waitcnt lgkmcnt(10)
    v_mfma_f32_32x32x16_bf16 a[128:143], v[76:79], v[112:115], a[128:143]
    ds_read_b64_tr_b16 v[72:73], v47 offset:21504
    ds_read_b64_tr_b16 v[74:75], v47 offset:23296
    s_add_u32 m0, s39, 63488
    s_nop 0
    v_mfma_f32_32x32x16_bf16 a[144:159], v[76:79], v[116:119], a[144:159]
    buffer_load_dwordx4 v46, s[12:15], s36 offen lds
    s_waitcnt lgkmcnt(10)
    v_mfma_f32_16x16x32_bf16 a[224:227], v[232:235], v[248:251], a[224:227]
    s_waitcnt lgkmcnt(8)
    v_mfma_f32_32x32x16_bf16 a[160:175], v[80:83], v[112:115], a[160:175]
    ds_read_b64_tr_b16 v[76:77], v47 offset:21568
    ds_read_b64_tr_b16 v[78:79], v47 offset:23360
    s_add_u32 m0, s38, 7168
    s_nop 0
    v_mfma_f32_32x32x16_bf16 a[176:191], v[80:83], v[116:119], a[176:191]
    buffer_load_dwordx4 v31, s[8:11], s67 offen lds
    s_waitcnt lgkmcnt(8)
    v_mfma_f32_16x16x32_bf16 a[228:231], v[236:239], v[248:251], a[228:231]
    s_waitcnt lgkmcnt(6)
    v_mfma_f32_32x32x16_bf16 a[192:207], v[68:71], v[112:115], a[192:207]
    ds_read_b64_tr_b16 v[80:81], v47 offset:21632
    ds_read_b64_tr_b16 v[82:83], v47 offset:23424
    s_add_u32 m0, s49, 4096
    s_nop 0
    v_mfma_f32_32x32x16_bf16 a[208:223], v[68:71], v[116:119], a[208:223]
    buffer_load_dwordx4 v63, s[8:11], s37 offen lds
    s_waitcnt vmcnt(24)
    s_waitcnt lgkmcnt(6)
    v_mfma_f32_16x16x32_bf16 a[232:235], v[240:243], v[248:251], a[232:235]
    s_waitcnt lgkmcnt(4)
    v_mfma_f32_32x32x16_bf16 a[0:15], v[72:75], v[120:123], a[0:15]
    s_waitcnt vmcnt(16)
    s_barrier
    ds_read_b64_tr_b16 v[68:69], v47 offset:21696
    ds_read_b64_tr_b16 v[70:71], v47 offset:23488
    ds_read_b128 v[128:131], v32 offset:8192
    v_mfma_f32_32x32x16_bf16 a[16:31], v[72:75], v[124:127], a[16:31]
    ds_read_b128 v[132:135], v32 offset:12288
    ds_read_b128 v[136:139], v33 offset:8192
    ds_read_b128 v[140:143], v33 offset:12288
    s_waitcnt lgkmcnt(8)
    v_mfma_f32_32x32x16_bf16 a[32:47], v[76:79], v[120:123], a[32:47]
    ds_read_b64_tr_b16 v[72:73], v47 offset:21760
    ds_read_b64_tr_b16 v[74:75], v47 offset:23552
    v_mfma_f32_32x32x16_bf16 a[48:63], v[76:79], v[124:127], a[48:63]
    s_waitcnt lgkmcnt(8)
    v_mfma_f32_32x32x16_bf16 a[64:79], v[80:83], v[120:123], a[64:79]
    ds_read_b64_tr_b16 v[76:77], v47 offset:21824
    ds_read_b64_tr_b16 v[78:79], v47 offset:23616
    v_mfma_f32_32x32x16_bf16 a[80:95], v[80:83], v[124:127], a[80:95]
    s_waitcnt lgkmcnt(8)
    v_mfma_f32_32x32x16_bf16 a[96:111], v[68:71], v[120:123], a[96:111]
    ds_read_b64_tr_b16 v[80:81], v47 offset:21888
    ds_read_b64_tr_b16 v[82:83], v47 offset:23680
    v_mfma_f32_32x32x16_bf16 a[112:127], v[68:71], v[124:127], a[112:127]
    s_waitcnt lgkmcnt(4)
    v_mfma_f32_32x32x16_bf16 a[128:143], v[72:75], v[120:123], a[128:143]
    ds_read_b64_tr_b16 v[68:69], v47 offset:28672
    ds_read_b64_tr_b16 v[70:71], v47 offset:30464
    ds_read_b128 v[144:147], v34 offset:8192
    ds_read_b128 v[148:151], v34 offset:12288
    v_mfma_f32_32x32x16_bf16 a[144:159], v[72:75], v[124:127], a[144:159]
    ds_read_b128 v[152:155], v35 offset:8192
    ds_read_b128 v[156:159], v35 offset:12288
    s_waitcnt lgkmcnt(8)
    v_mfma_f32_32x32x16_bf16 a[160:175], v[76:79], v[120:123], a[160:175]
    ds_read_b64_tr_b16 v[72:73], v47 offset:28736
    ds_read_b64_tr_b16 v[74:75], v47 offset:30528
    v_mfma_f32_32x32x16_bf16 a[176:191], v[76:79], v[124:127], a[176:191]
    s_waitcnt lgkmcnt(8)
    v_mfma_f32_32x32x16_bf16 a[192:207], v[80:83], v[120:123], a[192:207]
    ds_read_b64_tr_b16 v[76:77], v47 offset:28800
    ds_read_b64_tr_b16 v[78:79], v47 offset:30592
    v_mfma_f32_32x32x16_bf16 a[208:223], v[80:83], v[124:127], a[208:223]
    ds_read_b128 v[244:247], v57 offset:2048
    s_waitcnt lgkmcnt(9)
    v_mfma_f32_32x32x16_bf16 a[0:15], v[68:71], v[128:131], a[0:15]
    s_barrier
    ds_read_b64_tr_b16 v[80:81], v47 offset:28864
    ds_read_b64_tr_b16 v[82:83], v47 offset:30656
    s_waitcnt lgkmcnt(7)
    s_add_u32 s3, s3, 1
    s_cmp_eq_u32 s3, 9
    v_mfma_f32_32x32x16_bf16 a[16:31], v[68:71], v[132:135], a[16:31]
    s_cselect_b32 s3, 0, s3
    s_mov_b32 s40, 128
    s_cselect_b32 s40, 4294966272, s40
    s_add_u32 s64, s64, s40
    s_add_u32 s65, s65, s40
    s_add_u32 s66, s66, s40
    s_waitcnt lgkmcnt(5)
    v_mfma_f32_32x32x16_bf16 a[32:47], v[72:75], v[128:131], a[32:47]
    ds_read_b64_tr_b16 v[68:69], v47 offset:28928
    ds_read_b64_tr_b16 v[70:71], v47 offset:30720
    ds_read_b64_tr_b16 v[232:233], v54 offset:28672
    ds_read_b64_tr_b16 v[234:235], v54 offset:30464
    s_add_u32 s67, s67, s40
    s_add_u32 m0, s38, 8192
    s_nop 0
    v_mfma_f32_32x32x16_bf16 a[48:63], v[72:75], v[132:135], a[48:63]
    buffer_load_dwordx4 v38, s[8:11], s64 offen lds
    s_add_u32 s35, s35, 1
    s_waitcnt lgkmcnt(7)
    v_mfma_f32_32x32x16_bf16 a[64:79], v[76:79], v[128:131], a[64:79]
    ds_read_b64_tr_b16 v[72:73], v47 offset:28992
    ds_read_b64_tr_b16 v[74:75], v47 offset:30784
    ds_read_b64_tr_b16 v[236:237], v55 offset:28672
    ds_read_b64_tr_b16 v[238:239], v55 offset:30464
    s_cmp_eq_u32 s35, 9
    s_cselect_b32 s35, 0, s35
    s_mov_b32 s40, 128
    v_mfma_f32_32x32x16_bf16 a[80:95], v[76:79], v[132:135], a[80:95]
    s_cselect_b32 s40, 4294966272, s40
    s_mov_b32 s41, s40
    s_mov_b32 s40, 221184
    s_cselect_b32 s40, 4293197824, s40
    s_mov_b32 s42, s40
    s_add_u32 s36, s36, s42
    s_waitcnt lgkmcnt(8)
    v_mfma_f32_32x32x16_bf16 a[96:111], v[80:83], v[128:131], a[96:111]
    ds_read_b64_tr_b16 v[76:77], v47 offset:29056
    ds_read_b64_tr_b16 v[78:79], v47 offset:30848
    ds_read_b64_tr_b16 v[240:241], v56 offset:28672
    ds_read_b64_tr_b16 v[242:243], v56 offset:30464
    s_add_u32 s37, s37, s41
    s_add_u32 m0, s39, 0
    s_nop 0
    v_mfma_f32_32x32x16_bf16 a[112:127], v[80:83], v[132:135], a[112:127]
    buffer_load_dwordx4 v40, s[12:15], s36 offen lds
    s_add_u32 m0, s38, 9216
    s_waitcnt lgkmcnt(10)
    v_mfma_f32_32x32x16_bf16 a[128:143], v[68:71], v[128:131], a[128:143]
    ds_read_b64_tr_b16 v[80:81], v47 offset:35840
    ds_read_b64_tr_b16 v[82:83], v47 offset:37632
    s_nop 0
    v_mfma_f32_32x32x16_bf16 a[144:159], v[68:71], v[132:135], a[144:159]
    buffer_load_dwordx4 v31, s[8:11], s64 offen lds
    s_add_u32 m0, s39, 1024
    s_waitcnt lgkmcnt(10)
    v_mfma_f32_16x16x32_bf16 a[224:227], v[232:235], v[244:247], a[224:227]
    s_waitcnt lgkmcnt(8)
    v_mfma_f32_32x32x16_bf16 a[160:175], v[72:75], v[128:131], a[160:175]
    ds_read_b64_tr_b16 v[68:69], v47 offset:35904
    ds_read_b64_tr_b16 v[70:71], v47 offset:37696
    s_nop 0
    v_mfma_f32_32x32x16_bf16 a[176:191], v[72:75], v[132:135], a[176:191]
    buffer_load_dwordx4 v41, s[12:15], s36 offen lds
    s_add_u32 m0, s38, 10240
    s_waitcnt lgkmcnt(8)
    v_mfma_f32_16x16x32_bf16 a[228:231], v[236:239], v[244:247], a[228:231]
    s_waitcnt lgkmcnt(6)
    v_mfma_f32_32x32x16_bf16 a[192:207], v[76:79], v[128:131], a[192:207]
    ds_read_b64_tr_b16 v[72:73], v47 offset:35968
    ds_read_b64_tr_b16 v[74:75], v47 offset:37760
    s_nop 0
    v_mfma_f32_32x32x16_bf16 a[208:223], v[76:79], v[132:135], a[208:223]
    buffer_load_dwordx4 v38, s[8:11], s65 offen lds
    s_add_u32 m0, s39, 2048
    s_waitcnt lgkmcnt(6)
    v_mfma_f32_16x16x32_bf16 a[232:235], v[240:243], v[244:247], a[232:235]
    s_waitcnt lgkmcnt(4)
    v_mfma_f32_32x32x16_bf16 a[0:15], v[80:83], v[136:139], a[0:15]
    ds_read_b64_tr_b16 v[76:77], v47 offset:36032
    ds_read_b64_tr_b16 v[78:79], v47 offset:37824
    s_nop 0
    v_mfma_f32_32x32x16_bf16 a[16:31], v[80:83], v[140:143], a[16:31]
    buffer_load_dwordx4 v42, s[12:15], s36 offen lds
    s_add_u32 m0, s38, 11264
    s_waitcnt lgkmcnt(4)
    v_mfma_f32_32x32x16_bf16 a[32:47], v[68:71], v[136:139], a[32:47]
    ds_read_b64_tr_b16 v[80:81], v47 offset:36096
    ds_read_b64_tr_b16 v[82:83], v47 offset:37888
    s_nop 0
    v_mfma_f32_32x32x16_bf16 a[48:63], v[68:71], v[140:143], a[48:63]
    buffer_load_dwordx4 v31, s[8:11], s65 offen lds
    s_add_u32 m0, s39, 3072
    s_waitcnt lgkmcnt(4)
    v_mfma_f32_32x32x16_bf16 a[64:79], v[72:75], v[136:139], a[64:79]
    ds_read_b64_tr_b16 v[68:69], v47 offset:36160
    ds_read_b64_tr_b16 v[70:71], v47 offset:37952
    s_nop 0
    v_mfma_f32_32x32x16_bf16 a[80:95], v[72:75], v[140:143], a[80:95]
    buffer_load_dwordx4 v43, s[12:15], s36 offen lds
    s_add_u32 m0, s38, 12288
    s_waitcnt lgkmcnt(4)
    v_mfma_f32_32x32x16_bf16 a[96:111], v[76:79], v[136:139], a[96:111]
    ds_read_b64_tr_b16 v[72:73], v47 offset:36224
    ds_read_b64_tr_b16 v[74:75], v47 offset:38016
    s_nop 0
    v_mfma_f32_32x32x16_bf16 a[112:127], v[76:79], v[140:143], a[112:127]
    buffer_load_dwordx4 v38, s[8:11], s66 offen lds
    s_add_u32 m0, s39, 4096
    s_waitcnt lgkmcnt(4)
    v_mfma_f32_32x32x16_bf16 a[128:143], v[80:83], v[136:139], a[128:143]
    ds_read_b64_tr_b16 v[76:77], v47 offset:43008
    ds_read_b64_tr_b16 v[78:79], v47 offset:44800
    s_nop 0
    v_mfma_f32_32x32x16_bf16 a[144:159], v[80:83], v[140:143], a[144:159]
    buffer_load_dwordx4 v44, s[12:15], s36 offen lds
    s_add_u32 m0, s38, 13312
    s_waitcnt lgkmcnt(4)
    v_mfma_f32_32x32x16_bf16 a[160:175], v[68:71], v[136:139], a[160:175]
    ds_read_b64_tr_b16 v[80:81], v47 offset:43072
    ds_read_b64_tr_b16 v[82:83], v47 offset:44864
    s_nop 0
    v_mfma_f32_32x32x16_bf16 a[176:191], v[68:71], v[140:143], a[176:191]
    buffer_load_dwordx4 v31, s[8:11], s66 offen lds
    s_add_u32 m0, s39, 5120
    s_waitcnt lgkmcnt(4)
    v_mfma_f32_32x32x16_bf16 a[192:207], v[72:75], v[136:139], a[192:207]
    ds_read_b64_tr_b16 v[68:69], v47 offset:43136
    ds_read_b64_tr_b16 v[70:71], v47 offset:44928
    s_nop 0
    v_mfma_f32_32x32x16_bf16 a[208:223], v[72:75], v[140:143], a[208:223]
    buffer_load_dwordx4 v45, s[12:15], s36 offen lds
    s_add_u32 m0, s38, 14336
    ds_read_b128 v[248:251], v58 offset:2048
    s_waitcnt lgkmcnt(5)
    v_mfma_f32_32x32x16_bf16 a[0:15], v[76:79], v[144:147], a[0:15]
    ds_read_b64_tr_b16 v[72:73], v47 offset:43200
    ds_read_b64_tr_b16 v[74:75], v47 offset:44992
    s_nop 0
    v_mfma_f32_32x32x16_bf16 a[16:31], v[76:79], v[148:151], a[16:31]
    buffer_load_dwordx4 v38, s[8:11], s67 offen lds
    s_add_u32 m0, s39, 6144
    s_waitcnt lgkmcnt(5)
    v_mfma_f32_32x32x16_bf16 a[32:47], v[80:83], v[144:147], a[32:47]
    ds_read_b64_tr_b16 v[76:77], v47 offset:43264
    ds_read_b64_tr_b16 v[78:79], v47 offset:45056
    ds_read_b64_tr_b16 v[232:233], v54 offset:43008
    ds_read_b64_tr_b16 v[234:235], v54 offset:44800
    s_nop 0
    v_mfma_f32_32x32x16_bf16 a[48:63], v[80:83], v[148:151], a[48:63]
    buffer_load_dwordx4 v46, s[12:15], s36 offen lds
    s_add_u32 m0, s38, 15360
    s_waitcnt lgkmcnt(7)
    v_mfma_f32_32x32x16_bf16 a[64:79], v[68:71], v[144:147], a[64:79]
    ds_read_b64_tr_b16 v[80:81], v47 offset:43328
    ds_read_b64_tr_b16 v[82:83], v47 offset:45120
    ds_read_b64_tr_b16 v[236:237], v55 offset:43008
    ds_read_b64_tr_b16 v[238:239], v55 offset:44800
    s_nop 0
    v_mfma_f32_32x32x16_bf16 a[80:95], v[68:71], v[148:151], a[80:95]
    buffer_load_dwordx4 v31, s[8:11], s67 offen lds
    s_add_u32 m0, s49, 0
    s_waitcnt lgkmcnt(8)
    v_mfma_f32_32x32x16_bf16 a[96:111], v[72:75], v[144:147], a[96:111]
    ds_read_b64_tr_b16 v[68:69], v47 offset:43392
    ds_read_b64_tr_b16 v[70:71], v47 offset:45184
    ds_read_b64_tr_b16 v[240:241], v56 offset:43008
    ds_read_b64_tr_b16 v[242:243], v56 offset:44800
    s_nop 0
    v_mfma_f32_32x32x16_bf16 a[112:127], v[72:75], v[148:151], a[112:127]
    buffer_load_dwordx4 v63, s[8:11], s37 offen lds
    s_waitcnt lgkmcnt(10)
    v_mfma_f32_32x32x16_bf16 a[128:143], v[76:79], v[144:147], a[128:143]
    ds_read_b64_tr_b16 v[72:73], v47 offset:50176
    ds_read_b64_tr_b16 v[74:75], v47 offset:51968
    v_mfma_f32_32x32x16_bf16 a[144:159], v[76:79], v[148:151], a[144:159]
    s_waitcnt lgkmcnt(10)
    v_mfma_f32_16x16x32_bf16 a[224:227], v[232:235], v[248:251], a[224:227]
    s_waitcnt lgkmcnt(8)
    v_mfma_f32_32x32x16_bf16 a[160:175], v[80:83], v[144:147], a[160:175]
    ds_read_b64_tr_b16 v[76:77], v47 offset:50240
    ds_read_b64_tr_b16 v[78:79], v47 offset:52032
    v_mfma_f32_32x32x16_bf16 a[176:191], v[80:83], v[148:151], a[176:191]
    s_waitcnt lgkmcnt(8)
    v_mfma_f32_16x16x32_bf16 a[228:231], v[236:239], v[248:251], a[228:231]
    s_waitcnt lgkmcnt(6)
    v_mfma_f32_32x32x16_bf16 a[192:207], v[68:71], v[144:147], a[192:207]
    ds_read_b64_tr_b16 v[80:81], v47 offset:50304
    ds_read_b64_tr_b16 v[82:83], v47 offset:52096
    s_waitcnt vmcnt(17)
    ds_read_b128 v[160:163], v32 offset:0
    ds_read_b128 v[164:167], v32 offset:4096
    v_mfma_f32_32x32x16_bf16 a[208:223], v[68:71], v[148:151], a[208:223]
    s_waitcnt lgkmcnt(8)
    v_mfma_f32_16x16x32_bf16 a[232:235], v[240:243], v[248:251], a[232:235]
    s_waitcnt lgkmcnt(6)
    v_mfma_f32_32x32x16_bf16 a[0:15], v[72:75], v[152:155], a[0:15]
    s_waitcnt vmcnt(16)
    s_barrier
    ds_read_b64_tr_b16 v[68:69], v47 offset:50368
    ds_read_b64_tr_b16 v[70:71], v47 offset:52160
    ds_read_b128 v[168:171], v33 offset:0
    v_mfma_f32_32x32x16_bf16 a[16:31], v[72:75], v[156:159], a[16:31]
    ds_read_b128 v[172:175], v33 offset:4096
    s_waitcnt lgkmcnt(8)
    v_mfma_f32_32x32x16_bf16 a[32:47], v[76:79], v[152:155], a[32:47]
    ds_read_b64_tr_b16 v[72:73], v47 offset:50432
    ds_read_b64_tr_b16 v[74:75], v47 offset:52224
    v_mfma_f32_32x32x16_bf16 a[48:63], v[76:79], v[156:159], a[48:63]
    s_waitcnt lgkmcnt(8)
    v_mfma_f32_32x32x16_bf16 a[64:79], v[80:83], v[152:155], a[64:79]
    ds_read_b64_tr_b16 v[76:77], v47 offset:50496
    ds_read_b64_tr_b16 v[78:79], v47 offset:52288
    v_mfma_f32_32x32x16_bf16 a[80:95], v[80:83], v[156:159], a[80:95]
    s_waitcnt lgkmcnt(6)
    v_mfma_f32_32x32x16_bf16 a[96:111], v[68:71], v[152:155], a[96:111]
    ds_read_b64_tr_b16 v[80:81], v47 offset:50560
    ds_read_b64_tr_b16 v[82:83], v47 offset:52352
    ds_read_b128 v[176:179], v34 offset:0
    ds_read_b128 v[180:183], v34 offset:4096
    v_mfma_f32_32x32x16_bf16 a[112:127], v[68:71], v[156:159], a[112:127]
    s_waitcnt lgkmcnt(6)
    v_mfma_f32_32x32x16_bf16 a[128:143], v[72:75], v[152:155], a[128:143]
    ds_read_b64_tr_b16 v[68:69], v84 offset:0
    ds_read_b64_tr_b16 v[70:71], v84 offset:1792
    ds_read_b128 v[184:187], v35 offset:0
    ds_read_b128 v[188:191], v35 offset:4096
    v_mfma_f32_32x32x16_bf16 a[144:159], v[72:75], v[156:159], a[144:159]
    s_waitcnt lgkmcnt(8)
    v_mfma_f32_32x32x16_bf16 a[160:175], v[76:79], v[152:155], a[160:175]
    ds_read_b64_tr_b16 v[72:73], v84 offset:64
    ds_read_b64_tr_b16 v[74:75], v84 offset:1856
    v_mfma_f32_32x32x16_bf16 a[176:191], v[76:79], v[156:159], a[176:191]
    s_waitcnt lgkmcnt(8)
    v_mfma_f32_32x32x16_bf16 a[192:207], v[80:83], v[152:155], a[192:207]
    ds_read_b64_tr_b16 v[76:77], v84 offset:128
    ds_read_b64_tr_b16 v[78:79], v84 offset:1920
    v_mfma_f32_32x32x16_bf16 a[208:223], v[80:83], v[156:159], a[208:223]
    ds_read_b128 v[244:247], v57 offset:4096
    s_waitcnt lgkmcnt(7)
    v_mfma_f32_32x32x16_bf16 a[0:15], v[68:71], v[160:163], a[0:15]
    s_barrier
    ds_read_b64_tr_b16 v[80:81], v84 offset:192
    ds_read_b64_tr_b16 v[82:83], v84 offset:1984
    s_waitcnt lgkmcnt(7)
    s_add_u32 s3, s3, 1
    s_cmp_eq_u32 s3, 9
    v_mfma_f32_32x32x16_bf16 a[16:31], v[68:71], v[164:167], a[16:31]
    s_cselect_b32 s3, 0, s3
    s_mov_b32 s40, 128
    s_cselect_b32 s40, 4294966272, s40
    s_add_u32 s64, s64, s40
    s_add_u32 s65, s65, s40
    s_add_u32 s66, s66, s40
    s_waitcnt lgkmcnt(5)
    v_mfma_f32_32x32x16_bf16 a[32:47], v[72:75], v[160:163], a[32:47]
    ds_read_b64_tr_b16 v[68:69], v84 offset:256
    ds_read_b64_tr_b16 v[70:71], v84 offset:2048
    ds_read_b64_tr_b16 v[232:233], v91 offset:0
    ds_read_b64_tr_b16 v[234:235], v91 offset:1792
    s_add_u32 s67, s67, s40
    s_add_u32 m0, s38, 0
    s_nop 0
    v_mfma_f32_32x32x16_bf16 a[48:63], v[72:75], v[164:167], a[48:63]
    buffer_load_dwordx4 v38, s[8:11], s64 offen lds
    s_add_u32 s35, s35, 1
    s_waitcnt lgkmcnt(7)
    v_mfma_f32_32x32x16_bf16 a[64:79], v[76:79], v[160:163], a[64:79]
    ds_read_b64_tr_b16 v[72:73], v84 offset:320
    ds_read_b64_tr_b16 v[74:75], v84 offset:2112
    ds_read_b64_tr_b16 v[236:237], v92 offset:0
    ds_read_b64_tr_b16 v[238:239], v92 offset:1792
    s_cmp_eq_u32 s35, 9
    s_cselect_b32 s35, 0, s35
    s_mov_b32 s40, 128
    v_mfma_f32_32x32x16_bf16 a[80:95], v[76:79], v[164:167], a[80:95]
    s_cselect_b32 s40, 4294966272, s40
    s_mov_b32 s41, s40
    s_mov_b32 s40, 221184
    s_cselect_b32 s40, 4293197824, s40
    s_mov_b32 s42, s40
    s_add_u32 s36, s36, s42
    s_waitcnt lgkmcnt(8)
    v_mfma_f32_32x32x16_bf16 a[96:111], v[80:83], v[160:163], a[96:111]
    ds_read_b64_tr_b16 v[76:77], v84 offset:384
    ds_read_b64_tr_b16 v[78:79], v84 offset:2176
    ds_read_b64_tr_b16 v[240:241], v93 offset:0
    ds_read_b64_tr_b16 v[242:243], v93 offset:1792
    s_add_u32 s37, s37, s41
    s_add_u32 m0, s39, 28672
    s_nop 0
    v_mfma_f32_32x32x16_bf16 a[112:127], v[80:83], v[164:167], a[112:127]
    buffer_load_dwordx4 v40, s[12:15], s36 offen lds
    s_add_u32 m0, s38, 1024
    s_waitcnt lgkmcnt(10)
    v_mfma_f32_32x32x16_bf16 a[128:143], v[68:71], v[160:163], a[128:143]
    ds_read_b64_tr_b16 v[80:81], v84 offset:7168
    ds_read_b64_tr_b16 v[82:83], v84 offset:8960
    s_nop 0
    v_mfma_f32_32x32x16_bf16 a[144:159], v[68:71], v[164:167], a[144:159]
    buffer_load_dwordx4 v31, s[8:11], s64 offen lds
    s_add_u32 m0, s39, 29696
    s_waitcnt lgkmcnt(10)
    v_mfma_f32_16x16x32_bf16 a[224:227], v[232:235], v[244:247], a[224:227]
    s_waitcnt lgkmcnt(8)
    v_mfma_f32_32x32x16_bf16 a[160:175], v[72:75], v[160:163], a[160:175]
    ds_read_b64_tr_b16 v[68:69], v84 offset:7232
    ds_read_b64_tr_b16 v[70:71], v84 offset:9024
    s_nop 0
    v_mfma_f32_32x32x16_bf16 a[176:191], v[72:75], v[164:167], a[176:191]
    buffer_load_dwordx4 v41, s[12:15], s36 offen lds
    s_add_u32 m0, s38, 2048
    s_waitcnt lgkmcnt(8)
    v_mfma_f32_16x16x32_bf16 a[228:231], v[236:239], v[244:247], a[228:231]
    s_waitcnt lgkmcnt(6)
    v_mfma_f32_32x32x16_bf16 a[192:207], v[76:79], v[160:163], a[192:207]
    ds_read_b64_tr_b16 v[72:73], v84 offset:7296
    ds_read_b64_tr_b16 v[74:75], v84 offset:9088
    s_nop 0
    v_mfma_f32_32x32x16_bf16 a[208:223], v[76:79], v[164:167], a[208:223]
    buffer_load_dwordx4 v38, s[8:11], s65 offen lds
    s_add_u32 m0, s39, 30720
    s_waitcnt lgkmcnt(6)
    v_mfma_f32_16x16x32_bf16 a[232:235], v[240:243], v[244:247], a[232:235]
    s_waitcnt lgkmcnt(4)
    v_mfma_f32_32x32x16_bf16 a[0:15], v[80:83], v[168:171], a[0:15]
    ds_read_b64_tr_b16 v[76:77], v84 offset:7360
    ds_read_b64_tr_b16 v[78:79], v84 offset:9152
    s_nop 0
    v_mfma_f32_32x32x16_bf16 a[16:31], v[80:83], v[172:175], a[16:31]
    buffer_load_dwordx4 v42, s[12:15], s36 offen lds
    s_add_u32 m0, s38, 3072
    s_waitcnt lgkmcnt(4)
    v_mfma_f32_32x32x16_bf16 a[32:47], v[68:71], v[168:171], a[32:47]
    ds_read_b64_tr_b16 v[80:81], v84 offset:7424
    ds_read_b64_tr_b16 v[82:83], v84 offset:9216
    s_nop 0
    v_mfma_f32_32x32x16_bf16 a[48:63], v[68:71], v[172:175], a[48:63]
    buffer_load_dwordx4 v31, s[8:11], s65 offen lds
    s_add_u32 m0, s39, 31744
    s_waitcnt lgkmcnt(4)
    v_mfma_f32_32x32x16_bf16 a[64:79], v[72:75], v[168:171], a[64:79]
    ds_read_b64_tr_b16 v[68:69], v84 offset:7488
    ds_read_b64_tr_b16 v[70:71], v84 offset:9280
    s_nop 0
    v_mfma_f32_32x32x16_bf16 a[80:95], v[72:75], v[172:175], a[80:95]
    buffer_load_dwordx4 v43, s[12:15], s36 offen lds
    s_add_u32 m0, s38, 4096
    s_waitcnt lgkmcnt(4)
    v_mfma_f32_32x32x16_bf16 a[96:111], v[76:79], v[168:171], a[96:111]
    ds_read_b64_tr_b16 v[72:73], v84 offset:7552
    ds_read_b64_tr_b16 v[74:75], v84 offset:9344
    s_nop 0
    v_mfma_f32_32x32x16_bf16 a[112:127], v[76:79], v[172:175], a[112:127]
    buffer_load_dwordx4 v38, s[8:11], s66 offen lds
    s_add_u32 m0, s39, 32768
    s_waitcnt lgkmcnt(4)
    v_mfma_f32_32x32x16_bf16 a[128:143], v[80:83], v[168:171], a[128:143]
    ds_read_b64_tr_b16 v[76:77], v84 offset:14336
    ds_read_b64_tr_b16 v[78:79], v84 offset:16128
    s_nop 0
    v_mfma_f32_32x32x16_bf16 a[144:159], v[80:83], v[172:175], a[144:159]
    buffer_load_dwordx4 v44, s[12:15], s36 offen lds
    s_add_u32 m0, s38, 5120
    s_waitcnt lgkmcnt(4)
    v_mfma_f32_32x32x16_bf16 a[160:175], v[68:71], v[168:171], a[160:175]
    ds_read_b64_tr_b16 v[80:81], v84 offset:14400
    ds_read_b64_tr_b16 v[82:83], v84 offset:16192
    s_nop 0
    v_mfma_f32_32x32x16_bf16 a[176:191], v[68:71], v[172:175], a[176:191]
    buffer_load_dwordx4 v31, s[8:11], s66 offen lds
    s_add_u32 m0, s39, 33792
    s_waitcnt lgkmcnt(4)
    v_mfma_f32_32x32x16_bf16 a[192:207], v[72:75], v[168:171], a[192:207]
    ds_read_b64_tr_b16 v[68:69], v84 offset:14464
    ds_read_b64_tr_b16 v[70:71], v84 offset:16256
    s_nop 0
    v_mfma_f32_32x32x16_bf16 a[208:223], v[72:75], v[172:175], a[208:223]
    buffer_load_dwordx4 v45, s[12:15], s36 offen lds
    s_add_u32 m0, s38, 6144
    ds_read_b128 v[248:251], v58 offset:4096
    s_waitcnt lgkmcnt(5)
    v_mfma_f32_32x32x16_bf16 a[0:15], v[76:79], v[176:179], a[0:15]
    ds_read_b64_tr_b16 v[72:73], v84 offset:14528
    ds_read_b64_tr_b16 v[74:75], v84 offset:16320
    s_nop 0
    v_mfma_f32_32x32x16_bf16 a[16:31], v[76:79], v[180:183], a[16:31]
    buffer_load_dwordx4 v38, s[8:11], s67 offen lds
    s_add_u32 m0, s39, 34816
    s_waitcnt lgkmcnt(5)
    v_mfma_f32_32x32x16_bf16 a[32:47], v[80:83], v[176:179], a[32:47]
    ds_read_b64_tr_b16 v[76:77], v84 offset:14592
    ds_read_b64_tr_b16 v[78:79], v84 offset:16384
    ds_read_b64_tr_b16 v[232:233], v91 offset:14336
    ds_read_b64_tr_b16 v[234:235], v91 offset:16128
    s_nop 0
    v_mfma_f32_32x32x16_bf16 a[48:63], v[80:83], v[180:183], a[48:63]
    buffer_load_dwordx4 v46, s[12:15], s36 offen lds
    s_add_u32 m0, s38, 7168
    s_waitcnt lgkmcnt(7)
    v_mfma_f32_32x32x16_bf16 a[64:79], v[68:71], v[176:179], a[64:79]
    ds_read_b64_tr_b16 v[80:81], v84 offset:14656
    ds_read_b64_tr_b16 v[82:83], v84 offset:16448
    ds_read_b64_tr_b16 v[236:237], v92 offset:14336
    ds_read_b64_tr_b16 v[238:239], v92 offset:16128
    s_nop 0
    v_mfma_f32_32x32x16_bf16 a[80:95], v[68:71], v[180:183], a[80:95]
    buffer_load_dwordx4 v31, s[8:11], s67 offen lds
    s_add_u32 m0, s49, 2048
    s_waitcnt lgkmcnt(8)
    v_mfma_f32_32x32x16_bf16 a[96:111], v[72:75], v[176:179], a[96:111]
    ds_read_b64_tr_b16 v[68:69], v84 offset:14720
    ds_read_b64_tr_b16 v[70:71], v84 offset:16512
    ds_read_b64_tr_b16 v[240:241], v93 offset:14336
    ds_read_b64_tr_b16 v[242:243], v93 offset:16128
    s_nop 0
    v_mfma_f32_32x32x16_bf16 a[112:127], v[72:75], v[180:183], a[112:127]
    buffer_load_dwordx4 v63, s[8:11], s37 offen lds
    s_waitcnt lgkmcnt(10)
    v_mfma_f32_32x32x16_bf16 a[128:143], v[76:79], v[176:179], a[128:143]
    ds_read_b64_tr_b16 v[72:73], v84 offset:21504
    ds_read_b64_tr_b16 v[74:75], v84 offset:23296
    v_mfma_f32_32x32x16_bf16 a[144:159], v[76:79], v[180:183], a[144:159]
    s_waitcnt lgkmcnt(10)
    v_mfma_f32_16x16x32_bf16 a[224:227], v[232:235], v[248:251], a[224:227]
    s_waitcnt lgkmcnt(8)
    v_mfma_f32_32x32x16_bf16 a[160:175], v[80:83], v[176:179], a[160:175]
    ds_read_b64_tr_b16 v[76:77], v84 offset:21568
    ds_read_b64_tr_b16 v[78:79], v84 offset:23360
    v_mfma_f32_32x32x16_bf16 a[176:191], v[80:83], v[180:183], a[176:191]
    s_waitcnt lgkmcnt(8)
    v_mfma_f32_16x16x32_bf16 a[228:231], v[236:239], v[248:251], a[228:231]
    s_waitcnt lgkmcnt(6)
    v_mfma_f32_32x32x16_bf16 a[192:207], v[68:71], v[176:179], a[192:207]
    ds_read_b64_tr_b16 v[80:81], v84 offset:21632
    ds_read_b64_tr_b16 v[82:83], v84 offset:23424
    s_waitcnt vmcnt(17)
    ds_read_b128 v[192:195], v32 offset:8192
    ds_read_b128 v[196:199], v32 offset:12288
    v_mfma_f32_32x32x16_bf16 a[208:223], v[68:71], v[180:183], a[208:223]
    s_waitcnt lgkmcnt(8)
    v_mfma_f32_16x16x32_bf16 a[232:235], v[240:243], v[248:251], a[232:235]
    s_waitcnt lgkmcnt(6)
    v_mfma_f32_32x32x16_bf16 a[0:15], v[72:75], v[184:187], a[0:15]
    s_waitcnt vmcnt(16)
    s_barrier
    ds_read_b64_tr_b16 v[68:69], v84 offset:21696
    ds_read_b64_tr_b16 v[70:71], v84 offset:23488
    ds_read_b128 v[200:203], v33 offset:8192
    v_mfma_f32_32x32x16_bf16 a[16:31], v[72:75], v[188:191], a[16:31]
    ds_read_b128 v[204:207], v33 offset:12288
    s_waitcnt lgkmcnt(8)
    v_mfma_f32_32x32x16_bf16 a[32:47], v[76:79], v[184:187], a[32:47]
    ds_read_b64_tr_b16 v[72:73], v84 offset:21760
    ds_read_b64_tr_b16 v[74:75], v84 offset:23552
    v_mfma_f32_32x32x16_bf16 a[48:63], v[76:79], v[188:191], a[48:63]
    s_waitcnt lgkmcnt(8)
    v_mfma_f32_32x32x16_bf16 a[64:79], v[80:83], v[184:187], a[64:79]
    ds_read_b64_tr_b16 v[76:77], v84 offset:21824
    ds_read_b64_tr_b16 v[78:79], v84 offset:23616
    v_mfma_f32_32x32x16_bf16 a[80:95], v[80:83], v[188:191], a[80:95]
    s_waitcnt lgkmcnt(6)
    v_mfma_f32_32x32x16_bf16 a[96:111], v[68:71], v[184:187], a[96:111]
    ds_read_b64_tr_b16 v[80:81], v84 offset:21888
    ds_read_b64_tr_b16 v[82:83], v84 offset:23680
    ds_read_b128 v[208:211], v34 offset:8192
    ds_read_b128 v[212:215], v34 offset:12288
    v_mfma_f32_32x32x16_bf16 a[112:127], v[68:71], v[188:191], a[112:127]
    s_waitcnt lgkmcnt(6)
    v_mfma_f32_32x32x16_bf16 a[128:143], v[72:75], v[184:187], a[128:143]
    ds_read_b64_tr_b16 v[68:69], v47 offset:0
    ds_read_b64_tr_b16 v[70:71], v47 offset:1792
    ds_read_b128 v[216:219], v35 offset:8192
    ds_read_b128 v[220:223], v35 offset:12288
    v_mfma_f32_32x32x16_bf16 a[144:159], v[72:75], v[188:191], a[144:159]
    s_waitcnt lgkmcnt(8)
    v_mfma_f32_32x32x16_bf16 a[160:175], v[76:79], v[184:187], a[160:175]
    ds_read_b64_tr_b16 v[72:73], v47 offset:64
    ds_read_b64_tr_b16 v[74:75], v47 offset:1856
    v_mfma_f32_32x32x16_bf16 a[176:191], v[76:79], v[188:191], a[176:191]
    s_waitcnt lgkmcnt(8)
    v_mfma_f32_32x32x16_bf16 a[192:207], v[80:83], v[184:187], a[192:207]
    ds_read_b64_tr_b16 v[76:77], v47 offset:128
    ds_read_b64_tr_b16 v[78:79], v47 offset:1920
    v_mfma_f32_32x32x16_bf16 a[208:223], v[80:83], v[188:191], a[208:223]
    ds_read_b128 v[244:247], v57 offset:0
    s_waitcnt lgkmcnt(7)
    v_mfma_f32_32x32x16_bf16 a[0:15], v[68:71], v[192:195], a[0:15]
    s_barrier
    ds_read_b64_tr_b16 v[80:81], v47 offset:192
    ds_read_b64_tr_b16 v[82:83], v47 offset:1984
    s_waitcnt lgkmcnt(7)
    s_add_u32 s3, s3, 1
    s_cmp_eq_u32 s3, 9
    v_mfma_f32_32x32x16_bf16 a[16:31], v[68:71], v[196:199], a[16:31]
    s_cselect_b32 s3, 0, s3
    s_mov_b32 s40, 128
    s_cselect_b32 s40, 4294966272, s40
    s_add_u32 s64, s64, s40
    s_add_u32 s65, s65, s40
    s_add_u32 s66, s66, s40
    s_waitcnt lgkmcnt(5)
    v_mfma_f32_32x32x16_bf16 a[32:47], v[72:75], v[192:195], a[32:47]
    ds_read_b64_tr_b16 v[68:69], v47 offset:256
    ds_read_b64_tr_b16 v[70:71], v47 offset:2048
    ds_read_b64_tr_b16 v[232:233], v54 offset:0
    ds_read_b64_tr_b16 v[234:235], v54 offset:1792
    s_add_u32 s67, s67, s40
    s_add_u32 m0, s38, 8192
    s_nop 0
    v_mfma_f32_32x32x16_bf16 a[48:63], v[72:75], v[196:199], a[48:63]
    buffer_load_dwordx4 v38, s[8:11], s64 offen lds
    s_add_u32 s35, s35, 1
    s_waitcnt lgkmcnt(7)
    v_mfma_f32_32x32x16_bf16 a[64:79], v[76:79], v[192:195], a[64:79]
    ds_read_b64_tr_b16 v[72:73], v47 offset:320
    ds_read_b64_tr_b16 v[74:75], v47 offset:2112
    ds_read_b64_tr_b16 v[236:237], v55 offset:0
    ds_read_b64_tr_b16 v[238:239], v55 offset:1792
    s_cmp_eq_u32 s35, 9
    s_cselect_b32 s35, 0, s35
    s_mov_b32 s40, 128
    v_mfma_f32_32x32x16_bf16 a[80:95], v[76:79], v[196:199], a[80:95]
    s_cselect_b32 s40, 4294966272, s40
    s_mov_b32 s41, s40
    s_mov_b32 s40, 221184
    s_cselect_b32 s40, 4293197824, s40
    s_mov_b32 s42, s40
    s_add_u32 s36, s36, s42
    s_waitcnt lgkmcnt(8)
    v_mfma_f32_32x32x16_bf16 a[96:111], v[80:83], v[192:195], a[96:111]
    ds_read_b64_tr_b16 v[76:77], v47 offset:384
    ds_read_b64_tr_b16 v[78:79], v47 offset:2176
    ds_read_b64_tr_b16 v[240:241], v56 offset:0
    ds_read_b64_tr_b16 v[242:243], v56 offset:1792
    s_add_u32 s37, s37, s41
    s_add_u32 m0, s39, 57344
    s_nop 0
    v_mfma_f32_32x32x16_bf16 a[112:127], v[80:83], v[196:199], a[112:127]
    buffer_load_dwordx4 v40, s[12:15], s36 offen lds
    s_add_u32 m0, s38, 9216
    s_waitcnt lgkmcnt(10)
    v_mfma_f32_32x32x16_bf16 a[128:143], v[68:71], v[192:195], a[128:143]
    ds_read_b64_tr_b16 v[80:81], v47 offset:7168
    ds_read_b64_tr_b16 v[82:83], v47 offset:8960
    s_nop 0
    v_mfma_f32_32x32x16_bf16 a[144:159], v[68:71], v[196:199], a[144:159]
    buffer_load_dwordx4 v31, s[8:11], s64 offen lds
    s_add_u32 m0, s39, 58368
    s_waitcnt lgkmcnt(10)
    v_mfma_f32_16x16x32_bf16 a[224:227], v[232:235], v[244:247], a[224:227]
    s_waitcnt lgkmcnt(8)
    v_mfma_f32_32x32x16_bf16 a[160:175], v[72:75], v[192:195], a[160:175]
    ds_read_b64_tr_b16 v[68:69], v47 offset:7232
    ds_read_b64_tr_b16 v[70:71], v47 offset:9024
    s_nop 0
    v_mfma_f32_32x32x16_bf16 a[176:191], v[72:75], v[196:199], a[176:191]
    buffer_load_dwordx4 v41, s[12:15], s36 offen lds
    s_add_u32 m0, s38, 10240
    s_waitcnt lgkmcnt(8)
    v_mfma_f32_16x16x32_bf16 a[228:231], v[236:239], v[244:247], a[228:231]
    s_waitcnt lgkmcnt(6)
    v_mfma_f32_32x32x16_bf16 a[192:207], v[76:79], v[192:195], a[192:207]
    ds_read_b64_tr_b16 v[72:73], v47 offset:7296
    ds_read_b64_tr_b16 v[74:75], v47 offset:9088
    s_nop 0
    v_mfma_f32_32x32x16_bf16 a[208:223], v[76:79], v[196:199], a[208:223]
    buffer_load_dwordx4 v38, s[8:11], s65 offen lds
    s_add_u32 m0, s39, 59392
    s_waitcnt lgkmcnt(6)
    v_mfma_f32_16x16x32_bf16 a[232:235], v[240:243], v[244:247], a[232:235]
    s_waitcnt lgkmcnt(4)
    v_mfma_f32_32x32x16_bf16 a[0:15], v[80:83], v[200:203], a[0:15]
    ds_read_b64_tr_b16 v[76:77], v47 offset:7360
    ds_read_b64_tr_b16 v[78:79], v47 offset:9152
    s_nop 0
    v_mfma_f32_32x32x16_bf16 a[16:31], v[80:83], v[204:207], a[16:31]
    buffer_load_dwordx4 v42, s[12:15], s36 offen lds
    s_add_u32 m0, s38, 11264
    s_waitcnt lgkmcnt(4)
    v_mfma_f32_32x32x16_bf16 a[32:47], v[68:71], v[200:203], a[32:47]
    ds_read_b64_tr_b16 v[80:81], v47 offset:7424
    ds_read_b64_tr_b16 v[82:83], v47 offset:9216
    s_nop 0
    v_mfma_f32_32x32x16_bf16 a[48:63], v[68:71], v[204:207], a[48:63]
    buffer_load_dwordx4 v31, s[8:11], s65 offen lds
    s_add_u32 m0, s39, 60416
    s_waitcnt lgkmcnt(4)
    v_mfma_f32_32x32x16_bf16 a[64:79], v[72:75], v[200:203], a[64:79]
    ds_read_b64_tr_b16 v[68:69], v47 offset:7488
    ds_read_b64_tr_b16 v[70:71], v47 offset:9280
    s_nop 0
    v_mfma_f32_32x32x16_bf16 a[80:95], v[72:75], v[204:207], a[80:95]
    buffer_load_dwordx4 v43, s[12:15], s36 offen lds
    s_add_u32 m0, s38, 12288
    s_waitcnt lgkmcnt(4)
    v_mfma_f32_32x32x16_bf16 a[96:111], v[76:79], v[200:203], a[96:111]
    ds_read_b64_tr_b16 v[72:73], v47 offset:7552
    ds_read_b64_tr_b16 v[74:75], v47 offset:9344
    s_nop 0
    v_mfma_f32_32x32x16_bf16 a[112:127], v[76:79], v[204:207], a[112:127]
    buffer_load_dwordx4 v38, s[8:11], s66 offen lds
    s_add_u32 m0, s39, 61440
    s_waitcnt lgkmcnt(4)
    v_mfma_f32_32x32x16_bf16 a[128:143], v[80:83], v[200:203], a[128:143]
    ds_read_b64_tr_b16 v[76:77], v47 offset:14336
    ds_read_b64_tr_b16 v[78:79], v47 offset:16128
    s_nop 0
    v_mfma_f32_32x32x16_bf16 a[144:159], v[80:83], v[204:207], a[144:159]
    buffer_load_dwordx4 v44, s[12:15], s36 offen lds
    s_add_u32 m0, s38, 13312
    s_waitcnt lgkmcnt(4)
    v_mfma_f32_32x32x16_bf16 a[160:175], v[68:71], v[200:203], a[160:175]
    ds_read_b64_tr_b16 v[80:81], v47 offset:14400
    ds_read_b64_tr_b16 v[82:83], v47 offset:16192
    s_nop 0
    v_mfma_f32_32x32x16_bf16 a[176:191], v[68:71], v[204:207], a[176:191]
    buffer_load_dwordx4 v31, s[8:11], s66 offen lds
    s_add_u32 m0, s39, 62464
    s_waitcnt lgkmcnt(4)
    v_mfma_f32_32x32x16_bf16 a[192:207], v[72:75], v[200:203], a[192:207]
    ds_read_b64_tr_b16 v[68:69], v47 offset:14464
    ds_read_b64_tr_b16 v[70:71], v47 offset:16256
    s_nop 0
    v_mfma_f32_32x32x16_bf16 a[208:223], v[72:75], v[204:207], a[208:223]
    buffer_load_dwordx4 v45, s[12:15], s36 offen lds
    s_add_u32 m0, s38, 14336
    ds_read_b128 v[248:251], v58 offset:0
    s_waitcnt lgkmcnt(5)
    v_mfma_f32_32x32x16_bf16 a[0:15], v[76:79], v[208:211], a[0:15]
    ds_read_b64_tr_b16 v[72:73], v47 offset:14528
    ds_read_b64_tr_b16 v[74:75], v47 offset:16320
    s_nop 0
    v_mfma_f32_32x32x16_bf16 a[16:31], v[76:79], v[212:215], a[16:31]
    buffer_load_dwordx4 v38, s[8:11], s67 offen lds
    s_add_u32 m0, s39, 63488
    s_waitcnt lgkmcnt(5)
    v_mfma_f32_32x32x16_bf16 a[32:47], v[80:83], v[208:211], a[32:47]
    ds_read_b64_tr_b16 v[76:77], v47 offset:14592
    ds_read_b64_tr_b16 v[78:79], v47 offset:16384
    ds_read_b64_tr_b16 v[232:233], v54 offset:14336
    ds_read_b64_tr_b16 v[234:235], v54 offset:16128
    s_nop 0
    v_mfma_f32_32x32x16_bf16 a[48:63], v[80:83], v[212:215], a[48:63]
    buffer_load_dwordx4 v46, s[12:15], s36 offen lds
    s_add_u32 m0, s38, 15360
    s_waitcnt lgkmcnt(7)
    v_mfma_f32_32x32x16_bf16 a[64:79], v[68:71], v[208:211], a[64:79]
    ds_read_b64_tr_b16 v[80:81], v47 offset:14656
    ds_read_b64_tr_b16 v[82:83], v47 offset:16448
    ds_read_b64_tr_b16 v[236:237], v55 offset:14336
    ds_read_b64_tr_b16 v[238:239], v55 offset:16128
    s_nop 0
    v_mfma_f32_32x32x16_bf16 a[80:95], v[68:71], v[212:215], a[80:95]
    buffer_load_dwordx4 v31, s[8:11], s67 offen lds
    s_add_u32 m0, s49, 4096
    s_waitcnt lgkmcnt(8)
    v_mfma_f32_32x32x16_bf16 a[96:111], v[72:75], v[208:211], a[96:111]
    ds_read_b64_tr_b16 v[68:69], v47 offset:14720
    ds_read_b64_tr_b16 v[70:71], v47 offset:16512
    ds_read_b64_tr_b16 v[240:241], v56 offset:14336
    ds_read_b64_tr_b16 v[242:243], v56 offset:16128
    s_nop 0
    v_mfma_f32_32x32x16_bf16 a[112:127], v[72:75], v[212:215], a[112:127]
    buffer_load_dwordx4 v63, s[8:11], s37 offen lds
    s_waitcnt lgkmcnt(10)
    v_mfma_f32_32x32x16_bf16 a[128:143], v[76:79], v[208:211], a[128:143]
    ds_read_b64_tr_b16 v[72:73], v47 offset:21504
    ds_read_b64_tr_b16 v[74:75], v47 offset:23296
    v_mfma_f32_32x32x16_bf16 a[144:159], v[76:79], v[212:215], a[144:159]
    s_waitcnt lgkmcnt(10)
    v_mfma_f32_16x16x32_bf16 a[224:227], v[232:235], v[248:251], a[224:227]
    s_waitcnt lgkmcnt(8)
    v_mfma_f32_32x32x16_bf16 a[160:175], v[80:83], v[208:211], a[160:175]
    ds_read_b64_tr_b16 v[76:77], v47 offset:21568
    ds_read_b64_tr_b16 v[78:79], v47 offset:23360
    v_mfma_f32_32x32x16_bf16 a[176:191], v[80:83], v[212:215], a[176:191]
    s_waitcnt lgkmcnt(8)
    v_mfma_f32_16x16x32_bf16 a[228:231], v[236:239], v[248:251], a[228:231]
    s_waitcnt lgkmcnt(6)
    v_mfma_f32_32x32x16_bf16 a[192:207], v[68:71], v[208:211], a[192:207]
    ds_read_b64_tr_b16 v[80:81], v47 offset:21632
    ds_read_b64_tr_b16 v[82:83], v47 offset:23424
    s_waitcnt vmcnt(17)
    ds_read_b128 v[96:99], v32 offset:0
    ds_read_b128 v[100:103], v32 offset:4096
    v_mfma_f32_32x32x16_bf16 a[208:223], v[68:71], v[212:215], a[208:223]
    s_waitcnt lgkmcnt(8)
    v_mfma_f32_16x16x32_bf16 a[232:235], v[240:243], v[248:251], a[232:235]
    s_waitcnt lgkmcnt(6)
    v_mfma_f32_32x32x16_bf16 a[0:15], v[72:75], v[216:219], a[0:15]
    s_waitcnt vmcnt(16)
    s_barrier
    ds_read_b64_tr_b16 v[68:69], v47 offset:21696
    ds_read_b64_tr_b16 v[70:71], v47 offset:23488
    ds_read_b128 v[104:107], v33 offset:0
    v_mfma_f32_32x32x16_bf16 a[16:31], v[72:75], v[220:223], a[16:31]
    ds_read_b128 v[108:111], v33 offset:4096
    s_waitcnt lgkmcnt(8)
    v_mfma_f32_32x32x16_bf16 a[32:47], v[76:79], v[216:219], a[32:47]
    ds_read_b64_tr_b16 v[72:73], v47 offset:21760
    ds_read_b64_tr_b16 v[74:75], v47 offset:23552
    v_mfma_f32_32x32x16_bf16 a[48:63], v[76:79], v[220:223], a[48:63]
    s_waitcnt lgkmcnt(8)
    v_mfma_f32_32x32x16_bf16 a[64:79], v[80:83], v[216:219], a[64:79]
    ds_read_b64_tr_b16 v[76:77], v47 offset:21824
    ds_read_b64_tr_b16 v[78:79], v47 offset:23616
    v_mfma_f32_32x32x16_bf16 a[80:95], v[80:83], v[220:223], a[80:95]
    s_waitcnt lgkmcnt(6)
    v_mfma_f32_32x32x16_bf16 a[96:111], v[68:71], v[216:219], a[96:111]
    ds_read_b64_tr_b16 v[80:81], v47 offset:21888
    ds_read_b64_tr_b16 v[82:83], v47 offset:23680
    ds_read_b128 v[112:115], v34 offset:0
    ds_read_b128 v[116:119], v34 offset:4096
    v_mfma_f32_32x32x16_bf16 a[112:127], v[68:71], v[220:223], a[112:127]
    s_waitcnt lgkmcnt(6)
    v_mfma_f32_32x32x16_bf16 a[128:143], v[72:75], v[216:219], a[128:143]
    ds_read_b64_tr_b16 v[68:69], v47 offset:28672
    ds_read_b64_tr_b16 v[70:71], v47 offset:30464
    ds_read_b128 v[120:123], v35 offset:0
    ds_read_b128 v[124:127], v35 offset:4096
    v_mfma_f32_32x32x16_bf16 a[144:159], v[72:75], v[220:223], a[144:159]
    s_waitcnt lgkmcnt(8)
    v_mfma_f32_32x32x16_bf16 a[160:175], v[76:79], v[216:219], a[160:175]
    ds_read_b64_tr_b16 v[72:73], v47 offset:28736
    ds_read_b64_tr_b16 v[74:75], v47 offset:30528
    v_mfma_f32_32x32x16_bf16 a[176:191], v[76:79], v[220:223], a[176:191]
    s_waitcnt lgkmcnt(8)
    v_mfma_f32_32x32x16_bf16 a[192:207], v[80:83], v[216:219], a[192:207]
    ds_read_b64_tr_b16 v[76:77], v47 offset:28800
    ds_read_b64_tr_b16 v[78:79], v47 offset:30592
    v_mfma_f32_32x32x16_bf16 a[208:223], v[80:83], v[220:223], a[208:223]
    ds_read_b128 v[244:247], v57 offset:2048
    s_waitcnt lgkmcnt(7)
    v_mfma_f32_32x32x16_bf16 a[0:15], v[68:71], v[96:99], a[0:15]
    s_barrier
    ds_read_b64_tr_b16 v[80:81], v47 offset:28864
    ds_read_b64_tr_b16 v[82:83], v47 offset:30656
    s_waitcnt lgkmcnt(7)
    s_add_u32 s3, s3, 1
    s_cmp_eq_u32 s3, 9
    v_mfma_f32_32x32x16_bf16 a[16:31], v[68:71], v[100:103], a[16:31]
    s_cselect_b32 s3, 0, s3
    s_mov_b32 s40, 128
    s_cselect_b32 s40, 4294966272, s40
    s_add_u32 s64, s64, s40
    s_add_u32 s65, s65, s40
    s_add_u32 s66, s66, s40
    s_waitcnt lgkmcnt(5)
    v_mfma_f32_32x32x16_bf16 a[32:47], v[72:75], v[96:99], a[32:47]
    ds_read_b64_tr_b16 v[68:69], v47 offset:28928
    ds_read_b64_tr_b16 v[70:71], v47 offset:30720
    ds_read_b64_tr_b16 v[232:233], v54 offset:28672
    ds_read_b64_tr_b16 v[234:235], v54 offset:30464
    s_add_u32 s67, s67, s40
    s_add_u32 m0, s38, 0
    s_nop 0
    v_mfma_f32_32x32x16_bf16 a[48:63], v[72:75], v[100:103], a[48:63]
    buffer_load_dwordx4 v38, s[8:11], s64 offen lds
    s_add_u32 s35, s35, 1
    s_waitcnt lgkmcnt(7)
    v_mfma_f32_32x32x16_bf16 a[64:79], v[76:79], v[96:99], a[64:79]
    ds_read_b64_tr_b16 v[72:73], v47 offset:28992
    ds_read_b64_tr_b16 v[74:75], v47 offset:30784
    ds_read_b64_tr_b16 v[236:237], v55 offset:28672
    ds_read_b64_tr_b16 v[238:239], v55 offset:30464
    s_cmp_eq_u32 s35, 9
    s_cselect_b32 s35, 0, s35
    s_mov_b32 s40, 128
    v_mfma_f32_32x32x16_bf16 a[80:95], v[76:79], v[100:103], a[80:95]
    s_cselect_b32 s40, 4294966272, s40
    s_mov_b32 s41, s40
    s_mov_b32 s40, 221184
    s_cselect_b32 s40, 4293197824, s40
    s_mov_b32 s42, s40
    s_add_u32 s36, s36, s42
    s_waitcnt lgkmcnt(8)
    v_mfma_f32_32x32x16_bf16 a[96:111], v[80:83], v[96:99], a[96:111]
    ds_read_b64_tr_b16 v[76:77], v47 offset:29056
    ds_read_b64_tr_b16 v[78:79], v47 offset:30848
    ds_read_b64_tr_b16 v[240:241], v56 offset:28672
    ds_read_b64_tr_b16 v[242:243], v56 offset:30464
    s_add_u32 s37, s37, s41
    s_add_u32 m0, s39, 0
    s_nop 0
    v_mfma_f32_32x32x16_bf16 a[112:127], v[80:83], v[100:103], a[112:127]
    buffer_load_dwordx4 v40, s[12:15], s36 offen lds
    s_add_u32 m0, s38, 1024
    s_waitcnt lgkmcnt(10)
    v_mfma_f32_32x32x16_bf16 a[128:143], v[68:71], v[96:99], a[128:143]
    ds_read_b64_tr_b16 v[80:81], v47 offset:35840
    ds_read_b64_tr_b16 v[82:83], v47 offset:37632
    s_nop 0
    v_mfma_f32_32x32x16_bf16 a[144:159], v[68:71], v[100:103], a[144:159]
    buffer_load_dwordx4 v31, s[8:11], s64 offen lds
    s_add_u32 m0, s39, 1024
    s_waitcnt lgkmcnt(10)
    v_mfma_f32_16x16x32_bf16 a[224:227], v[232:235], v[244:247], a[224:227]
    s_waitcnt lgkmcnt(8)
    v_mfma_f32_32x32x16_bf16 a[160:175], v[72:75], v[96:99], a[160:175]
    ds_read_b64_tr_b16 v[68:69], v47 offset:35904
    ds_read_b64_tr_b16 v[70:71], v47 offset:37696
    s_nop 0
    v_mfma_f32_32x32x16_bf16 a[176:191], v[72:75], v[100:103], a[176:191]
    buffer_load_dwordx4 v41, s[12:15], s36 offen lds
    s_add_u32 m0, s38, 2048
    s_waitcnt lgkmcnt(8)
    v_mfma_f32_16x16x32_bf16 a[228:231], v[236:239], v[244:247], a[228:231]
    s_waitcnt lgkmcnt(6)
    v_mfma_f32_32x32x16_bf16 a[192:207], v[76:79], v[96:99], a[192:207]
    ds_read_b64_tr_b16 v[72:73], v47 offset:35968
    ds_read_b64_tr_b16 v[74:75], v47 offset:37760
    s_nop 0
    v_mfma_f32_32x32x16_bf16 a[208:223], v[76:79], v[100:103], a[208:223]
    buffer_load_dwordx4 v38, s[8:11], s65 offen lds
    s_add_u32 m0, s39, 2048
    s_waitcnt lgkmcnt(6)
    v_mfma_f32_16x16x32_bf16 a[232:235], v[240:243], v[244:247], a[232:235]
    s_waitcnt lgkmcnt(4)
    v_mfma_f32_32x32x16_bf16 a[0:15], v[80:83], v[104:107], a[0:15]
    ds_read_b64_tr_b16 v[76:77], v47 offset:36032
    ds_read_b64_tr_b16 v[78:79], v47 offset:37824
    s_nop 0
    v_mfma_f32_32x32x16_bf16 a[16:31], v[80:83], v[108:111], a[16:31]
    buffer_load_dwordx4 v42, s[12:15], s36 offen lds
    s_add_u32 m0, s38, 3072
    s_waitcnt lgkmcnt(4)
    v_mfma_f32_32x32x16_bf16 a[32:47], v[68:71], v[104:107], a[32:47]
    ds_read_b64_tr_b16 v[80:81], v47 offset:36096
    ds_read_b64_tr_b16 v[82:83], v47 offset:37888
    s_nop 0
    v_mfma_f32_32x32x16_bf16 a[48:63], v[68:71], v[108:111], a[48:63]
    buffer_load_dwordx4 v31, s[8:11], s65 offen lds
    s_add_u32 m0, s39, 3072
    s_waitcnt lgkmcnt(4)
    v_mfma_f32_32x32x16_bf16 a[64:79], v[72:75], v[104:107], a[64:79]
    ds_read_b64_tr_b16 v[68:69], v47 offset:36160
    ds_read_b64_tr_b16 v[70:71], v47 offset:37952
    s_nop 0
    v_mfma_f32_32x32x16_bf16 a[80:95], v[72:75], v[108:111], a[80:95]
    buffer_load_dwordx4 v43, s[12:15], s36 offen lds
    s_add_u32 m0, s38, 4096
    s_waitcnt lgkmcnt(4)
    v_mfma_f32_32x32x16_bf16 a[96:111], v[76:79], v[104:107], a[96:111]
    ds_read_b64_tr_b16 v[72:73], v47 offset:36224
    ds_read_b64_tr_b16 v[74:75], v47 offset:38016
    s_nop 0
    v_mfma_f32_32x32x16_bf16 a[112:127], v[76:79], v[108:111], a[112:127]
    buffer_load_dwordx4 v38, s[8:11], s66 offen lds
    s_add_u32 m0, s39, 4096
    s_waitcnt lgkmcnt(4)
    v_mfma_f32_32x32x16_bf16 a[128:143], v[80:83], v[104:107], a[128:143]
    ds_read_b64_tr_b16 v[76:77], v47 offset:43008
    ds_read_b64_tr_b16 v[78:79], v47 offset:44800
    s_nop 0
    v_mfma_f32_32x32x16_bf16 a[144:159], v[80:83], v[108:111], a[144:159]
    buffer_load_dwordx4 v44, s[12:15], s36 offen lds
    s_add_u32 m0, s38, 5120
    s_waitcnt lgkmcnt(4)
    v_mfma_f32_32x32x16_bf16 a[160:175], v[68:71], v[104:107], a[160:175]
    ds_read_b64_tr_b16 v[80:81], v47 offset:43072
    ds_read_b64_tr_b16 v[82:83], v47 offset:44864
    s_nop 0
    v_mfma_f32_32x32x16_bf16 a[176:191], v[68:71], v[108:111], a[176:191]
    buffer_load_dwordx4 v31, s[8:11], s66 offen lds
    s_add_u32 m0, s39, 5120
    s_waitcnt lgkmcnt(4)
    v_mfma_f32_32x32x16_bf16 a[192:207], v[72:75], v[104:107], a[192:207]
    ds_read_b64_tr_b16 v[68:69], v47 offset:43136
    ds_read_b64_tr_b16 v[70:71], v47 offset:44928
    s_nop 0
    v_mfma_f32_32x32x16_bf16 a[208:223], v[72:75], v[108:111], a[208:223]
    buffer_load_dwordx4 v45, s[12:15], s36 offen lds
    s_add_u32 m0, s38, 6144
    ds_read_b128 v[248:251], v58 offset:2048
    s_waitcnt lgkmcnt(5)
    v_mfma_f32_32x32x16_bf16 a[0:15], v[76:79], v[112:115], a[0:15]
    ds_read_b64_tr_b16 v[72:73], v47 offset:43200
    ds_read_b64_tr_b16 v[74:75], v47 offset:44992
    s_nop 0
    v_mfma_f32_32x32x16_bf16 a[16:31], v[76:79], v[116:119], a[16:31]
    buffer_load_dwordx4 v38, s[8:11], s67 offen lds
    s_add_u32 m0, s39, 6144
    s_waitcnt lgkmcnt(5)
    v_mfma_f32_32x32x16_bf16 a[32:47], v[80:83], v[112:115], a[32:47]
    ds_read_b64_tr_b16 v[76:77], v47 offset:43264
    ds_read_b64_tr_b16 v[78:79], v47 offset:45056
    ds_read_b64_tr_b16 v[232:233], v54 offset:43008
    ds_read_b64_tr_b16 v[234:235], v54 offset:44800
    s_nop 0
    v_mfma_f32_32x32x16_bf16 a[48:63], v[80:83], v[116:119], a[48:63]
    buffer_load_dwordx4 v46, s[12:15], s36 offen lds
    s_add_u32 m0, s38, 7168
    s_waitcnt lgkmcnt(7)
    v_mfma_f32_32x32x16_bf16 a[64:79], v[68:71], v[112:115], a[64:79]
    ds_read_b64_tr_b16 v[80:81], v47 offset:43328
    ds_read_b64_tr_b16 v[82:83], v47 offset:45120
    ds_read_b64_tr_b16 v[236:237], v55 offset:43008
    ds_read_b64_tr_b16 v[238:239], v55 offset:44800
    s_nop 0
    v_mfma_f32_32x32x16_bf16 a[80:95], v[68:71], v[116:119], a[80:95]
    buffer_load_dwordx4 v31, s[8:11], s67 offen lds
    s_add_u32 m0, s49, 0
    s_waitcnt lgkmcnt(8)
    v_mfma_f32_32x32x16_bf16 a[96:111], v[72:75], v[112:115], a[96:111]
    ds_read_b64_tr_b16 v[68:69], v47 offset:43392
    ds_read_b64_tr_b16 v[70:71], v47 offset:45184
    ds_read_b64_tr_b16 v[240:241], v56 offset:43008
    ds_read_b64_tr_b16 v[242:243], v56 offset:44800
    s_nop 0
    v_mfma_f32_32x32x16_bf16 a[112:127], v[72:75], v[116:119], a[112:127]
    buffer_load_dwordx4 v63, s[8:11], s37 offen lds
    s_waitcnt lgkmcnt(10)
    v_mfma_f32_32x32x16_bf16 a[128:143], v[76:79], v[112:115], a[128:143]
    ds_read_b64_tr_b16 v[72:73], v47 offset:50176
    ds_read_b64_tr_b16 v[74:75], v47 offset:51968
    v_mfma_f32_32x32x16_bf16 a[144:159], v[76:79], v[116:119], a[144:159]
    s_waitcnt lgkmcnt(10)
    v_mfma_f32_16x16x32_bf16 a[224:227], v[232:235], v[248:251], a[224:227]
    s_waitcnt lgkmcnt(8)
    v_mfma_f32_32x32x16_bf16 a[160:175], v[80:83], v[112:115], a[160:175]
    ds_read_b64_tr_b16 v[76:77], v47 offset:50240
    ds_read_b64_tr_b16 v[78:79], v47 offset:52032
    v_mfma_f32_32x32x16_bf16 a[176:191], v[80:83], v[116:119], a[176:191]
    s_waitcnt lgkmcnt(8)
    v_mfma_f32_16x16x32_bf16 a[228:231], v[236:239], v[248:251], a[228:231]
    s_waitcnt lgkmcnt(6)
    v_mfma_f32_32x32x16_bf16 a[192:207], v[68:71], v[112:115], a[192:207]
    ds_read_b64_tr_b16 v[80:81], v47 offset:50304
    ds_read_b64_tr_b16 v[82:83], v47 offset:52096
    s_waitcnt vmcnt(17)
    ds_read_b128 v[128:131], v32 offset:8192
    ds_read_b128 v[132:135], v32 offset:12288
    v_mfma_f32_32x32x16_bf16 a[208:223], v[68:71], v[116:119], a[208:223]
    s_waitcnt lgkmcnt(8)
    v_mfma_f32_16x16x32_bf16 a[232:235], v[240:243], v[248:251], a[232:235]
    s_waitcnt lgkmcnt(6)
    v_mfma_f32_32x32x16_bf16 a[0:15], v[72:75], v[120:123], a[0:15]
    s_waitcnt vmcnt(16)
    s_barrier
    ds_read_b64_tr_b16 v[68:69], v47 offset:50368
    ds_read_b64_tr_b16 v[70:71], v47 offset:52160
    ds_read_b128 v[136:139], v33 offset:8192
    v_mfma_f32_32x32x16_bf16 a[16:31], v[72:75], v[124:127], a[16:31]
    ds_read_b128 v[140:143], v33 offset:12288
    s_waitcnt lgkmcnt(8)
    v_mfma_f32_32x32x16_bf16 a[32:47], v[76:79], v[120:123], a[32:47]
    ds_read_b64_tr_b16 v[72:73], v47 offset:50432
    ds_read_b64_tr_b16 v[74:75], v47 offset:52224
    v_mfma_f32_32x32x16_bf16 a[48:63], v[76:79], v[124:127], a[48:63]
    s_waitcnt lgkmcnt(8)
    v_mfma_f32_32x32x16_bf16 a[64:79], v[80:83], v[120:123], a[64:79]
    ds_read_b64_tr_b16 v[76:77], v47 offset:50496
    ds_read_b64_tr_b16 v[78:79], v47 offset:52288
    v_mfma_f32_32x32x16_bf16 a[80:95], v[80:83], v[124:127], a[80:95]
    s_waitcnt lgkmcnt(6)
    v_mfma_f32_32x32x16_bf16 a[96:111], v[68:71], v[120:123], a[96:111]
    ds_read_b64_tr_b16 v[80:81], v47 offset:50560
    ds_read_b64_tr_b16 v[82:83], v47 offset:52352
    ds_read_b128 v[144:147], v34 offset:8192
    ds_read_b128 v[148:151], v34 offset:12288
    v_mfma_f32_32x32x16_bf16 a[112:127], v[68:71], v[124:127], a[112:127]
    s_waitcnt lgkmcnt(6)
    v_mfma_f32_32x32x16_bf16 a[128:143], v[72:75], v[120:123], a[128:143]
    ds_read_b64_tr_b16 v[68:69], v84 offset:0
    ds_read_b64_tr_b16 v[70:71], v84 offset:1792
    ds_read_b128 v[152:155], v35 offset:8192
    ds_read_b128 v[156:159], v35 offset:12288
    v_mfma_f32_32x32x16_bf16 a[144:159], v[72:75], v[124:127], a[144:159]
    s_waitcnt lgkmcnt(8)
    v_mfma_f32_32x32x16_bf16 a[160:175], v[76:79], v[120:123], a[160:175]
    ds_read_b64_tr_b16 v[72:73], v84 offset:64
    ds_read_b64_tr_b16 v[74:75], v84 offset:1856
    v_mfma_f32_32x32x16_bf16 a[176:191], v[76:79], v[124:127], a[176:191]
    s_waitcnt lgkmcnt(8)
    v_mfma_f32_32x32x16_bf16 a[192:207], v[80:83], v[120:123], a[192:207]
    ds_read_b64_tr_b16 v[76:77], v84 offset:128
    ds_read_b64_tr_b16 v[78:79], v84 offset:1920
    v_mfma_f32_32x32x16_bf16 a[208:223], v[80:83], v[124:127], a[208:223]
    ds_read_b128 v[244:247], v57 offset:4096
    s_waitcnt lgkmcnt(7)
    v_mfma_f32_32x32x16_bf16 a[0:15], v[68:71], v[128:131], a[0:15]
    s_barrier
    ds_read_b64_tr_b16 v[80:81], v84 offset:192
    ds_read_b64_tr_b16 v[82:83], v84 offset:1984
    s_waitcnt lgkmcnt(7)
    s_add_u32 s3, s3, 1
    s_cmp_eq_u32 s3, 9
    v_mfma_f32_32x32x16_bf16 a[16:31], v[68:71], v[132:135], a[16:31]
    s_cselect_b32 s3, 0, s3
    s_mov_b32 s40, 128
    s_cselect_b32 s40, 4294966272, s40
    s_add_u32 s64, s64, s40
    s_add_u32 s65, s65, s40
    s_add_u32 s66, s66, s40
    s_waitcnt lgkmcnt(5)
    v_mfma_f32_32x32x16_bf16 a[32:47], v[72:75], v[128:131], a[32:47]
    ds_read_b64_tr_b16 v[68:69], v84 offset:256
    ds_read_b64_tr_b16 v[70:71], v84 offset:2048
    ds_read_b64_tr_b16 v[232:233], v91 offset:0
    ds_read_b64_tr_b16 v[234:235], v91 offset:1792
    s_add_u32 s67, s67, s40
    s_add_u32 m0, s38, 8192
    s_nop 0
    v_mfma_f32_32x32x16_bf16 a[48:63], v[72:75], v[132:135], a[48:63]
    buffer_load_dwordx4 v38, s[8:11], s64 offen lds
    s_add_u32 s35, s35, 1
    s_waitcnt lgkmcnt(7)
    v_mfma_f32_32x32x16_bf16 a[64:79], v[76:79], v[128:131], a[64:79]
    ds_read_b64_tr_b16 v[72:73], v84 offset:320
    ds_read_b64_tr_b16 v[74:75], v84 offset:2112
    ds_read_b64_tr_b16 v[236:237], v92 offset:0
    ds_read_b64_tr_b16 v[238:239], v92 offset:1792
    s_cmp_eq_u32 s35, 9
    s_cselect_b32 s35, 0, s35
    s_mov_b32 s40, 128
    v_mfma_f32_32x32x16_bf16 a[80:95], v[76:79], v[132:135], a[80:95]
    s_cselect_b32 s40, 4294966272, s40
    s_mov_b32 s41, s40
    s_mov_b32 s40, 221184
    s_cselect_b32 s40, 4293197824, s40
    s_mov_b32 s42, s40
    s_add_u32 s36, s36, s42
    s_waitcnt lgkmcnt(8)
    v_mfma_f32_32x32x16_bf16 a[96:111], v[80:83], v[128:131], a[96:111]
    ds_read_b64_tr_b16 v[76:77], v84 offset:384
    ds_read_b64_tr_b16 v[78:79], v84 offset:2176
    ds_read_b64_tr_b16 v[240:241], v93 offset:0
    ds_read_b64_tr_b16 v[242:243], v93 offset:1792
    s_add_u32 s37, s37, s41
    s_add_u32 m0, s39, 28672
    s_nop 0
    v_mfma_f32_32x32x16_bf16 a[112:127], v[80:83], v[132:135], a[112:127]
    buffer_load_dwordx4 v40, s[12:15], s36 offen lds
    s_add_u32 m0, s38, 9216
    s_waitcnt lgkmcnt(10)
    v_mfma_f32_32x32x16_bf16 a[128:143], v[68:71], v[128:131], a[128:143]
    ds_read_b64_tr_b16 v[80:81], v84 offset:7168
    ds_read_b64_tr_b16 v[82:83], v84 offset:8960
    s_nop 0
    v_mfma_f32_32x32x16_bf16 a[144:159], v[68:71], v[132:135], a[144:159]
    buffer_load_dwordx4 v31, s[8:11], s64 offen lds
    s_add_u32 m0, s39, 29696
    s_waitcnt lgkmcnt(10)
    v_mfma_f32_16x16x32_bf16 a[224:227], v[232:235], v[244:247], a[224:227]
    s_waitcnt lgkmcnt(8)
    v_mfma_f32_32x32x16_bf16 a[160:175], v[72:75], v[128:131], a[160:175]
    ds_read_b64_tr_b16 v[68:69], v84 offset:7232
    ds_read_b64_tr_b16 v[70:71], v84 offset:9024
    s_nop 0
    v_mfma_f32_32x32x16_bf16 a[176:191], v[72:75], v[132:135], a[176:191]
    buffer_load_dwordx4 v41, s[12:15], s36 offen lds
    s_add_u32 m0, s38, 10240
    s_waitcnt lgkmcnt(8)
    v_mfma_f32_16x16x32_bf16 a[228:231], v[236:239], v[244:247], a[228:231]
    s_waitcnt lgkmcnt(6)
    v_mfma_f32_32x32x16_bf16 a[192:207], v[76:79], v[128:131], a[192:207]
    ds_read_b64_tr_b16 v[72:73], v84 offset:7296
    ds_read_b64_tr_b16 v[74:75], v84 offset:9088
    s_nop 0
    v_mfma_f32_32x32x16_bf16 a[208:223], v[76:79], v[132:135], a[208:223]
    buffer_load_dwordx4 v38, s[8:11], s65 offen lds
    s_add_u32 m0, s39, 30720
    s_waitcnt lgkmcnt(6)
    v_mfma_f32_16x16x32_bf16 a[232:235], v[240:243], v[244:247], a[232:235]
    s_waitcnt lgkmcnt(4)
    v_mfma_f32_32x32x16_bf16 a[0:15], v[80:83], v[136:139], a[0:15]
    ds_read_b64_tr_b16 v[76:77], v84 offset:7360
    ds_read_b64_tr_b16 v[78:79], v84 offset:9152
    s_nop 0
    v_mfma_f32_32x32x16_bf16 a[16:31], v[80:83], v[140:143], a[16:31]
    buffer_load_dwordx4 v42, s[12:15], s36 offen lds
    s_add_u32 m0, s38, 11264
    s_waitcnt lgkmcnt(4)
    v_mfma_f32_32x32x16_bf16 a[32:47], v[68:71], v[136:139], a[32:47]
    ds_read_b64_tr_b16 v[80:81], v84 offset:7424
    ds_read_b64_tr_b16 v[82:83], v84 offset:9216
    s_nop 0
    v_mfma_f32_32x32x16_bf16 a[48:63], v[68:71], v[140:143], a[48:63]
    buffer_load_dwordx4 v31, s[8:11], s65 offen lds
    s_add_u32 m0, s39, 31744
    s_waitcnt lgkmcnt(4)
    v_mfma_f32_32x32x16_bf16 a[64:79], v[72:75], v[136:139], a[64:79]
    ds_read_b64_tr_b16 v[68:69], v84 offset:7488
    ds_read_b64_tr_b16 v[70:71], v84 offset:9280
    s_nop 0
    v_mfma_f32_32x32x16_bf16 a[80:95], v[72:75], v[140:143], a[80:95]
    buffer_load_dwordx4 v43, s[12:15], s36 offen lds
    s_add_u32 m0, s38, 12288
    s_waitcnt lgkmcnt(4)
    v_mfma_f32_32x32x16_bf16 a[96:111], v[76:79], v[136:139], a[96:111]
    ds_read_b64_tr_b16 v[72:73], v84 offset:7552
    ds_read_b64_tr_b16 v[74:75], v84 offset:9344
    s_nop 0
    v_mfma_f32_32x32x16_bf16 a[112:127], v[76:79], v[140:143], a[112:127]
    buffer_load_dwordx4 v38, s[8:11], s66 offen lds
    s_add_u32 m0, s39, 32768
    s_waitcnt lgkmcnt(4)
    v_mfma_f32_32x32x16_bf16 a[128:143], v[80:83], v[136:139], a[128:143]
    ds_read_b64_tr_b16 v[76:77], v84 offset:14336
    ds_read_b64_tr_b16 v[78:79], v84 offset:16128
    s_nop 0
    v_mfma_f32_32x32x16_bf16 a[144:159], v[80:83], v[140:143], a[144:159]
    buffer_load_dwordx4 v44, s[12:15], s36 offen lds
    s_add_u32 m0, s38, 13312
    s_waitcnt lgkmcnt(4)
    v_mfma_f32_32x32x16_bf16 a[160:175], v[68:71], v[136:139], a[160:175]
    ds_read_b64_tr_b16 v[80:81], v84 offset:14400
    ds_read_b64_tr_b16 v[82:83], v84 offset:16192
    s_nop 0
    v_mfma_f32_32x32x16_bf16 a[176:191], v[68:71], v[140:143], a[176:191]
    buffer_load_dwordx4 v31, s[8:11], s66 offen lds
    s_add_u32 m0, s39, 33792
    s_waitcnt lgkmcnt(4)
    v_mfma_f32_32x32x16_bf16 a[192:207], v[72:75], v[136:139], a[192:207]
    ds_read_b64_tr_b16 v[68:69], v84 offset:14464
    ds_read_b64_tr_b16 v[70:71], v84 offset:16256
    s_nop 0
    v_mfma_f32_32x32x16_bf16 a[208:223], v[72:75], v[140:143], a[208:223]
    buffer_load_dwordx4 v45, s[12:15], s36 offen lds
    s_add_u32 m0, s38, 14336
    ds_read_b128 v[248:251], v58 offset:4096
    s_waitcnt lgkmcnt(5)
    v_mfma_f32_32x32x16_bf16 a[0:15], v[76:79], v[144:147], a[0:15]
    ds_read_b64_tr_b16 v[72:73], v84 offset:14528
    ds_read_b64_tr_b16 v[74:75], v84 offset:16320
    s_nop 0
    v_mfma_f32_32x32x16_bf16 a[16:31], v[76:79], v[148:151], a[16:31]
    buffer_load_dwordx4 v38, s[8:11], s67 offen lds
    s_add_u32 m0, s39, 34816
    s_waitcnt lgkmcnt(5)
    v_mfma_f32_32x32x16_bf16 a[32:47], v[80:83], v[144:147], a[32:47]
    ds_read_b64_tr_b16 v[76:77], v84 offset:14592
    ds_read_b64_tr_b16 v[78:79], v84 offset:16384
    ds_read_b64_tr_b16 v[232:233], v91 offset:14336
    ds_read_b64_tr_b16 v[234:235], v91 offset:16128
    s_nop 0
    v_mfma_f32_32x32x16_bf16 a[48:63], v[80:83], v[148:151], a[48:63]
    buffer_load_dwordx4 v46, s[12:15], s36 offen lds
    s_add_u32 m0, s38, 15360
    s_waitcnt lgkmcnt(7)
    v_mfma_f32_32x32x16_bf16 a[64:79], v[68:71], v[144:147], a[64:79]
    ds_read_b64_tr_b16 v[80:81], v84 offset:14656
    ds_read_b64_tr_b16 v[82:83], v84 offset:16448
    ds_read_b64_tr_b16 v[236:237], v92 offset:14336
    ds_read_b64_tr_b16 v[238:239], v92 offset:16128
    s_nop 0
    v_mfma_f32_32x32x16_bf16 a[80:95], v[68:71], v[148:151], a[80:95]
    buffer_load_dwordx4 v31, s[8:11], s67 offen lds
    s_add_u32 m0, s49, 2048
    s_waitcnt lgkmcnt(8)
    v_mfma_f32_32x32x16_bf16 a[96:111], v[72:75], v[144:147], a[96:111]
    ds_read_b64_tr_b16 v[68:69], v84 offset:14720
    ds_read_b64_tr_b16 v[70:71], v84 offset:16512
    ds_read_b64_tr_b16 v[240:241], v93 offset:14336
    ds_read_b64_tr_b16 v[242:243], v93 offset:16128
    s_nop 0
    v_mfma_f32_32x32x16_bf16 a[112:127], v[72:75], v[148:151], a[112:127]
    buffer_load_dwordx4 v63, s[8:11], s37 offen lds
    s_waitcnt lgkmcnt(10)
    v_mfma_f32_32x32x16_bf16 a[128:143], v[76:79], v[144:147], a[128:143]
    ds_read_b64_tr_b16 v[72:73], v84 offset:21504
    ds_read_b64_tr_b16 v[74:75], v84 offset:23296
    v_mfma_f32_32x32x16_bf16 a[144:159], v[76:79], v[148:151], a[144:159]
    s_waitcnt lgkmcnt(10)
    v_mfma_f32_16x16x32_bf16 a[224:227], v[232:235], v[248:251], a[224:227]
    s_waitcnt lgkmcnt(8)
    v_mfma_f32_32x32x16_bf16 a[160:175], v[80:83], v[144:147], a[160:175]
    ds_read_b64_tr_b16 v[76:77], v84 offset:21568
    ds_read_b64_tr_b16 v[78:79], v84 offset:23360
    v_mfma_f32_32x32x16_bf16 a[176:191], v[80:83], v[148:151], a[176:191]
    s_waitcnt lgkmcnt(8)
    v_mfma_f32_16x16x32_bf16 a[228:231], v[236:239], v[248:251], a[228:231]
    s_waitcnt lgkmcnt(6)
    v_mfma_f32_32x32x16_bf16 a[192:207], v[68:71], v[144:147], a[192:207]
    ds_read_b64_tr_b16 v[80:81], v84 offset:21632
    ds_read_b64_tr_b16 v[82:83], v84 offset:23424
    s_waitcnt vmcnt(17)
    ds_read_b128 v[160:163], v32 offset:0
    ds_read_b128 v[164:167], v32 offset:4096
    v_mfma_f32_32x32x16_bf16 a[208:223], v[68:71], v[148:151], a[208:223]
    s_waitcnt lgkmcnt(8)
    v_mfma_f32_16x16x32_bf16 a[232:235], v[240:243], v[248:251], a[232:235]
    s_waitcnt lgkmcnt(6)
    v_mfma_f32_32x32x16_bf16 a[0:15], v[72:75], v[152:155], a[0:15]
    s_waitcnt vmcnt(16)
    s_barrier
    ds_read_b64_tr_b16 v[68:69], v84 offset:21696
    ds_read_b64_tr_b16 v[70:71], v84 offset:23488
    ds_read_b128 v[168:171], v33 offset:0
    v_mfma_f32_32x32x16_bf16 a[16:31], v[72:75], v[156:159], a[16:31]
    ds_read_b128 v[172:175], v33 offset:4096
    s_waitcnt lgkmcnt(8)
    v_mfma_f32_32x32x16_bf16 a[32:47], v[76:79], v[152:155], a[32:47]
    ds_read_b64_tr_b16 v[72:73], v84 offset:21760
    ds_read_b64_tr_b16 v[74:75], v84 offset:23552
    v_mfma_f32_32x32x16_bf16 a[48:63], v[76:79], v[156:159], a[48:63]
    s_waitcnt lgkmcnt(8)
    v_mfma_f32_32x32x16_bf16 a[64:79], v[80:83], v[152:155], a[64:79]
    ds_read_b64_tr_b16 v[76:77], v84 offset:21824
    ds_read_b64_tr_b16 v[78:79], v84 offset:23616
    v_mfma_f32_32x32x16_bf16 a[80:95], v[80:83], v[156:159], a[80:95]
    s_waitcnt lgkmcnt(6)
    v_mfma_f32_32x32x16_bf16 a[96:111], v[68:71], v[152:155], a[96:111]
    ds_read_b64_tr_b16 v[80:81], v84 offset:21888
    ds_read_b64_tr_b16 v[82:83], v84 offset:23680
    ds_read_b128 v[176:179], v34 offset:0
    ds_read_b128 v[180:183], v34 offset:4096
    v_mfma_f32_32x32x16_bf16 a[112:127], v[68:71], v[156:159], a[112:127]
    s_waitcnt lgkmcnt(6)
    v_mfma_f32_32x32x16_bf16 a[128:143], v[72:75], v[152:155], a[128:143]
    ds_read_b64_tr_b16 v[68:69], v47 offset:0
    ds_read_b64_tr_b16 v[70:71], v47 offset:1792
    ds_read_b128 v[184:187], v35 offset:0
    ds_read_b128 v[188:191], v35 offset:4096
    v_mfma_f32_32x32x16_bf16 a[144:159], v[72:75], v[156:159], a[144:159]
    s_waitcnt lgkmcnt(8)
    v_mfma_f32_32x32x16_bf16 a[160:175], v[76:79], v[152:155], a[160:175]
    ds_read_b64_tr_b16 v[72:73], v47 offset:64
    ds_read_b64_tr_b16 v[74:75], v47 offset:1856
    v_mfma_f32_32x32x16_bf16 a[176:191], v[76:79], v[156:159], a[176:191]
    s_waitcnt lgkmcnt(8)
    v_mfma_f32_32x32x16_bf16 a[192:207], v[80:83], v[152:155], a[192:207]
    ds_read_b64_tr_b16 v[76:77], v47 offset:128
    ds_read_b64_tr_b16 v[78:79], v47 offset:1920
    v_mfma_f32_32x32x16_bf16 a[208:223], v[80:83], v[156:159], a[208:223]
    ds_read_b128 v[244:247], v57 offset:0
    s_waitcnt lgkmcnt(7)
    v_mfma_f32_32x32x16_bf16 a[0:15], v[68:71], v[160:163], a[0:15]
    s_barrier
    ds_read_b64_tr_b16 v[80:81], v47 offset:192
    ds_read_b64_tr_b16 v[82:83], v47 offset:1984
    s_waitcnt lgkmcnt(7)
    s_add_u32 s3, s3, 1
    s_cmp_eq_u32 s3, 9
    v_mfma_f32_32x32x16_bf16 a[16:31], v[68:71], v[164:167], a[16:31]
    s_cselect_b32 s3, 0, s3
    s_mov_b32 s40, 128
    s_cselect_b32 s40, 4294966272, s40
    s_add_u32 s64, s64, s40
    s_add_u32 s65, s65, s40
    s_add_u32 s66, s66, s40
    s_waitcnt lgkmcnt(5)
    v_mfma_f32_32x32x16_bf16 a[32:47], v[72:75], v[160:163], a[32:47]
    ds_read_b64_tr_b16 v[68:69], v47 offset:256
    ds_read_b64_tr_b16 v[70:71], v47 offset:2048
    ds_read_b64_tr_b16 v[232:233], v54 offset:0
    ds_read_b64_tr_b16 v[234:235], v54 offset:1792
    s_add_u32 s67, s67, s40
    s_add_u32 m0, s38, 0
    s_nop 0
    v_mfma_f32_32x32x16_bf16 a[48:63], v[72:75], v[164:167], a[48:63]
    buffer_load_dwordx4 v38, s[8:11], s64 offen lds
    s_add_u32 s35, s35, 1
    s_waitcnt lgkmcnt(7)
    v_mfma_f32_32x32x16_bf16 a[64:79], v[76:79], v[160:163], a[64:79]
    ds_read_b64_tr_b16 v[72:73], v47 offset:320
    ds_read_b64_tr_b16 v[74:75], v47 offset:2112
    ds_read_b64_tr_b16 v[236:237], v55 offset:0
    ds_read_b64_tr_b16 v[238:239], v55 offset:1792
    s_cmp_eq_u32 s35, 9
    s_cselect_b32 s35, 0, s35
    s_mov_b32 s40, 128
    v_mfma_f32_32x32x16_bf16 a[80:95], v[76:79], v[164:167], a[80:95]
    s_cselect_b32 s40, 4294966272, s40
    s_mov_b32 s41, s40
    s_mov_b32 s40, 221184
    s_cselect_b32 s40, 4293197824, s40
    s_mov_b32 s42, s40
    s_add_u32 s36, s36, s42
    s_waitcnt lgkmcnt(8)
    v_mfma_f32_32x32x16_bf16 a[96:111], v[80:83], v[160:163], a[96:111]
    ds_read_b64_tr_b16 v[76:77], v47 offset:384
    ds_read_b64_tr_b16 v[78:79], v47 offset:2176
    ds_read_b64_tr_b16 v[240:241], v56 offset:0
    ds_read_b64_tr_b16 v[242:243], v56 offset:1792
    s_add_u32 s37, s37, s41
    s_add_u32 m0, s39, 57344
    s_nop 0
    v_mfma_f32_32x32x16_bf16 a[112:127], v[80:83], v[164:167], a[112:127]
    buffer_load_dwordx4 v40, s[12:15], s36 offen lds
    s_add_u32 m0, s38, 1024
    s_waitcnt lgkmcnt(10)
    v_mfma_f32_32x32x16_bf16 a[128:143], v[68:71], v[160:163], a[128:143]
    ds_read_b64_tr_b16 v[80:81], v47 offset:7168
    ds_read_b64_tr_b16 v[82:83], v47 offset:8960
    s_nop 0
    v_mfma_f32_32x32x16_bf16 a[144:159], v[68:71], v[164:167], a[144:159]
    buffer_load_dwordx4 v31, s[8:11], s64 offen lds
    s_add_u32 m0, s39, 58368
    s_waitcnt lgkmcnt(10)
    v_mfma_f32_16x16x32_bf16 a[224:227], v[232:235], v[244:247], a[224:227]
    s_waitcnt lgkmcnt(8)
    v_mfma_f32_32x32x16_bf16 a[160:175], v[72:75], v[160:163], a[160:175]
    ds_read_b64_tr_b16 v[68:69], v47 offset:7232
    ds_read_b64_tr_b16 v[70:71], v47 offset:9024
    s_nop 0
    v_mfma_f32_32x32x16_bf16 a[176:191], v[72:75], v[164:167], a[176:191]
    buffer_load_dwordx4 v41, s[12:15], s36 offen lds
    s_add_u32 m0, s38, 2048
    s_waitcnt lgkmcnt(8)
    v_mfma_f32_16x16x32_bf16 a[228:231], v[236:239], v[244:247], a[228:231]
    s_waitcnt lgkmcnt(6)
    v_mfma_f32_32x32x16_bf16 a[192:207], v[76:79], v[160:163], a[192:207]
    ds_read_b64_tr_b16 v[72:73], v47 offset:7296
    ds_read_b64_tr_b16 v[74:75], v47 offset:9088
    s_nop 0
    v_mfma_f32_32x32x16_bf16 a[208:223], v[76:79], v[164:167], a[208:223]
    buffer_load_dwordx4 v38, s[8:11], s65 offen lds
    s_add_u32 m0, s39, 59392
    s_waitcnt lgkmcnt(6)
    v_mfma_f32_16x16x32_bf16 a[232:235], v[240:243], v[244:247], a[232:235]
    s_waitcnt lgkmcnt(4)
    v_mfma_f32_32x32x16_bf16 a[0:15], v[80:83], v[168:171], a[0:15]
    ds_read_b64_tr_b16 v[76:77], v47 offset:7360
    ds_read_b64_tr_b16 v[78:79], v47 offset:9152
    s_nop 0
    v_mfma_f32_32x32x16_bf16 a[16:31], v[80:83], v[172:175], a[16:31]
    buffer_load_dwordx4 v42, s[12:15], s36 offen lds
    s_add_u32 m0, s38, 3072
    s_waitcnt lgkmcnt(4)
    v_mfma_f32_32x32x16_bf16 a[32:47], v[68:71], v[168:171], a[32:47]
    ds_read_b64_tr_b16 v[80:81], v47 offset:7424
    ds_read_b64_tr_b16 v[82:83], v47 offset:9216
    s_nop 0
    v_mfma_f32_32x32x16_bf16 a[48:63], v[68:71], v[172:175], a[48:63]
    buffer_load_dwordx4 v31, s[8:11], s65 offen lds
    s_add_u32 m0, s39, 60416
    s_waitcnt lgkmcnt(4)
    v_mfma_f32_32x32x16_bf16 a[64:79], v[72:75], v[168:171], a[64:79]
    ds_read_b64_tr_b16 v[68:69], v47 offset:7488
    ds_read_b64_tr_b16 v[70:71], v47 offset:9280
    s_nop 0
    v_mfma_f32_32x32x16_bf16 a[80:95], v[72:75], v[172:175], a[80:95]
    buffer_load_dwordx4 v43, s[12:15], s36 offen lds
    s_add_u32 m0, s38, 4096
    s_waitcnt lgkmcnt(4)
    v_mfma_f32_32x32x16_bf16 a[96:111], v[76:79], v[168:171], a[96:111]
    ds_read_b64_tr_b16 v[72:73], v47 offset:7552
    ds_read_b64_tr_b16 v[74:75], v47 offset:9344
    s_nop 0
    v_mfma_f32_32x32x16_bf16 a[112:127], v[76:79], v[172:175], a[112:127]
    buffer_load_dwordx4 v38, s[8:11], s66 offen lds
    s_add_u32 m0, s39, 61440
    s_waitcnt lgkmcnt(4)
    v_mfma_f32_32x32x16_bf16 a[128:143], v[80:83], v[168:171], a[128:143]
    ds_read_b64_tr_b16 v[76:77], v47 offset:14336
    ds_read_b64_tr_b16 v[78:79], v47 offset:16128
    s_nop 0
    v_mfma_f32_32x32x16_bf16 a[144:159], v[80:83], v[172:175], a[144:159]
    buffer_load_dwordx4 v44, s[12:15], s36 offen lds
    s_add_u32 m0, s38, 5120
    s_waitcnt lgkmcnt(4)
    v_mfma_f32_32x32x16_bf16 a[160:175], v[68:71], v[168:171], a[160:175]
    ds_read_b64_tr_b16 v[80:81], v47 offset:14400
    ds_read_b64_tr_b16 v[82:83], v47 offset:16192
    s_nop 0
    v_mfma_f32_32x32x16_bf16 a[176:191], v[68:71], v[172:175], a[176:191]
    buffer_load_dwordx4 v31, s[8:11], s66 offen lds
    s_add_u32 m0, s39, 62464
    s_waitcnt lgkmcnt(4)
    v_mfma_f32_32x32x16_bf16 a[192:207], v[72:75], v[168:171], a[192:207]
    ds_read_b64_tr_b16 v[68:69], v47 offset:14464
    ds_read_b64_tr_b16 v[70:71], v47 offset:16256
    s_nop 0
    v_mfma_f32_32x32x16_bf16 a[208:223], v[72:75], v[172:175], a[208:223]
    buffer_load_dwordx4 v45, s[12:15], s36 offen lds
    s_add_u32 m0, s38, 6144
    ds_read_b128 v[248:251], v58 offset:0
    s_waitcnt lgkmcnt(5)
    v_mfma_f32_32x32x16_bf16 a[0:15], v[76:79], v[176:179], a[0:15]
    ds_read_b64_tr_b16 v[72:73], v47 offset:14528
    ds_read_b64_tr_b16 v[74:75], v47 offset:16320
    s_nop 0
    v_mfma_f32_32x32x16_bf16 a[16:31], v[76:79], v[180:183], a[16:31]
    buffer_load_dwordx4 v38, s[8:11], s67 offen lds
    s_add_u32 m0, s39, 63488
    s_waitcnt lgkmcnt(5)
    v_mfma_f32_32x32x16_bf16 a[32:47], v[80:83], v[176:179], a[32:47]
    ds_read_b64_tr_b16 v[76:77], v47 offset:14592
    ds_read_b64_tr_b16 v[78:79], v47 offset:16384
    ds_read_b64_tr_b16 v[232:233], v54 offset:14336
    ds_read_b64_tr_b16 v[234:235], v54 offset:16128
    s_nop 0
    v_mfma_f32_32x32x16_bf16 a[48:63], v[80:83], v[180:183], a[48:63]
    buffer_load_dwordx4 v46, s[12:15], s36 offen lds
    s_add_u32 m0, s38, 7168
    s_waitcnt lgkmcnt(7)
    v_mfma_f32_32x32x16_bf16 a[64:79], v[68:71], v[176:179], a[64:79]
    ds_read_b64_tr_b16 v[80:81], v47 offset:14656
    ds_read_b64_tr_b16 v[82:83], v47 offset:16448
    ds_read_b64_tr_b16 v[236:237], v55 offset:14336
    ds_read_b64_tr_b16 v[238:239], v55 offset:16128
    s_nop 0
    v_mfma_f32_32x32x16_bf16 a[80:95], v[68:71], v[180:183], a[80:95]
    buffer_load_dwordx4 v31, s[8:11], s67 offen lds
    s_add_u32 m0, s49, 4096
    s_waitcnt lgkmcnt(8)
    v_mfma_f32_32x32x16_bf16 a[96:111], v[72:75], v[176:179], a[96:111]
    ds_read_b64_tr_b16 v[68:69], v47 offset:14720
    ds_read_b64_tr_b16 v[70:71], v47 offset:16512
    ds_read_b64_tr_b16 v[240:241], v56 offset:14336
    ds_read_b64_tr_b16 v[242:243], v56 offset:16128
    s_nop 0
    v_mfma_f32_32x32x16_bf16 a[112:127], v[72:75], v[180:183], a[112:127]
    buffer_load_dwordx4 v63, s[8:11], s37 offen lds
    s_mov_b32 s20, s30
    s_waitcnt lgkmcnt(10)
    v_mfma_f32_32x32x16_bf16 a[128:143], v[76:79], v[176:179], a[128:143]
    ds_read_b64_tr_b16 v[72:73], v47 offset:21504
    ds_read_b64_tr_b16 v[74:75], v47 offset:23296
    s_mov_b32 s21, s31
    s_mov_b32 s22, 256
    s_mov_b32 s23, 0x00020000
    v_mov_b32 v253, 0
    v_mfma_f32_32x32x16_bf16 a[144:159], v[76:79], v[180:183], a[144:159]
    buffer_load_dword v252, v253, s[20:23], 0 offen sc0 sc1
    s_waitcnt lgkmcnt(10)
    v_mfma_f32_16x16x32_bf16 a[224:227], v[232:235], v[248:251], a[224:227]
    s_waitcnt lgkmcnt(8)
    v_mfma_f32_32x32x16_bf16 a[160:175], v[80:83], v[176:179], a[160:175]
    ds_read_b64_tr_b16 v[76:77], v47 offset:21568
    ds_read_b64_tr_b16 v[78:79], v47 offset:23360
    v_mfma_f32_32x32x16_bf16 a[176:191], v[80:83], v[180:183], a[176:191]
    s_waitcnt lgkmcnt(8)
    v_mfma_f32_16x16x32_bf16 a[228:231], v[236:239], v[248:251], a[228:231]
    s_waitcnt lgkmcnt(6)
    v_mfma_f32_32x32x16_bf16 a[192:207], v[68:71], v[176:179], a[192:207]
    ds_read_b64_tr_b16 v[80:81], v47 offset:21632
    ds_read_b64_tr_b16 v[82:83], v47 offset:23424
    s_waitcnt vmcnt(18)
    ds_read_b128 v[192:195], v32 offset:8192
    ds_read_b128 v[196:199], v32 offset:12288
    v_mfma_f32_32x32x16_bf16 a[208:223], v[68:71], v[180:183], a[208:223]
    s_waitcnt lgkmcnt(8)
    v_mfma_f32_16x16x32_bf16 a[232:235], v[240:243], v[248:251], a[232:235]
    s_waitcnt lgkmcnt(6)
    v_mfma_f32_32x32x16_bf16 a[0:15], v[72:75], v[184:187], a[0:15]
    s_waitcnt vmcnt(17)
    s_barrier
    ds_read_b64_tr_b16 v[68:69], v47 offset:21696
    ds_read_b64_tr_b16 v[70:71], v47 offset:23488
    ds_read_b128 v[200:203], v33 offset:8192
    v_mfma_f32_32x32x16_bf16 a[16:31], v[72:75], v[188:191], a[16:31]
    ds_read_b128 v[204:207], v33 offset:12288
    s_waitcnt lgkmcnt(8)
    v_mfma_f32_32x32x16_bf16 a[32:47], v[76:79], v[184:187], a[32:47]
    ds_read_b64_tr_b16 v[72:73], v47 offset:21760
    ds_read_b64_tr_b16 v[74:75], v47 offset:23552
    v_mfma_f32_32x32x16_bf16 a[48:63], v[76:79], v[188:191], a[48:63]
    s_waitcnt lgkmcnt(8)
    v_mfma_f32_32x32x16_bf16 a[64:79], v[80:83], v[184:187], a[64:79]
    ds_read_b64_tr_b16 v[76:77], v47 offset:21824
    ds_read_b64_tr_b16 v[78:79], v47 offset:23616
    v_mfma_f32_32x32x16_bf16 a[80:95], v[80:83], v[188:191], a[80:95]
    s_waitcnt lgkmcnt(6)
    v_mfma_f32_32x32x16_bf16 a[96:111], v[68:71], v[184:187], a[96:111]
    ds_read_b64_tr_b16 v[80:81], v47 offset:21888
    ds_read_b64_tr_b16 v[82:83], v47 offset:23680
    ds_read_b128 v[208:211], v34 offset:8192
    ds_read_b128 v[212:215], v34 offset:12288
    v_mfma_f32_32x32x16_bf16 a[112:127], v[68:71], v[188:191], a[112:127]
    s_waitcnt lgkmcnt(6)
    v_mfma_f32_32x32x16_bf16 a[128:143], v[72:75], v[184:187], a[128:143]
    ds_read_b64_tr_b16 v[68:69], v47 offset:28672
    ds_read_b64_tr_b16 v[70:71], v47 offset:30464
    ds_read_b128 v[216:219], v35 offset:8192
    ds_read_b128 v[220:223], v35 offset:12288
    v_mfma_f32_32x32x16_bf16 a[144:159], v[72:75], v[188:191], a[144:159]
    s_waitcnt lgkmcnt(8)
    v_mfma_f32_32x32x16_bf16 a[160:175], v[76:79], v[184:187], a[160:175]
    ds_read_b64_tr_b16 v[72:73], v47 offset:28736
    ds_read_b64_tr_b16 v[74:75], v47 offset:30528
    v_mfma_f32_32x32x16_bf16 a[176:191], v[76:79], v[188:191], a[176:191]
    s_waitcnt lgkmcnt(8)
    v_mfma_f32_32x32x16_bf16 a[192:207], v[80:83], v[184:187], a[192:207]
    ds_read_b64_tr_b16 v[76:77], v47 offset:28800
    ds_read_b64_tr_b16 v[78:79], v47 offset:30592
    v_mfma_f32_32x32x16_bf16 a[208:223], v[80:83], v[188:191], a[208:223]
    ds_read_b128 v[244:247], v57 offset:2048
    s_waitcnt lgkmcnt(7)
    v_mfma_f32_32x32x16_bf16 a[0:15], v[68:71], v[192:195], a[0:15]
    ds_read_b64_tr_b16 v[80:81], v47 offset:28864
    ds_read_b64_tr_b16 v[82:83], v47 offset:30656
    v_mfma_f32_32x32x16_bf16 a[16:31], v[68:71], v[196:199], a[16:31]
    s_waitcnt lgkmcnt(5)
    v_mfma_f32_32x32x16_bf16 a[32:47], v[72:75], v[192:195], a[32:47]
    ds_read_b64_tr_b16 v[68:69], v47 offset:28928
    ds_read_b64_tr_b16 v[70:71], v47 offset:30720
    ds_read_b64_tr_b16 v[232:233], v54 offset:28672
    ds_read_b64_tr_b16 v[234:235], v54 offset:30464
    v_mul_u32_u24 v2, 7282, v0
    v_lshrrev_b32 v2, 16, v2
    v_mul_u32_u24 v3, 9, v2
    v_mfma_f32_32x32x16_bf16 a[48:63], v[72:75], v[196:199], a[48:63]
    v_sub_u32 v3, v0, v3
    v_min_u32 v2, 5, v2
    v_mul_u32_u24 v2, 1152, v2
    v_lshl_add_u32 v2, v3, 7, v2
    s_mov_b32 s60, s52
    s_mov_b32 s61, s53
    s_waitcnt lgkmcnt(7)
    v_mfma_f32_32x32x16_bf16 a[64:79], v[76:79], v[192:195], a[64:79]
    ds_read_b64_tr_b16 v[72:73], v47 offset:28992
    ds_read_b64_tr_b16 v[74:75], v47 offset:30784
    ds_read_b64_tr_b16 v[236:237], v55 offset:28672
    ds_read_b64_tr_b16 v[238:239], v55 offset:30464
    s_mov_b32 s62, 5308416
    s_mov_b32 s63, 0x00020000
    s_sub_u32 s48, s51, 24
    v_mfma_f32_32x32x16_bf16 a[80:95], v[76:79], v[196:199], a[80:95]
    s_lshl_b32 s48, s48, 2
    s_add_u32 s48, s48, s32
    s_lshr_b32 s46, s33, 2
    s_lshl_b32 s46, s46, 5
    s_add_u32 s48, s48, s46
    s_lshl_b32 s47, s43, 6
    s_waitcnt lgkmcnt(8)
    v_mfma_f32_32x32x16_bf16 a[96:111], v[80:83], v[192:195], a[96:111]
    ds_read_b64_tr_b16 v[76:77], v47 offset:29056
    ds_read_b64_tr_b16 v[78:79], v47 offset:30848
    ds_read_b64_tr_b16 v[240:241], v56 offset:28672
    ds_read_b64_tr_b16 v[242:243], v56 offset:30464
    s_add_u32 s48, s48, s47
    s_mul_i32 s50, s48, 6912
    v_mfma_f32_32x32x16_bf16 a[112:127], v[80:83], v[196:199], a[112:127]
    s_waitcnt lgkmcnt(10)
    v_mfma_f32_32x32x16_bf16 a[128:143], v[68:71], v[192:195], a[128:143]
    ds_read_b64_tr_b16 v[80:81], v47 offset:35840
    ds_read_b64_tr_b16 v[82:83], v47 offset:37632
    v_mfma_f32_32x32x16_bf16 a[144:159], v[68:71], v[196:199], a[144:159]
    s_waitcnt lgkmcnt(10)
    v_mfma_f32_16x16x32_bf16 a[224:227], v[232:235], v[244:247], a[224:227]
    s_waitcnt lgkmcnt(8)
    v_mfma_f32_32x32x16_bf16 a[160:175], v[72:75], v[192:195], a[160:175]
    ds_read_b64_tr_b16 v[68:69], v47 offset:35904
    ds_read_b64_tr_b16 v[70:71], v47 offset:37696
    v_mfma_f32_32x32x16_bf16 a[176:191], v[72:75], v[196:199], a[176:191]
    s_waitcnt lgkmcnt(8)
    v_mfma_f32_16x16x32_bf16 a[228:231], v[236:239], v[244:247], a[228:231]
    s_waitcnt lgkmcnt(6)
    v_mfma_f32_32x32x16_bf16 a[192:207], v[76:79], v[192:195], a[192:207]
    ds_read_b64_tr_b16 v[72:73], v47 offset:35968
    ds_read_b64_tr_b16 v[74:75], v47 offset:37760
    v_mfma_f32_32x32x16_bf16 a[208:223], v[76:79], v[196:199], a[208:223]
    s_waitcnt lgkmcnt(6)
    v_mfma_f32_16x16x32_bf16 a[232:235], v[240:243], v[244:247], a[232:235]
    s_waitcnt lgkmcnt(4)
    v_mfma_f32_32x32x16_bf16 a[0:15], v[80:83], v[200:203], a[0:15]
    ds_read_b64_tr_b16 v[76:77], v47 offset:36032
    ds_read_b64_tr_b16 v[78:79], v47 offset:37824
    v_mfma_f32_32x32x16_bf16 a[16:31], v[80:83], v[204:207], a[16:31]
    s_waitcnt lgkmcnt(4)
    v_mfma_f32_32x32x16_bf16 a[32:47], v[68:71], v[200:203], a[32:47]
    ds_read_b64_tr_b16 v[80:81], v47 offset:36096
    ds_read_b64_tr_b16 v[82:83], v47 offset:37888
    s_add_u32 s47, s50, 0
    v_mfma_f32_32x32x16_bf16 a[48:63], v[68:71], v[204:207], a[48:63]
    buffer_load_dword v1, v2, s[60:63], s47 offen
    s_waitcnt lgkmcnt(4)
    v_mfma_f32_32x32x16_bf16 a[64:79], v[72:75], v[200:203], a[64:79]
    ds_read_b64_tr_b16 v[68:69], v47 offset:36160
    ds_read_b64_tr_b16 v[70:71], v47 offset:37952
    v_mfma_f32_32x32x16_bf16 a[80:95], v[72:75], v[204:207], a[80:95]
    s_waitcnt lgkmcnt(4)
    v_mfma_f32_32x32x16_bf16 a[96:111], v[76:79], v[200:203], a[96:111]
    ds_read_b64_tr_b16 v[72:73], v47 offset:36224
    ds_read_b64_tr_b16 v[74:75], v47 offset:38016
    v_mfma_f32_32x32x16_bf16 a[112:127], v[76:79], v[204:207], a[112:127]
    s_waitcnt lgkmcnt(4)
    v_mfma_f32_32x32x16_bf16 a[128:143], v[80:83], v[200:203], a[128:143]
    ds_read_b64_tr_b16 v[76:77], v47 offset:43008
    ds_read_b64_tr_b16 v[78:79], v47 offset:44800
    v_mfma_f32_32x32x16_bf16 a[144:159], v[80:83], v[204:207], a[144:159]
    s_waitcnt lgkmcnt(4)
    v_mfma_f32_32x32x16_bf16 a[160:175], v[68:71], v[200:203], a[160:175]
    ds_read_b64_tr_b16 v[80:81], v47 offset:43072
    ds_read_b64_tr_b16 v[82:83], v47 offset:44864
    v_mfma_f32_32x32x16_bf16 a[176:191], v[68:71], v[204:207], a[176:191]
    s_waitcnt lgkmcnt(4)
    v_mfma_f32_32x32x16_bf16 a[192:207], v[72:75], v[200:203], a[192:207]
    ds_read_b64_tr_b16 v[68:69], v47 offset:43136
    ds_read_b64_tr_b16 v[70:71], v47 offset:44928
    v_mfma_f32_32x32x16_bf16 a[208:223], v[72:75], v[204:207], a[208:223]
    ds_read_b128 v[248:251], v58 offset:2048
    s_waitcnt lgkmcnt(5)
    v_mfma_f32_32x32x16_bf16 a[0:15], v[76:79], v[208:211], a[0:15]
    ds_read_b64_tr_b16 v[72:73], v47 offset:43200
    ds_read_b64_tr_b16 v[74:75], v47 offset:44992
    v_mfma_f32_32x32x16_bf16 a[16:31], v[76:79], v[212:215], a[16:31]
    s_add_u32 s47, s50, 1769472
    buffer_load_dword v1, v2, s[60:63], s47 offen
    s_waitcnt lgkmcnt(5)
    v_mfma_f32_32x32x16_bf16 a[32:47], v[80:83], v[208:211], a[32:47]
    ds_read_b64_tr_b16 v[76:77], v47 offset:43264
    ds_read_b64_tr_b16 v[78:79], v47 offset:45056
    ds_read_b64_tr_b16 v[232:233], v54 offset:43008
    ds_read_b64_tr_b16 v[234:235], v54 offset:44800
    v_mfma_f32_32x32x16_bf16 a[48:63], v[80:83], v[212:215], a[48:63]
    s_waitcnt lgkmcnt(7)
    v_mfma_f32_32x32x16_bf16 a[64:79], v[68:71], v[208:211], a[64:79]
    ds_read_b64_tr_b16 v[80:81], v47 offset:43328
    ds_read_b64_tr_b16 v[82:83], v47 offset:45120
    ds_read_b64_tr_b16 v[236:237], v55 offset:43008
    ds_read_b64_tr_b16 v[238:239], v55 offset:44800
    v_mfma_f32_32x32x16_bf16 a[80:95], v[68:71], v[212:215], a[80:95]
    s_waitcnt lgkmcnt(8)
    v_mfma_f32_32x32x16_bf16 a[96:111], v[72:75], v[208:211], a[96:111]
    ds_read_b64_tr_b16 v[68:69], v47 offset:43392
    ds_read_b64_tr_b16 v[70:71], v47 offset:45184
    ds_read_b64_tr_b16 v[240:241], v56 offset:43008
    ds_read_b64_tr_b16 v[242:243], v56 offset:44800
    v_mfma_f32_32x32x16_bf16 a[112:127], v[72:75], v[212:215], a[112:127]
    s_waitcnt lgkmcnt(10)
    v_mfma_f32_32x32x16_bf16 a[128:143], v[76:79], v[208:211], a[128:143]
    ds_read_b64_tr_b16 v[72:73], v47 offset:50176
    ds_read_b64_tr_b16 v[74:75], v47 offset:51968
    v_mfma_f32_32x32x16_bf16 a[144:159], v[76:79], v[212:215], a[144:159]
    s_waitcnt lgkmcnt(10)
    v_mfma_f32_16x16x32_bf16 a[224:227], v[232:235], v[248:251], a[224:227]
    s_waitcnt lgkmcnt(8)
    v_mfma_f32_32x32x16_bf16 a[160:175], v[80:83], v[208:211], a[160:175]
    ds_read_b64_tr_b16 v[76:77], v47 offset:50240
    ds_read_b64_tr_b16 v[78:79], v47 offset:52032
    v_mfma_f32_32x32x16_bf16 a[176:191], v[80:83], v[212:215], a[176:191]
    s_waitcnt lgkmcnt(8)
    v_mfma_f32_16x16x32_bf16 a[228:231], v[236:239], v[248:251], a[228:231]
    s_waitcnt lgkmcnt(6)
    v_mfma_f32_32x32x16_bf16 a[192:207], v[68:71], v[208:211], a[192:207]
    ds_read_b64_tr_b16 v[80:81], v47 offset:50304
    ds_read_b64_tr_b16 v[82:83], v47 offset:52096
    s_waitcnt vmcnt(4)
    ds_read_b128 v[96:99], v32 offset:0
    ds_read_b128 v[100:103], v32 offset:4096
    v_mfma_f32_32x32x16_bf16 a[208:223], v[68:71], v[212:215], a[208:223]
    s_waitcnt lgkmcnt(8)
    v_mfma_f32_16x16x32_bf16 a[232:235], v[240:243], v[248:251], a[232:235]
    s_waitcnt lgkmcnt(6)
    v_mfma_f32_32x32x16_bf16 a[0:15], v[72:75], v[216:219], a[0:15]
    s_waitcnt vmcnt(3)
    s_barrier
    ds_read_b64_tr_b16 v[68:69], v47 offset:50368
    ds_read_b64_tr_b16 v[70:71], v47 offset:52160
    s_add_u32 s47, s50, 3538944
    v_mfma_f32_32x32x16_bf16 a[16:31], v[72:75], v[220:223], a[16:31]
    buffer_load_dword v1, v2, s[60:63], s47 offen
    s_waitcnt lgkmcnt(6)
    v_mfma_f32_32x32x16_bf16 a[32:47], v[76:79], v[216:219], a[32:47]
    ds_read_b64_tr_b16 v[72:73], v47 offset:50432
    ds_read_b64_tr_b16 v[74:75], v47 offset:52224
    ds_read_b128 v[104:107], v33 offset:0
    ds_read_b128 v[108:111], v33 offset:4096
    v_mfma_f32_32x32x16_bf16 a[48:63], v[76:79], v[220:223], a[48:63]
    s_waitcnt lgkmcnt(8)
    v_mfma_f32_32x32x16_bf16 a[64:79], v[80:83], v[216:219], a[64:79]
    ds_read_b64_tr_b16 v[76:77], v47 offset:50496
    ds_read_b64_tr_b16 v[78:79], v47 offset:52288
    v_mfma_f32_32x32x16_bf16 a[80:95], v[80:83], v[220:223], a[80:95]
    s_waitcnt lgkmcnt(6)
    v_mfma_f32_32x32x16_bf16 a[96:111], v[68:71], v[216:219], a[96:111]
    ds_read_b64_tr_b16 v[80:81], v47 offset:50560
    ds_read_b64_tr_b16 v[82:83], v47 offset:52352
    ds_read_b128 v[112:115], v34 offset:0
    ds_read_b128 v[116:119], v34 offset:4096
    v_mfma_f32_32x32x16_bf16 a[112:127], v[68:71], v[220:223], a[112:127]
    s_waitcnt lgkmcnt(8)
    v_mfma_f32_32x32x16_bf16 a[128:143], v[72:75], v[216:219], a[128:143]
    ds_read_b64_tr_b16 v[68:69], v84 offset:0
    ds_read_b64_tr_b16 v[70:71], v84 offset:1792
    v_mfma_f32_32x32x16_bf16 a[144:159], v[72:75], v[220:223], a[144:159]
    s_waitcnt lgkmcnt(6)
    v_mfma_f32_32x32x16_bf16 a[160:175], v[76:79], v[216:219], a[160:175]
    ds_read_b64_tr_b16 v[72:73], v84 offset:64
    ds_read_b64_tr_b16 v[74:75], v84 offset:1856
    ds_read_b128 v[120:123], v35 offset:0
    ds_read_b128 v[124:127], v35 offset:4096
    v_mfma_f32_32x32x16_bf16 a[176:191], v[76:79], v[220:223], a[176:191]
    s_waitcnt lgkmcnt(8)
    v_mfma_f32_32x32x16_bf16 a[192:207], v[80:83], v[216:219], a[192:207]
    ds_read_b64_tr_b16 v[76:77], v84 offset:128
    ds_read_b64_tr_b16 v[78:79], v84 offset:1920
    v_mfma_f32_32x32x16_bf16 a[208:223], v[80:83], v[220:223], a[208:223]
    s_mov_b32 s60, s56
    s_mov_b32 s61, s57
    s_mov_b32 s62, 663552
    s_mov_b32 s63, 0x00020000
    ds_read_b128 v[244:247], v57 offset:4096
    s_waitcnt lgkmcnt(7)
    v_mfma_f32_32x32x16_bf16 a[0:15], v[68:71], v[96:99], a[0:15]
    ds_read_b64_tr_b16 v[80:81], v84 offset:192
    ds_read_b64_tr_b16 v[82:83], v84 offset:1984
    buffer_load_dword v1, v2, s[60:63], s50 offen
    v_mfma_f32_32x32x16_bf16 a[16:31], v[68:71], v[100:103], a[16:31]
    s_waitcnt lgkmcnt(7)
    v_mfma_f32_32x32x16_bf16 a[32:47], v[72:75], v[96:99], a[32:47]
    ds_read_b64_tr_b16 v[68:69], v84 offset:256
    ds_read_b64_tr_b16 v[70:71], v84 offset:2048
    ds_read_b64_tr_b16 v[232:233], v91 offset:0
    ds_read_b64_tr_b16 v[234:235], v91 offset:1792
    v_mfma_f32_32x32x16_bf16 a[48:63], v[72:75], v[100:103], a[48:63]
    s_waitcnt lgkmcnt(7)
    v_mfma_f32_32x32x16_bf16 a[64:79], v[76:79], v[96:99], a[64:79]
    ds_read_b64_tr_b16 v[72:73], v84 offset:320
    ds_read_b64_tr_b16 v[74:75], v84 offset:2112
    ds_read_b64_tr_b16 v[236:237], v92 offset:0
    ds_read_b64_tr_b16 v[238:239], v92 offset:1792
    v_mfma_f32_32x32x16_bf16 a[80:95], v[76:79], v[100:103], a[80:95]
    s_waitcnt lgkmcnt(8)
    v_mfma_f32_32x32x16_bf16 a[96:111], v[80:83], v[96:99], a[96:111]
    ds_read_b64_tr_b16 v[76:77], v84 offset:384
    ds_read_b64_tr_b16 v[78:79], v84 offset:2176
    ds_read_b64_tr_b16 v[240:241], v93 offset:0
    ds_read_b64_tr_b16 v[242:243], v93 offset:1792
    v_mfma_f32_32x32x16_bf16 a[112:127], v[80:83], v[100:103], a[112:127]
    s_waitcnt lgkmcnt(10)
    v_mfma_f32_32x32x16_bf16 a[128:143], v[68:71], v[96:99], a[128:143]
    ds_read_b64_tr_b16 v[80:81], v84 offset:7168
    ds_read_b64_tr_b16 v[82:83], v84 offset:8960
    v_mfma_f32_32x32x16_bf16 a[144:159], v[68:71], v[100:103], a[144:159]
    s_waitcnt lgkmcnt(10)
    v_mfma_f32_16x16x32_bf16 a[224:227], v[232:235], v[244:247], a[224:227]
    s_waitcnt lgkmcnt(8)
    v_mfma_f32_32x32x16_bf16 a[160:175], v[72:75], v[96:99], a[160:175]
    ds_read_b64_tr_b16 v[68:69], v84 offset:7232
    ds_read_b64_tr_b16 v[70:71], v84 offset:9024
    v_mfma_f32_32x32x16_bf16 a[176:191], v[72:75], v[100:103], a[176:191]
    s_waitcnt lgkmcnt(8)
    v_mfma_f32_16x16x32_bf16 a[228:231], v[236:239], v[244:247], a[228:231]
    s_waitcnt lgkmcnt(6)
    v_mfma_f32_32x32x16_bf16 a[192:207], v[76:79], v[96:99], a[192:207]
    ds_read_b64_tr_b16 v[72:73], v84 offset:7296
    ds_read_b64_tr_b16 v[74:75], v84 offset:9088
    v_mfma_f32_32x32x16_bf16 a[208:223], v[76:79], v[100:103], a[208:223]
    s_waitcnt lgkmcnt(6)
    v_mfma_f32_16x16x32_bf16 a[232:235], v[240:243], v[244:247], a[232:235]
    s_waitcnt lgkmcnt(4)
    v_mfma_f32_32x32x16_bf16 a[0:15], v[80:83], v[104:107], a[0:15]
    ds_read_b64_tr_b16 v[76:77], v84 offset:7360
    ds_read_b64_tr_b16 v[78:79], v84 offset:9152
    v_mfma_f32_32x32x16_bf16 a[16:31], v[80:83], v[108:111], a[16:31]
    s_waitcnt lgkmcnt(4)
    v_mfma_f32_32x32x16_bf16 a[32:47], v[68:71], v[104:107], a[32:47]
    ds_read_b64_tr_b16 v[80:81], v84 offset:7424
    ds_read_b64_tr_b16 v[82:83], v84 offset:9216
    v_mfma_f32_32x32x16_bf16 a[48:63], v[68:71], v[108:111], a[48:63]
    s_waitcnt lgkmcnt(4)
    v_mfma_f32_32x32x16_bf16 a[64:79], v[72:75], v[104:107], a[64:79]
    ds_read_b64_tr_b16 v[68:69], v84 offset:7488
    ds_read_b64_tr_b16 v[70:71], v84 offset:9280
    v_mfma_f32_32x32x16_bf16 a[80:95], v[72:75], v[108:111], a[80:95]
    s_waitcnt lgkmcnt(4)
    v_mfma_f32_32x32x16_bf16 a[96:111], v[76:79], v[104:107], a[96:111]
    ds_read_b64_tr_b16 v[72:73], v84 offset:7552
    ds_read_b64_tr_b16 v[74:75], v84 offset:9344
    v_mfma_f32_32x32x16_bf16 a[112:127], v[76:79], v[108:111], a[112:127]
    s_waitcnt lgkmcnt(4)
    v_mfma_f32_32x32x16_bf16 a[128:143], v[80:83], v[104:107], a[128:143]
    ds_read_b64_tr_b16 v[76:77], v84 offset:14336
    ds_read_b64_tr_b16 v[78:79], v84 offset:16128
    v_mfma_f32_32x32x16_bf16 a[144:159], v[80:83], v[108:111], a[144:159]
    s_waitcnt lgkmcnt(4)
    v_mfma_f32_32x32x16_bf16 a[160:175], v[68:71], v[104:107], a[160:175]
    ds_read_b64_tr_b16 v[80:81], v84 offset:14400
    ds_read_b64_tr_b16 v[82:83], v84 offset:16192
    v_mfma_f32_32x32x16_bf16 a[176:191], v[68:71], v[108:111], a[176:191]
    s_waitcnt lgkmcnt(4)
    v_mfma_f32_32x32x16_bf16 a[192:207], v[72:75], v[104:107], a[192:207]
    ds_read_b64_tr_b16 v[68:69], v84 offset:14464
    ds_read_b64_tr_b16 v[70:71], v84 offset:16256
    v_mfma_f32_32x32x16_bf16 a[208:223], v[72:75], v[108:111], a[208:223]
    ds_read_b128 v[248:251], v58 offset:4096
    s_waitcnt lgkmcnt(5)
    v_mfma_f32_32x32x16_bf16 a[0:15], v[76:79], v[112:115], a[0:15]
    ds_read_b64_tr_b16 v[72:73], v84 offset:14528
    ds_read_b64_tr_b16 v[74:75], v84 offset:16320
    v_mfma_f32_32x32x16_bf16 a[16:31], v[76:79], v[116:119], a[16:31]
    s_waitcnt lgkmcnt(5)
    v_mfma_f32_32x32x16_bf16 a[32:47], v[80:83], v[112:115], a[32:47]
    ds_read_b64_tr_b16 v[76:77], v84 offset:14592
    ds_read_b64_tr_b16 v[78:79], v84 offset:16384
    ds_read_b64_tr_b16 v[232:233], v91 offset:14336
    ds_read_b64_tr_b16 v[234:235], v91 offset:16128
    v_mfma_f32_32x32x16_bf16 a[48:63], v[80:83], v[116:119], a[48:63]
    s_waitcnt lgkmcnt(7)
    v_mfma_f32_32x32x16_bf16 a[64:79], v[68:71], v[112:115], a[64:79]
    ds_read_b64_tr_b16 v[80:81], v84 offset:14656
    ds_read_b64_tr_b16 v[82:83], v84 offset:16448
    ds_read_b64_tr_b16 v[236:237], v92 offset:14336
    ds_read_b64_tr_b16 v[238:239], v92 offset:16128
    v_mfma_f32_32x32x16_bf16 a[80:95], v[68:71], v[116:119], a[80:95]
    s_waitcnt lgkmcnt(8)
    v_mfma_f32_32x32x16_bf16 a[96:111], v[72:75], v[112:115], a[96:111]
    ds_read_b64_tr_b16 v[68:69], v84 offset:14720
    ds_read_b64_tr_b16 v[70:71], v84 offset:16512
    ds_read_b64_tr_b16 v[240:241], v93 offset:14336
    ds_read_b64_tr_b16 v[242:243], v93 offset:16128
    v_mfma_f32_32x32x16_bf16 a[112:127], v[72:75], v[116:119], a[112:127]
    s_waitcnt lgkmcnt(10)
    v_mfma_f32_32x32x16_bf16 a[128:143], v[76:79], v[112:115], a[128:143]
    ds_read_b64_tr_b16 v[72:73], v84 offset:21504
    ds_read_b64_tr_b16 v[74:75], v84 offset:23296
    v_mfma_f32_32x32x16_bf16 a[144:159], v[76:79], v[116:119], a[144:159]
    s_waitcnt lgkmcnt(10)
    v_mfma_f32_16x16x32_bf16 a[224:227], v[232:235], v[248:251], a[224:227]
    s_waitcnt lgkmcnt(8)
    v_mfma_f32_32x32x16_bf16 a[160:175], v[80:83], v[112:115], a[160:175]
    ds_read_b64_tr_b16 v[76:77], v84 offset:21568
    ds_read_b64_tr_b16 v[78:79], v84 offset:23360
    v_mfma_f32_32x32x16_bf16 a[176:191], v[80:83], v[116:119], a[176:191]
    s_waitcnt lgkmcnt(8)
    v_mfma_f32_16x16x32_bf16 a[228:231], v[236:239], v[248:251], a[228:231]
    s_waitcnt lgkmcnt(6)
    v_mfma_f32_32x32x16_bf16 a[192:207], v[68:71], v[112:115], a[192:207]
    ds_read_b64_tr_b16 v[80:81], v84 offset:21632
    ds_read_b64_tr_b16 v[82:83], v84 offset:23424
    v_mfma_f32_32x32x16_bf16 a[208:223], v[68:71], v[116:119], a[208:223]
    s_waitcnt lgkmcnt(6)
    v_mfma_f32_16x16x32_bf16 a[232:235], v[240:243], v[248:251], a[232:235]
    s_waitcnt lgkmcnt(4)
    v_mfma_f32_32x32x16_bf16 a[0:15], v[72:75], v[120:123], a[0:15]
    ds_read_b64_tr_b16 v[68:69], v84 offset:21696
    ds_read_b64_tr_b16 v[70:71], v84 offset:23488
    v_mfma_f32_32x32x16_bf16 a[16:31], v[72:75], v[124:127], a[16:31]
    s_waitcnt lgkmcnt(4)
    v_mfma_f32_32x32x16_bf16 a[32:47], v[76:79], v[120:123], a[32:47]
    ds_read_b64_tr_b16 v[72:73], v84 offset:21760
    ds_read_b64_tr_b16 v[74:75], v84 offset:23552
    v_mfma_f32_32x32x16_bf16 a[48:63], v[76:79], v[124:127], a[48:63]
    s_waitcnt lgkmcnt(4)
    v_mfma_f32_32x32x16_bf16 a[64:79], v[80:83], v[120:123], a[64:79]
    ds_read_b64_tr_b16 v[76:77], v84 offset:21824
    ds_read_b64_tr_b16 v[78:79], v84 offset:23616
    v_mfma_f32_32x32x16_bf16 a[80:95], v[80:83], v[124:127], a[80:95]
    s_waitcnt lgkmcnt(4)
    v_mfma_f32_32x32x16_bf16 a[96:111], v[68:71], v[120:123], a[96:111]
    ds_read_b64_tr_b16 v[80:81], v84 offset:21888
    ds_read_b64_tr_b16 v[82:83], v84 offset:23680
    v_mfma_f32_32x32x16_bf16 a[112:127], v[68:71], v[124:127], a[112:127]
    s_waitcnt lgkmcnt(4)
    v_mfma_f32_32x32x16_bf16 a[128:143], v[72:75], v[120:123], a[128:143]
    v_mfma_f32_32x32x16_bf16 a[144:159], v[72:75], v[124:127], a[144:159]
    s_waitcnt lgkmcnt(2)
    v_mfma_f32_32x32x16_bf16 a[160:175], v[76:79], v[120:123], a[160:175]
    v_mfma_f32_32x32x16_bf16 a[176:191], v[76:79], v[124:127], a[176:191]
    s_waitcnt lgkmcnt(0)
    v_mfma_f32_32x32x16_bf16 a[192:207], v[80:83], v[120:123], a[192:207]
    v_mfma_f32_32x32x16_bf16 a[208:223], v[80:83], v[124:127], a[208:223]
    s_waitcnt lgkmcnt(0)
    s_nop 7
    s_nop 7
    s_barrier
    v_and_b32 v2, 31, v0
    v_lshrrev_b32 v3, 5, v0
    s_lshl_b32 s46, s32, 6
    s_add_u32 s46, s46, 16
    v_add_u32 v4, s46, v2
    v_mul_u32_u24 v4, 592, v4
    v_lshl_add_u32 v8, v3, 4, v4
    v_mul_u32_u24 v5, 144, v3
    v_add_u32 v4, v4, v5
    ds_write_b128 v8, a[0:3] offset:0
    ds_write_b128 v8, a[4:7] offset:32
    ds_write_b128 v8, a[8:11] offset:64
    ds_write_b128 v8, a[12:15] offset:96
    ds_write_b128 v8, a[32:35] offset:128
    ds_write_b128 v8, a[36:39] offset:160
    ds_write_b128 v8, a[40:43] offset:192
    ds_write_b128 v8, a[44:47] offset:224
    ds_write_b128 v8, a[64:67] offset:256
    ds_write_b128 v8, a[16:19] offset:18944
    ds_write_b128 v8, a[20:23] offset:18976
    ds_write_b128 v8, a[24:27] offset:19008
    ds_write_b128 v8, a[28:31] offset:19040
    s_waitcnt lgkmcnt(0)
    ds_write_b128 v8, a[48:51] offset:19072
    ds_write_b128 v8, a[52:55] offset:19104
    ds_write_b128 v8, a[56:59] offset:19136
    ds_write_b128 v8, a[60:63] offset:19168
    ds_write_b128 v8, a[80:83] offset:19200
    ds_read_b128 v[84:87], v4 offset:0
    ds_read_b128 v[88:91], v4 offset:16
    ds_read_b128 v[92:95], v4 offset:32
    ds_read_b128 v[96:99], v4 offset:48
    ds_read_b128 v[100:103], v4 offset:64
    ds_read_b128 v[104:107], v4 offset:80
    ds_read_b128 v[108:111], v4 offset:96
    ds_read_b128 v[112:115], v4 offset:112
    s_waitcnt lgkmcnt(8)
    ds_read_b128 v[116:119], v4 offset:128
    ds_read_b128 v[120:123], v4 offset:18944
    ds_read_b128 v[124:127], v4 offset:18960
    ds_read_b128 v[128:131], v4 offset:18976
    ds_read_b128 v[132:135], v4 offset:18992
    s_waitcnt lgkmcnt(0)
    ds_read_b128 v[136:139], v4 offset:19008
    ds_read_b128 v[140:143], v4 offset:19024
    ds_read_b128 v[144:147], v4 offset:19040
    ds_read_b128 v[148:151], v4 offset:19056
    ds_read_b128 v[152:155], v4 offset:19072
    ds_write_b128 v8, a[68:71] offset:0
    ds_write_b128 v8, a[72:75] offset:32
    ds_write_b128 v8, a[76:79] offset:64
    ds_write_b128 v8, a[96:99] offset:96
    ds_write_b128 v8, a[100:103] offset:128
    ds_write_b128 v8, a[104:107] offset:160
    ds_write_b128 v8, a[108:111] offset:192
    ds_write_b128 v8, a[128:131] offset:224
    s_waitcnt lgkmcnt(8)
    ds_write_b128 v8, a[132:135] offset:256
    ds_write_b128 v8, a[136:139] offset:288
    ds_write_b128 v8, a[140:143] offset:320
    ds_write_b128 v8, a[160:163] offset:352
    ds_write_b128 v8, a[164:167] offset:384
    s_waitcnt lgkmcnt(0)
    ds_write_b128 v8, a[168:171] offset:416
    ds_write_b128 v8, a[172:175] offset:448
    ds_write_b128 v8, a[192:195] offset:480
    ds_write_b128 v8, a[196:199] offset:512
    ds_write_b128 v8, a[200:203] offset:544
    ds_write_b128 v8, a[84:87] offset:18944
    ds_write_b128 v8, a[88:91] offset:18976
    ds_write_b128 v8, a[92:95] offset:19008
    ds_write_b128 v8, a[112:115] offset:19040
    ds_write_b128 v8, a[116:119] offset:19072
    ds_write_b128 v8, a[120:123] offset:19104
    ds_write_b128 v8, a[124:127] offset:19136
    ds_write_b128 v8, a[144:147] offset:19168
    s_waitcnt lgkmcnt(0)
    ds_write_b128 v8, a[148:151] offset:19200
    ds_write_b128 v8, a[152:155] offset:19232
    ds_write_b128 v8, a[156:159] offset:19264
    ds_write_b128 v8, a[176:179] offset:19296
    ds_write_b128 v8, a[180:183] offset:19328
    ds_write_b128 v8, a[184:187] offset:19360
    ds_write_b128 v8, a[188:191] offset:19392
    ds_write_b128 v8, a[208:211] offset:19424
    ds_write_b128 v8, a[212:215] offset:19456
    ds_write_b128 v8, a[216:219] offset:19488
    ds_write_b128 v60, a[224:227]
    ds_write_b128 v61, a[228:231]
    ds_write_b128 v62, a[232:235]
    s_mov_b32 s48, 0x3eae1a93
    s_waitcnt lgkmcnt(0)
    s_waitcnt vmcnt(4)
    s_mov_b32 s69, 200000
L_NG9339:
    v_readfirstlane_b32 s68, v252
    s_nop 3
    s_cmp_lg_u32 s68, 0
    s_cbranch_scc1 L_NG9339_D
    s_sub_u32 s69, s69, 1
    s_cmp_eq_u32 s69, 0
    s_cbranch_scc1 L_NG9339_D
    s_sleep 4
    buffer_load_dword v252, v253, s[20:23], 0 offen sc0 sc1
    s_waitcnt vmcnt(0)
    s_branch L_NG9339
L_NG9339_D:
    s_barrier
    s_lshl_b32 s46, s33, 2
    s_add_u32 s46, s46, s32
    s_lshl_b32 s46, s46, 6
    v_add_u32 v5, s46, v2
    v_subrev_u32 v9, 8288, v4
    s_mul_i32 s47, s34, 4608
    v_mul_u32_u24 v6, 2560, v3
    v_lshl_add_u32 v7, v2, 4, s47
    v_add_u32 v240, v6, v7
    v_mul_u32_u24 v6, 331776, v3
    v_add3_u32 v241, v6, v7, 0
    v_add_u32 v241, 2048, v241
    s_lshl_b32 s46, s33, 3
    s_lshl_b32 s47, s32, 1
    s_add_u32 s46, s46, s47
    s_mul_i32 s37, s46, 331776
    ds_read_b128 v[160:163], v9 offset:8288
    ds_read_b128 v[164:167], v9 offset:8304
    ds_read_b128 v[168:171], v9 offset:8320
    ds_read_b128 v[172:175], v9 offset:8336
    ds_read_b128 v[176:179], v9 offset:8352
    ds_read_b128 v[180:183], v9 offset:8368
    ds_read_b128 v[184:187], v9 offset:8384
    ds_read_b128 v[188:191], v9 offset:8400
    ds_read_b128 v[192:195], v9 offset:8416
    s_waitcnt lgkmcnt(0)
    ds_read_b128 v[196:199], v9 offset:7104
    ds_read_b128 v[200:203], v9 offset:7120
    ds_read_b128 v[204:207], v9 offset:7136
    ds_read_b128 v[208:211], v9 offset:7152
    ds_read_b128 v[212:215], v9 offset:7168
    ds_read_b128 v[216:219], v9 offset:7184
    ds_read_b128 v[220:223], v9 offset:7200
    ds_read_b128 v[224:227], v9 offset:7216
    ds_read_b128 v[228:231], v9 offset:7232
    v_pk_mul_f32 v[232:233], v[84:85], v[160:161]
    v_pk_mul_f32 v[236:237], v[102:103], v[178:179]
    v_pk_mul_f32 v[234:235], v[86:87], v[162:163]
    v_pk_mul_f32 v[238:239], v[104:105], v[180:181]
    v_pk_fma_f32 v[232:233], v[88:89], v[164:165], v[232:233]
    v_pk_fma_f32 v[236:237], v[106:107], v[182:183], v[236:237]
    v_pk_fma_f32 v[234:235], v[90:91], v[166:167], v[234:235]
    v_pk_fma_f32 v[238:239], v[108:109], v[184:185], v[238:239]
    v_pk_fma_f32 v[232:233], v[92:93], v[168:169], v[232:233]
    v_pk_fma_f32 v[236:237], v[110:111], v[186:187], v[236:237]
    v_pk_fma_f32 v[234:235], v[94:95], v[170:171], v[234:235]
    v_pk_fma_f32 v[238:239], v[112:113], v[188:189], v[238:239]
    v_pk_fma_f32 v[232:233], v[96:97], v[172:173], v[232:233]
    v_pk_fma_f32 v[236:237], v[114:115], v[190:191], v[236:237]
    v_pk_fma_f32 v[234:235], v[98:99], v[174:175], v[234:235]
    v_pk_fma_f32 v[238:239], v[116:117], v[192:193], v[238:239]
    v_pk_fma_f32 v[232:233], v[100:101], v[176:177], v[232:233]
    v_pk_fma_f32 v[236:237], v[118:119], v[194:195], v[236:237]
    v_pk_add_f32 v[232:233], v[232:233], v[234:235]
    v_pk_add_f32 v[236:237], v[236:237], v[238:239]
    v_add_f32 v10, v232, v233
    v_add_f32 v18, v236, v237
    s_waitcnt lgkmcnt(0)
    ds_read_b128 v[160:163], v9 offset:5920
    ds_read_b128 v[164:167], v9 offset:5936
    ds_read_b128 v[168:171], v9 offset:5952
    ds_read_b128 v[172:175], v9 offset:5968
    ds_read_b128 v[176:179], v9 offset:5984
    ds_read_b128 v[180:183], v9 offset:6000
    ds_read_b128 v[184:187], v9 offset:6016
    ds_read_b128 v[188:191], v9 offset:6032
    ds_read_b128 v[192:195], v9 offset:6048
    v_pk_mul_f32 v[232:233], v[84:85], v[196:197]
    v_pk_mul_f32 v[236:237], v[102:103], v[214:215]
    v_pk_mul_f32 v[234:235], v[86:87], v[198:199]
    v_pk_mul_f32 v[238:239], v[104:105], v[216:217]
    v_pk_fma_f32 v[232:233], v[88:89], v[200:201], v[232:233]
    v_pk_fma_f32 v[236:237], v[106:107], v[218:219], v[236:237]
    v_pk_fma_f32 v[234:235], v[90:91], v[202:203], v[234:235]
    v_pk_fma_f32 v[238:239], v[108:109], v[220:221], v[238:239]
    v_pk_fma_f32 v[232:233], v[92:93], v[204:205], v[232:233]
    v_pk_fma_f32 v[236:237], v[110:111], v[222:223], v[236:237]
    v_pk_fma_f32 v[234:235], v[94:95], v[206:207], v[234:235]
    v_pk_fma_f32 v[238:239], v[112:113], v[224:225], v[238:239]
    v_pk_fma_f32 v[232:233], v[96:97], v[208:209], v[232:233]
    v_pk_fma_f32 v[236:237], v[114:115], v[226:227], v[236:237]
    v_pk_fma_f32 v[234:235], v[98:99], v[210:211], v[234:235]
    v_pk_fma_f32 v[238:239], v[116:117], v[228:229], v[238:239]
    v_pk_fma_f32 v[232:233], v[100:101], v[212:213], v[232:233]
    v_pk_fma_f32 v[236:237], v[118:119], v[230:231], v[236:237]
    v_pk_add_f32 v[232:233], v[232:233], v[234:235]
    v_pk_add_f32 v[236:237], v[236:237], v[238:239]
    v_add_f32 v11, v232, v233
    v_add_f32 v19, v236, v237
    s_waitcnt lgkmcnt(0)
    ds_read_b128 v[196:199], v9 offset:4736
    ds_read_b128 v[200:203], v9 offset:4752
    ds_read_b128 v[204:207], v9 offset:4768
    ds_read_b128 v[208:211], v9 offset:4784
    ds_read_b128 v[212:215], v9 offset:4800
    ds_read_b128 v[216:219], v9 offset:4816
    ds_read_b128 v[220:223], v9 offset:4832
    ds_read_b128 v[224:227], v9 offset:4848
    ds_read_b128 v[228:231], v9 offset:4864
    v_pk_mul_f32 v[232:233], v[84:85], v[160:161]
    v_pk_mul_f32 v[236:237], v[102:103], v[178:179]
    v_pk_mul_f32 v[234:235], v[86:87], v[162:163]
    v_pk_mul_f32 v[238:239], v[104:105], v[180:181]
    v_pk_fma_f32 v[232:233], v[88:89], v[164:165], v[232:233]
    v_pk_fma_f32 v[236:237], v[106:107], v[182:183], v[236:237]
    v_pk_fma_f32 v[234:235], v[90:91], v[166:167], v[234:235]
    v_pk_fma_f32 v[238:239], v[108:109], v[184:185], v[238:239]
    v_pk_fma_f32 v[232:233], v[92:93], v[168:169], v[232:233]
    v_pk_fma_f32 v[236:237], v[110:111], v[186:187], v[236:237]
    v_pk_fma_f32 v[234:235], v[94:95], v[170:171], v[234:235]
    v_pk_fma_f32 v[238:239], v[112:113], v[188:189], v[238:239]
    v_pk_fma_f32 v[232:233], v[96:97], v[172:173], v[232:233]
    v_pk_fma_f32 v[236:237], v[114:115], v[190:191], v[236:237]
    v_pk_fma_f32 v[234:235], v[98:99], v[174:175], v[234:235]
    v_pk_fma_f32 v[238:239], v[116:117], v[192:193], v[238:239]
    v_pk_fma_f32 v[232:233], v[100:101], v[176:177], v[232:233]
    v_pk_fma_f32 v[236:237], v[118:119], v[194:195], v[236:237]
    v_pk_add_f32 v[232:233], v[232:233], v[234:235]
    v_pk_add_f32 v[236:237], v[236:237], v[238:239]
    v_add_f32 v12, v232, v233
    v_add_f32 v20, v236, v237
    s_waitcnt lgkmcnt(0)
    ds_read_b128 v[160:163], v9 offset:3552
    ds_read_b128 v[164:167], v9 offset:3568
    ds_read_b128 v[168:171], v9 offset:3584
    ds_read_b128 v[172:175], v9 offset:3600
    ds_read_b128 v[176:179], v9 offset:3616
    ds_read_b128 v[180:183], v9 offset:3632
    ds_read_b128 v[184:187], v9 offset:3648
    ds_read_b128 v[188:191], v9 offset:3664
    ds_read_b128 v[192:195], v9 offset:3680
    v_pk_mul_f32 v[232:233], v[84:85], v[196:197]
    v_pk_mul_f32 v[236:237], v[102:103], v[214:215]
    v_pk_mul_f32 v[234:235], v[86:87], v[198:199]
    v_pk_mul_f32 v[238:239], v[104:105], v[216:217]
    v_pk_fma_f32 v[232:233], v[88:89], v[200:201], v[232:233]
    v_pk_fma_f32 v[236:237], v[106:107], v[218:219], v[236:237]
    v_pk_fma_f32 v[234:235], v[90:91], v[202:203], v[234:235]
    v_pk_fma_f32 v[238:239], v[108:109], v[220:221], v[238:239]
    v_pk_fma_f32 v[232:233], v[92:93], v[204:205], v[232:233]
    v_pk_fma_f32 v[236:237], v[110:111], v[222:223], v[236:237]
    v_pk_fma_f32 v[234:235], v[94:95], v[206:207], v[234:235]
    v_pk_fma_f32 v[238:239], v[112:113], v[224:225], v[238:239]
    v_pk_fma_f32 v[232:233], v[96:97], v[208:209], v[232:233]
    v_pk_fma_f32 v[236:237], v[114:115], v[226:227], v[236:237]
    v_pk_fma_f32 v[234:235], v[98:99], v[210:211], v[234:235]
    v_pk_fma_f32 v[238:239], v[116:117], v[228:229], v[238:239]
    v_pk_fma_f32 v[232:233], v[100:101], v[212:213], v[232:233]
    v_pk_fma_f32 v[236:237], v[118:119], v[230:231], v[236:237]
    v_pk_add_f32 v[232:233], v[232:233], v[234:235]
    v_pk_add_f32 v[236:237], v[236:237], v[238:239]
    v_add_f32 v13, v232, v233
    v_add_f32 v21, v236, v237
    s_waitcnt lgkmcnt(0)
    ds_read_b128 v[196:199], v9 offset:2368
    ds_read_b128 v[200:203], v9 offset:2384
    ds_read_b128 v[204:207], v9 offset:2400
    ds_read_b128 v[208:211], v9 offset:2416
    ds_read_b128 v[212:215], v9 offset:2432
    ds_read_b128 v[216:219], v9 offset:2448
    ds_read_b128 v[220:223], v9 offset:2464
    ds_read_b128 v[224:227], v9 offset:2480
    ds_read_b128 v[228:231], v9 offset:2496
    v_pk_mul_f32 v[232:233], v[84:85], v[160:161]
    v_pk_mul_f32 v[236:237], v[102:103], v[178:179]
    v_pk_mul_f32 v[234:235], v[86:87], v[162:163]
    v_pk_mul_f32 v[238:239], v[104:105], v[180:181]
    v_pk_fma_f32 v[232:233], v[88:89], v[164:165], v[232:233]
    v_pk_fma_f32 v[236:237], v[106:107], v[182:183], v[236:237]
    v_pk_fma_f32 v[234:235], v[90:91], v[166:167], v[234:235]
    v_pk_fma_f32 v[238:239], v[108:109], v[184:185], v[238:239]
    v_pk_fma_f32 v[232:233], v[92:93], v[168:169], v[232:233]
    v_pk_fma_f32 v[236:237], v[110:111], v[186:187], v[236:237]
    v_pk_fma_f32 v[234:235], v[94:95], v[170:171], v[234:235]
    v_pk_fma_f32 v[238:239], v[112:113], v[188:189], v[238:239]
    v_pk_fma_f32 v[232:233], v[96:97], v[172:173], v[232:233]
    v_pk_fma_f32 v[236:237], v[114:115], v[190:191], v[236:237]
    v_pk_fma_f32 v[234:235], v[98:99], v[174:175], v[234:235]
    v_pk_fma_f32 v[238:239], v[116:117], v[192:193], v[238:239]
    v_pk_fma_f32 v[232:233], v[100:101], v[176:177], v[232:233]
    v_pk_fma_f32 v[236:237], v[118:119], v[194:195], v[236:237]
    v_pk_add_f32 v[232:233], v[232:233], v[234:235]
    v_pk_add_f32 v[236:237], v[236:237], v[238:239]
    v_add_f32 v14, v232, v233
    v_add_f32 v22, v236, v237
    s_waitcnt lgkmcnt(0)
    ds_read_b128 v[160:163], v9 offset:1184
    ds_read_b128 v[164:167], v9 offset:1200
    ds_read_b128 v[168:171], v9 offset:1216
    ds_read_b128 v[172:175], v9 offset:1232
    ds_read_b128 v[176:179], v9 offset:1248
    ds_read_b128 v[180:183], v9 offset:1264
    ds_read_b128 v[184:187], v9 offset:1280
    ds_read_b128 v[188:191], v9 offset:1296
    ds_read_b128 v[192:195], v9 offset:1312
    v_pk_mul_f32 v[232:233], v[84:85], v[196:197]
    v_pk_mul_f32 v[236:237], v[102:103], v[214:215]
    v_pk_mul_f32 v[234:235], v[86:87], v[198:199]
    v_pk_mul_f32 v[238:239], v[104:105], v[216:217]
    v_pk_fma_f32 v[232:233], v[88:89], v[200:201], v[232:233]
    v_pk_fma_f32 v[236:237], v[106:107], v[218:219], v[236:237]
    v_pk_fma_f32 v[234:235], v[90:91], v[202:203], v[234:235]
    v_pk_fma_f32 v[238:239], v[108:109], v[220:221], v[238:239]
    v_pk_fma_f32 v[232:233], v[92:93], v[204:205], v[232:233]
    v_pk_fma_f32 v[236:237], v[110:111], v[222:223], v[236:237]
    v_pk_fma_f32 v[234:235], v[94:95], v[206:207], v[234:235]
    v_pk_fma_f32 v[238:239], v[112:113], v[224:225], v[238:239]
    v_pk_fma_f32 v[232:233], v[96:97], v[208:209], v[232:233]
    v_pk_fma_f32 v[236:237], v[114:115], v[226:227], v[236:237]
    v_pk_fma_f32 v[234:235], v[98:99], v[210:211], v[234:235]
    v_pk_fma_f32 v[238:239], v[116:117], v[228:229], v[238:239]
    v_pk_fma_f32 v[232:233], v[100:101], v[212:213], v[232:233]
    v_pk_fma_f32 v[236:237], v[118:119], v[230:231], v[236:237]
    v_pk_add_f32 v[232:233], v[232:233], v[234:235]
    v_pk_add_f32 v[236:237], v[236:237], v[238:239]
    v_add_f32 v15, v232, v233
    v_add_f32 v23, v236, v237
    s_waitcnt lgkmcnt(0)
    ds_read_b128 v[196:199], v9 offset:0
    ds_read_b128 v[200:203], v9 offset:16
    ds_read_b128 v[204:207], v9 offset:32
    ds_read_b128 v[208:211], v9 offset:48
    ds_read_b128 v[212:215], v9 offset:64
    ds_read_b128 v[216:219], v9 offset:80
    ds_read_b128 v[220:223], v9 offset:96
    ds_read_b128 v[224:227], v9 offset:112
    ds_read_b128 v[228:231], v9 offset:128
    v_pk_mul_f32 v[232:233], v[84:85], v[160:161]
    v_pk_mul_f32 v[236:237], v[102:103], v[178:179]
    v_pk_mul_f32 v[234:235], v[86:87], v[162:163]
    v_pk_mul_f32 v[238:239], v[104:105], v[180:181]
    v_pk_fma_f32 v[232:233], v[88:89], v[164:165], v[232:233]
    v_pk_fma_f32 v[236:237], v[106:107], v[182:183], v[236:237]
    v_pk_fma_f32 v[234:235], v[90:91], v[166:167], v[234:235]
    v_pk_fma_f32 v[238:239], v[108:109], v[184:185], v[238:239]
    v_pk_fma_f32 v[232:233], v[92:93], v[168:169], v[232:233]
    v_pk_fma_f32 v[236:237], v[110:111], v[186:187], v[236:237]
    v_pk_fma_f32 v[234:235], v[94:95], v[170:171], v[234:235]
    v_pk_fma_f32 v[238:239], v[112:113], v[188:189], v[238:239]
    v_pk_fma_f32 v[232:233], v[96:97], v[172:173], v[232:233]
    v_pk_fma_f32 v[236:237], v[114:115], v[190:191], v[236:237]
    v_pk_fma_f32 v[234:235], v[98:99], v[174:175], v[234:235]
    v_pk_fma_f32 v[238:239], v[116:117], v[192:193], v[238:239]
    v_pk_fma_f32 v[232:233], v[100:101], v[176:177], v[232:233]
    v_pk_fma_f32 v[236:237], v[118:119], v[194:195], v[236:237]
    v_pk_add_f32 v[232:233], v[232:233], v[234:235]
    v_pk_add_f32 v[236:237], v[236:237], v[238:239]
    v_add_f32 v16, v232, v233
    v_add_f32 v24, v236, v237
    s_waitcnt lgkmcnt(0)
    ds_read_b128 v[160:163], v9 offset:8576
    ds_read_b128 v[164:167], v9 offset:8592
    ds_read_b128 v[168:171], v9 offset:8608
    ds_read_b128 v[172:175], v9 offset:8624
    ds_read_b128 v[176:179], v9 offset:8640
    ds_read_b128 v[180:183], v9 offset:8656
    ds_read_b128 v[184:187], v9 offset:8672
    ds_read_b128 v[188:191], v9 offset:8688
    ds_read_b128 v[192:195], v9 offset:8704
    v_pk_mul_f32 v[232:233], v[84:85], v[196:197]
    v_pk_mul_f32 v[236:237], v[102:103], v[214:215]
    v_pk_mul_f32 v[234:235], v[86:87], v[198:199]
    v_pk_mul_f32 v[238:239], v[104:105], v[216:217]
    v_pk_fma_f32 v[232:233], v[88:89], v[200:201], v[232:233]
    v_pk_fma_f32 v[236:237], v[106:107], v[218:219], v[236:237]
    v_pk_fma_f32 v[234:235], v[90:91], v[202:203], v[234:235]
    v_pk_fma_f32 v[238:239], v[108:109], v[220:221], v[238:239]
    v_pk_fma_f32 v[232:233], v[92:93], v[204:205], v[232:233]
    v_pk_fma_f32 v[236:237], v[110:111], v[222:223], v[236:237]
    v_pk_fma_f32 v[234:235], v[94:95], v[206:207], v[234:235]
    v_pk_fma_f32 v[238:239], v[112:113], v[224:225], v[238:239]
    v_pk_fma_f32 v[232:233], v[96:97], v[208:209], v[232:233]
    v_pk_fma_f32 v[236:237], v[114:115], v[226:227], v[236:237]
    v_pk_fma_f32 v[234:235], v[98:99], v[210:211], v[234:235]
    v_pk_fma_f32 v[238:239], v[116:117], v[228:229], v[238:239]
    v_pk_fma_f32 v[232:233], v[100:101], v[212:213], v[232:233]
    v_pk_fma_f32 v[236:237], v[118:119], v[230:231], v[236:237]
    v_pk_add_f32 v[232:233], v[232:233], v[234:235]
    v_pk_add_f32 v[236:237], v[236:237], v[238:239]
    v_add_f32 v17, v232, v233
    v_add_f32 v25, v236, v237
    v_add_u32 v26, 0, v5
    v_mov_b32 v27, 0xff7fffff
    v_cmp_le_u32 vcc, 2, v26
    s_nop 1
    v_cndmask_b32 v11, v27, v11, vcc
    v_cndmask_b32 v19, v27, v19, vcc
    v_cmp_le_u32 vcc, 4, v26
    s_nop 1
    v_cndmask_b32 v12, v27, v12, vcc
    v_cndmask_b32 v20, v27, v20, vcc
    v_cmp_le_u32 vcc, 6, v26
    s_nop 1
    v_cndmask_b32 v13, v27, v13, vcc
    v_cndmask_b32 v21, v27, v21, vcc
    v_cmp_le_u32 vcc, 8, v26
    s_nop 1
    v_cndmask_b32 v14, v27, v14, vcc
    v_cndmask_b32 v22, v27, v22, vcc
    v_cmp_le_u32 vcc, 10, v26
    s_nop 1
    v_cndmask_b32 v15, v27, v15, vcc
    v_cndmask_b32 v23, v27, v23, vcc
    v_cmp_le_u32 vcc, 12, v26
    s_nop 1
    v_cndmask_b32 v16, v27, v16, vcc
    v_cndmask_b32 v24, v27, v24, vcc
    v_cmp_le_u32 vcc, 14, v26
    s_nop 1
    v_cndmask_b32 v17, v27, v17, vcc
    v_cndmask_b32 v25, v27, v25, vcc
    v_max3_f32 v28, v10, v11, v12
    v_max3_f32 v28, v28, v13, v14
    v_max3_f32 v28, v28, v15, v16
    v_max_f32 v28, v28, v17
    v_max3_f32 v29, v18, v19, v20
    v_max3_f32 v29, v29, v21, v22
    v_max3_f32 v29, v29, v23, v24
    v_max_f32 v29, v29, v25
    v_sub_f32 v10, v10, v28
    v_sub_f32 v11, v11, v28
    v_sub_f32 v12, v12, v28
    v_sub_f32 v13, v13, v28
    v_sub_f32 v14, v14, v28
    v_sub_f32 v15, v15, v28
    v_sub_f32 v16, v16, v28
    v_sub_f32 v17, v17, v28
    v_mul_f32 v10, s48, v10
    v_mul_f32 v11, s48, v11
    v_mul_f32 v12, s48, v12
    v_mul_f32 v13, s48, v13
    v_mul_f32 v14, s48, v14
    v_mul_f32 v15, s48, v15
    v_mul_f32 v16, s48, v16
    v_mul_f32 v17, s48, v17
    v_sub_f32 v18, v18, v29
    v_sub_f32 v19, v19, v29
    v_sub_f32 v20, v20, v29
    v_sub_f32 v21, v21, v29
    v_sub_f32 v22, v22, v29
    v_sub_f32 v23, v23, v29
    v_sub_f32 v24, v24, v29
    v_sub_f32 v25, v25, v29
    v_mul_f32 v18, s48, v18
    v_mul_f32 v19, s48, v19
    v_mul_f32 v20, s48, v20
    v_mul_f32 v21, s48, v21
    v_mul_f32 v22, s48, v22
    v_mul_f32 v23, s48, v23
    v_mul_f32 v24, s48, v24
    v_mul_f32 v25, s48, v25
    v_exp_f32 v10, v10
    v_exp_f32 v11, v11
    v_exp_f32 v12, v12
    v_exp_f32 v13, v13
    v_exp_f32 v14, v14
    v_exp_f32 v15, v15
    v_exp_f32 v16, v16
    v_exp_f32 v17, v17
    v_exp_f32 v18, v18
    v_exp_f32 v19, v19
    v_exp_f32 v20, v20
    v_exp_f32 v21, v21
    v_exp_f32 v22, v22
    v_exp_f32 v23, v23
    v_exp_f32 v24, v24
    v_exp_f32 v25, v25
    s_nop 0
    v_add_f32 v28, v10, v11
    v_add_f32 v29, v18, v19
    v_add_f32 v28, v28, v12
    v_add_f32 v29, v29, v20
    v_add_f32 v28, v28, v13
    v_add_f32 v29, v29, v21
    v_add_f32 v28, v28, v14
    v_add_f32 v29, v29, v22
    v_add_f32 v28, v28, v15
    v_add_f32 v29, v29, v23
    v_add_f32 v28, v28, v16
    v_add_f32 v29, v29, v24
    v_add_f32 v28, v28, v17
    v_add_f32 v29, v29, v25
    v_rcp_f32 v28, v28
    v_rcp_f32 v29, v29
    s_nop 0
    v_mul_f32 v10, v10, v28
    v_mul_f32 v11, v11, v28
    v_mul_f32 v12, v12, v28
    v_mul_f32 v13, v13, v28
    v_mul_f32 v14, v14, v28
    v_mul_f32 v15, v15, v28
    v_mul_f32 v16, v16, v28
    v_mul_f32 v17, v17, v28
    v_mul_f32 v18, v18, v29
    v_mul_f32 v19, v19, v29
    v_mul_f32 v20, v20, v29
    v_mul_f32 v21, v21, v29
    v_mul_f32 v22, v22, v29
    v_mul_f32 v23, v23, v29
    v_mul_f32 v24, v24, v29
    v_mul_f32 v25, v25, v29
    s_waitcnt lgkmcnt(0)
    ds_read_b128 v[196:199], v9 offset:7392
    ds_read_b128 v[200:203], v9 offset:7408
    ds_read_b128 v[204:207], v9 offset:7424
    ds_read_b128 v[208:211], v9 offset:7440
    ds_read_b128 v[212:215], v9 offset:7456
    ds_read_b128 v[216:219], v9 offset:7472
    ds_read_b128 v[220:223], v9 offset:7488
    ds_read_b128 v[224:227], v9 offset:7504
    ds_read_b128 v[228:231], v9 offset:7520
    v_pk_mul_f32 v[40:41], v[10:11], v[160:161] op_sel:[0,0] op_sel_hi:[0,1]
    v_pk_mul_f32 v[42:43], v[10:11], v[162:163] op_sel:[0,0] op_sel_hi:[0,1]
    v_pk_mul_f32 v[44:45], v[10:11], v[164:165] op_sel:[0,0] op_sel_hi:[0,1]
    v_pk_mul_f32 v[46:47], v[10:11], v[166:167] op_sel:[0,0] op_sel_hi:[0,1]
    v_pk_mul_f32 v[48:49], v[10:11], v[168:169] op_sel:[0,0] op_sel_hi:[0,1]
    v_pk_mul_f32 v[50:51], v[10:11], v[170:171] op_sel:[0,0] op_sel_hi:[0,1]
    v_pk_mul_f32 v[52:53], v[10:11], v[172:173] op_sel:[0,0] op_sel_hi:[0,1]
    v_pk_mul_f32 v[54:55], v[10:11], v[174:175] op_sel:[0,0] op_sel_hi:[0,1]
    v_pk_mul_f32 v[56:57], v[10:11], v[176:177] op_sel:[0,0] op_sel_hi:[0,1]
    v_pk_mul_f32 v[58:59], v[18:19], v[178:179] op_sel:[0,0] op_sel_hi:[0,1]
    v_pk_mul_f32 v[60:61], v[18:19], v[180:181] op_sel:[0,0] op_sel_hi:[0,1]
    v_pk_mul_f32 v[62:63], v[18:19], v[182:183] op_sel:[0,0] op_sel_hi:[0,1]
    v_pk_mul_f32 v[64:65], v[18:19], v[184:185] op_sel:[0,0] op_sel_hi:[0,1]
    v_pk_mul_f32 v[66:67], v[18:19], v[186:187] op_sel:[0,0] op_sel_hi:[0,1]
    v_pk_mul_f32 v[68:69], v[18:19], v[188:189] op_sel:[0,0] op_sel_hi:[0,1]
    v_pk_mul_f32 v[70:71], v[18:19], v[190:191] op_sel:[0,0] op_sel_hi:[0,1]
    v_pk_mul_f32 v[72:73], v[18:19], v[192:193] op_sel:[0,0] op_sel_hi:[0,1]
    v_pk_mul_f32 v[74:75], v[18:19], v[194:195] op_sel:[0,0] op_sel_hi:[0,1]
    s_waitcnt lgkmcnt(0)
    ds_read_b128 v[160:163], v9 offset:6208
    ds_read_b128 v[164:167], v9 offset:6224
    ds_read_b128 v[168:171], v9 offset:6240
    ds_read_b128 v[172:175], v9 offset:6256
    ds_read_b128 v[176:179], v9 offset:6272
    ds_read_b128 v[180:183], v9 offset:6288
    ds_read_b128 v[184:187], v9 offset:6304
    ds_read_b128 v[188:191], v9 offset:6320
    ds_read_b128 v[192:195], v9 offset:6336
    v_pk_fma_f32 v[40:41], v[10:11], v[196:197], v[40:41] op_sel:[1,0,0] op_sel_hi:[1,1,1]
    v_pk_fma_f32 v[42:43], v[10:11], v[198:199], v[42:43] op_sel:[1,0,0] op_sel_hi:[1,1,1]
    v_pk_fma_f32 v[44:45], v[10:11], v[200:201], v[44:45] op_sel:[1,0,0] op_sel_hi:[1,1,1]
    v_pk_fma_f32 v[46:47], v[10:11], v[202:203], v[46:47] op_sel:[1,0,0] op_sel_hi:[1,1,1]
    v_pk_fma_f32 v[48:49], v[10:11], v[204:205], v[48:49] op_sel:[1,0,0] op_sel_hi:[1,1,1]
    v_pk_fma_f32 v[50:51], v[10:11], v[206:207], v[50:51] op_sel:[1,0,0] op_sel_hi:[1,1,1]
    v_pk_fma_f32 v[52:53], v[10:11], v[208:209], v[52:53] op_sel:[1,0,0] op_sel_hi:[1,1,1]
    v_pk_fma_f32 v[54:55], v[10:11], v[210:211], v[54:55] op_sel:[1,0,0] op_sel_hi:[1,1,1]
    v_pk_fma_f32 v[56:57], v[10:11], v[212:213], v[56:57] op_sel:[1,0,0] op_sel_hi:[1,1,1]
    v_pk_fma_f32 v[58:59], v[18:19], v[214:215], v[58:59] op_sel:[1,0,0] op_sel_hi:[1,1,1]
    v_pk_fma_f32 v[60:61], v[18:19], v[216:217], v[60:61] op_sel:[1,0,0] op_sel_hi:[1,1,1]
    v_pk_fma_f32 v[62:63], v[18:19], v[218:219], v[62:63] op_sel:[1,0,0] op_sel_hi:[1,1,1]
    v_pk_fma_f32 v[64:65], v[18:19], v[220:221], v[64:65] op_sel:[1,0,0] op_sel_hi:[1,1,1]
    v_pk_fma_f32 v[66:67], v[18:19], v[222:223], v[66:67] op_sel:[1,0,0] op_sel_hi:[1,1,1]
    v_pk_fma_f32 v[68:69], v[18:19], v[224:225], v[68:69] op_sel:[1,0,0] op_sel_hi:[1,1,1]
    v_pk_fma_f32 v[70:71], v[18:19], v[226:227], v[70:71] op_sel:[1,0,0] op_sel_hi:[1,1,1]
    v_pk_fma_f32 v[72:73], v[18:19], v[228:229], v[72:73] op_sel:[1,0,0] op_sel_hi:[1,1,1]
    v_pk_fma_f32 v[74:75], v[18:19], v[230:231], v[74:75] op_sel:[1,0,0] op_sel_hi:[1,1,1]
    s_waitcnt lgkmcnt(0)
    ds_read_b128 v[196:199], v9 offset:5024
    ds_read_b128 v[200:203], v9 offset:5040
    ds_read_b128 v[204:207], v9 offset:5056
    ds_read_b128 v[208:211], v9 offset:5072
    ds_read_b128 v[212:215], v9 offset:5088
    ds_read_b128 v[216:219], v9 offset:5104
    ds_read_b128 v[220:223], v9 offset:5120
    ds_read_b128 v[224:227], v9 offset:5136
    ds_read_b128 v[228:231], v9 offset:5152
    v_pk_fma_f32 v[40:41], v[12:13], v[160:161], v[40:41] op_sel:[0,0,0] op_sel_hi:[0,1,1]
    v_pk_fma_f32 v[42:43], v[12:13], v[162:163], v[42:43] op_sel:[0,0,0] op_sel_hi:[0,1,1]
    v_pk_fma_f32 v[44:45], v[12:13], v[164:165], v[44:45] op_sel:[0,0,0] op_sel_hi:[0,1,1]
    v_pk_fma_f32 v[46:47], v[12:13], v[166:167], v[46:47] op_sel:[0,0,0] op_sel_hi:[0,1,1]
    v_pk_fma_f32 v[48:49], v[12:13], v[168:169], v[48:49] op_sel:[0,0,0] op_sel_hi:[0,1,1]
    v_pk_fma_f32 v[50:51], v[12:13], v[170:171], v[50:51] op_sel:[0,0,0] op_sel_hi:[0,1,1]
    v_pk_fma_f32 v[52:53], v[12:13], v[172:173], v[52:53] op_sel:[0,0,0] op_sel_hi:[0,1,1]
    v_pk_fma_f32 v[54:55], v[12:13], v[174:175], v[54:55] op_sel:[0,0,0] op_sel_hi:[0,1,1]
    v_pk_fma_f32 v[56:57], v[12:13], v[176:177], v[56:57] op_sel:[0,0,0] op_sel_hi:[0,1,1]
    v_pk_fma_f32 v[58:59], v[20:21], v[178:179], v[58:59] op_sel:[0,0,0] op_sel_hi:[0,1,1]
    v_pk_fma_f32 v[60:61], v[20:21], v[180:181], v[60:61] op_sel:[0,0,0] op_sel_hi:[0,1,1]
    v_pk_fma_f32 v[62:63], v[20:21], v[182:183], v[62:63] op_sel:[0,0,0] op_sel_hi:[0,1,1]
    v_pk_fma_f32 v[64:65], v[20:21], v[184:185], v[64:65] op_sel:[0,0,0] op_sel_hi:[0,1,1]
    v_pk_fma_f32 v[66:67], v[20:21], v[186:187], v[66:67] op_sel:[0,0,0] op_sel_hi:[0,1,1]
    v_pk_fma_f32 v[68:69], v[20:21], v[188:189], v[68:69] op_sel:[0,0,0] op_sel_hi:[0,1,1]
    v_pk_fma_f32 v[70:71], v[20:21], v[190:191], v[70:71] op_sel:[0,0,0] op_sel_hi:[0,1,1]
    v_pk_fma_f32 v[72:73], v[20:21], v[192:193], v[72:73] op_sel:[0,0,0] op_sel_hi:[0,1,1]
    v_pk_fma_f32 v[74:75], v[20:21], v[194:195], v[74:75] op_sel:[0,0,0] op_sel_hi:[0,1,1]
    s_waitcnt lgkmcnt(0)
    ds_read_b128 v[160:163], v9 offset:3840
    ds_read_b128 v[164:167], v9 offset:3856
    ds_read_b128 v[168:171], v9 offset:3872
    ds_read_b128 v[172:175], v9 offset:3888
    ds_read_b128 v[176:179], v9 offset:3904
    ds_read_b128 v[180:183], v9 offset:3920
    ds_read_b128 v[184:187], v9 offset:3936
    ds_read_b128 v[188:191], v9 offset:3952
    ds_read_b128 v[192:195], v9 offset:3968
    v_pk_fma_f32 v[40:41], v[12:13], v[196:197], v[40:41] op_sel:[1,0,0] op_sel_hi:[1,1,1]
    v_pk_fma_f32 v[42:43], v[12:13], v[198:199], v[42:43] op_sel:[1,0,0] op_sel_hi:[1,1,1]
    v_pk_fma_f32 v[44:45], v[12:13], v[200:201], v[44:45] op_sel:[1,0,0] op_sel_hi:[1,1,1]
    v_pk_fma_f32 v[46:47], v[12:13], v[202:203], v[46:47] op_sel:[1,0,0] op_sel_hi:[1,1,1]
    v_pk_fma_f32 v[48:49], v[12:13], v[204:205], v[48:49] op_sel:[1,0,0] op_sel_hi:[1,1,1]
    v_pk_fma_f32 v[50:51], v[12:13], v[206:207], v[50:51] op_sel:[1,0,0] op_sel_hi:[1,1,1]
    v_pk_fma_f32 v[52:53], v[12:13], v[208:209], v[52:53] op_sel:[1,0,0] op_sel_hi:[1,1,1]
    v_pk_fma_f32 v[54:55], v[12:13], v[210:211], v[54:55] op_sel:[1,0,0] op_sel_hi:[1,1,1]
    v_pk_fma_f32 v[56:57], v[12:13], v[212:213], v[56:57] op_sel:[1,0,0] op_sel_hi:[1,1,1]
    v_pk_fma_f32 v[58:59], v[20:21], v[214:215], v[58:59] op_sel:[1,0,0] op_sel_hi:[1,1,1]
    v_pk_fma_f32 v[60:61], v[20:21], v[216:217], v[60:61] op_sel:[1,0,0] op_sel_hi:[1,1,1]
    v_pk_fma_f32 v[62:63], v[20:21], v[218:219], v[62:63] op_sel:[1,0,0] op_sel_hi:[1,1,1]
    v_pk_fma_f32 v[64:65], v[20:21], v[220:221], v[64:65] op_sel:[1,0,0] op_sel_hi:[1,1,1]
    v_pk_fma_f32 v[66:67], v[20:21], v[222:223], v[66:67] op_sel:[1,0,0] op_sel_hi:[1,1,1]
    v_pk_fma_f32 v[68:69], v[20:21], v[224:225], v[68:69] op_sel:[1,0,0] op_sel_hi:[1,1,1]
    v_pk_fma_f32 v[70:71], v[20:21], v[226:227], v[70:71] op_sel:[1,0,0] op_sel_hi:[1,1,1]
    v_pk_fma_f32 v[72:73], v[20:21], v[228:229], v[72:73] op_sel:[1,0,0] op_sel_hi:[1,1,1]
    v_pk_fma_f32 v[74:75], v[20:21], v[230:231], v[74:75] op_sel:[1,0,0] op_sel_hi:[1,1,1]
    s_waitcnt lgkmcnt(0)
    ds_read_b128 v[196:199], v9 offset:2656
    ds_read_b128 v[200:203], v9 offset:2672
    ds_read_b128 v[204:207], v9 offset:2688
    ds_read_b128 v[208:211], v9 offset:2704
    ds_read_b128 v[212:215], v9 offset:2720
    ds_read_b128 v[216:219], v9 offset:2736
    ds_read_b128 v[220:223], v9 offset:2752
    ds_read_b128 v[224:227], v9 offset:2768
    ds_read_b128 v[228:231], v9 offset:2784
    v_pk_fma_f32 v[40:41], v[14:15], v[160:161], v[40:41] op_sel:[0,0,0] op_sel_hi:[0,1,1]
    v_pk_fma_f32 v[42:43], v[14:15], v[162:163], v[42:43] op_sel:[0,0,0] op_sel_hi:[0,1,1]
    v_pk_fma_f32 v[44:45], v[14:15], v[164:165], v[44:45] op_sel:[0,0,0] op_sel_hi:[0,1,1]
    v_pk_fma_f32 v[46:47], v[14:15], v[166:167], v[46:47] op_sel:[0,0,0] op_sel_hi:[0,1,1]
    v_pk_fma_f32 v[48:49], v[14:15], v[168:169], v[48:49] op_sel:[0,0,0] op_sel_hi:[0,1,1]
    v_pk_fma_f32 v[50:51], v[14:15], v[170:171], v[50:51] op_sel:[0,0,0] op_sel_hi:[0,1,1]
    v_pk_fma_f32 v[52:53], v[14:15], v[172:173], v[52:53] op_sel:[0,0,0] op_sel_hi:[0,1,1]
    v_pk_fma_f32 v[54:55], v[14:15], v[174:175], v[54:55] op_sel:[0,0,0] op_sel_hi:[0,1,1]
    v_pk_fma_f32 v[56:57], v[14:15], v[176:177], v[56:57] op_sel:[0,0,0] op_sel_hi:[0,1,1]
    v_pk_fma_f32 v[58:59], v[22:23], v[178:179], v[58:59] op_sel:[0,0,0] op_sel_hi:[0,1,1]
    v_pk_fma_f32 v[60:61], v[22:23], v[180:181], v[60:61] op_sel:[0,0,0] op_sel_hi:[0,1,1]
    v_pk_fma_f32 v[62:63], v[22:23], v[182:183], v[62:63] op_sel:[0,0,0] op_sel_hi:[0,1,1]
    v_pk_fma_f32 v[64:65], v[22:23], v[184:185], v[64:65] op_sel:[0,0,0] op_sel_hi:[0,1,1]
    v_pk_fma_f32 v[66:67], v[22:23], v[186:187], v[66:67] op_sel:[0,0,0] op_sel_hi:[0,1,1]
    v_pk_fma_f32 v[68:69], v[22:23], v[188:189], v[68:69] op_sel:[0,0,0] op_sel_hi:[0,1,1]
    v_pk_fma_f32 v[70:71], v[22:23], v[190:191], v[70:71] op_sel:[0,0,0] op_sel_hi:[0,1,1]
    v_pk_fma_f32 v[72:73], v[22:23], v[192:193], v[72:73] op_sel:[0,0,0] op_sel_hi:[0,1,1]
    v_pk_fma_f32 v[74:75], v[22:23], v[194:195], v[74:75] op_sel:[0,0,0] op_sel_hi:[0,1,1]
    s_waitcnt lgkmcnt(0)
    ds_read_b128 v[160:163], v9 offset:1472
    ds_read_b128 v[164:167], v9 offset:1488
    ds_read_b128 v[168:171], v9 offset:1504
    ds_read_b128 v[172:175], v9 offset:1520
    ds_read_b128 v[176:179], v9 offset:1536
    ds_read_b128 v[180:183], v9 offset:1552
    ds_read_b128 v[184:187], v9 offset:1568
    ds_read_b128 v[188:191], v9 offset:1584
    ds_read_b128 v[192:195], v9 offset:1600
    v_pk_fma_f32 v[40:41], v[14:15], v[196:197], v[40:41] op_sel:[1,0,0] op_sel_hi:[1,1,1]
    v_pk_fma_f32 v[42:43], v[14:15], v[198:199], v[42:43] op_sel:[1,0,0] op_sel_hi:[1,1,1]
    v_pk_fma_f32 v[44:45], v[14:15], v[200:201], v[44:45] op_sel:[1,0,0] op_sel_hi:[1,1,1]
    v_pk_fma_f32 v[46:47], v[14:15], v[202:203], v[46:47] op_sel:[1,0,0] op_sel_hi:[1,1,1]
    v_pk_fma_f32 v[48:49], v[14:15], v[204:205], v[48:49] op_sel:[1,0,0] op_sel_hi:[1,1,1]
    v_pk_fma_f32 v[50:51], v[14:15], v[206:207], v[50:51] op_sel:[1,0,0] op_sel_hi:[1,1,1]
    v_pk_fma_f32 v[52:53], v[14:15], v[208:209], v[52:53] op_sel:[1,0,0] op_sel_hi:[1,1,1]
    v_pk_fma_f32 v[54:55], v[14:15], v[210:211], v[54:55] op_sel:[1,0,0] op_sel_hi:[1,1,1]
    v_pk_fma_f32 v[56:57], v[14:15], v[212:213], v[56:57] op_sel:[1,0,0] op_sel_hi:[1,1,1]
    v_pk_fma_f32 v[58:59], v[22:23], v[214:215], v[58:59] op_sel:[1,0,0] op_sel_hi:[1,1,1]
    v_pk_fma_f32 v[60:61], v[22:23], v[216:217], v[60:61] op_sel:[1,0,0] op_sel_hi:[1,1,1]
    v_pk_fma_f32 v[62:63], v[22:23], v[218:219], v[62:63] op_sel:[1,0,0] op_sel_hi:[1,1,1]
    v_pk_fma_f32 v[64:65], v[22:23], v[220:221], v[64:65] op_sel:[1,0,0] op_sel_hi:[1,1,1]
    v_pk_fma_f32 v[66:67], v[22:23], v[222:223], v[66:67] op_sel:[1,0,0] op_sel_hi:[1,1,1]
    v_pk_fma_f32 v[68:69], v[22:23], v[224:225], v[68:69] op_sel:[1,0,0] op_sel_hi:[1,1,1]
    v_pk_fma_f32 v[70:71], v[22:23], v[226:227], v[70:71] op_sel:[1,0,0] op_sel_hi:[1,1,1]
    v_pk_fma_f32 v[72:73], v[22:23], v[228:229], v[72:73] op_sel:[1,0,0] op_sel_hi:[1,1,1]
    v_pk_fma_f32 v[74:75], v[22:23], v[230:231], v[74:75] op_sel:[1,0,0] op_sel_hi:[1,1,1]
    s_waitcnt lgkmcnt(0)
    ds_read_b128 v[196:199], v9 offset:288
    ds_read_b128 v[200:203], v9 offset:304
    ds_read_b128 v[204:207], v9 offset:320
    ds_read_b128 v[208:211], v9 offset:336
    ds_read_b128 v[212:215], v9 offset:352
    ds_read_b128 v[216:219], v9 offset:368
    ds_read_b128 v[220:223], v9 offset:384
    ds_read_b128 v[224:227], v9 offset:400
    ds_read_b128 v[228:231], v9 offset:416
    v_pk_fma_f32 v[40:41], v[16:17], v[160:161], v[40:41] op_sel:[0,0,0] op_sel_hi:[0,1,1]
    v_pk_fma_f32 v[42:43], v[16:17], v[162:163], v[42:43] op_sel:[0,0,0] op_sel_hi:[0,1,1]
    v_pk_fma_f32 v[44:45], v[16:17], v[164:165], v[44:45] op_sel:[0,0,0] op_sel_hi:[0,1,1]
    v_pk_fma_f32 v[46:47], v[16:17], v[166:167], v[46:47] op_sel:[0,0,0] op_sel_hi:[0,1,1]
    v_pk_fma_f32 v[48:49], v[16:17], v[168:169], v[48:49] op_sel:[0,0,0] op_sel_hi:[0,1,1]
    v_pk_fma_f32 v[50:51], v[16:17], v[170:171], v[50:51] op_sel:[0,0,0] op_sel_hi:[0,1,1]
    v_pk_fma_f32 v[52:53], v[16:17], v[172:173], v[52:53] op_sel:[0,0,0] op_sel_hi:[0,1,1]
    v_pk_fma_f32 v[54:55], v[16:17], v[174:175], v[54:55] op_sel:[0,0,0] op_sel_hi:[0,1,1]
    v_pk_fma_f32 v[56:57], v[16:17], v[176:177], v[56:57] op_sel:[0,0,0] op_sel_hi:[0,1,1]
    v_pk_fma_f32 v[58:59], v[24:25], v[178:179], v[58:59] op_sel:[0,0,0] op_sel_hi:[0,1,1]
    v_pk_fma_f32 v[60:61], v[24:25], v[180:181], v[60:61] op_sel:[0,0,0] op_sel_hi:[0,1,1]
    v_pk_fma_f32 v[62:63], v[24:25], v[182:183], v[62:63] op_sel:[0,0,0] op_sel_hi:[0,1,1]
    v_pk_fma_f32 v[64:65], v[24:25], v[184:185], v[64:65] op_sel:[0,0,0] op_sel_hi:[0,1,1]
    v_pk_fma_f32 v[66:67], v[24:25], v[186:187], v[66:67] op_sel:[0,0,0] op_sel_hi:[0,1,1]
    v_pk_fma_f32 v[68:69], v[24:25], v[188:189], v[68:69] op_sel:[0,0,0] op_sel_hi:[0,1,1]
    v_pk_fma_f32 v[70:71], v[24:25], v[190:191], v[70:71] op_sel:[0,0,0] op_sel_hi:[0,1,1]
    v_pk_fma_f32 v[72:73], v[24:25], v[192:193], v[72:73] op_sel:[0,0,0] op_sel_hi:[0,1,1]
    v_pk_fma_f32 v[74:75], v[24:25], v[194:195], v[74:75] op_sel:[0,0,0] op_sel_hi:[0,1,1]
    s_waitcnt lgkmcnt(0)
    v_pk_fma_f32 v[40:41], v[16:17], v[196:197], v[40:41] op_sel:[1,0,0] op_sel_hi:[1,1,1]
    v_pk_fma_f32 v[42:43], v[16:17], v[198:199], v[42:43] op_sel:[1,0,0] op_sel_hi:[1,1,1]
    v_pk_fma_f32 v[44:45], v[16:17], v[200:201], v[44:45] op_sel:[1,0,0] op_sel_hi:[1,1,1]
    v_pk_fma_f32 v[46:47], v[16:17], v[202:203], v[46:47] op_sel:[1,0,0] op_sel_hi:[1,1,1]
    v_pk_fma_f32 v[48:49], v[16:17], v[204:205], v[48:49] op_sel:[1,0,0] op_sel_hi:[1,1,1]
    v_pk_fma_f32 v[50:51], v[16:17], v[206:207], v[50:51] op_sel:[1,0,0] op_sel_hi:[1,1,1]
    v_pk_fma_f32 v[52:53], v[16:17], v[208:209], v[52:53] op_sel:[1,0,0] op_sel_hi:[1,1,1]
    v_pk_fma_f32 v[54:55], v[16:17], v[210:211], v[54:55] op_sel:[1,0,0] op_sel_hi:[1,1,1]
    v_pk_fma_f32 v[56:57], v[16:17], v[212:213], v[56:57] op_sel:[1,0,0] op_sel_hi:[1,1,1]
    v_pk_fma_f32 v[58:59], v[24:25], v[214:215], v[58:59] op_sel:[1,0,0] op_sel_hi:[1,1,1]
    v_pk_fma_f32 v[60:61], v[24:25], v[216:217], v[60:61] op_sel:[1,0,0] op_sel_hi:[1,1,1]
    v_pk_fma_f32 v[62:63], v[24:25], v[218:219], v[62:63] op_sel:[1,0,0] op_sel_hi:[1,1,1]
    v_pk_fma_f32 v[64:65], v[24:25], v[220:221], v[64:65] op_sel:[1,0,0] op_sel_hi:[1,1,1]
    v_pk_fma_f32 v[66:67], v[24:25], v[222:223], v[66:67] op_sel:[1,0,0] op_sel_hi:[1,1,1]
    v_pk_fma_f32 v[68:69], v[24:25], v[224:225], v[68:69] op_sel:[1,0,0] op_sel_hi:[1,1,1]
    v_pk_fma_f32 v[70:71], v[24:25], v[226:227], v[70:71] op_sel:[1,0,0] op_sel_hi:[1,1,1]
    v_pk_fma_f32 v[72:73], v[24:25], v[228:229], v[72:73] op_sel:[1,0,0] op_sel_hi:[1,1,1]
    v_pk_fma_f32 v[74:75], v[24:25], v[230:231], v[74:75] op_sel:[1,0,0] op_sel_hi:[1,1,1]
    v_cvt_pk_bf16_f32 v84, v40, v41
    v_cvt_pk_bf16_f32 v85, v42, v43
    v_cvt_pk_bf16_f32 v86, v44, v45
    v_cvt_pk_bf16_f32 v87, v46, v47
    v_cvt_pk_bf16_f32 v88, v48, v49
    v_cvt_pk_bf16_f32 v89, v50, v51
    v_cvt_pk_bf16_f32 v90, v52, v53
    v_cvt_pk_bf16_f32 v91, v54, v55
    v_cvt_pk_bf16_f32 v92, v56, v57
    v_cvt_pk_bf16_f32 v93, v58, v59
    v_cvt_pk_bf16_f32 v94, v60, v61
    v_cvt_pk_bf16_f32 v95, v62, v63
    v_cvt_pk_bf16_f32 v96, v64, v65
    v_cvt_pk_bf16_f32 v97, v66, v67
    v_cvt_pk_bf16_f32 v98, v68, v69
    v_cvt_pk_bf16_f32 v99, v70, v71
    v_cvt_pk_bf16_f32 v100, v72, v73
    v_cvt_pk_bf16_f32 v101, v74, v75
    v_cmp_ne_u32 vcc, 0, v3
    s_add_u32 s42, s37, 0
    s_nop 0
    v_cndmask_b32 v104, v84, v86, vcc
    v_cndmask_b32 v105, v85, v87, vcc
    v_cndmask_b32 v106, v86, v88, vcc
    v_cndmask_b32 v107, v87, v89, vcc
    v_cndmask_b32 v108, v88, v90, vcc
    v_cndmask_b32 v109, v89, v91, vcc
    v_cndmask_b32 v110, v90, v92, vcc
    v_cndmask_b32 v111, v91, v93, vcc
    v_cndmask_b32 v112, v92, v94, vcc
    v_cndmask_b32 v113, v93, v95, vcc
    v_cndmask_b32 v114, v94, v96, vcc
    v_cndmask_b32 v115, v95, v97, vcc
    v_cndmask_b32 v116, v96, v98, vcc
    v_cndmask_b32 v117, v97, v99, vcc
    v_cndmask_b32 v118, v98, v100, vcc
    v_cndmask_b32 v119, v99, v101, vcc
    v_cndmask_b32 v244, v100, v84, vcc
    v_cndmask_b32 v245, v101, v85, vcc
    buffer_store_dwordx4 v[104:107], v240, s[16:19], s42 offen offset:0 sc0 sc1
    buffer_store_dwordx4 v[108:111], v240, s[16:19], s42 offen offset:512 sc0 sc1
    buffer_store_dwordx4 v[112:115], v240, s[16:19], s42 offen offset:1024 sc0 sc1
    buffer_store_dwordx4 v[116:119], v240, s[16:19], s42 offen offset:1536 sc0 sc1
    ds_read_b128 v[160:163], v9 offset:27232
    ds_read_b128 v[164:167], v9 offset:27248
    ds_read_b128 v[168:171], v9 offset:27264
    ds_read_b128 v[172:175], v9 offset:27280
    ds_read_b128 v[176:179], v9 offset:27296
    ds_read_b128 v[180:183], v9 offset:27312
    ds_read_b128 v[184:187], v9 offset:27328
    ds_read_b128 v[188:191], v9 offset:27344
    ds_read_b128 v[192:195], v9 offset:27360
    s_waitcnt lgkmcnt(0)
    ds_read_b128 v[196:199], v9 offset:26048
    ds_read_b128 v[200:203], v9 offset:26064
    ds_read_b128 v[204:207], v9 offset:26080
    ds_read_b128 v[208:211], v9 offset:26096
    ds_read_b128 v[212:215], v9 offset:26112
    ds_read_b128 v[216:219], v9 offset:26128
    ds_read_b128 v[220:223], v9 offset:26144
    ds_read_b128 v[224:227], v9 offset:26160
    ds_read_b128 v[228:231], v9 offset:26176
    v_pk_mul_f32 v[232:233], v[120:121], v[160:161]
    v_pk_mul_f32 v[236:237], v[138:139], v[178:179]
    v_pk_mul_f32 v[234:235], v[122:123], v[162:163]
    v_pk_mul_f32 v[238:239], v[140:141], v[180:181]
    v_pk_fma_f32 v[232:233], v[124:125], v[164:165], v[232:233]
    v_pk_fma_f32 v[236:237], v[142:143], v[182:183], v[236:237]
    v_pk_fma_f32 v[234:235], v[126:127], v[166:167], v[234:235]
    v_pk_fma_f32 v[238:239], v[144:145], v[184:185], v[238:239]
    v_pk_fma_f32 v[232:233], v[128:129], v[168:169], v[232:233]
    v_pk_fma_f32 v[236:237], v[146:147], v[186:187], v[236:237]
    v_pk_fma_f32 v[234:235], v[130:131], v[170:171], v[234:235]
    v_pk_fma_f32 v[238:239], v[148:149], v[188:189], v[238:239]
    v_pk_fma_f32 v[232:233], v[132:133], v[172:173], v[232:233]
    v_pk_fma_f32 v[236:237], v[150:151], v[190:191], v[236:237]
    v_pk_fma_f32 v[234:235], v[134:135], v[174:175], v[234:235]
    v_pk_fma_f32 v[238:239], v[152:153], v[192:193], v[238:239]
    v_pk_fma_f32 v[232:233], v[136:137], v[176:177], v[232:233]
    v_pk_fma_f32 v[236:237], v[154:155], v[194:195], v[236:237]
    v_pk_add_f32 v[232:233], v[232:233], v[234:235]
    v_pk_add_f32 v[236:237], v[236:237], v[238:239]
    v_add_f32 v10, v232, v233
    v_add_f32 v18, v236, v237
    s_waitcnt lgkmcnt(0)
    ds_read_b128 v[160:163], v9 offset:24864
    ds_read_b128 v[164:167], v9 offset:24880
    ds_read_b128 v[168:171], v9 offset:24896
    ds_read_b128 v[172:175], v9 offset:24912
    ds_read_b128 v[176:179], v9 offset:24928
    ds_read_b128 v[180:183], v9 offset:24944
    ds_read_b128 v[184:187], v9 offset:24960
    ds_read_b128 v[188:191], v9 offset:24976
    ds_read_b128 v[192:195], v9 offset:24992
    v_pk_mul_f32 v[232:233], v[120:121], v[196:197]
    v_pk_mul_f32 v[236:237], v[138:139], v[214:215]
    v_pk_mul_f32 v[234:235], v[122:123], v[198:199]
    v_pk_mul_f32 v[238:239], v[140:141], v[216:217]
    v_pk_fma_f32 v[232:233], v[124:125], v[200:201], v[232:233]
    v_pk_fma_f32 v[236:237], v[142:143], v[218:219], v[236:237]
    v_pk_fma_f32 v[234:235], v[126:127], v[202:203], v[234:235]
    v_pk_fma_f32 v[238:239], v[144:145], v[220:221], v[238:239]
    v_pk_fma_f32 v[232:233], v[128:129], v[204:205], v[232:233]
    v_pk_fma_f32 v[236:237], v[146:147], v[222:223], v[236:237]
    v_pk_fma_f32 v[234:235], v[130:131], v[206:207], v[234:235]
    v_pk_fma_f32 v[238:239], v[148:149], v[224:225], v[238:239]
    v_pk_fma_f32 v[232:233], v[132:133], v[208:209], v[232:233]
    v_pk_fma_f32 v[236:237], v[150:151], v[226:227], v[236:237]
    v_pk_fma_f32 v[234:235], v[134:135], v[210:211], v[234:235]
    v_pk_fma_f32 v[238:239], v[152:153], v[228:229], v[238:239]
    v_pk_fma_f32 v[232:233], v[136:137], v[212:213], v[232:233]
    v_pk_fma_f32 v[236:237], v[154:155], v[230:231], v[236:237]
    v_pk_add_f32 v[232:233], v[232:233], v[234:235]
    v_pk_add_f32 v[236:237], v[236:237], v[238:239]
    v_add_f32 v11, v232, v233
    v_add_f32 v19, v236, v237
    s_waitcnt lgkmcnt(0)
    ds_read_b128 v[196:199], v9 offset:23680
    ds_read_b128 v[200:203], v9 offset:23696
    ds_read_b128 v[204:207], v9 offset:23712
    ds_read_b128 v[208:211], v9 offset:23728
    ds_read_b128 v[212:215], v9 offset:23744
    ds_read_b128 v[216:219], v9 offset:23760
    ds_read_b128 v[220:223], v9 offset:23776
    ds_read_b128 v[224:227], v9 offset:23792
    ds_read_b128 v[228:231], v9 offset:23808
    v_pk_mul_f32 v[232:233], v[120:121], v[160:161]
    v_pk_mul_f32 v[236:237], v[138:139], v[178:179]
    v_pk_mul_f32 v[234:235], v[122:123], v[162:163]
    v_pk_mul_f32 v[238:239], v[140:141], v[180:181]
    v_pk_fma_f32 v[232:233], v[124:125], v[164:165], v[232:233]
    v_pk_fma_f32 v[236:237], v[142:143], v[182:183], v[236:237]
    v_pk_fma_f32 v[234:235], v[126:127], v[166:167], v[234:235]
    v_pk_fma_f32 v[238:239], v[144:145], v[184:185], v[238:239]
    v_pk_fma_f32 v[232:233], v[128:129], v[168:169], v[232:233]
    v_pk_fma_f32 v[236:237], v[146:147], v[186:187], v[236:237]
    v_pk_fma_f32 v[234:235], v[130:131], v[170:171], v[234:235]
    v_pk_fma_f32 v[238:239], v[148:149], v[188:189], v[238:239]
    v_pk_fma_f32 v[232:233], v[132:133], v[172:173], v[232:233]
    v_pk_fma_f32 v[236:237], v[150:151], v[190:191], v[236:237]
    v_pk_fma_f32 v[234:235], v[134:135], v[174:175], v[234:235]
    v_pk_fma_f32 v[238:239], v[152:153], v[192:193], v[238:239]
    v_pk_fma_f32 v[232:233], v[136:137], v[176:177], v[232:233]
    v_pk_fma_f32 v[236:237], v[154:155], v[194:195], v[236:237]
    v_pk_add_f32 v[232:233], v[232:233], v[234:235]
    v_pk_add_f32 v[236:237], v[236:237], v[238:239]
    v_add_f32 v12, v232, v233
    v_add_f32 v20, v236, v237
    s_waitcnt lgkmcnt(0)
    ds_read_b128 v[160:163], v9 offset:22496
    ds_read_b128 v[164:167], v9 offset:22512
    ds_read_b128 v[168:171], v9 offset:22528
    ds_read_b128 v[172:175], v9 offset:22544
    ds_read_b128 v[176:179], v9 offset:22560
    ds_read_b128 v[180:183], v9 offset:22576
    ds_read_b128 v[184:187], v9 offset:22592
    ds_read_b128 v[188:191], v9 offset:22608
    ds_read_b128 v[192:195], v9 offset:22624
    v_pk_mul_f32 v[232:233], v[120:121], v[196:197]
    v_pk_mul_f32 v[236:237], v[138:139], v[214:215]
    v_pk_mul_f32 v[234:235], v[122:123], v[198:199]
    v_pk_mul_f32 v[238:239], v[140:141], v[216:217]
    v_pk_fma_f32 v[232:233], v[124:125], v[200:201], v[232:233]
    v_pk_fma_f32 v[236:237], v[142:143], v[218:219], v[236:237]
    v_pk_fma_f32 v[234:235], v[126:127], v[202:203], v[234:235]
    v_pk_fma_f32 v[238:239], v[144:145], v[220:221], v[238:239]
    v_pk_fma_f32 v[232:233], v[128:129], v[204:205], v[232:233]
    v_pk_fma_f32 v[236:237], v[146:147], v[222:223], v[236:237]
    v_pk_fma_f32 v[234:235], v[130:131], v[206:207], v[234:235]
    v_pk_fma_f32 v[238:239], v[148:149], v[224:225], v[238:239]
    v_pk_fma_f32 v[232:233], v[132:133], v[208:209], v[232:233]
    v_pk_fma_f32 v[236:237], v[150:151], v[226:227], v[236:237]
    v_pk_fma_f32 v[234:235], v[134:135], v[210:211], v[234:235]
    v_pk_fma_f32 v[238:239], v[152:153], v[228:229], v[238:239]
    v_pk_fma_f32 v[232:233], v[136:137], v[212:213], v[232:233]
    v_pk_fma_f32 v[236:237], v[154:155], v[230:231], v[236:237]
    v_pk_add_f32 v[232:233], v[232:233], v[234:235]
    v_pk_add_f32 v[236:237], v[236:237], v[238:239]
    v_add_f32 v13, v232, v233
    v_add_f32 v21, v236, v237
    s_waitcnt lgkmcnt(0)
    ds_read_b128 v[196:199], v9 offset:21312
    ds_read_b128 v[200:203], v9 offset:21328
    ds_read_b128 v[204:207], v9 offset:21344
    ds_read_b128 v[208:211], v9 offset:21360
    ds_read_b128 v[212:215], v9 offset:21376
    ds_read_b128 v[216:219], v9 offset:21392
    ds_read_b128 v[220:223], v9 offset:21408
    ds_read_b128 v[224:227], v9 offset:21424
    ds_read_b128 v[228:231], v9 offset:21440
    v_pk_mul_f32 v[232:233], v[120:121], v[160:161]
    v_pk_mul_f32 v[236:237], v[138:139], v[178:179]
    v_pk_mul_f32 v[234:235], v[122:123], v[162:163]
    v_pk_mul_f32 v[238:239], v[140:141], v[180:181]
    v_pk_fma_f32 v[232:233], v[124:125], v[164:165], v[232:233]
    v_pk_fma_f32 v[236:237], v[142:143], v[182:183], v[236:237]
    v_pk_fma_f32 v[234:235], v[126:127], v[166:167], v[234:235]
    v_pk_fma_f32 v[238:239], v[144:145], v[184:185], v[238:239]
    v_pk_fma_f32 v[232:233], v[128:129], v[168:169], v[232:233]
    v_pk_fma_f32 v[236:237], v[146:147], v[186:187], v[236:237]
    v_pk_fma_f32 v[234:235], v[130:131], v[170:171], v[234:235]
    v_pk_fma_f32 v[238:239], v[148:149], v[188:189], v[238:239]
    v_pk_fma_f32 v[232:233], v[132:133], v[172:173], v[232:233]
    v_pk_fma_f32 v[236:237], v[150:151], v[190:191], v[236:237]
    v_pk_fma_f32 v[234:235], v[134:135], v[174:175], v[234:235]
    v_pk_fma_f32 v[238:239], v[152:153], v[192:193], v[238:239]
    v_pk_fma_f32 v[232:233], v[136:137], v[176:177], v[232:233]
    v_pk_fma_f32 v[236:237], v[154:155], v[194:195], v[236:237]
    v_pk_add_f32 v[232:233], v[232:233], v[234:235]
    v_pk_add_f32 v[236:237], v[236:237], v[238:239]
    v_add_f32 v14, v232, v233
    v_add_f32 v22, v236, v237
    s_waitcnt lgkmcnt(0)
    ds_read_b128 v[160:163], v9 offset:20128
    ds_read_b128 v[164:167], v9 offset:20144
    ds_read_b128 v[168:171], v9 offset:20160
    ds_read_b128 v[172:175], v9 offset:20176
    ds_read_b128 v[176:179], v9 offset:20192
    ds_read_b128 v[180:183], v9 offset:20208
    ds_read_b128 v[184:187], v9 offset:20224
    ds_read_b128 v[188:191], v9 offset:20240
    ds_read_b128 v[192:195], v9 offset:20256
    v_pk_mul_f32 v[232:233], v[120:121], v[196:197]
    v_pk_mul_f32 v[236:237], v[138:139], v[214:215]
    v_pk_mul_f32 v[234:235], v[122:123], v[198:199]
    v_pk_mul_f32 v[238:239], v[140:141], v[216:217]
    v_pk_fma_f32 v[232:233], v[124:125], v[200:201], v[232:233]
    v_pk_fma_f32 v[236:237], v[142:143], v[218:219], v[236:237]
    v_pk_fma_f32 v[234:235], v[126:127], v[202:203], v[234:235]
    v_pk_fma_f32 v[238:239], v[144:145], v[220:221], v[238:239]
    v_pk_fma_f32 v[232:233], v[128:129], v[204:205], v[232:233]
    v_pk_fma_f32 v[236:237], v[146:147], v[222:223], v[236:237]
    v_pk_fma_f32 v[234:235], v[130:131], v[206:207], v[234:235]
    v_pk_fma_f32 v[238:239], v[148:149], v[224:225], v[238:239]
    v_pk_fma_f32 v[232:233], v[132:133], v[208:209], v[232:233]
    v_pk_fma_f32 v[236:237], v[150:151], v[226:227], v[236:237]
    v_pk_fma_f32 v[234:235], v[134:135], v[210:211], v[234:235]
    v_pk_fma_f32 v[238:239], v[152:153], v[228:229], v[238:239]
    v_pk_fma_f32 v[232:233], v[136:137], v[212:213], v[232:233]
    v_pk_fma_f32 v[236:237], v[154:155], v[230:231], v[236:237]
    v_pk_add_f32 v[232:233], v[232:233], v[234:235]
    v_pk_add_f32 v[236:237], v[236:237], v[238:239]
    v_add_f32 v15, v232, v233
    v_add_f32 v23, v236, v237
    s_waitcnt lgkmcnt(0)
    ds_read_b128 v[196:199], v9 offset:18944
    ds_read_b128 v[200:203], v9 offset:18960
    ds_read_b128 v[204:207], v9 offset:18976
    ds_read_b128 v[208:211], v9 offset:18992
    ds_read_b128 v[212:215], v9 offset:19008
    ds_read_b128 v[216:219], v9 offset:19024
    ds_read_b128 v[220:223], v9 offset:19040
    ds_read_b128 v[224:227], v9 offset:19056
    ds_read_b128 v[228:231], v9 offset:19072
    v_pk_mul_f32 v[232:233], v[120:121], v[160:161]
    v_pk_mul_f32 v[236:237], v[138:139], v[178:179]
    v_pk_mul_f32 v[234:235], v[122:123], v[162:163]
    v_pk_mul_f32 v[238:239], v[140:141], v[180:181]
    v_pk_fma_f32 v[232:233], v[124:125], v[164:165], v[232:233]
    v_pk_fma_f32 v[236:237], v[142:143], v[182:183], v[236:237]
    v_pk_fma_f32 v[234:235], v[126:127], v[166:167], v[234:235]
    v_pk_fma_f32 v[238:239], v[144:145], v[184:185], v[238:239]
    v_pk_fma_f32 v[232:233], v[128:129], v[168:169], v[232:233]
    v_pk_fma_f32 v[236:237], v[146:147], v[186:187], v[236:237]
    v_pk_fma_f32 v[234:235], v[130:131], v[170:171], v[234:235]
    v_pk_fma_f32 v[238:239], v[148:149], v[188:189], v[238:239]
    v_pk_fma_f32 v[232:233], v[132:133], v[172:173], v[232:233]
    v_pk_fma_f32 v[236:237], v[150:151], v[190:191], v[236:237]
    v_pk_fma_f32 v[234:235], v[134:135], v[174:175], v[234:235]
    v_pk_fma_f32 v[238:239], v[152:153], v[192:193], v[238:239]
    v_pk_fma_f32 v[232:233], v[136:137], v[176:177], v[232:233]
    v_pk_fma_f32 v[236:237], v[154:155], v[194:195], v[236:237]
    v_pk_add_f32 v[232:233], v[232:233], v[234:235]
    v_pk_add_f32 v[236:237], v[236:237], v[238:239]
    v_add_f32 v16, v232, v233
    v_add_f32 v24, v236, v237
    s_waitcnt lgkmcnt(0)
    ds_read_b128 v[160:163], v9 offset:27520
    ds_read_b128 v[164:167], v9 offset:27536
    ds_read_b128 v[168:171], v9 offset:27552
    ds_read_b128 v[172:175], v9 offset:27568
    ds_read_b128 v[176:179], v9 offset:27584
    ds_read_b128 v[180:183], v9 offset:27600
    ds_read_b128 v[184:187], v9 offset:27616
    ds_read_b128 v[188:191], v9 offset:27632
    ds_read_b128 v[192:195], v9 offset:27648
    v_pk_mul_f32 v[232:233], v[120:121], v[196:197]
    v_pk_mul_f32 v[236:237], v[138:139], v[214:215]
    v_pk_mul_f32 v[234:235], v[122:123], v[198:199]
    v_pk_mul_f32 v[238:239], v[140:141], v[216:217]
    v_pk_fma_f32 v[232:233], v[124:125], v[200:201], v[232:233]
    v_pk_fma_f32 v[236:237], v[142:143], v[218:219], v[236:237]
    v_pk_fma_f32 v[234:235], v[126:127], v[202:203], v[234:235]
    v_pk_fma_f32 v[238:239], v[144:145], v[220:221], v[238:239]
    v_pk_fma_f32 v[232:233], v[128:129], v[204:205], v[232:233]
    v_pk_fma_f32 v[236:237], v[146:147], v[222:223], v[236:237]
    v_pk_fma_f32 v[234:235], v[130:131], v[206:207], v[234:235]
    v_pk_fma_f32 v[238:239], v[148:149], v[224:225], v[238:239]
    v_pk_fma_f32 v[232:233], v[132:133], v[208:209], v[232:233]
    v_pk_fma_f32 v[236:237], v[150:151], v[226:227], v[236:237]
    v_pk_fma_f32 v[234:235], v[134:135], v[210:211], v[234:235]
    v_pk_fma_f32 v[238:239], v[152:153], v[228:229], v[238:239]
    v_pk_fma_f32 v[232:233], v[136:137], v[212:213], v[232:233]
    v_pk_fma_f32 v[236:237], v[154:155], v[230:231], v[236:237]
    v_pk_add_f32 v[232:233], v[232:233], v[234:235]
    v_pk_add_f32 v[236:237], v[236:237], v[238:239]
    v_add_f32 v17, v232, v233
    v_add_f32 v25, v236, v237
    v_add_u32 v26, 32, v5
    v_mov_b32 v27, 0xff7fffff
    v_cmp_le_u32 vcc, 2, v26
    s_nop 1
    v_cndmask_b32 v11, v27, v11, vcc
    v_cndmask_b32 v19, v27, v19, vcc
    v_cmp_le_u32 vcc, 4, v26
    s_nop 1
    v_cndmask_b32 v12, v27, v12, vcc
    v_cndmask_b32 v20, v27, v20, vcc
    v_cmp_le_u32 vcc, 6, v26
    s_nop 1
    v_cndmask_b32 v13, v27, v13, vcc
    v_cndmask_b32 v21, v27, v21, vcc
    v_cmp_le_u32 vcc, 8, v26
    s_nop 1
    v_cndmask_b32 v14, v27, v14, vcc
    v_cndmask_b32 v22, v27, v22, vcc
    v_cmp_le_u32 vcc, 10, v26
    s_nop 1
    v_cndmask_b32 v15, v27, v15, vcc
    v_cndmask_b32 v23, v27, v23, vcc
    v_cmp_le_u32 vcc, 12, v26
    s_nop 1
    v_cndmask_b32 v16, v27, v16, vcc
    v_cndmask_b32 v24, v27, v24, vcc
    v_cmp_le_u32 vcc, 14, v26
    s_nop 1
    v_cndmask_b32 v17, v27, v17, vcc
    v_cndmask_b32 v25, v27, v25, vcc
    v_max3_f32 v28, v10, v11, v12
    v_max3_f32 v28, v28, v13, v14
    v_max3_f32 v28, v28, v15, v16
    v_max_f32 v28, v28, v17
    v_max3_f32 v29, v18, v19, v20
    v_max3_f32 v29, v29, v21, v22
    v_max3_f32 v29, v29, v23, v24
    v_max_f32 v29, v29, v25
    v_sub_f32 v10, v10, v28
    v_sub_f32 v11, v11, v28
    v_sub_f32 v12, v12, v28
    v_sub_f32 v13, v13, v28
    v_sub_f32 v14, v14, v28
    v_sub_f32 v15, v15, v28
    v_sub_f32 v16, v16, v28
    v_sub_f32 v17, v17, v28
    v_mul_f32 v10, s48, v10
    v_mul_f32 v11, s48, v11
    v_mul_f32 v12, s48, v12
    v_mul_f32 v13, s48, v13
    v_mul_f32 v14, s48, v14
    v_mul_f32 v15, s48, v15
    v_mul_f32 v16, s48, v16
    v_mul_f32 v17, s48, v17
    v_sub_f32 v18, v18, v29
    v_sub_f32 v19, v19, v29
    v_sub_f32 v20, v20, v29
    v_sub_f32 v21, v21, v29
    v_sub_f32 v22, v22, v29
    v_sub_f32 v23, v23, v29
    v_sub_f32 v24, v24, v29
    v_sub_f32 v25, v25, v29
    v_mul_f32 v18, s48, v18
    v_mul_f32 v19, s48, v19
    v_mul_f32 v20, s48, v20
    v_mul_f32 v21, s48, v21
    v_mul_f32 v22, s48, v22
    v_mul_f32 v23, s48, v23
    v_mul_f32 v24, s48, v24
    v_mul_f32 v25, s48, v25
    v_exp_f32 v10, v10
    v_exp_f32 v11, v11
    v_exp_f32 v12, v12
    v_exp_f32 v13, v13
    v_exp_f32 v14, v14
    v_exp_f32 v15, v15
    v_exp_f32 v16, v16
    v_exp_f32 v17, v17
    v_exp_f32 v18, v18
    v_exp_f32 v19, v19
    v_exp_f32 v20, v20
    v_exp_f32 v21, v21
    v_exp_f32 v22, v22
    v_exp_f32 v23, v23
    v_exp_f32 v24, v24
    v_exp_f32 v25, v25
    s_nop 0
    v_add_f32 v28, v10, v11
    v_add_f32 v29, v18, v19
    v_add_f32 v28, v28, v12
    v_add_f32 v29, v29, v20
    v_add_f32 v28, v28, v13
    v_add_f32 v29, v29, v21
    v_add_f32 v28, v28, v14
    v_add_f32 v29, v29, v22
    v_add_f32 v28, v28, v15
    v_add_f32 v29, v29, v23
    v_add_f32 v28, v28, v16
    v_add_f32 v29, v29, v24
    v_add_f32 v28, v28, v17
    v_add_f32 v29, v29, v25
    v_rcp_f32 v28, v28
    v_rcp_f32 v29, v29
    s_nop 0
    v_mul_f32 v10, v10, v28
    v_mul_f32 v11, v11, v28
    v_mul_f32 v12, v12, v28
    v_mul_f32 v13, v13, v28
    v_mul_f32 v14, v14, v28
    v_mul_f32 v15, v15, v28
    v_mul_f32 v16, v16, v28
    v_mul_f32 v17, v17, v28
    v_mul_f32 v18, v18, v29
    v_mul_f32 v19, v19, v29
    v_mul_f32 v20, v20, v29
    v_mul_f32 v21, v21, v29
    v_mul_f32 v22, v22, v29
    v_mul_f32 v23, v23, v29
    v_mul_f32 v24, v24, v29
    v_mul_f32 v25, v25, v29
    s_waitcnt lgkmcnt(0)
    ds_read_b128 v[196:199], v9 offset:26336
    ds_read_b128 v[200:203], v9 offset:26352
    ds_read_b128 v[204:207], v9 offset:26368
    ds_read_b128 v[208:211], v9 offset:26384
    ds_read_b128 v[212:215], v9 offset:26400
    ds_read_b128 v[216:219], v9 offset:26416
    ds_read_b128 v[220:223], v9 offset:26432
    ds_read_b128 v[224:227], v9 offset:26448
    ds_read_b128 v[228:231], v9 offset:26464
    v_pk_mul_f32 v[40:41], v[10:11], v[160:161] op_sel:[0,0] op_sel_hi:[0,1]
    v_pk_mul_f32 v[42:43], v[10:11], v[162:163] op_sel:[0,0] op_sel_hi:[0,1]
    v_pk_mul_f32 v[44:45], v[10:11], v[164:165] op_sel:[0,0] op_sel_hi:[0,1]
    v_pk_mul_f32 v[46:47], v[10:11], v[166:167] op_sel:[0,0] op_sel_hi:[0,1]
    v_pk_mul_f32 v[48:49], v[10:11], v[168:169] op_sel:[0,0] op_sel_hi:[0,1]
    v_pk_mul_f32 v[50:51], v[10:11], v[170:171] op_sel:[0,0] op_sel_hi:[0,1]
    v_pk_mul_f32 v[52:53], v[10:11], v[172:173] op_sel:[0,0] op_sel_hi:[0,1]
    v_pk_mul_f32 v[54:55], v[10:11], v[174:175] op_sel:[0,0] op_sel_hi:[0,1]
    v_pk_mul_f32 v[56:57], v[10:11], v[176:177] op_sel:[0,0] op_sel_hi:[0,1]
    v_pk_mul_f32 v[58:59], v[18:19], v[178:179] op_sel:[0,0] op_sel_hi:[0,1]
    v_pk_mul_f32 v[60:61], v[18:19], v[180:181] op_sel:[0,0] op_sel_hi:[0,1]
    v_pk_mul_f32 v[62:63], v[18:19], v[182:183] op_sel:[0,0] op_sel_hi:[0,1]
    v_pk_mul_f32 v[64:65], v[18:19], v[184:185] op_sel:[0,0] op_sel_hi:[0,1]
    v_pk_mul_f32 v[66:67], v[18:19], v[186:187] op_sel:[0,0] op_sel_hi:[0,1]
    v_pk_mul_f32 v[68:69], v[18:19], v[188:189] op_sel:[0,0] op_sel_hi:[0,1]
    v_pk_mul_f32 v[70:71], v[18:19], v[190:191] op_sel:[0,0] op_sel_hi:[0,1]
    v_pk_mul_f32 v[72:73], v[18:19], v[192:193] op_sel:[0,0] op_sel_hi:[0,1]
    v_pk_mul_f32 v[74:75], v[18:19], v[194:195] op_sel:[0,0] op_sel_hi:[0,1]
    s_waitcnt lgkmcnt(0)
    ds_read_b128 v[160:163], v9 offset:25152
    ds_read_b128 v[164:167], v9 offset:25168
    ds_read_b128 v[168:171], v9 offset:25184
    ds_read_b128 v[172:175], v9 offset:25200
    ds_read_b128 v[176:179], v9 offset:25216
    ds_read_b128 v[180:183], v9 offset:25232
    ds_read_b128 v[184:187], v9 offset:25248
    ds_read_b128 v[188:191], v9 offset:25264
    ds_read_b128 v[192:195], v9 offset:25280
    v_pk_fma_f32 v[40:41], v[10:11], v[196:197], v[40:41] op_sel:[1,0,0] op_sel_hi:[1,1,1]
    v_pk_fma_f32 v[42:43], v[10:11], v[198:199], v[42:43] op_sel:[1,0,0] op_sel_hi:[1,1,1]
    v_pk_fma_f32 v[44:45], v[10:11], v[200:201], v[44:45] op_sel:[1,0,0] op_sel_hi:[1,1,1]
    v_pk_fma_f32 v[46:47], v[10:11], v[202:203], v[46:47] op_sel:[1,0,0] op_sel_hi:[1,1,1]
    v_pk_fma_f32 v[48:49], v[10:11], v[204:205], v[48:49] op_sel:[1,0,0] op_sel_hi:[1,1,1]
    v_pk_fma_f32 v[50:51], v[10:11], v[206:207], v[50:51] op_sel:[1,0,0] op_sel_hi:[1,1,1]
    v_pk_fma_f32 v[52:53], v[10:11], v[208:209], v[52:53] op_sel:[1,0,0] op_sel_hi:[1,1,1]
    v_pk_fma_f32 v[54:55], v[10:11], v[210:211], v[54:55] op_sel:[1,0,0] op_sel_hi:[1,1,1]
    v_pk_fma_f32 v[56:57], v[10:11], v[212:213], v[56:57] op_sel:[1,0,0] op_sel_hi:[1,1,1]
    v_pk_fma_f32 v[58:59], v[18:19], v[214:215], v[58:59] op_sel:[1,0,0] op_sel_hi:[1,1,1]
    v_pk_fma_f32 v[60:61], v[18:19], v[216:217], v[60:61] op_sel:[1,0,0] op_sel_hi:[1,1,1]
    v_pk_fma_f32 v[62:63], v[18:19], v[218:219], v[62:63] op_sel:[1,0,0] op_sel_hi:[1,1,1]
    v_pk_fma_f32 v[64:65], v[18:19], v[220:221], v[64:65] op_sel:[1,0,0] op_sel_hi:[1,1,1]
    v_pk_fma_f32 v[66:67], v[18:19], v[222:223], v[66:67] op_sel:[1,0,0] op_sel_hi:[1,1,1]
    v_pk_fma_f32 v[68:69], v[18:19], v[224:225], v[68:69] op_sel:[1,0,0] op_sel_hi:[1,1,1]
    v_pk_fma_f32 v[70:71], v[18:19], v[226:227], v[70:71] op_sel:[1,0,0] op_sel_hi:[1,1,1]
    v_pk_fma_f32 v[72:73], v[18:19], v[228:229], v[72:73] op_sel:[1,0,0] op_sel_hi:[1,1,1]
    v_pk_fma_f32 v[74:75], v[18:19], v[230:231], v[74:75] op_sel:[1,0,0] op_sel_hi:[1,1,1]
    s_waitcnt lgkmcnt(0)
    ds_read_b128 v[196:199], v9 offset:23968
    ds_read_b128 v[200:203], v9 offset:23984
    ds_read_b128 v[204:207], v9 offset:24000
    ds_read_b128 v[208:211], v9 offset:24016
    ds_read_b128 v[212:215], v9 offset:24032
    ds_read_b128 v[216:219], v9 offset:24048
    ds_read_b128 v[220:223], v9 offset:24064
    ds_read_b128 v[224:227], v9 offset:24080
    ds_read_b128 v[228:231], v9 offset:24096
    v_pk_fma_f32 v[40:41], v[12:13], v[160:161], v[40:41] op_sel:[0,0,0] op_sel_hi:[0,1,1]
    v_pk_fma_f32 v[42:43], v[12:13], v[162:163], v[42:43] op_sel:[0,0,0] op_sel_hi:[0,1,1]
    v_pk_fma_f32 v[44:45], v[12:13], v[164:165], v[44:45] op_sel:[0,0,0] op_sel_hi:[0,1,1]
    v_pk_fma_f32 v[46:47], v[12:13], v[166:167], v[46:47] op_sel:[0,0,0] op_sel_hi:[0,1,1]
    v_pk_fma_f32 v[48:49], v[12:13], v[168:169], v[48:49] op_sel:[0,0,0] op_sel_hi:[0,1,1]
    v_pk_fma_f32 v[50:51], v[12:13], v[170:171], v[50:51] op_sel:[0,0,0] op_sel_hi:[0,1,1]
    v_pk_fma_f32 v[52:53], v[12:13], v[172:173], v[52:53] op_sel:[0,0,0] op_sel_hi:[0,1,1]
    v_pk_fma_f32 v[54:55], v[12:13], v[174:175], v[54:55] op_sel:[0,0,0] op_sel_hi:[0,1,1]
    v_pk_fma_f32 v[56:57], v[12:13], v[176:177], v[56:57] op_sel:[0,0,0] op_sel_hi:[0,1,1]
    v_pk_fma_f32 v[58:59], v[20:21], v[178:179], v[58:59] op_sel:[0,0,0] op_sel_hi:[0,1,1]
    v_pk_fma_f32 v[60:61], v[20:21], v[180:181], v[60:61] op_sel:[0,0,0] op_sel_hi:[0,1,1]
    v_pk_fma_f32 v[62:63], v[20:21], v[182:183], v[62:63] op_sel:[0,0,0] op_sel_hi:[0,1,1]
    v_pk_fma_f32 v[64:65], v[20:21], v[184:185], v[64:65] op_sel:[0,0,0] op_sel_hi:[0,1,1]
    v_pk_fma_f32 v[66:67], v[20:21], v[186:187], v[66:67] op_sel:[0,0,0] op_sel_hi:[0,1,1]
    v_pk_fma_f32 v[68:69], v[20:21], v[188:189], v[68:69] op_sel:[0,0,0] op_sel_hi:[0,1,1]
    v_pk_fma_f32 v[70:71], v[20:21], v[190:191], v[70:71] op_sel:[0,0,0] op_sel_hi:[0,1,1]
    v_pk_fma_f32 v[72:73], v[20:21], v[192:193], v[72:73] op_sel:[0,0,0] op_sel_hi:[0,1,1]
    v_pk_fma_f32 v[74:75], v[20:21], v[194:195], v[74:75] op_sel:[0,0,0] op_sel_hi:[0,1,1]
    s_waitcnt lgkmcnt(0)
    ds_read_b128 v[160:163], v9 offset:22784
    ds_read_b128 v[164:167], v9 offset:22800
    ds_read_b128 v[168:171], v9 offset:22816
    ds_read_b128 v[172:175], v9 offset:22832
    ds_read_b128 v[176:179], v9 offset:22848
    ds_read_b128 v[180:183], v9 offset:22864
    ds_read_b128 v[184:187], v9 offset:22880
    ds_read_b128 v[188:191], v9 offset:22896
    ds_read_b128 v[192:195], v9 offset:22912
    v_pk_fma_f32 v[40:41], v[12:13], v[196:197], v[40:41] op_sel:[1,0,0] op_sel_hi:[1,1,1]
    v_pk_fma_f32 v[42:43], v[12:13], v[198:199], v[42:43] op_sel:[1,0,0] op_sel_hi:[1,1,1]
    v_pk_fma_f32 v[44:45], v[12:13], v[200:201], v[44:45] op_sel:[1,0,0] op_sel_hi:[1,1,1]
    v_pk_fma_f32 v[46:47], v[12:13], v[202:203], v[46:47] op_sel:[1,0,0] op_sel_hi:[1,1,1]
    v_pk_fma_f32 v[48:49], v[12:13], v[204:205], v[48:49] op_sel:[1,0,0] op_sel_hi:[1,1,1]
    v_pk_fma_f32 v[50:51], v[12:13], v[206:207], v[50:51] op_sel:[1,0,0] op_sel_hi:[1,1,1]
    v_pk_fma_f32 v[52:53], v[12:13], v[208:209], v[52:53] op_sel:[1,0,0] op_sel_hi:[1,1,1]
    v_pk_fma_f32 v[54:55], v[12:13], v[210:211], v[54:55] op_sel:[1,0,0] op_sel_hi:[1,1,1]
    v_pk_fma_f32 v[56:57], v[12:13], v[212:213], v[56:57] op_sel:[1,0,0] op_sel_hi:[1,1,1]
    v_pk_fma_f32 v[58:59], v[20:21], v[214:215], v[58:59] op_sel:[1,0,0] op_sel_hi:[1,1,1]
    v_pk_fma_f32 v[60:61], v[20:21], v[216:217], v[60:61] op_sel:[1,0,0] op_sel_hi:[1,1,1]
    v_pk_fma_f32 v[62:63], v[20:21], v[218:219], v[62:63] op_sel:[1,0,0] op_sel_hi:[1,1,1]
    v_pk_fma_f32 v[64:65], v[20:21], v[220:221], v[64:65] op_sel:[1,0,0] op_sel_hi:[1,1,1]
    v_pk_fma_f32 v[66:67], v[20:21], v[222:223], v[66:67] op_sel:[1,0,0] op_sel_hi:[1,1,1]
    v_pk_fma_f32 v[68:69], v[20:21], v[224:225], v[68:69] op_sel:[1,0,0] op_sel_hi:[1,1,1]
    v_pk_fma_f32 v[70:71], v[20:21], v[226:227], v[70:71] op_sel:[1,0,0] op_sel_hi:[1,1,1]
    v_pk_fma_f32 v[72:73], v[20:21], v[228:229], v[72:73] op_sel:[1,0,0] op_sel_hi:[1,1,1]
    v_pk_fma_f32 v[74:75], v[20:21], v[230:231], v[74:75] op_sel:[1,0,0] op_sel_hi:[1,1,1]
    s_waitcnt lgkmcnt(0)
    ds_read_b128 v[196:199], v9 offset:21600
    ds_read_b128 v[200:203], v9 offset:21616
    ds_read_b128 v[204:207], v9 offset:21632
    ds_read_b128 v[208:211], v9 offset:21648
    ds_read_b128 v[212:215], v9 offset:21664
    ds_read_b128 v[216:219], v9 offset:21680
    ds_read_b128 v[220:223], v9 offset:21696
    ds_read_b128 v[224:227], v9 offset:21712
    ds_read_b128 v[228:231], v9 offset:21728
    v_pk_fma_f32 v[40:41], v[14:15], v[160:161], v[40:41] op_sel:[0,0,0] op_sel_hi:[0,1,1]
    v_pk_fma_f32 v[42:43], v[14:15], v[162:163], v[42:43] op_sel:[0,0,0] op_sel_hi:[0,1,1]
    v_pk_fma_f32 v[44:45], v[14:15], v[164:165], v[44:45] op_sel:[0,0,0] op_sel_hi:[0,1,1]
    v_pk_fma_f32 v[46:47], v[14:15], v[166:167], v[46:47] op_sel:[0,0,0] op_sel_hi:[0,1,1]
    v_pk_fma_f32 v[48:49], v[14:15], v[168:169], v[48:49] op_sel:[0,0,0] op_sel_hi:[0,1,1]
    v_pk_fma_f32 v[50:51], v[14:15], v[170:171], v[50:51] op_sel:[0,0,0] op_sel_hi:[0,1,1]
    v_pk_fma_f32 v[52:53], v[14:15], v[172:173], v[52:53] op_sel:[0,0,0] op_sel_hi:[0,1,1]
    v_pk_fma_f32 v[54:55], v[14:15], v[174:175], v[54:55] op_sel:[0,0,0] op_sel_hi:[0,1,1]
    v_pk_fma_f32 v[56:57], v[14:15], v[176:177], v[56:57] op_sel:[0,0,0] op_sel_hi:[0,1,1]
    v_pk_fma_f32 v[58:59], v[22:23], v[178:179], v[58:59] op_sel:[0,0,0] op_sel_hi:[0,1,1]
    v_pk_fma_f32 v[60:61], v[22:23], v[180:181], v[60:61] op_sel:[0,0,0] op_sel_hi:[0,1,1]
    v_pk_fma_f32 v[62:63], v[22:23], v[182:183], v[62:63] op_sel:[0,0,0] op_sel_hi:[0,1,1]
    v_pk_fma_f32 v[64:65], v[22:23], v[184:185], v[64:65] op_sel:[0,0,0] op_sel_hi:[0,1,1]
    v_pk_fma_f32 v[66:67], v[22:23], v[186:187], v[66:67] op_sel:[0,0,0] op_sel_hi:[0,1,1]
    v_pk_fma_f32 v[68:69], v[22:23], v[188:189], v[68:69] op_sel:[0,0,0] op_sel_hi:[0,1,1]
    v_pk_fma_f32 v[70:71], v[22:23], v[190:191], v[70:71] op_sel:[0,0,0] op_sel_hi:[0,1,1]
    v_pk_fma_f32 v[72:73], v[22:23], v[192:193], v[72:73] op_sel:[0,0,0] op_sel_hi:[0,1,1]
    v_pk_fma_f32 v[74:75], v[22:23], v[194:195], v[74:75] op_sel:[0,0,0] op_sel_hi:[0,1,1]
    s_waitcnt lgkmcnt(0)
    ds_read_b128 v[160:163], v9 offset:20416
    ds_read_b128 v[164:167], v9 offset:20432
    ds_read_b128 v[168:171], v9 offset:20448
    ds_read_b128 v[172:175], v9 offset:20464
    ds_read_b128 v[176:179], v9 offset:20480
    ds_read_b128 v[180:183], v9 offset:20496
    ds_read_b128 v[184:187], v9 offset:20512
    ds_read_b128 v[188:191], v9 offset:20528
    ds_read_b128 v[192:195], v9 offset:20544
    v_pk_fma_f32 v[40:41], v[14:15], v[196:197], v[40:41] op_sel:[1,0,0] op_sel_hi:[1,1,1]
    v_pk_fma_f32 v[42:43], v[14:15], v[198:199], v[42:43] op_sel:[1,0,0] op_sel_hi:[1,1,1]
    v_pk_fma_f32 v[44:45], v[14:15], v[200:201], v[44:45] op_sel:[1,0,0] op_sel_hi:[1,1,1]
    v_pk_fma_f32 v[46:47], v[14:15], v[202:203], v[46:47] op_sel:[1,0,0] op_sel_hi:[1,1,1]
    v_pk_fma_f32 v[48:49], v[14:15], v[204:205], v[48:49] op_sel:[1,0,0] op_sel_hi:[1,1,1]
    v_pk_fma_f32 v[50:51], v[14:15], v[206:207], v[50:51] op_sel:[1,0,0] op_sel_hi:[1,1,1]
    v_pk_fma_f32 v[52:53], v[14:15], v[208:209], v[52:53] op_sel:[1,0,0] op_sel_hi:[1,1,1]
    v_pk_fma_f32 v[54:55], v[14:15], v[210:211], v[54:55] op_sel:[1,0,0] op_sel_hi:[1,1,1]
    v_pk_fma_f32 v[56:57], v[14:15], v[212:213], v[56:57] op_sel:[1,0,0] op_sel_hi:[1,1,1]
    v_pk_fma_f32 v[58:59], v[22:23], v[214:215], v[58:59] op_sel:[1,0,0] op_sel_hi:[1,1,1]
    v_pk_fma_f32 v[60:61], v[22:23], v[216:217], v[60:61] op_sel:[1,0,0] op_sel_hi:[1,1,1]
    v_pk_fma_f32 v[62:63], v[22:23], v[218:219], v[62:63] op_sel:[1,0,0] op_sel_hi:[1,1,1]
    v_pk_fma_f32 v[64:65], v[22:23], v[220:221], v[64:65] op_sel:[1,0,0] op_sel_hi:[1,1,1]
    v_pk_fma_f32 v[66:67], v[22:23], v[222:223], v[66:67] op_sel:[1,0,0] op_sel_hi:[1,1,1]
    v_pk_fma_f32 v[68:69], v[22:23], v[224:225], v[68:69] op_sel:[1,0,0] op_sel_hi:[1,1,1]
    v_pk_fma_f32 v[70:71], v[22:23], v[226:227], v[70:71] op_sel:[1,0,0] op_sel_hi:[1,1,1]
    v_pk_fma_f32 v[72:73], v[22:23], v[228:229], v[72:73] op_sel:[1,0,0] op_sel_hi:[1,1,1]
    v_pk_fma_f32 v[74:75], v[22:23], v[230:231], v[74:75] op_sel:[1,0,0] op_sel_hi:[1,1,1]
    s_waitcnt lgkmcnt(0)
    ds_read_b128 v[196:199], v9 offset:19232
    ds_read_b128 v[200:203], v9 offset:19248
    ds_read_b128 v[204:207], v9 offset:19264
    ds_read_b128 v[208:211], v9 offset:19280
    ds_read_b128 v[212:215], v9 offset:19296
    ds_read_b128 v[216:219], v9 offset:19312
    ds_read_b128 v[220:223], v9 offset:19328
    ds_read_b128 v[224:227], v9 offset:19344
    ds_read_b128 v[228:231], v9 offset:19360
    v_pk_fma_f32 v[40:41], v[16:17], v[160:161], v[40:41] op_sel:[0,0,0] op_sel_hi:[0,1,1]
    v_pk_fma_f32 v[42:43], v[16:17], v[162:163], v[42:43] op_sel:[0,0,0] op_sel_hi:[0,1,1]
    v_pk_fma_f32 v[44:45], v[16:17], v[164:165], v[44:45] op_sel:[0,0,0] op_sel_hi:[0,1,1]
    v_pk_fma_f32 v[46:47], v[16:17], v[166:167], v[46:47] op_sel:[0,0,0] op_sel_hi:[0,1,1]
    v_pk_fma_f32 v[48:49], v[16:17], v[168:169], v[48:49] op_sel:[0,0,0] op_sel_hi:[0,1,1]
    v_pk_fma_f32 v[50:51], v[16:17], v[170:171], v[50:51] op_sel:[0,0,0] op_sel_hi:[0,1,1]
    v_pk_fma_f32 v[52:53], v[16:17], v[172:173], v[52:53] op_sel:[0,0,0] op_sel_hi:[0,1,1]
    v_pk_fma_f32 v[54:55], v[16:17], v[174:175], v[54:55] op_sel:[0,0,0] op_sel_hi:[0,1,1]
    v_pk_fma_f32 v[56:57], v[16:17], v[176:177], v[56:57] op_sel:[0,0,0] op_sel_hi:[0,1,1]
    v_pk_fma_f32 v[58:59], v[24:25], v[178:179], v[58:59] op_sel:[0,0,0] op_sel_hi:[0,1,1]
    v_pk_fma_f32 v[60:61], v[24:25], v[180:181], v[60:61] op_sel:[0,0,0] op_sel_hi:[0,1,1]
    v_pk_fma_f32 v[62:63], v[24:25], v[182:183], v[62:63] op_sel:[0,0,0] op_sel_hi:[0,1,1]
    v_pk_fma_f32 v[64:65], v[24:25], v[184:185], v[64:65] op_sel:[0,0,0] op_sel_hi:[0,1,1]
    v_pk_fma_f32 v[66:67], v[24:25], v[186:187], v[66:67] op_sel:[0,0,0] op_sel_hi:[0,1,1]
    v_pk_fma_f32 v[68:69], v[24:25], v[188:189], v[68:69] op_sel:[0,0,0] op_sel_hi:[0,1,1]
    v_pk_fma_f32 v[70:71], v[24:25], v[190:191], v[70:71] op_sel:[0,0,0] op_sel_hi:[0,1,1]
    v_pk_fma_f32 v[72:73], v[24:25], v[192:193], v[72:73] op_sel:[0,0,0] op_sel_hi:[0,1,1]
    v_pk_fma_f32 v[74:75], v[24:25], v[194:195], v[74:75] op_sel:[0,0,0] op_sel_hi:[0,1,1]
    s_waitcnt lgkmcnt(0)
    v_pk_fma_f32 v[40:41], v[16:17], v[196:197], v[40:41] op_sel:[1,0,0] op_sel_hi:[1,1,1]
    v_pk_fma_f32 v[42:43], v[16:17], v[198:199], v[42:43] op_sel:[1,0,0] op_sel_hi:[1,1,1]
    v_pk_fma_f32 v[44:45], v[16:17], v[200:201], v[44:45] op_sel:[1,0,0] op_sel_hi:[1,1,1]
    v_pk_fma_f32 v[46:47], v[16:17], v[202:203], v[46:47] op_sel:[1,0,0] op_sel_hi:[1,1,1]
    v_pk_fma_f32 v[48:49], v[16:17], v[204:205], v[48:49] op_sel:[1,0,0] op_sel_hi:[1,1,1]
    v_pk_fma_f32 v[50:51], v[16:17], v[206:207], v[50:51] op_sel:[1,0,0] op_sel_hi:[1,1,1]
    v_pk_fma_f32 v[52:53], v[16:17], v[208:209], v[52:53] op_sel:[1,0,0] op_sel_hi:[1,1,1]
    v_pk_fma_f32 v[54:55], v[16:17], v[210:211], v[54:55] op_sel:[1,0,0] op_sel_hi:[1,1,1]
    v_pk_fma_f32 v[56:57], v[16:17], v[212:213], v[56:57] op_sel:[1,0,0] op_sel_hi:[1,1,1]
    v_pk_fma_f32 v[58:59], v[24:25], v[214:215], v[58:59] op_sel:[1,0,0] op_sel_hi:[1,1,1]
    v_pk_fma_f32 v[60:61], v[24:25], v[216:217], v[60:61] op_sel:[1,0,0] op_sel_hi:[1,1,1]
    v_pk_fma_f32 v[62:63], v[24:25], v[218:219], v[62:63] op_sel:[1,0,0] op_sel_hi:[1,1,1]
    v_pk_fma_f32 v[64:65], v[24:25], v[220:221], v[64:65] op_sel:[1,0,0] op_sel_hi:[1,1,1]
    v_pk_fma_f32 v[66:67], v[24:25], v[222:223], v[66:67] op_sel:[1,0,0] op_sel_hi:[1,1,1]
    v_pk_fma_f32 v[68:69], v[24:25], v[224:225], v[68:69] op_sel:[1,0,0] op_sel_hi:[1,1,1]
    v_pk_fma_f32 v[70:71], v[24:25], v[226:227], v[70:71] op_sel:[1,0,0] op_sel_hi:[1,1,1]
    v_pk_fma_f32 v[72:73], v[24:25], v[228:229], v[72:73] op_sel:[1,0,0] op_sel_hi:[1,1,1]
    v_pk_fma_f32 v[74:75], v[24:25], v[230:231], v[74:75] op_sel:[1,0,0] op_sel_hi:[1,1,1]
    v_cvt_pk_bf16_f32 v120, v40, v41
    v_cvt_pk_bf16_f32 v121, v42, v43
    v_cvt_pk_bf16_f32 v122, v44, v45
    v_cvt_pk_bf16_f32 v123, v46, v47
    v_cvt_pk_bf16_f32 v124, v48, v49
    v_cvt_pk_bf16_f32 v125, v50, v51
    v_cvt_pk_bf16_f32 v126, v52, v53
    v_cvt_pk_bf16_f32 v127, v54, v55
    v_cvt_pk_bf16_f32 v128, v56, v57
    v_cvt_pk_bf16_f32 v129, v58, v59
    v_cvt_pk_bf16_f32 v130, v60, v61
    v_cvt_pk_bf16_f32 v131, v62, v63
    v_cvt_pk_bf16_f32 v132, v64, v65
    v_cvt_pk_bf16_f32 v133, v66, v67
    v_cvt_pk_bf16_f32 v134, v68, v69
    v_cvt_pk_bf16_f32 v135, v70, v71
    v_cvt_pk_bf16_f32 v136, v72, v73
    v_cvt_pk_bf16_f32 v137, v74, v75
    v_cmp_ne_u32 vcc, 0, v3
    s_add_u32 s42, s37, 331776
    s_nop 0
    v_cndmask_b32 v140, v120, v122, vcc
    v_cndmask_b32 v141, v121, v123, vcc
    v_cndmask_b32 v142, v122, v124, vcc
    v_cndmask_b32 v143, v123, v125, vcc
    v_cndmask_b32 v144, v124, v126, vcc
    v_cndmask_b32 v145, v125, v127, vcc
    v_cndmask_b32 v146, v126, v128, vcc
    v_cndmask_b32 v147, v127, v129, vcc
    v_cndmask_b32 v148, v128, v130, vcc
    v_cndmask_b32 v149, v129, v131, vcc
    v_cndmask_b32 v150, v130, v132, vcc
    v_cndmask_b32 v151, v131, v133, vcc
    v_cndmask_b32 v152, v132, v134, vcc
    v_cndmask_b32 v153, v133, v135, vcc
    v_cndmask_b32 v154, v134, v136, vcc
    v_cndmask_b32 v155, v135, v137, vcc
    v_cndmask_b32 v246, v136, v120, vcc
    v_cndmask_b32 v247, v137, v121, vcc
    buffer_store_dwordx4 v[140:143], v240, s[16:19], s42 offen offset:0 sc0 sc1
    buffer_store_dwordx4 v[144:147], v240, s[16:19], s42 offen offset:512 sc0 sc1
    buffer_store_dwordx4 v[148:151], v240, s[16:19], s42 offen offset:1024 sc0 sc1
    buffer_store_dwordx4 v[152:155], v240, s[16:19], s42 offen offset:1536 sc0 sc1
    s_nop 1
    v_permlane32_swap_b32 v244, v246
    v_permlane32_swap_b32 v245, v247
    s_nop 1
    buffer_store_dwordx4 v[244:247], v241, s[16:19], s37 offen sc0 sc1
    s_add_u32 s35, s33, 32
    s_lshl_b32 s35, s35, 7
    s_add_u32 s35, s35, 22085632
    s_lshl_b32 s46, s34, 2
    s_add_u32 s50, s46, s35
    s_waitcnt lgkmcnt(0)
    s_waitcnt vmcnt(0)
    s_barrier
    s_cmp_lg_u32 s32, 0
    s_cbranch_scc1 L_PUB10666
    v_mov_b32 v2, s68
    v_mov_b32 v3, 0
    s_mov_b64 exec, 1
    buffer_store_dword v2, v3, s[16:19], s50 offen sc0 sc1
    s_mov_b64 exec, -1
L_PUB10666:
    s_cmp_lt_u32 s34, 6
    s_cbranch_scc1 L_QB
    s_waitcnt vmcnt(0) lgkmcnt(0)
    s_mov_b32 s20, s54
    s_mov_b32 s21, s55
    s_mov_b32 s22, 1152
    s_mov_b32 s23, 0x00020000
    v_and_b32 v3, 7, v0
    v_lshlrev_b32 v3, 4, v3
    buffer_load_dwordx4 v[64:67], v3, s[20:23], 0 offen offset:0
    buffer_load_dwordx4 v[68:71], v3, s[20:23], 0 offen offset:128
    buffer_load_dwordx4 v[72:75], v3, s[20:23], 0 offen offset:256
    buffer_load_dwordx4 v[76:79], v3, s[20:23], 0 offen offset:384
    buffer_load_dwordx4 v[80:83], v3, s[20:23], 0 offen offset:512
    buffer_load_dwordx4 v[84:87], v3, s[20:23], 0 offen offset:640
    buffer_load_dwordx4 v[88:91], v3, s[20:23], 0 offen offset:768
    buffer_load_dwordx4 v[92:95], v3, s[20:23], 0 offen offset:896
    buffer_load_dwordx4 v[96:99], v3, s[20:23], 0 offen offset:1024
    s_lshl_b32 s46, s33, 1
    s_add_u32 s46, s46, s34
    s_sub_u32 s49, s46, 6
    s_lshl_b32 s46, s49, 2
    s_add_u32 s46, s46, s32
    s_mul_i32 s64, s46, 36864
    s_add_u32 s65, s64, 18432
    s_lshl_b32 s48, s46, 7
    s_add_u32 s48, s48, 22020096
    buffer_load_dwordx4 v[100:103], v36, s[8:11], s64 offen offset:0
    buffer_load_dwordx4 v[104:107], v36, s[8:11], s64 offen offset:128
    buffer_load_dwordx4 v[108:111], v36, s[8:11], s64 offen offset:256
    buffer_load_dwordx4 v[112:115], v36, s[8:11], s64 offen offset:384
    buffer_load_dwordx4 v[116:119], v36, s[8:11], s64 offen offset:512
    buffer_load_dwordx4 v[120:123], v36, s[8:11], s64 offen offset:640
    buffer_load_dwordx4 v[124:127], v36, s[8:11], s64 offen offset:768
    buffer_load_dwordx4 v[128:131], v36, s[8:11], s64 offen offset:896
    buffer_load_dwordx4 v[132:135], v36, s[8:11], s64 offen offset:1024
    buffer_load_dwordx4 v[136:139], v37, s[8:11], s64 offen offset:0
    buffer_load_dwordx4 v[140:143], v37, s[8:11], s64 offen offset:128
    buffer_load_dwordx4 v[144:147], v37, s[8:11], s64 offen offset:256
    buffer_load_dwordx4 v[148:151], v37, s[8:11], s64 offen offset:384
    buffer_load_dwordx4 v[152:155], v37, s[8:11], s64 offen offset:512
    buffer_load_dwordx4 v[156:159], v37, s[8:11], s64 offen offset:640
    buffer_load_dwordx4 v[160:163], v37, s[8:11], s64 offen offset:768
    buffer_load_dwordx4 v[164:167], v37, s[8:11], s64 offen offset:896
    buffer_load_dwordx4 v[168:171], v37, s[8:11], s64 offen offset:1024
    buffer_load_dwordx4 v[172:175], v36, s[8:11], s65 offen offset:0
    buffer_load_dwordx4 v[176:179], v36, s[8:11], s65 offen offset:128
    buffer_load_dwordx4 v[180:183], v36, s[8:11], s65 offen offset:256
    buffer_load_dwordx4 v[184:187], v36, s[8:11], s65 offen offset:384
    buffer_load_dwordx4 v[188:191], v36, s[8:11], s65 offen offset:512
    buffer_load_dwordx4 v[192:195], v36, s[8:11], s65 offen offset:640
    buffer_load_dwordx4 v[196:199], v36, s[8:11], s65 offen offset:768
    buffer_load_dwordx4 v[200:203], v36, s[8:11], s65 offen offset:896
    buffer_load_dwordx4 v[204:207], v36, s[8:11], s65 offen offset:1024
    buffer_load_dwordx4 v[208:211], v37, s[8:11], s65 offen offset:0
    buffer_load_dwordx4 v[212:215], v37, s[8:11], s65 offen offset:128
    buffer_load_dwordx4 v[216:219], v37, s[8:11], s65 offen offset:256
    buffer_load_dwordx4 v[220:223], v37, s[8:11], s65 offen offset:384
    buffer_load_dwordx4 v[224:227], v37, s[8:11], s65 offen offset:512
    buffer_load_dwordx4 v[228:231], v37, s[8:11], s65 offen offset:640
    buffer_load_dwordx4 v[232:235], v37, s[8:11], s65 offen offset:768
    buffer_load_dwordx4 v[236:239], v37, s[8:11], s65 offen offset:896
    buffer_load_dwordx4 v[240:243], v37, s[8:11], s65 offen offset:1024
    v_mov_b32 v4, 0
    v_mov_b32 v5, 0
    v_mov_b32 v6, 0
    v_mov_b32 v7, 0
    s_waitcnt vmcnt(27)
    v_dot2_f32_bf16 v4, v100, v64, v4
    v_dot2_f32_bf16 v4, v101, v65, v4
    v_dot2_f32_bf16 v4, v102, v66, v4
    v_dot2_f32_bf16 v4, v103, v67, v4
    v_dot2_f32_bf16 v4, v104, v68, v4
    v_dot2_f32_bf16 v4, v105, v69, v4
    v_dot2_f32_bf16 v4, v106, v70, v4
    v_dot2_f32_bf16 v4, v107, v71, v4
    v_dot2_f32_bf16 v4, v108, v72, v4
    v_dot2_f32_bf16 v4, v109, v73, v4
    v_dot2_f32_bf16 v4, v110, v74, v4
    v_dot2_f32_bf16 v4, v111, v75, v4
    v_dot2_f32_bf16 v4, v112, v76, v4
    v_dot2_f32_bf16 v4, v113, v77, v4
    v_dot2_f32_bf16 v4, v114, v78, v4
    v_dot2_f32_bf16 v4, v115, v79, v4
    v_dot2_f32_bf16 v4, v116, v80, v4
    v_dot2_f32_bf16 v4, v117, v81, v4
    v_dot2_f32_bf16 v4, v118, v82, v4
    v_dot2_f32_bf16 v4, v119, v83, v4
    v_dot2_f32_bf16 v4, v120, v84, v4
    v_dot2_f32_bf16 v4, v121, v85, v4
    v_dot2_f32_bf16 v4, v122, v86, v4
    v_dot2_f32_bf16 v4, v123, v87, v4
    v_dot2_f32_bf16 v4, v124, v88, v4
    v_dot2_f32_bf16 v4, v125, v89, v4
    v_dot2_f32_bf16 v4, v126, v90, v4
    v_dot2_f32_bf16 v4, v127, v91, v4
    v_dot2_f32_bf16 v4, v128, v92, v4
    v_dot2_f32_bf16 v4, v129, v93, v4
    v_dot2_f32_bf16 v4, v130, v94, v4
    v_dot2_f32_bf16 v4, v131, v95, v4
    v_dot2_f32_bf16 v4, v132, v96, v4
    v_dot2_f32_bf16 v4, v133, v97, v4
    v_dot2_f32_bf16 v4, v134, v98, v4
    v_dot2_f32_bf16 v4, v135, v99, v4
    s_waitcnt vmcnt(18)
    v_dot2_f32_bf16 v5, v136, v64, v5
    v_dot2_f32_bf16 v5, v137, v65, v5
    v_dot2_f32_bf16 v5, v138, v66, v5
    v_dot2_f32_bf16 v5, v139, v67, v5
    v_dot2_f32_bf16 v5, v140, v68, v5
    v_dot2_f32_bf16 v5, v141, v69, v5
    v_dot2_f32_bf16 v5, v142, v70, v5
    v_dot2_f32_bf16 v5, v143, v71, v5
    v_dot2_f32_bf16 v5, v144, v72, v5
    v_dot2_f32_bf16 v5, v145, v73, v5
    v_dot2_f32_bf16 v5, v146, v74, v5
    v_dot2_f32_bf16 v5, v147, v75, v5
    v_dot2_f32_bf16 v5, v148, v76, v5
    v_dot2_f32_bf16 v5, v149, v77, v5
    v_dot2_f32_bf16 v5, v150, v78, v5
    v_dot2_f32_bf16 v5, v151, v79, v5
    v_dot2_f32_bf16 v5, v152, v80, v5
    v_dot2_f32_bf16 v5, v153, v81, v5
    v_dot2_f32_bf16 v5, v154, v82, v5
    v_dot2_f32_bf16 v5, v155, v83, v5
    v_dot2_f32_bf16 v5, v156, v84, v5
    v_dot2_f32_bf16 v5, v157, v85, v5
    v_dot2_f32_bf16 v5, v158, v86, v5
    v_dot2_f32_bf16 v5, v159, v87, v5
    v_dot2_f32_bf16 v5, v160, v88, v5
    v_dot2_f32_bf16 v5, v161, v89, v5
    v_dot2_f32_bf16 v5, v162, v90, v5
    v_dot2_f32_bf16 v5, v163, v91, v5
    v_dot2_f32_bf16 v5, v164, v92, v5
    v_dot2_f32_bf16 v5, v165, v93, v5
    v_dot2_f32_bf16 v5, v166, v94, v5
    v_dot2_f32_bf16 v5, v167, v95, v5
    v_dot2_f32_bf16 v5, v168, v96, v5
    v_dot2_f32_bf16 v5, v169, v97, v5
    v_dot2_f32_bf16 v5, v170, v98, v5
    v_dot2_f32_bf16 v5, v171, v99, v5
    s_waitcnt vmcnt(9)
    v_dot2_f32_bf16 v6, v172, v64, v6
    v_dot2_f32_bf16 v6, v173, v65, v6
    v_dot2_f32_bf16 v6, v174, v66, v6
    v_dot2_f32_bf16 v6, v175, v67, v6
    v_dot2_f32_bf16 v6, v176, v68, v6
    v_dot2_f32_bf16 v6, v177, v69, v6
    v_dot2_f32_bf16 v6, v178, v70, v6
    v_dot2_f32_bf16 v6, v179, v71, v6
    v_dot2_f32_bf16 v6, v180, v72, v6
    v_dot2_f32_bf16 v6, v181, v73, v6
    v_dot2_f32_bf16 v6, v182, v74, v6
    v_dot2_f32_bf16 v6, v183, v75, v6
    v_dot2_f32_bf16 v6, v184, v76, v6
    v_dot2_f32_bf16 v6, v185, v77, v6
    v_dot2_f32_bf16 v6, v186, v78, v6
    v_dot2_f32_bf16 v6, v187, v79, v6
    v_dot2_f32_bf16 v6, v188, v80, v6
    v_dot2_f32_bf16 v6, v189, v81, v6
    v_dot2_f32_bf16 v6, v190, v82, v6
    v_dot2_f32_bf16 v6, v191, v83, v6
    v_dot2_f32_bf16 v6, v192, v84, v6
    v_dot2_f32_bf16 v6, v193, v85, v6
    v_dot2_f32_bf16 v6, v194, v86, v6
    v_dot2_f32_bf16 v6, v195, v87, v6
    v_dot2_f32_bf16 v6, v196, v88, v6
    v_dot2_f32_bf16 v6, v197, v89, v6
    v_dot2_f32_bf16 v6, v198, v90, v6
    v_dot2_f32_bf16 v6, v199, v91, v6
    v_dot2_f32_bf16 v6, v200, v92, v6
    v_dot2_f32_bf16 v6, v201, v93, v6
    v_dot2_f32_bf16 v6, v202, v94, v6
    v_dot2_f32_bf16 v6, v203, v95, v6
    v_dot2_f32_bf16 v6, v204, v96, v6
    v_dot2_f32_bf16 v6, v205, v97, v6
    v_dot2_f32_bf16 v6, v206, v98, v6
    v_dot2_f32_bf16 v6, v207, v99, v6
    s_waitcnt vmcnt(0)
    v_dot2_f32_bf16 v7, v208, v64, v7
    v_dot2_f32_bf16 v7, v209, v65, v7
    v_dot2_f32_bf16 v7, v210, v66, v7
    v_dot2_f32_bf16 v7, v211, v67, v7
    v_dot2_f32_bf16 v7, v212, v68, v7
    v_dot2_f32_bf16 v7, v213, v69, v7
    v_dot2_f32_bf16 v7, v214, v70, v7
    v_dot2_f32_bf16 v7, v215, v71, v7
    v_dot2_f32_bf16 v7, v216, v72, v7
    v_dot2_f32_bf16 v7, v217, v73, v7
    v_dot2_f32_bf16 v7, v218, v74, v7
    v_dot2_f32_bf16 v7, v219, v75, v7
    v_dot2_f32_bf16 v7, v220, v76, v7
    v_dot2_f32_bf16 v7, v221, v77, v7
    v_dot2_f32_bf16 v7, v222, v78, v7
    v_dot2_f32_bf16 v7, v223, v79, v7
    v_dot2_f32_bf16 v7, v224, v80, v7
    v_dot2_f32_bf16 v7, v225, v81, v7
    v_dot2_f32_bf16 v7, v226, v82, v7
    v_dot2_f32_bf16 v7, v227, v83, v7
    v_dot2_f32_bf16 v7, v228, v84, v7
    v_dot2_f32_bf16 v7, v229, v85, v7
    v_dot2_f32_bf16 v7, v230, v86, v7
    v_dot2_f32_bf16 v7, v231, v87, v7
    v_dot2_f32_bf16 v7, v232, v88, v7
    v_dot2_f32_bf16 v7, v233, v89, v7
    v_dot2_f32_bf16 v7, v234, v90, v7
    v_dot2_f32_bf16 v7, v235, v91, v7
    v_dot2_f32_bf16 v7, v236, v92, v7
    v_dot2_f32_bf16 v7, v237, v93, v7
    v_dot2_f32_bf16 v7, v238, v94, v7
    v_dot2_f32_bf16 v7, v239, v95, v7
    v_dot2_f32_bf16 v7, v240, v96, v7
    v_dot2_f32_bf16 v7, v241, v97, v7
    v_dot2_f32_bf16 v7, v242, v98, v7
    v_dot2_f32_bf16 v7, v243, v99, v7
    s_nop 3
    ds_swizzle_b32 v8, v4 offset:1055
    ds_swizzle_b32 v9, v5 offset:1055
    ds_swizzle_b32 v10, v6 offset:1055
    ds_swizzle_b32 v11, v7 offset:1055
    s_waitcnt lgkmcnt(0)
    v_add_f32 v4, v4, v8
    v_add_f32 v5, v5, v9
    v_add_f32 v6, v6, v10
    v_add_f32 v7, v7, v11
    ds_swizzle_b32 v8, v4 offset:2079
    ds_swizzle_b32 v9, v5 offset:2079
    ds_swizzle_b32 v10, v6 offset:2079
    ds_swizzle_b32 v11, v7 offset:2079
    s_waitcnt lgkmcnt(0)
    v_add_f32 v4, v4, v8
    v_add_f32 v5, v5, v9
    v_add_f32 v6, v6, v10
    v_add_f32 v7, v7, v11
    ds_swizzle_b32 v8, v4 offset:4127
    ds_swizzle_b32 v9, v5 offset:4127
    ds_swizzle_b32 v10, v6 offset:4127
    ds_swizzle_b32 v11, v7 offset:4127
    s_waitcnt lgkmcnt(0)
    v_add_f32 v4, v4, v8
    v_add_f32 v5, v5, v9
    v_add_f32 v6, v6, v10
    v_add_f32 v7, v7, v11
    v_mul_f32 v4, 0xbfb8aa3b, v4
    v_mul_f32 v5, 0xbfb8aa3b, v5
    v_mul_f32 v6, 0xbfb8aa3b, v6
    v_mul_f32 v7, 0xbfb8aa3b, v7
    v_exp_f32 v4, v4
    v_exp_f32 v5, v5
    v_exp_f32 v6, v6
    v_exp_f32 v7, v7
    s_nop 0
    v_add_f32 v4, 1.0, v4
    v_add_f32 v5, 1.0, v5
    v_add_f32 v6, 1.0, v6
    v_add_f32 v7, 1.0, v7
    v_rcp_f32 v4, v4
    v_rcp_f32 v5, v5
    v_rcp_f32 v6, v6
    v_rcp_f32 v7, v7
    v_lshrrev_b32 v2, 3, v0
    v_lshlrev_b32 v2, 2, v2
    buffer_store_dword v4, v2, s[16:19], s48 offen offset:0 sc0 sc1
    buffer_store_dword v5, v2, s[16:19], s48 offen offset:32 sc0 sc1
    buffer_store_dword v6, v2, s[16:19], s48 offen offset:64 sc0 sc1
    buffer_store_dword v7, v2, s[16:19], s48 offen offset:96 sc0 sc1
    s_waitcnt vmcnt(0) lgkmcnt(0)
    s_barrier
    s_cmp_lg_u32 s32, 0
    s_cbranch_scc1 L_QEND
    s_mul_i32 s46, s49, 3
    s_add_u32 s46, s46, 40
    s_lshl_b32 s46, s46, 7
    s_add_u32 s46, s46, 22085652
    v_mov_b32 v4, s68
    v_lshlrev_b32 v5, 7, v0
    s_mov_b64 exec, 7
    buffer_store_dword v4, v5, s[16:19], s46 offen sc0 sc1
    s_mov_b64 exec, -1
    s_branch L_QEND
L_QB:
    s_and_b32 s46, s34, 1
    s_lshr_b32 s66, s34, 1
    s_mov_b32 s49, 4
    s_mov_b32 s60, s56
    s_mov_b32 s61, s57
    s_mov_b32 s62, 663552
    s_mov_b32 s63, 0x00020000
    s_lshl_b32 s65, s33, 1
    s_add_u32 s65, s65, s46
    s_mul_i32 s64, s32, 9216
    s_mul_i32 s46, s66, 384
    s_add_u32 s64, s64, s46
    s_mul_i32 s38, s32, 3072
    s_lshl_b32 s46, s65, 2
    s_add_u32 s46, s46, s32
    s_mul_i32 s46, s46, 324
    s_lshl_b32 s67, s46, 10
    v_add_u32 v2, 0, v0
    v_mul_u32_u24 v3, 2731, v2
    v_lshrrev_b32 v3, 16, v3
    v_mul_u32_u24 v4, 24, v3
    v_sub_u32 v4, v2, v4
    v_bfe_u32 v5, v3, 1, 1
    v_lshlrev_b32 v5, 2, v5
    v_xor_b32 v4, v4, v5
    v_mul_u32_u24 v3, 1152, v3
    v_lshl_add_u32 v32, v4, 4, v3
    v_add_u32 v2, 64, v0
    v_mul_u32_u24 v3, 2731, v2
    v_lshrrev_b32 v3, 16, v3
    v_mul_u32_u24 v4, 24, v3
    v_sub_u32 v4, v2, v4
    v_bfe_u32 v5, v3, 1, 1
    v_lshlrev_b32 v5, 2, v5
    v_xor_b32 v4, v4, v5
    v_mul_u32_u24 v3, 1152, v3
    v_lshl_add_u32 v33, v4, 4, v3
    v_subrev_u32 v33, 1024, v33
    v_add_u32 v2, 128, v0
    v_mul_u32_u24 v3, 2731, v2
    v_lshrrev_b32 v3, 16, v3
    v_mul_u32_u24 v4, 24, v3
    v_sub_u32 v4, v2, v4
    v_bfe_u32 v5, v3, 1, 1
    v_lshlrev_b32 v5, 2, v5
    v_xor_b32 v4, v4, v5
    v_mul_u32_u24 v3, 1152, v3
    v_lshl_add_u32 v34, v4, 4, v3
    v_subrev_u32 v34, 2048, v34
    v_lshrrev_b32 v2, 4, v0
    v_bfe_u32 v3, v0, 2, 2
    v_and_b32 v4, 3, v0
    v_lshrrev_b32 v5, 1, v2
    v_lshl_add_u32 v5, v5, 3, v3
    v_mul_u32_u24 v5, 384, v5
    v_and_b32 v6, 1, v2
    v_lshl_add_u32 v5, v6, 5, v5
    v_lshl_add_u32 v5, v4, 3, v5
    v_lshrrev_b32 v6, 1, v3
    v_lshlrev_b32 v6, 6, v6
    v_add_u32 v5, 49152, v5
    v_add_u32 v35, v5, v6
    v_sub_u32 v36, v5, v6
    v_add_u32 v36, 64, v36
    v_add_u32 v37, 49152, v35
    v_add_u32 v38, 49152, v36
    v_add_u32 v31, 98304, v35
    v_add_u32 v30, 98304, v36
    s_add_u32 m0, s38, 147456
    s_add_u32 s41, s64, 0
    buffer_load_dwordx4 v32, s[60:63], s41 offen offset:0 lds
    s_add_u32 m0, s38, 147456
    s_add_u32 s41, s64, 0
    buffer_load_dwordx4 v33, s[60:63], s41 offen offset:1024 lds
    s_add_u32 m0, s38, 147456
    s_add_u32 s41, s64, 0
    buffer_load_dwordx4 v34, s[60:63], s41 offen offset:2048 lds
    s_add_u32 m0, s38, 135168
    s_add_u32 s41, s64, 36864
    buffer_load_dwordx4 v32, s[60:63], s41 offen offset:0 lds
    s_add_u32 m0, s38, 135168
    s_add_u32 s41, s64, 36864
    buffer_load_dwordx4 v33, s[60:63], s41 offen offset:1024 lds
    s_add_u32 m0, s38, 135168
    s_add_u32 s41, s64, 36864
    buffer_load_dwordx4 v34, s[60:63], s41 offen offset:2048 lds
    s_add_u32 m0, s38, 122880
    s_add_u32 s41, s64, 73728
    buffer_load_dwordx4 v32, s[60:63], s41 offen offset:0 lds
    s_add_u32 m0, s38, 122880
    s_add_u32 s41, s64, 73728
    buffer_load_dwordx4 v33, s[60:63], s41 offen offset:1024 lds
    s_add_u32 m0, s38, 122880
    s_add_u32 s41, s64, 73728
    buffer_load_dwordx4 v34, s[60:63], s41 offen offset:2048 lds
    s_add_u32 m0, s38, 110592
    s_add_u32 s41, s64, 110592
    buffer_load_dwordx4 v32, s[60:63], s41 offen offset:0 lds
    s_add_u32 m0, s38, 110592
    s_add_u32 s41, s64, 110592
    buffer_load_dwordx4 v33, s[60:63], s41 offen offset:1024 lds
    s_add_u32 m0, s38, 110592
    s_add_u32 s41, s64, 110592
    buffer_load_dwordx4 v34, s[60:63], s41 offen offset:2048 lds
    s_add_u32 m0, s38, 98304
    s_add_u32 s41, s64, 147456
    buffer_load_dwordx4 v32, s[60:63], s41 offen offset:0 lds
    s_add_u32 m0, s38, 98304
    s_add_u32 s41, s64, 147456
    buffer_load_dwordx4 v33, s[60:63], s41 offen offset:1024 lds
    s_add_u32 m0, s38, 98304
    s_add_u32 s41, s64, 147456
    buffer_load_dwordx4 v34, s[60:63], s41 offen offset:2048 lds
    s_add_u32 m0, s38, 86016
    s_add_u32 s41, s64, 184320
    buffer_load_dwordx4 v32, s[60:63], s41 offen offset:0 lds
    s_add_u32 m0, s38, 86016
    s_add_u32 s41, s64, 184320
    buffer_load_dwordx4 v33, s[60:63], s41 offen offset:1024 lds
    s_add_u32 m0, s38, 86016
    s_add_u32 s41, s64, 184320
    buffer_load_dwordx4 v34, s[60:63], s41 offen offset:2048 lds
    v_lshlrev_b32 v10, 2, v0
    s_mov_b32 s69, 200000
    s_mov_b64 exec, 255
L_POLL11077:
    buffer_load_dword v11, v10, s[16:19], s35 offen sc0 sc1
    s_waitcnt vmcnt(0)
    v_cmp_ne_u32 vcc, s68, v11
    s_sub_u32 s69, s69, 1
    s_nop 4
    s_cbranch_vccz L_POLL11077_D
    s_cmp_eq_u32 s69, 0
    s_cbranch_scc1 L_POLL11077_D
    s_sleep 1
    s_branch L_POLL11077
L_POLL11077_D:
    s_mov_b64 exec, -1
    s_barrier
    s_add_u32 s40, s67, 0
    buffer_load_dwordx4 a[0:3], v39, s[16:19], s40 offen offset:0 sc0 sc1
    s_add_u32 s40, s67, 0
    buffer_load_dwordx4 a[4:7], v39, s[16:19], s40 offen offset:1024 sc0 sc1
    s_add_u32 s40, s67, 2048
    buffer_load_dwordx4 a[8:11], v39, s[16:19], s40 offen offset:0 sc0 sc1
    s_add_u32 s40, s67, 2048
    buffer_load_dwordx4 a[12:15], v39, s[16:19], s40 offen offset:1024 sc0 sc1
    s_add_u32 s40, s67, 4096
    buffer_load_dwordx4 a[16:19], v39, s[16:19], s40 offen offset:0 sc0 sc1
    s_add_u32 s40, s67, 4096
    buffer_load_dwordx4 a[20:23], v39, s[16:19], s40 offen offset:1024 sc0 sc1
    s_add_u32 s40, s67, 6144
    buffer_load_dwordx4 a[24:27], v39, s[16:19], s40 offen offset:0 sc0 sc1
    s_add_u32 s40, s67, 6144
    buffer_load_dwordx4 a[28:31], v39, s[16:19], s40 offen offset:1024 sc0 sc1
    ds_read_b64_tr_b16 v[64:65], v31 offset:0
    ds_read_b64_tr_b16 v[66:67], v31 offset:1536
    s_waitcnt vmcnt(7)
    s_waitcnt lgkmcnt(0)
    v_mfma_f32_32x32x16_bf16 v[160:175], v[64:67], a[0:3], 0
    ds_read_b64_tr_b16 v[68:69], v30 offset:0
    ds_read_b64_tr_b16 v[70:71], v30 offset:1536
    ds_read_b64_tr_b16 v[72:73], v31 offset:128
    ds_read_b64_tr_b16 v[74:75], v31 offset:1664
    ds_read_b64_tr_b16 v[76:77], v30 offset:128
    ds_read_b64_tr_b16 v[78:79], v30 offset:1664
    ds_read_b64_tr_b16 v[80:81], v31 offset:256
    ds_read_b64_tr_b16 v[82:83], v31 offset:1792
    ds_read_b64_tr_b16 v[84:85], v30 offset:256
    ds_read_b64_tr_b16 v[86:87], v30 offset:1792
    s_waitcnt lgkmcnt(8)
    v_mfma_f32_32x32x16_bf16 v[176:191], v[68:71], a[0:3], 0
    s_waitcnt lgkmcnt(4)
    v_mfma_f32_32x32x16_bf16 v[192:207], v[72:75], a[0:3], 0
    ds_read_b64_tr_b16 v[88:89], v31 offset:6144
    ds_read_b64_tr_b16 v[90:91], v31 offset:7680
    ds_read_b64_tr_b16 v[92:93], v30 offset:6144
    ds_read_b64_tr_b16 v[94:95], v30 offset:7680
    s_add_u32 s40, s67, 8192
    v_mfma_f32_32x32x16_bf16 v[208:223], v[76:79], a[0:3], 0
    buffer_load_dwordx4 a[32:35], v39, s[16:19], s40 offen offset:0 sc0 sc1
    s_waitcnt lgkmcnt(4)
    v_mfma_f32_32x32x16_bf16 v[224:239], v[80:83], a[0:3], 0
    ds_read_b64_tr_b16 v[64:65], v31 offset:6272
    ds_read_b64_tr_b16 v[66:67], v31 offset:7808
    ds_read_b64_tr_b16 v[68:69], v30 offset:6272
    ds_read_b64_tr_b16 v[70:71], v30 offset:7808
    v_mfma_f32_32x32x16_bf16 v[240:255], v[84:87], a[0:3], 0
    buffer_load_dwordx4 a[36:39], v39, s[16:19], s40 offen offset:1024 sc0 sc1
    s_waitcnt vmcnt(8)
    s_waitcnt lgkmcnt(4)
    v_mfma_f32_32x32x16_bf16 v[160:175], v[88:91], a[4:7], v[160:175]
    ds_read_b64_tr_b16 v[72:73], v31 offset:6400
    ds_read_b64_tr_b16 v[74:75], v31 offset:7936
    ds_read_b64_tr_b16 v[76:77], v30 offset:6400
    ds_read_b64_tr_b16 v[78:79], v30 offset:7936
    s_add_u32 m0, s38, 73728
    s_add_u32 s41, s64, 221184
    v_mfma_f32_32x32x16_bf16 v[176:191], v[92:95], a[4:7], v[176:191]
    buffer_load_dwordx4 v32, s[60:63], s41 offen offset:0 lds
    s_waitcnt lgkmcnt(4)
    v_mfma_f32_32x32x16_bf16 v[192:207], v[64:67], a[4:7], v[192:207]
    ds_read_b64_tr_b16 v[80:81], v37 offset:36864
    ds_read_b64_tr_b16 v[82:83], v37 offset:38400
    ds_read_b64_tr_b16 v[84:85], v38 offset:36864
    ds_read_b64_tr_b16 v[86:87], v38 offset:38400
    v_mfma_f32_32x32x16_bf16 v[208:223], v[68:71], a[4:7], v[208:223]
    buffer_load_dwordx4 v33, s[60:63], s41 offen offset:1024 lds
    s_waitcnt lgkmcnt(4)
    v_mfma_f32_32x32x16_bf16 v[224:239], v[72:75], a[4:7], v[224:239]
    ds_read_b64_tr_b16 v[88:89], v37 offset:36992
    ds_read_b64_tr_b16 v[90:91], v37 offset:38528
    ds_read_b64_tr_b16 v[92:93], v38 offset:36992
    ds_read_b64_tr_b16 v[94:95], v38 offset:38528
    v_mfma_f32_32x32x16_bf16 v[240:255], v[76:79], a[4:7], v[240:255]
    buffer_load_dwordx4 v34, s[60:63], s41 offen offset:2048 lds
    s_waitcnt vmcnt(10)
    s_waitcnt lgkmcnt(4)
    v_mfma_f32_32x32x16_bf16 v[160:175], v[80:83], a[8:11], v[160:175]
    ds_read_b64_tr_b16 v[64:65], v37 offset:37120
    ds_read_b64_tr_b16 v[66:67], v37 offset:38656
    ds_read_b64_tr_b16 v[68:69], v38 offset:37120
    ds_read_b64_tr_b16 v[70:71], v38 offset:38656
    s_add_u32 s40, s67, 10240
    v_mfma_f32_32x32x16_bf16 v[176:191], v[84:87], a[8:11], v[176:191]
    buffer_load_dwordx4 a[0:3], v39, s[16:19], s40 offen offset:0 sc0 sc1
    s_waitcnt lgkmcnt(4)
    v_mfma_f32_32x32x16_bf16 v[192:207], v[88:91], a[8:11], v[192:207]
    ds_read_b64_tr_b16 v[72:73], v37 offset:43008
    ds_read_b64_tr_b16 v[74:75], v37 offset:44544
    ds_read_b64_tr_b16 v[76:77], v38 offset:43008
    ds_read_b64_tr_b16 v[78:79], v38 offset:44544
    v_mfma_f32_32x32x16_bf16 v[208:223], v[92:95], a[8:11], v[208:223]
    buffer_load_dwordx4 a[4:7], v39, s[16:19], s40 offen offset:1024 sc0 sc1
    s_waitcnt lgkmcnt(4)
    v_mfma_f32_32x32x16_bf16 v[224:239], v[64:67], a[8:11], v[224:239]
    ds_read_b64_tr_b16 v[80:81], v37 offset:43136
    ds_read_b64_tr_b16 v[82:83], v37 offset:44672
    ds_read_b64_tr_b16 v[84:85], v38 offset:43136
    ds_read_b64_tr_b16 v[86:87], v38 offset:44672
    s_add_u32 m0, s38, 61440
    s_add_u32 s41, s64, 258048
    v_mfma_f32_32x32x16_bf16 v[240:255], v[68:71], a[8:11], v[240:255]
    buffer_load_dwordx4 v32, s[60:63], s41 offen offset:0 lds
    s_waitcnt vmcnt(12)
    s_waitcnt lgkmcnt(4)
    v_mfma_f32_32x32x16_bf16 v[160:175], v[72:75], a[12:15], v[160:175]
    ds_read_b64_tr_b16 v[88:89], v37 offset:43264
    ds_read_b64_tr_b16 v[90:91], v37 offset:44800
    ds_read_b64_tr_b16 v[92:93], v38 offset:43264
    ds_read_b64_tr_b16 v[94:95], v38 offset:44800
    v_mfma_f32_32x32x16_bf16 v[176:191], v[76:79], a[12:15], v[176:191]
    buffer_load_dwordx4 v33, s[60:63], s41 offen offset:1024 lds
    s_waitcnt lgkmcnt(4)
    v_mfma_f32_32x32x16_bf16 v[192:207], v[80:83], a[12:15], v[192:207]
    ds_read_b64_tr_b16 v[64:65], v37 offset:24576
    ds_read_b64_tr_b16 v[66:67], v37 offset:26112
    ds_read_b64_tr_b16 v[68:69], v38 offset:24576
    ds_read_b64_tr_b16 v[70:71], v38 offset:26112
    v_mfma_f32_32x32x16_bf16 v[208:223], v[84:87], a[12:15], v[208:223]
    buffer_load_dwordx4 v34, s[60:63], s41 offen offset:2048 lds
    s_waitcnt lgkmcnt(4)
    v_mfma_f32_32x32x16_bf16 v[224:239], v[88:91], a[12:15], v[224:239]
    ds_read_b64_tr_b16 v[72:73], v37 offset:24704
    ds_read_b64_tr_b16 v[74:75], v37 offset:26240
    ds_read_b64_tr_b16 v[76:77], v38 offset:24704
    ds_read_b64_tr_b16 v[78:79], v38 offset:26240
    v_mfma_f32_32x32x16_bf16 v[240:255], v[92:95], a[12:15], v[240:255]
    s_waitcnt vmcnt(13)
    s_waitcnt lgkmcnt(4)
    v_mfma_f32_32x32x16_bf16 v[160:175], v[64:67], a[16:19], v[160:175]
    s_barrier
    ds_read_b64_tr_b16 v[80:81], v37 offset:24832
    ds_read_b64_tr_b16 v[82:83], v37 offset:26368
    ds_read_b64_tr_b16 v[84:85], v38 offset:24832
    ds_read_b64_tr_b16 v[86:87], v38 offset:26368
    s_add_u32 s40, s67, 12288
    v_mfma_f32_32x32x16_bf16 v[176:191], v[68:71], a[16:19], v[176:191]
    buffer_load_dwordx4 a[8:11], v39, s[16:19], s40 offen offset:0 sc0 sc1
    s_waitcnt lgkmcnt(4)
    v_mfma_f32_32x32x16_bf16 v[192:207], v[72:75], a[16:19], v[192:207]
    ds_read_b64_tr_b16 v[88:89], v37 offset:30720
    ds_read_b64_tr_b16 v[90:91], v37 offset:32256
    ds_read_b64_tr_b16 v[92:93], v38 offset:30720
    ds_read_b64_tr_b16 v[94:95], v38 offset:32256
    v_mfma_f32_32x32x16_bf16 v[208:223], v[76:79], a[16:19], v[208:223]
    buffer_load_dwordx4 a[12:15], v39, s[16:19], s40 offen offset:1024 sc0 sc1
    s_add_u32 m0, s38, 49152
    s_waitcnt lgkmcnt(4)
    v_mfma_f32_32x32x16_bf16 v[224:239], v[80:83], a[16:19], v[224:239]
    ds_read_b64_tr_b16 v[64:65], v37 offset:30848
    ds_read_b64_tr_b16 v[66:67], v37 offset:32384
    ds_read_b64_tr_b16 v[68:69], v38 offset:30848
    ds_read_b64_tr_b16 v[70:71], v38 offset:32384
    s_add_u32 s41, s64, 294912
    v_mfma_f32_32x32x16_bf16 v[240:255], v[84:87], a[16:19], v[240:255]
    buffer_load_dwordx4 v32, s[60:63], s41 offen offset:0 lds
    s_waitcnt vmcnt(15)
    s_waitcnt lgkmcnt(4)
    v_mfma_f32_32x32x16_bf16 v[160:175], v[88:91], a[20:23], v[160:175]
    ds_read_b64_tr_b16 v[72:73], v37 offset:30976
    ds_read_b64_tr_b16 v[74:75], v37 offset:32512
    ds_read_b64_tr_b16 v[76:77], v38 offset:30976
    ds_read_b64_tr_b16 v[78:79], v38 offset:32512
    v_mfma_f32_32x32x16_bf16 v[176:191], v[92:95], a[20:23], v[176:191]
    buffer_load_dwordx4 v33, s[60:63], s41 offen offset:1024 lds
    s_waitcnt lgkmcnt(4)
    v_mfma_f32_32x32x16_bf16 v[192:207], v[64:67], a[20:23], v[192:207]
    ds_read_b64_tr_b16 v[80:81], v37 offset:12288
    ds_read_b64_tr_b16 v[82:83], v37 offset:13824
    ds_read_b64_tr_b16 v[84:85], v38 offset:12288
    ds_read_b64_tr_b16 v[86:87], v38 offset:13824
    v_mfma_f32_32x32x16_bf16 v[208:223], v[68:71], a[20:23], v[208:223]
    buffer_load_dwordx4 v34, s[60:63], s41 offen offset:2048 lds
    s_waitcnt lgkmcnt(4)
    v_mfma_f32_32x32x16_bf16 v[224:239], v[72:75], a[20:23], v[224:239]
    ds_read_b64_tr_b16 v[88:89], v37 offset:12416
    ds_read_b64_tr_b16 v[90:91], v37 offset:13952
    ds_read_b64_tr_b16 v[92:93], v38 offset:12416
    ds_read_b64_tr_b16 v[94:95], v38 offset:13952
    v_mfma_f32_32x32x16_bf16 v[240:255], v[76:79], a[20:23], v[240:255]
    s_waitcnt vmcnt(16)
    s_waitcnt lgkmcnt(4)
    v_mfma_f32_32x32x16_bf16 v[160:175], v[80:83], a[24:27], v[160:175]
    ds_read_b64_tr_b16 v[64:65], v37 offset:12544
    ds_read_b64_tr_b16 v[66:67], v37 offset:14080
    ds_read_b64_tr_b16 v[68:69], v38 offset:12544
    ds_read_b64_tr_b16 v[70:71], v38 offset:14080
    s_add_u32 s40, s67, 14336
    v_mfma_f32_32x32x16_bf16 v[176:191], v[84:87], a[24:27], v[176:191]
    buffer_load_dwordx4 a[16:19], v39, s[16:19], s40 offen offset:0 sc0 sc1
    s_waitcnt lgkmcnt(4)
    v_mfma_f32_32x32x16_bf16 v[192:207], v[88:91], a[24:27], v[192:207]
    ds_read_b64_tr_b16 v[72:73], v37 offset:18432
    ds_read_b64_tr_b16 v[74:75], v37 offset:19968
    ds_read_b64_tr_b16 v[76:77], v38 offset:18432
    ds_read_b64_tr_b16 v[78:79], v38 offset:19968
    v_mfma_f32_32x32x16_bf16 v[208:223], v[92:95], a[24:27], v[208:223]
    buffer_load_dwordx4 a[20:23], v39, s[16:19], s40 offen offset:1024 sc0 sc1
    s_add_u32 m0, s38, 147456
    s_waitcnt lgkmcnt(4)
    v_mfma_f32_32x32x16_bf16 v[224:239], v[64:67], a[24:27], v[224:239]
    ds_read_b64_tr_b16 v[80:81], v37 offset:18560
    ds_read_b64_tr_b16 v[82:83], v37 offset:20096
    ds_read_b64_tr_b16 v[84:85], v38 offset:18560
    ds_read_b64_tr_b16 v[86:87], v38 offset:20096
    s_add_u32 s41, s64, 331776
    v_mfma_f32_32x32x16_bf16 v[240:255], v[68:71], a[24:27], v[240:255]
    buffer_load_dwordx4 v32, s[60:63], s41 offen offset:0 lds
    s_waitcnt vmcnt(18)
    s_waitcnt lgkmcnt(4)
    v_mfma_f32_32x32x16_bf16 v[160:175], v[72:75], a[28:31], v[160:175]
    ds_read_b64_tr_b16 v[88:89], v37 offset:18688
    ds_read_b64_tr_b16 v[90:91], v37 offset:20224
    ds_read_b64_tr_b16 v[92:93], v38 offset:18688
    ds_read_b64_tr_b16 v[94:95], v38 offset:20224
    v_mfma_f32_32x32x16_bf16 v[176:191], v[76:79], a[28:31], v[176:191]
    buffer_load_dwordx4 v33, s[60:63], s41 offen offset:1024 lds
    s_waitcnt lgkmcnt(4)
    v_mfma_f32_32x32x16_bf16 v[192:207], v[80:83], a[28:31], v[192:207]
    ds_read_b64_tr_b16 v[64:65], v37 offset:0
    ds_read_b64_tr_b16 v[66:67], v37 offset:1536
    ds_read_b64_tr_b16 v[68:69], v38 offset:0
    ds_read_b64_tr_b16 v[70:71], v38 offset:1536
    v_mfma_f32_32x32x16_bf16 v[208:223], v[84:87], a[28:31], v[208:223]
    buffer_load_dwordx4 v34, s[60:63], s41 offen offset:2048 lds
    s_waitcnt lgkmcnt(4)
    v_mfma_f32_32x32x16_bf16 v[224:239], v[88:91], a[28:31], v[224:239]
    ds_read_b64_tr_b16 v[72:73], v37 offset:128
    ds_read_b64_tr_b16 v[74:75], v37 offset:1664
    ds_read_b64_tr_b16 v[76:77], v38 offset:128
    ds_read_b64_tr_b16 v[78:79], v38 offset:1664
    v_mfma_f32_32x32x16_bf16 v[240:255], v[92:95], a[28:31], v[240:255]
    s_waitcnt vmcnt(19)
    s_waitcnt lgkmcnt(4)
    v_mfma_f32_32x32x16_bf16 v[160:175], v[64:67], a[32:35], v[160:175]
    s_waitcnt vmcnt(15)
    s_barrier
    ds_read_b64_tr_b16 v[80:81], v37 offset:256
    ds_read_b64_tr_b16 v[82:83], v37 offset:1792
    ds_read_b64_tr_b16 v[84:85], v38 offset:256
    ds_read_b64_tr_b16 v[86:87], v38 offset:1792
    s_add_u32 s40, s67, 16384
    v_mfma_f32_32x32x16_bf16 v[176:191], v[68:71], a[32:35], v[176:191]
    buffer_load_dwordx4 a[24:27], v39, s[16:19], s40 offen offset:0 sc0 sc1
    s_waitcnt lgkmcnt(4)
    v_mfma_f32_32x32x16_bf16 v[192:207], v[72:75], a[32:35], v[192:207]
    ds_read_b64_tr_b16 v[88:89], v37 offset:6144
    ds_read_b64_tr_b16 v[90:91], v37 offset:7680
    ds_read_b64_tr_b16 v[92:93], v38 offset:6144
    ds_read_b64_tr_b16 v[94:95], v38 offset:7680
    v_mfma_f32_32x32x16_bf16 v[208:223], v[76:79], a[32:35], v[208:223]
    buffer_load_dwordx4 a[28:31], v39, s[16:19], s40 offen offset:1024 sc0 sc1
    s_add_u32 m0, s38, 135168
    s_waitcnt lgkmcnt(4)
    v_mfma_f32_32x32x16_bf16 v[224:239], v[80:83], a[32:35], v[224:239]
    ds_read_b64_tr_b16 v[64:65], v37 offset:6272
    ds_read_b64_tr_b16 v[66:67], v37 offset:7808
    ds_read_b64_tr_b16 v[68:69], v38 offset:6272
    ds_read_b64_tr_b16 v[70:71], v38 offset:7808
    s_add_u32 s41, s64, 368640
    v_mfma_f32_32x32x16_bf16 v[240:255], v[84:87], a[32:35], v[240:255]
    buffer_load_dwordx4 v32, s[60:63], s41 offen offset:0 lds
    s_waitcnt lgkmcnt(4)
    v_mfma_f32_32x32x16_bf16 v[160:175], v[88:91], a[36:39], v[160:175]
    ds_read_b64_tr_b16 v[72:73], v37 offset:6400
    ds_read_b64_tr_b16 v[74:75], v37 offset:7936
    ds_read_b64_tr_b16 v[76:77], v38 offset:6400
    ds_read_b64_tr_b16 v[78:79], v38 offset:7936
    v_mfma_f32_32x32x16_bf16 v[176:191], v[92:95], a[36:39], v[176:191]
    buffer_load_dwordx4 v33, s[60:63], s41 offen offset:1024 lds
    s_waitcnt lgkmcnt(4)
    v_mfma_f32_32x32x16_bf16 v[192:207], v[64:67], a[36:39], v[192:207]
    ds_read_b64_tr_b16 v[80:81], v35 offset:36864
    ds_read_b64_tr_b16 v[82:83], v35 offset:38400
    ds_read_b64_tr_b16 v[84:85], v36 offset:36864
    ds_read_b64_tr_b16 v[86:87], v36 offset:38400
    v_mfma_f32_32x32x16_bf16 v[208:223], v[68:71], a[36:39], v[208:223]
    buffer_load_dwordx4 v34, s[60:63], s41 offen offset:2048 lds
    s_waitcnt lgkmcnt(4)
    v_mfma_f32_32x32x16_bf16 v[224:239], v[72:75], a[36:39], v[224:239]
    ds_read_b64_tr_b16 v[88:89], v35 offset:36992
    ds_read_b64_tr_b16 v[90:91], v35 offset:38528
    ds_read_b64_tr_b16 v[92:93], v36 offset:36992
    ds_read_b64_tr_b16 v[94:95], v36 offset:38528
    v_mfma_f32_32x32x16_bf16 v[240:255], v[76:79], a[36:39], v[240:255]
    s_waitcnt vmcnt(19)
    s_waitcnt lgkmcnt(4)
    v_mfma_f32_32x32x16_bf16 v[160:175], v[80:83], a[0:3], v[160:175]
    ds_read_b64_tr_b16 v[64:65], v35 offset:37120
    ds_read_b64_tr_b16 v[66:67], v35 offset:38656
    ds_read_b64_tr_b16 v[68:69], v36 offset:37120
    ds_read_b64_tr_b16 v[70:71], v36 offset:38656
    s_add_u32 s40, s67, 18432
    v_mfma_f32_32x32x16_bf16 v[176:191], v[84:87], a[0:3], v[176:191]
    buffer_load_dwordx4 a[32:35], v39, s[16:19], s40 offen offset:0 sc0 sc1
    s_waitcnt lgkmcnt(4)
    v_mfma_f32_32x32x16_bf16 v[192:207], v[88:91], a[0:3], v[192:207]
    ds_read_b64_tr_b16 v[72:73], v35 offset:43008
    ds_read_b64_tr_b16 v[74:75], v35 offset:44544
    ds_read_b64_tr_b16 v[76:77], v36 offset:43008
    ds_read_b64_tr_b16 v[78:79], v36 offset:44544
    v_mfma_f32_32x32x16_bf16 v[208:223], v[92:95], a[0:3], v[208:223]
    buffer_load_dwordx4 a[36:39], v39, s[16:19], s40 offen offset:1024 sc0 sc1
    s_add_u32 m0, s38, 122880
    s_waitcnt lgkmcnt(4)
    v_mfma_f32_32x32x16_bf16 v[224:239], v[64:67], a[0:3], v[224:239]
    ds_read_b64_tr_b16 v[80:81], v35 offset:43136
    ds_read_b64_tr_b16 v[82:83], v35 offset:44672
    ds_read_b64_tr_b16 v[84:85], v36 offset:43136
    ds_read_b64_tr_b16 v[86:87], v36 offset:44672
    s_add_u32 s41, s64, 405504
    v_mfma_f32_32x32x16_bf16 v[240:255], v[68:71], a[0:3], v[240:255]
    buffer_load_dwordx4 v32, s[60:63], s41 offen offset:0 lds
    s_waitcnt vmcnt(21)
    s_waitcnt lgkmcnt(4)
    v_mfma_f32_32x32x16_bf16 v[160:175], v[72:75], a[4:7], v[160:175]
    ds_read_b64_tr_b16 v[88:89], v35 offset:43264
    ds_read_b64_tr_b16 v[90:91], v35 offset:44800
    ds_read_b64_tr_b16 v[92:93], v36 offset:43264
    ds_read_b64_tr_b16 v[94:95], v36 offset:44800
    v_mfma_f32_32x32x16_bf16 v[176:191], v[76:79], a[4:7], v[176:191]
    buffer_load_dwordx4 v33, s[60:63], s41 offen offset:1024 lds
    s_waitcnt lgkmcnt(4)
    v_mfma_f32_32x32x16_bf16 v[192:207], v[80:83], a[4:7], v[192:207]
    ds_read_b64_tr_b16 v[64:65], v35 offset:24576
    ds_read_b64_tr_b16 v[66:67], v35 offset:26112
    ds_read_b64_tr_b16 v[68:69], v36 offset:24576
    ds_read_b64_tr_b16 v[70:71], v36 offset:26112
    v_mfma_f32_32x32x16_bf16 v[208:223], v[84:87], a[4:7], v[208:223]
    buffer_load_dwordx4 v34, s[60:63], s41 offen offset:2048 lds
    s_waitcnt lgkmcnt(4)
    v_mfma_f32_32x32x16_bf16 v[224:239], v[88:91], a[4:7], v[224:239]
    ds_read_b64_tr_b16 v[72:73], v35 offset:24704
    ds_read_b64_tr_b16 v[74:75], v35 offset:26240
    ds_read_b64_tr_b16 v[76:77], v36 offset:24704
    ds_read_b64_tr_b16 v[78:79], v36 offset:26240
    v_mfma_f32_32x32x16_bf16 v[240:255], v[92:95], a[4:7], v[240:255]
    s_waitcnt vmcnt(19)
    s_waitcnt lgkmcnt(4)
    v_mfma_f32_32x32x16_bf16 v[160:175], v[64:67], a[8:11], v[160:175]
    s_waitcnt vmcnt(15)
    s_barrier
    ds_read_b64_tr_b16 v[80:81], v35 offset:24832
    ds_read_b64_tr_b16 v[82:83], v35 offset:26368
    ds_read_b64_tr_b16 v[84:85], v36 offset:24832
    ds_read_b64_tr_b16 v[86:87], v36 offset:26368
    s_add_u32 s40, s67, 20480
    v_mfma_f32_32x32x16_bf16 v[176:191], v[68:71], a[8:11], v[176:191]
    buffer_load_dwordx4 a[0:3], v39, s[16:19], s40 offen offset:0 sc0 sc1
    s_waitcnt lgkmcnt(4)
    v_mfma_f32_32x32x16_bf16 v[192:207], v[72:75], a[8:11], v[192:207]
    ds_read_b64_tr_b16 v[88:89], v35 offset:30720
    ds_read_b64_tr_b16 v[90:91], v35 offset:32256
    ds_read_b64_tr_b16 v[92:93], v36 offset:30720
    ds_read_b64_tr_b16 v[94:95], v36 offset:32256
    v_mfma_f32_32x32x16_bf16 v[208:223], v[76:79], a[8:11], v[208:223]
    buffer_load_dwordx4 a[4:7], v39, s[16:19], s40 offen offset:1024 sc0 sc1
    s_add_u32 m0, s38, 110592
    s_waitcnt lgkmcnt(4)
    v_mfma_f32_32x32x16_bf16 v[224:239], v[80:83], a[8:11], v[224:239]
    ds_read_b64_tr_b16 v[64:65], v35 offset:30848
    ds_read_b64_tr_b16 v[66:67], v35 offset:32384
    ds_read_b64_tr_b16 v[68:69], v36 offset:30848
    ds_read_b64_tr_b16 v[70:71], v36 offset:32384
    s_add_u32 s41, s64, 442368
    v_mfma_f32_32x32x16_bf16 v[240:255], v[84:87], a[8:11], v[240:255]
    buffer_load_dwordx4 v32, s[60:63], s41 offen offset:0 lds
    s_waitcnt lgkmcnt(4)
    v_mfma_f32_32x32x16_bf16 v[160:175], v[88:91], a[12:15], v[160:175]
    ds_read_b64_tr_b16 v[72:73], v35 offset:30976
    ds_read_b64_tr_b16 v[74:75], v35 offset:32512
    ds_read_b64_tr_b16 v[76:77], v36 offset:30976
    ds_read_b64_tr_b16 v[78:79], v36 offset:32512
    v_mfma_f32_32x32x16_bf16 v[176:191], v[92:95], a[12:15], v[176:191]
    buffer_load_dwordx4 v33, s[60:63], s41 offen offset:1024 lds
    s_waitcnt lgkmcnt(4)
    v_mfma_f32_32x32x16_bf16 v[192:207], v[64:67], a[12:15], v[192:207]
    ds_read_b64_tr_b16 v[80:81], v35 offset:12288
    ds_read_b64_tr_b16 v[82:83], v35 offset:13824
    ds_read_b64_tr_b16 v[84:85], v36 offset:12288
    ds_read_b64_tr_b16 v[86:87], v36 offset:13824
    v_mfma_f32_32x32x16_bf16 v[208:223], v[68:71], a[12:15], v[208:223]
    buffer_load_dwordx4 v34, s[60:63], s41 offen offset:2048 lds
    s_waitcnt lgkmcnt(4)
    v_mfma_f32_32x32x16_bf16 v[224:239], v[72:75], a[12:15], v[224:239]
    ds_read_b64_tr_b16 v[88:89], v35 offset:12416
    ds_read_b64_tr_b16 v[90:91], v35 offset:13952
    ds_read_b64_tr_b16 v[92:93], v36 offset:12416
    ds_read_b64_tr_b16 v[94:95], v36 offset:13952
    v_mfma_f32_32x32x16_bf16 v[240:255], v[76:79], a[12:15], v[240:255]
    s_waitcnt vmcnt(19)
    s_waitcnt lgkmcnt(4)
    v_mfma_f32_32x32x16_bf16 v[160:175], v[80:83], a[16:19], v[160:175]
    ds_read_b64_tr_b16 v[64:65], v35 offset:12544
    ds_read_b64_tr_b16 v[66:67], v35 offset:14080
    ds_read_b64_tr_b16 v[68:69], v36 offset:12544
    ds_read_b64_tr_b16 v[70:71], v36 offset:14080
    s_add_u32 s40, s67, 22528
    v_mfma_f32_32x32x16_bf16 v[176:191], v[84:87], a[16:19], v[176:191]
    buffer_load_dwordx4 a[8:11], v39, s[16:19], s40 offen offset:0 sc0 sc1
    s_waitcnt lgkmcnt(4)
    v_mfma_f32_32x32x16_bf16 v[192:207], v[88:91], a[16:19], v[192:207]
    ds_read_b64_tr_b16 v[72:73], v35 offset:18432
    ds_read_b64_tr_b16 v[74:75], v35 offset:19968
    ds_read_b64_tr_b16 v[76:77], v36 offset:18432
    ds_read_b64_tr_b16 v[78:79], v36 offset:19968
    v_mfma_f32_32x32x16_bf16 v[208:223], v[92:95], a[16:19], v[208:223]
    buffer_load_dwordx4 a[12:15], v39, s[16:19], s40 offen offset:1024 sc0 sc1
    s_add_u32 m0, s38, 98304
    s_waitcnt lgkmcnt(4)
    v_mfma_f32_32x32x16_bf16 v[224:239], v[64:67], a[16:19], v[224:239]
    ds_read_b64_tr_b16 v[80:81], v35 offset:18560
    ds_read_b64_tr_b16 v[82:83], v35 offset:20096
    ds_read_b64_tr_b16 v[84:85], v36 offset:18560
    ds_read_b64_tr_b16 v[86:87], v36 offset:20096
    s_add_u32 s41, s64, 479232
    v_mfma_f32_32x32x16_bf16 v[240:255], v[68:71], a[16:19], v[240:255]
    buffer_load_dwordx4 v32, s[60:63], s41 offen offset:0 lds
    s_waitcnt vmcnt(21)
    s_waitcnt lgkmcnt(4)
    v_mfma_f32_32x32x16_bf16 v[160:175], v[72:75], a[20:23], v[160:175]
    ds_read_b64_tr_b16 v[88:89], v35 offset:18688
    ds_read_b64_tr_b16 v[90:91], v35 offset:20224
    ds_read_b64_tr_b16 v[92:93], v36 offset:18688
    ds_read_b64_tr_b16 v[94:95], v36 offset:20224
    v_mfma_f32_32x32x16_bf16 v[176:191], v[76:79], a[20:23], v[176:191]
    buffer_load_dwordx4 v33, s[60:63], s41 offen offset:1024 lds
    s_waitcnt lgkmcnt(4)
    v_mfma_f32_32x32x16_bf16 v[192:207], v[80:83], a[20:23], v[192:207]
    ds_read_b64_tr_b16 v[64:65], v35 offset:0
    ds_read_b64_tr_b16 v[66:67], v35 offset:1536
    ds_read_b64_tr_b16 v[68:69], v36 offset:0
    ds_read_b64_tr_b16 v[70:71], v36 offset:1536
    v_mfma_f32_32x32x16_bf16 v[208:223], v[84:87], a[20:23], v[208:223]
    buffer_load_dwordx4 v34, s[60:63], s41 offen offset:2048 lds
    s_waitcnt lgkmcnt(4)
    v_mfma_f32_32x32x16_bf16 v[224:239], v[88:91], a[20:23], v[224:239]
    ds_read_b64_tr_b16 v[72:73], v35 offset:128
    ds_read_b64_tr_b16 v[74:75], v35 offset:1664
    ds_read_b64_tr_b16 v[76:77], v36 offset:128
    ds_read_b64_tr_b16 v[78:79], v36 offset:1664
    v_mfma_f32_32x32x16_bf16 v[240:255], v[92:95], a[20:23], v[240:255]
    s_waitcnt vmcnt(19)
    s_waitcnt lgkmcnt(4)
    v_mfma_f32_32x32x16_bf16 v[160:175], v[64:67], a[24:27], v[160:175]
    s_waitcnt vmcnt(15)
    s_barrier
    ds_read_b64_tr_b16 v[80:81], v35 offset:256
    ds_read_b64_tr_b16 v[82:83], v35 offset:1792
    ds_read_b64_tr_b16 v[84:85], v36 offset:256
    ds_read_b64_tr_b16 v[86:87], v36 offset:1792
    s_add_u32 s40, s67, 24576
    v_mfma_f32_32x32x16_bf16 v[176:191], v[68:71], a[24:27], v[176:191]
    buffer_load_dwordx4 a[16:19], v39, s[16:19], s40 offen offset:0 sc0 sc1
    s_waitcnt lgkmcnt(4)
    v_mfma_f32_32x32x16_bf16 v[192:207], v[72:75], a[24:27], v[192:207]
    ds_read_b64_tr_b16 v[88:89], v35 offset:6144
    ds_read_b64_tr_b16 v[90:91], v35 offset:7680
    ds_read_b64_tr_b16 v[92:93], v36 offset:6144
    ds_read_b64_tr_b16 v[94:95], v36 offset:7680
    v_mfma_f32_32x32x16_bf16 v[208:223], v[76:79], a[24:27], v[208:223]
    buffer_load_dwordx4 a[20:23], v39, s[16:19], s40 offen offset:1024 sc0 sc1
    s_add_u32 m0, s38, 86016
    s_waitcnt lgkmcnt(4)
    v_mfma_f32_32x32x16_bf16 v[224:239], v[80:83], a[24:27], v[224:239]
    ds_read_b64_tr_b16 v[64:65], v35 offset:6272
    ds_read_b64_tr_b16 v[66:67], v35 offset:7808
    ds_read_b64_tr_b16 v[68:69], v36 offset:6272
    ds_read_b64_tr_b16 v[70:71], v36 offset:7808
    s_add_u32 s41, s64, 516096
    v_mfma_f32_32x32x16_bf16 v[240:255], v[84:87], a[24:27], v[240:255]
    buffer_load_dwordx4 v32, s[60:63], s41 offen offset:0 lds
    s_waitcnt lgkmcnt(4)
    v_mfma_f32_32x32x16_bf16 v[160:175], v[88:91], a[28:31], v[160:175]
    ds_read_b64_tr_b16 v[72:73], v35 offset:6400
    ds_read_b64_tr_b16 v[74:75], v35 offset:7936
    ds_read_b64_tr_b16 v[76:77], v36 offset:6400
    ds_read_b64_tr_b16 v[78:79], v36 offset:7936
    v_mfma_f32_32x32x16_bf16 v[176:191], v[92:95], a[28:31], v[176:191]
    buffer_load_dwordx4 v33, s[60:63], s41 offen offset:1024 lds
    s_waitcnt lgkmcnt(4)
    v_mfma_f32_32x32x16_bf16 v[192:207], v[64:67], a[28:31], v[192:207]
    ds_read_b64_tr_b16 v[80:81], v31 offset:0
    ds_read_b64_tr_b16 v[82:83], v31 offset:1536
    ds_read_b64_tr_b16 v[84:85], v30 offset:0
    ds_read_b64_tr_b16 v[86:87], v30 offset:1536
    v_mfma_f32_32x32x16_bf16 v[208:223], v[68:71], a[28:31], v[208:223]
    buffer_load_dwordx4 v34, s[60:63], s41 offen offset:2048 lds
    s_waitcnt lgkmcnt(4)
    v_mfma_f32_32x32x16_bf16 v[224:239], v[72:75], a[28:31], v[224:239]
    ds_read_b64_tr_b16 v[88:89], v31 offset:128
    ds_read_b64_tr_b16 v[90:91], v31 offset:1664
    ds_read_b64_tr_b16 v[92:93], v30 offset:128
    ds_read_b64_tr_b16 v[94:95], v30 offset:1664
    v_mfma_f32_32x32x16_bf16 v[240:255], v[76:79], a[28:31], v[240:255]
    s_waitcnt vmcnt(19)
    s_waitcnt lgkmcnt(4)
    v_mfma_f32_32x32x16_bf16 v[160:175], v[80:83], a[32:35], v[160:175]
    ds_read_b64_tr_b16 v[64:65], v31 offset:256
    ds_read_b64_tr_b16 v[66:67], v31 offset:1792
    ds_read_b64_tr_b16 v[68:69], v30 offset:256
    ds_read_b64_tr_b16 v[70:71], v30 offset:1792
    s_add_u32 s40, s67, 26624
    v_mfma_f32_32x32x16_bf16 v[176:191], v[84:87], a[32:35], v[176:191]
    buffer_load_dwordx4 a[24:27], v39, s[16:19], s40 offen offset:0 sc0 sc1
    s_waitcnt lgkmcnt(4)
    v_mfma_f32_32x32x16_bf16 v[192:207], v[88:91], a[32:35], v[192:207]
    ds_read_b64_tr_b16 v[72:73], v31 offset:6144
    ds_read_b64_tr_b16 v[74:75], v31 offset:7680
    ds_read_b64_tr_b16 v[76:77], v30 offset:6144
    ds_read_b64_tr_b16 v[78:79], v30 offset:7680
    v_mfma_f32_32x32x16_bf16 v[208:223], v[92:95], a[32:35], v[208:223]
    buffer_load_dwordx4 a[28:31], v39, s[16:19], s40 offen offset:1024 sc0 sc1
    s_add_u32 m0, s38, 73728
    s_waitcnt lgkmcnt(4)
    v_mfma_f32_32x32x16_bf16 v[224:239], v[64:67], a[32:35], v[224:239]
    ds_read_b64_tr_b16 v[80:81], v31 offset:6272
    ds_read_b64_tr_b16 v[82:83], v31 offset:7808
    ds_read_b64_tr_b16 v[84:85], v30 offset:6272
    ds_read_b64_tr_b16 v[86:87], v30 offset:7808
    s_add_u32 s41, s64, 552960
    v_mfma_f32_32x32x16_bf16 v[240:255], v[68:71], a[32:35], v[240:255]
    buffer_load_dwordx4 v32, s[60:63], s41 offen offset:0 lds
    s_waitcnt vmcnt(21)
    s_waitcnt lgkmcnt(4)
    v_mfma_f32_32x32x16_bf16 v[160:175], v[72:75], a[36:39], v[160:175]
    ds_read_b64_tr_b16 v[88:89], v31 offset:6400
    ds_read_b64_tr_b16 v[90:91], v31 offset:7936
    ds_read_b64_tr_b16 v[92:93], v30 offset:6400
    ds_read_b64_tr_b16 v[94:95], v30 offset:7936
    v_mfma_f32_32x32x16_bf16 v[176:191], v[76:79], a[36:39], v[176:191]
    buffer_load_dwordx4 v33, s[60:63], s41 offen offset:1024 lds
    s_waitcnt lgkmcnt(4)
    v_mfma_f32_32x32x16_bf16 v[192:207], v[80:83], a[36:39], v[192:207]
    ds_read_b64_tr_b16 v[64:65], v37 offset:36864
    ds_read_b64_tr_b16 v[66:67], v37 offset:38400
    ds_read_b64_tr_b16 v[68:69], v38 offset:36864
    ds_read_b64_tr_b16 v[70:71], v38 offset:38400
    v_mfma_f32_32x32x16_bf16 v[208:223], v[84:87], a[36:39], v[208:223]
    buffer_load_dwordx4 v34, s[60:63], s41 offen offset:2048 lds
    s_waitcnt lgkmcnt(4)
    v_mfma_f32_32x32x16_bf16 v[224:239], v[88:91], a[36:39], v[224:239]
    ds_read_b64_tr_b16 v[72:73], v37 offset:36992
    ds_read_b64_tr_b16 v[74:75], v37 offset:38528
    ds_read_b64_tr_b16 v[76:77], v38 offset:36992
    ds_read_b64_tr_b16 v[78:79], v38 offset:38528
    v_mfma_f32_32x32x16_bf16 v[240:255], v[92:95], a[36:39], v[240:255]
    s_waitcnt vmcnt(19)
    s_waitcnt lgkmcnt(4)
    v_mfma_f32_32x32x16_bf16 v[160:175], v[64:67], a[0:3], v[160:175]
    s_waitcnt vmcnt(15)
    s_barrier
    ds_read_b64_tr_b16 v[80:81], v37 offset:37120
    ds_read_b64_tr_b16 v[82:83], v37 offset:38656
    ds_read_b64_tr_b16 v[84:85], v38 offset:37120
    ds_read_b64_tr_b16 v[86:87], v38 offset:38656
    s_add_u32 s40, s67, 28672
    v_mfma_f32_32x32x16_bf16 v[176:191], v[68:71], a[0:3], v[176:191]
    buffer_load_dwordx4 a[32:35], v39, s[16:19], s40 offen offset:0 sc0 sc1
    s_waitcnt lgkmcnt(4)
    v_mfma_f32_32x32x16_bf16 v[192:207], v[72:75], a[0:3], v[192:207]
    ds_read_b64_tr_b16 v[88:89], v37 offset:43008
    ds_read_b64_tr_b16 v[90:91], v37 offset:44544
    ds_read_b64_tr_b16 v[92:93], v38 offset:43008
    ds_read_b64_tr_b16 v[94:95], v38 offset:44544
    v_mfma_f32_32x32x16_bf16 v[208:223], v[76:79], a[0:3], v[208:223]
    buffer_load_dwordx4 a[36:39], v39, s[16:19], s40 offen offset:1024 sc0 sc1
    s_add_u32 m0, s38, 61440
    s_waitcnt lgkmcnt(4)
    v_mfma_f32_32x32x16_bf16 v[224:239], v[80:83], a[0:3], v[224:239]
    ds_read_b64_tr_b16 v[64:65], v37 offset:43136
    ds_read_b64_tr_b16 v[66:67], v37 offset:44672
    ds_read_b64_tr_b16 v[68:69], v38 offset:43136
    ds_read_b64_tr_b16 v[70:71], v38 offset:44672
    s_add_u32 s41, s64, 589824
    v_mfma_f32_32x32x16_bf16 v[240:255], v[84:87], a[0:3], v[240:255]
    buffer_load_dwordx4 v32, s[60:63], s41 offen offset:0 lds
    s_waitcnt lgkmcnt(4)
    v_mfma_f32_32x32x16_bf16 v[160:175], v[88:91], a[4:7], v[160:175]
    ds_read_b64_tr_b16 v[72:73], v37 offset:43264
    ds_read_b64_tr_b16 v[74:75], v37 offset:44800
    ds_read_b64_tr_b16 v[76:77], v38 offset:43264
    ds_read_b64_tr_b16 v[78:79], v38 offset:44800
    v_mfma_f32_32x32x16_bf16 v[176:191], v[92:95], a[4:7], v[176:191]
    buffer_load_dwordx4 v33, s[60:63], s41 offen offset:1024 lds
    s_waitcnt lgkmcnt(4)
    v_mfma_f32_32x32x16_bf16 v[192:207], v[64:67], a[4:7], v[192:207]
    ds_read_b64_tr_b16 v[80:81], v37 offset:24576
    ds_read_b64_tr_b16 v[82:83], v37 offset:26112
    ds_read_b64_tr_b16 v[84:85], v38 offset:24576
    ds_read_b64_tr_b16 v[86:87], v38 offset:26112
    v_mfma_f32_32x32x16_bf16 v[208:223], v[68:71], a[4:7], v[208:223]
    buffer_load_dwordx4 v34, s[60:63], s41 offen offset:2048 lds
    s_waitcnt lgkmcnt(4)
    v_mfma_f32_32x32x16_bf16 v[224:239], v[72:75], a[4:7], v[224:239]
    ds_read_b64_tr_b16 v[88:89], v37 offset:24704
    ds_read_b64_tr_b16 v[90:91], v37 offset:26240
    ds_read_b64_tr_b16 v[92:93], v38 offset:24704
    ds_read_b64_tr_b16 v[94:95], v38 offset:26240
    v_mfma_f32_32x32x16_bf16 v[240:255], v[76:79], a[4:7], v[240:255]
    s_waitcnt vmcnt(19)
    s_waitcnt lgkmcnt(4)
    v_mfma_f32_32x32x16_bf16 v[160:175], v[80:83], a[8:11], v[160:175]
    ds_read_b64_tr_b16 v[64:65], v37 offset:24832
    ds_read_b64_tr_b16 v[66:67], v37 offset:26368
    ds_read_b64_tr_b16 v[68:69], v38 offset:24832
    ds_read_b64_tr_b16 v[70:71], v38 offset:26368
    s_add_u32 s40, s67, 30720
    v_mfma_f32_32x32x16_bf16 v[176:191], v[84:87], a[8:11], v[176:191]
    buffer_load_dwordx4 a[0:3], v39, s[16:19], s40 offen offset:0 sc0 sc1
    s_waitcnt lgkmcnt(4)
    v_mfma_f32_32x32x16_bf16 v[192:207], v[88:91], a[8:11], v[192:207]
    ds_read_b64_tr_b16 v[72:73], v37 offset:30720
    ds_read_b64_tr_b16 v[74:75], v37 offset:32256
    ds_read_b64_tr_b16 v[76:77], v38 offset:30720
    ds_read_b64_tr_b16 v[78:79], v38 offset:32256
    v_mfma_f32_32x32x16_bf16 v[208:223], v[92:95], a[8:11], v[208:223]
    buffer_load_dwordx4 a[4:7], v39, s[16:19], s40 offen offset:1024 sc0 sc1
    s_add_u32 m0, s38, 49152
    s_waitcnt lgkmcnt(4)
    v_mfma_f32_32x32x16_bf16 v[224:239], v[64:67], a[8:11], v[224:239]
    ds_read_b64_tr_b16 v[80:81], v37 offset:30848
    ds_read_b64_tr_b16 v[82:83], v37 offset:32384
    ds_read_b64_tr_b16 v[84:85], v38 offset:30848
    ds_read_b64_tr_b16 v[86:87], v38 offset:32384
    s_add_u32 s41, s64, 626688
    v_mfma_f32_32x32x16_bf16 v[240:255], v[68:71], a[8:11], v[240:255]
    buffer_load_dwordx4 v32, s[60:63], s41 offen offset:0 lds
    s_waitcnt vmcnt(21)
    s_waitcnt lgkmcnt(4)
    v_mfma_f32_32x32x16_bf16 v[160:175], v[72:75], a[12:15], v[160:175]
    ds_read_b64_tr_b16 v[88:89], v37 offset:30976
    ds_read_b64_tr_b16 v[90:91], v37 offset:32512
    ds_read_b64_tr_b16 v[92:93], v38 offset:30976
    ds_read_b64_tr_b16 v[94:95], v38 offset:32512
    v_mfma_f32_32x32x16_bf16 v[176:191], v[76:79], a[12:15], v[176:191]
    buffer_load_dwordx4 v33, s[60:63], s41 offen offset:1024 lds
    s_waitcnt lgkmcnt(4)
    v_mfma_f32_32x32x16_bf16 v[192:207], v[80:83], a[12:15], v[192:207]
    ds_read_b64_tr_b16 v[64:65], v37 offset:12288
    ds_read_b64_tr_b16 v[66:67], v37 offset:13824
    ds_read_b64_tr_b16 v[68:69], v38 offset:12288
    ds_read_b64_tr_b16 v[70:71], v38 offset:13824
    v_mfma_f32_32x32x16_bf16 v[208:223], v[84:87], a[12:15], v[208:223]
    buffer_load_dwordx4 v34, s[60:63], s41 offen offset:2048 lds
    s_mul_i32 s46, s65, 3
    s_waitcnt lgkmcnt(4)
    v_mfma_f32_32x32x16_bf16 v[224:239], v[88:91], a[12:15], v[224:239]
    ds_read_b64_tr_b16 v[72:73], v37 offset:12416
    ds_read_b64_tr_b16 v[74:75], v37 offset:13952
    ds_read_b64_tr_b16 v[76:77], v38 offset:12416
    ds_read_b64_tr_b16 v[78:79], v38 offset:13952
    s_add_u32 s46, s46, s66
    s_add_u32 s35, s46, 40
    s_lshl_b32 s35, s35, 7
    v_mfma_f32_32x32x16_bf16 v[240:255], v[92:95], a[12:15], v[240:255]
    s_add_u32 s35, s35, 22085632
    s_mul_i32 s46, s46, 20
    s_add_u32 s46, s46, s32
    s_mul_i32 s36, s46, 12288
    s_add_u32 s36, s36, 23068672
    s_mul_i32 s46, s49, 49152
    s_waitcnt vmcnt(19)
    s_waitcnt lgkmcnt(4)
    v_mfma_f32_32x32x16_bf16 v[160:175], v[64:67], a[16:19], v[160:175]
    s_waitcnt vmcnt(15)
    s_barrier
    ds_read_b64_tr_b16 v[80:81], v37 offset:12544
    ds_read_b64_tr_b16 v[82:83], v37 offset:14080
    ds_read_b64_tr_b16 v[84:85], v38 offset:12544
    ds_read_b64_tr_b16 v[86:87], v38 offset:14080
    s_add_u32 s47, s36, s46
    v_mfma_f32_32x32x16_bf16 v[176:191], v[68:71], a[16:19], v[176:191]
    s_add_u32 s24, s47, 0
    s_add_u32 s25, s47, 3072
    s_add_u32 s26, s47, 6144
    s_add_u32 s27, s47, 9216
    s_lshl_b32 s46, s49, 2
    s_add_u32 s50, s46, s35
    s_waitcnt lgkmcnt(4)
    v_mfma_f32_32x32x16_bf16 v[192:207], v[72:75], a[16:19], v[192:207]
    ds_read_b64_tr_b16 v[88:89], v37 offset:18432
    ds_read_b64_tr_b16 v[90:91], v37 offset:19968
    ds_read_b64_tr_b16 v[92:93], v38 offset:18432
    ds_read_b64_tr_b16 v[94:95], v38 offset:19968
    s_add_u32 s40, s67, 32768
    v_mfma_f32_32x32x16_bf16 v[208:223], v[76:79], a[16:19], v[208:223]
    buffer_load_dwordx4 a[8:11], v39, s[16:19], s40 offen offset:0 sc0 sc1
    s_waitcnt lgkmcnt(4)
    v_mfma_f32_32x32x16_bf16 v[224:239], v[80:83], a[16:19], v[224:239]
    ds_read_b64_tr_b16 v[64:65], v37 offset:18560
    ds_read_b64_tr_b16 v[66:67], v37 offset:20096
    ds_read_b64_tr_b16 v[68:69], v38 offset:18560
    ds_read_b64_tr_b16 v[70:71], v38 offset:20096
    v_mfma_f32_32x32x16_bf16 v[240:255], v[84:87], a[16:19], v[240:255]
    buffer_load_dwordx4 a[12:15], v39, s[16:19], s40 offen offset:1024 sc0 sc1
    s_waitcnt lgkmcnt(4)
    v_mfma_f32_32x32x16_bf16 v[160:175], v[88:91], a[20:23], v[160:175]
    ds_read_b64_tr_b16 v[72:73], v37 offset:18688
    ds_read_b64_tr_b16 v[74:75], v37 offset:20224
    ds_read_b64_tr_b16 v[76:77], v38 offset:18688
    ds_read_b64_tr_b16 v[78:79], v38 offset:20224
    v_mfma_f32_32x32x16_bf16 v[176:191], v[92:95], a[20:23], v[176:191]
    s_waitcnt lgkmcnt(4)
    v_mfma_f32_32x32x16_bf16 v[192:207], v[64:67], a[20:23], v[192:207]
    ds_read_b64_tr_b16 v[80:81], v37 offset:0
    ds_read_b64_tr_b16 v[82:83], v37 offset:1536
    ds_read_b64_tr_b16 v[84:85], v38 offset:0
    ds_read_b64_tr_b16 v[86:87], v38 offset:1536
    v_mfma_f32_32x32x16_bf16 v[208:223], v[68:71], a[20:23], v[208:223]
    s_waitcnt lgkmcnt(4)
    v_mfma_f32_32x32x16_bf16 v[224:239], v[72:75], a[20:23], v[224:239]
    ds_read_b64_tr_b16 v[88:89], v37 offset:128
    ds_read_b64_tr_b16 v[90:91], v37 offset:1664
    ds_read_b64_tr_b16 v[92:93], v38 offset:128
    ds_read_b64_tr_b16 v[94:95], v38 offset:1664
    v_mfma_f32_32x32x16_bf16 v[240:255], v[76:79], a[20:23], v[240:255]
    s_waitcnt vmcnt(16)
    s_waitcnt lgkmcnt(4)
    v_mfma_f32_32x32x16_bf16 v[160:175], v[80:83], a[24:27], v[160:175]
    ds_read_b64_tr_b16 v[64:65], v37 offset:256
    ds_read_b64_tr_b16 v[66:67], v37 offset:1792
    ds_read_b64_tr_b16 v[68:69], v38 offset:256
    ds_read_b64_tr_b16 v[70:71], v38 offset:1792
    s_add_u32 s40, s67, 34816
    v_mfma_f32_32x32x16_bf16 v[176:191], v[84:87], a[24:27], v[176:191]
    buffer_load_dwordx4 a[16:19], v39, s[16:19], s40 offen offset:0 sc0 sc1
    s_waitcnt lgkmcnt(4)
    v_mfma_f32_32x32x16_bf16 v[192:207], v[88:91], a[24:27], v[192:207]
    ds_read_b64_tr_b16 v[72:73], v37 offset:6144
    ds_read_b64_tr_b16 v[74:75], v37 offset:7680
    ds_read_b64_tr_b16 v[76:77], v38 offset:6144
    ds_read_b64_tr_b16 v[78:79], v38 offset:7680
    v_mfma_f32_32x32x16_bf16 v[208:223], v[92:95], a[24:27], v[208:223]
    buffer_load_dwordx4 a[20:23], v39, s[16:19], s40 offen offset:1024 sc0 sc1
    s_waitcnt lgkmcnt(4)
    v_mfma_f32_32x32x16_bf16 v[224:239], v[64:67], a[24:27], v[224:239]
    ds_read_b64_tr_b16 v[80:81], v37 offset:6272
    ds_read_b64_tr_b16 v[82:83], v37 offset:7808
    ds_read_b64_tr_b16 v[84:85], v38 offset:6272
    ds_read_b64_tr_b16 v[86:87], v38 offset:7808
    v_mfma_f32_32x32x16_bf16 v[240:255], v[68:71], a[24:27], v[240:255]
    s_waitcnt vmcnt(17)
    s_waitcnt lgkmcnt(4)
    v_mfma_f32_32x32x16_bf16 v[160:175], v[72:75], a[28:31], v[160:175]
    ds_read_b64_tr_b16 v[88:89], v37 offset:6400
    ds_read_b64_tr_b16 v[90:91], v37 offset:7936
    ds_read_b64_tr_b16 v[92:93], v38 offset:6400
    ds_read_b64_tr_b16 v[94:95], v38 offset:7936
    v_mfma_f32_32x32x16_bf16 v[176:191], v[76:79], a[28:31], v[176:191]
    s_waitcnt lgkmcnt(4)
    v_mfma_f32_32x32x16_bf16 v[192:207], v[80:83], a[28:31], v[192:207]
    ds_read_b64_tr_b16 v[64:65], v35 offset:36864
    ds_read_b64_tr_b16 v[66:67], v35 offset:38400
    ds_read_b64_tr_b16 v[68:69], v36 offset:36864
    ds_read_b64_tr_b16 v[70:71], v36 offset:38400
    v_mfma_f32_32x32x16_bf16 v[208:223], v[84:87], a[28:31], v[208:223]
    s_waitcnt lgkmcnt(4)
    v_mfma_f32_32x32x16_bf16 v[224:239], v[88:91], a[28:31], v[224:239]
    ds_read_b64_tr_b16 v[72:73], v35 offset:36992
    ds_read_b64_tr_b16 v[74:75], v35 offset:38528
    ds_read_b64_tr_b16 v[76:77], v36 offset:36992
    ds_read_b64_tr_b16 v[78:79], v36 offset:38528
    v_mfma_f32_32x32x16_bf16 v[240:255], v[92:95], a[28:31], v[240:255]
    s_waitcnt vmcnt(13)
    s_waitcnt lgkmcnt(4)
    v_mfma_f32_32x32x16_bf16 v[160:175], v[64:67], a[32:35], v[160:175]
    s_waitcnt vmcnt(9)
    s_barrier
    ds_read_b64_tr_b16 v[80:81], v35 offset:37120
    ds_read_b64_tr_b16 v[82:83], v35 offset:38656
    ds_read_b64_tr_b16 v[84:85], v36 offset:37120
    ds_read_b64_tr_b16 v[86:87], v36 offset:38656
    v_mfma_f32_32x32x16_bf16 v[176:191], v[68:71], a[32:35], v[176:191]
    s_waitcnt lgkmcnt(4)
    v_mfma_f32_32x32x16_bf16 v[192:207], v[72:75], a[32:35], v[192:207]
    ds_read_b64_tr_b16 v[88:89], v35 offset:43008
    ds_read_b64_tr_b16 v[90:91], v35 offset:44544
    ds_read_b64_tr_b16 v[92:93], v36 offset:43008
    ds_read_b64_tr_b16 v[94:95], v36 offset:44544
    v_mfma_f32_32x32x16_bf16 v[208:223], v[76:79], a[32:35], v[208:223]
    s_waitcnt lgkmcnt(4)
    v_mfma_f32_32x32x16_bf16 v[224:239], v[80:83], a[32:35], v[224:239]
    ds_read_b64_tr_b16 v[64:65], v35 offset:43136
    ds_read_b64_tr_b16 v[66:67], v35 offset:44672
    ds_read_b64_tr_b16 v[68:69], v36 offset:43136
    ds_read_b64_tr_b16 v[70:71], v36 offset:44672
    v_mfma_f32_32x32x16_bf16 v[240:255], v[84:87], a[32:35], v[240:255]
    s_waitcnt lgkmcnt(4)
    v_mfma_f32_32x32x16_bf16 v[160:175], v[88:91], a[36:39], v[160:175]
    ds_read_b64_tr_b16 v[72:73], v35 offset:43264
    ds_read_b64_tr_b16 v[74:75], v35 offset:44800
    ds_read_b64_tr_b16 v[76:77], v36 offset:43264
    ds_read_b64_tr_b16 v[78:79], v36 offset:44800
    v_mfma_f32_32x32x16_bf16 v[176:191], v[92:95], a[36:39], v[176:191]
    s_waitcnt lgkmcnt(4)
    v_mfma_f32_32x32x16_bf16 v[192:207], v[64:67], a[36:39], v[192:207]
    ds_read_b64_tr_b16 v[80:81], v35 offset:24576
    ds_read_b64_tr_b16 v[82:83], v35 offset:26112
    ds_read_b64_tr_b16 v[84:85], v36 offset:24576
    ds_read_b64_tr_b16 v[86:87], v36 offset:26112
    v_mfma_f32_32x32x16_bf16 v[208:223], v[68:71], a[36:39], v[208:223]
    s_waitcnt lgkmcnt(4)
    v_mfma_f32_32x32x16_bf16 v[224:239], v[72:75], a[36:39], v[224:239]
    ds_read_b64_tr_b16 v[88:89], v35 offset:24704
    ds_read_b64_tr_b16 v[90:91], v35 offset:26240
    ds_read_b64_tr_b16 v[92:93], v36 offset:24704
    ds_read_b64_tr_b16 v[94:95], v36 offset:26240
    v_mfma_f32_32x32x16_bf16 v[240:255], v[76:79], a[36:39], v[240:255]
    s_waitcnt vmcnt(8)
    s_waitcnt lgkmcnt(4)
    v_mfma_f32_32x32x16_bf16 v[160:175], v[80:83], a[0:3], v[160:175]
    ds_read_b64_tr_b16 v[64:65], v35 offset:24832
    ds_read_b64_tr_b16 v[66:67], v35 offset:26368
    ds_read_b64_tr_b16 v[68:69], v36 offset:24832
    ds_read_b64_tr_b16 v[70:71], v36 offset:26368
    v_mfma_f32_32x32x16_bf16 v[176:191], v[84:87], a[0:3], v[176:191]
    s_waitcnt lgkmcnt(4)
    v_mfma_f32_32x32x16_bf16 v[192:207], v[88:91], a[0:3], v[192:207]
    ds_read_b64_tr_b16 v[72:73], v35 offset:30720
    ds_read_b64_tr_b16 v[74:75], v35 offset:32256
    ds_read_b64_tr_b16 v[76:77], v36 offset:30720
    ds_read_b64_tr_b16 v[78:79], v36 offset:32256
    v_mfma_f32_32x32x16_bf16 v[208:223], v[92:95], a[0:3], v[208:223]
    s_waitcnt lgkmcnt(4)
    v_mfma_f32_32x32x16_bf16 v[224:239], v[64:67], a[0:3], v[224:239]
    ds_read_b64_tr_b16 v[80:81], v35 offset:30848
    ds_read_b64_tr_b16 v[82:83], v35 offset:32384
    ds_read_b64_tr_b16 v[84:85], v36 offset:30848
    ds_read_b64_tr_b16 v[86:87], v36 offset:32384
    v_mfma_f32_32x32x16_bf16 v[240:255], v[68:71], a[0:3], v[240:255]
    s_waitcnt vmcnt(7)
    s_waitcnt lgkmcnt(4)
    v_mfma_f32_32x32x16_bf16 v[160:175], v[72:75], a[4:7], v[160:175]
    ds_read_b64_tr_b16 v[88:89], v35 offset:30976
    ds_read_b64_tr_b16 v[90:91], v35 offset:32512
    ds_read_b64_tr_b16 v[92:93], v36 offset:30976
    ds_read_b64_tr_b16 v[94:95], v36 offset:32512
    v_mfma_f32_32x32x16_bf16 v[176:191], v[76:79], a[4:7], v[176:191]
    s_waitcnt lgkmcnt(4)
    v_mfma_f32_32x32x16_bf16 v[192:207], v[80:83], a[4:7], v[192:207]
    ds_read_b64_tr_b16 v[64:65], v35 offset:12288
    ds_read_b64_tr_b16 v[66:67], v35 offset:13824
    ds_read_b64_tr_b16 v[68:69], v36 offset:12288
    ds_read_b64_tr_b16 v[70:71], v36 offset:13824
    v_mfma_f32_32x32x16_bf16 v[208:223], v[84:87], a[4:7], v[208:223]
    s_waitcnt lgkmcnt(4)
    v_mfma_f32_32x32x16_bf16 v[224:239], v[88:91], a[4:7], v[224:239]
    ds_read_b64_tr_b16 v[72:73], v35 offset:12416
    ds_read_b64_tr_b16 v[74:75], v35 offset:13952
    ds_read_b64_tr_b16 v[76:77], v36 offset:12416
    ds_read_b64_tr_b16 v[78:79], v36 offset:13952
    v_mfma_f32_32x32x16_bf16 v[240:255], v[92:95], a[4:7], v[240:255]
    s_waitcnt vmcnt(3)
    s_waitcnt lgkmcnt(4)
    v_mfma_f32_32x32x16_bf16 v[160:175], v[64:67], a[8:11], v[160:175]
    s_barrier
    ds_read_b64_tr_b16 v[80:81], v35 offset:12544
    ds_read_b64_tr_b16 v[82:83], v35 offset:14080
    ds_read_b64_tr_b16 v[84:85], v36 offset:12544
    ds_read_b64_tr_b16 v[86:87], v36 offset:14080
    v_mfma_f32_32x32x16_bf16 v[176:191], v[68:71], a[8:11], v[176:191]
    s_waitcnt lgkmcnt(4)
    v_mfma_f32_32x32x16_bf16 v[192:207], v[72:75], a[8:11], v[192:207]
    ds_read_b64_tr_b16 v[88:89], v35 offset:18432
    ds_read_b64_tr_b16 v[90:91], v35 offset:19968
    ds_read_b64_tr_b16 v[92:93], v36 offset:18432
    ds_read_b64_tr_b16 v[94:95], v36 offset:19968
    v_mfma_f32_32x32x16_bf16 v[208:223], v[76:79], a[8:11], v[208:223]
    s_waitcnt lgkmcnt(4)
    v_mfma_f32_32x32x16_bf16 v[224:239], v[80:83], a[8:11], v[224:239]
    ds_read_b64_tr_b16 v[64:65], v35 offset:18560
    ds_read_b64_tr_b16 v[66:67], v35 offset:20096
    ds_read_b64_tr_b16 v[68:69], v36 offset:18560
    ds_read_b64_tr_b16 v[70:71], v36 offset:20096
    v_mfma_f32_32x32x16_bf16 v[240:255], v[84:87], a[8:11], v[240:255]
    s_waitcnt vmcnt(2)
    s_waitcnt lgkmcnt(4)
    v_mfma_f32_32x32x16_bf16 v[160:175], v[88:91], a[12:15], v[160:175]
    ds_read_b64_tr_b16 v[72:73], v35 offset:18688
    ds_read_b64_tr_b16 v[74:75], v35 offset:20224
    ds_read_b64_tr_b16 v[76:77], v36 offset:18688
    ds_read_b64_tr_b16 v[78:79], v36 offset:20224
    v_mfma_f32_32x32x16_bf16 v[176:191], v[92:95], a[12:15], v[176:191]
    s_waitcnt lgkmcnt(4)
    v_mfma_f32_32x32x16_bf16 v[192:207], v[64:67], a[12:15], v[192:207]
    ds_read_b64_tr_b16 v[80:81], v35 offset:128
    ds_read_b64_tr_b16 v[82:83], v35 offset:1664
    ds_read_b64_tr_b16 v[84:85], v35 offset:6272
    ds_read_b64_tr_b16 v[86:87], v35 offset:7808
    v_mfma_f32_32x32x16_bf16 v[208:223], v[68:71], a[12:15], v[208:223]
    s_waitcnt lgkmcnt(4)
    v_mfma_f32_32x32x16_bf16 v[224:239], v[72:75], a[12:15], v[224:239]
    ds_read_b64_tr_b16 v[88:89], v36 offset:128
    ds_read_b64_tr_b16 v[90:91], v36 offset:1664
    ds_read_b64_tr_b16 v[92:93], v36 offset:6272
    ds_read_b64_tr_b16 v[94:95], v36 offset:7808
    v_mfma_f32_32x32x16_bf16 v[240:255], v[76:79], a[12:15], v[240:255]
    s_waitcnt vmcnt(1)
    s_waitcnt lgkmcnt(4)
    v_mfma_f32_32x32x16_bf16 v[192:207], v[80:83], a[16:19], v[192:207]
    ds_read_b64_tr_b16 v[64:65], v35 offset:256
    ds_read_b64_tr_b16 v[66:67], v35 offset:1792
    ds_read_b64_tr_b16 v[68:69], v35 offset:6400
    ds_read_b64_tr_b16 v[70:71], v35 offset:7936
    s_waitcnt vmcnt(0)
    v_mfma_f32_32x32x16_bf16 v[192:207], v[84:87], a[20:23], v[192:207]
    s_waitcnt lgkmcnt(4)
    v_mfma_f32_32x32x16_bf16 v[208:223], v[88:91], a[16:19], v[208:223]
    ds_read_b64_tr_b16 v[72:73], v36 offset:256
    ds_read_b64_tr_b16 v[74:75], v36 offset:1792
    ds_read_b64_tr_b16 v[76:77], v36 offset:6400
    ds_read_b64_tr_b16 v[78:79], v36 offset:7936
    v_mfma_f32_32x32x16_bf16 v[208:223], v[92:95], a[20:23], v[208:223]
    s_waitcnt lgkmcnt(4)
    v_mfma_f32_32x32x16_bf16 v[224:239], v[64:67], a[16:19], v[224:239]
    ds_read_b64_tr_b16 v[80:81], v36 offset:0
    ds_read_b64_tr_b16 v[82:83], v36 offset:1536
    ds_read_b64_tr_b16 v[84:85], v36 offset:6144
    ds_read_b64_tr_b16 v[86:87], v36 offset:7680
    v_cvt_pk_bf16_f32 v112, v192, v193
    v_cvt_pk_bf16_f32 v113, v194, v195
    v_cvt_pk_bf16_f32 v114, v196, v197
    v_mfma_f32_32x32x16_bf16 v[224:239], v[68:71], a[20:23], v[224:239]
    v_cvt_pk_bf16_f32 v115, v198, v199
    s_nop 0
    v_cvt_pk_bf16_f32 v116, v200, v201
    v_cvt_pk_bf16_f32 v117, v202, v203
    v_cvt_pk_bf16_f32 v118, v204, v205
    v_cvt_pk_bf16_f32 v119, v206, v207
    s_waitcnt lgkmcnt(4)
    v_mfma_f32_32x32x16_bf16 v[240:255], v[72:75], a[16:19], v[240:255]
    ds_read_b64_tr_b16 v[88:89], v35 offset:0
    ds_read_b64_tr_b16 v[90:91], v35 offset:1536
    ds_read_b64_tr_b16 v[92:93], v35 offset:6144
    ds_read_b64_tr_b16 v[94:95], v35 offset:7680
    v_mfma_f32_32x32x16_bf16 v[240:255], v[76:79], a[20:23], v[240:255]
    buffer_store_dwordx4 v[112:115], v39, s[16:19], s25 offen offset:1024 sc0 sc1
    s_nop 0
    s_waitcnt lgkmcnt(4)
    v_mfma_f32_32x32x16_bf16 v[176:191], v[80:83], a[16:19], v[176:191]
    buffer_store_dwordx4 v[116:119], v39, s[16:19], s25 offen offset:2048 sc0 sc1
    v_cvt_pk_bf16_f32 v120, v208, v209
    v_cvt_pk_bf16_f32 v121, v210, v211
    v_mfma_f32_32x32x16_bf16 v[176:191], v[84:87], a[20:23], v[176:191]
    v_cvt_pk_bf16_f32 v122, v212, v213
    v_cvt_pk_bf16_f32 v123, v214, v215
    s_nop 0
    v_cvt_pk_bf16_f32 v124, v216, v217
    v_cvt_pk_bf16_f32 v125, v218, v219
    v_cvt_pk_bf16_f32 v126, v220, v221
    s_waitcnt lgkmcnt(0)
    v_mfma_f32_32x32x16_bf16 v[160:175], v[88:91], a[16:19], v[160:175]
    buffer_store_dwordx4 v[120:123], v39, s[16:19], s26 offen offset:0 sc0 sc1
    v_cvt_pk_bf16_f32 v127, v222, v223
    s_nop 0
    v_mfma_f32_32x32x16_bf16 v[160:175], v[92:95], a[20:23], v[160:175]
    buffer_store_dwordx4 v[124:127], v39, s[16:19], s26 offen offset:1024 sc0 sc1
    v_cvt_pk_bf16_f32 v128, v224, v225
    v_cvt_pk_bf16_f32 v129, v226, v227
    v_cvt_pk_bf16_f32 v130, v228, v229
    v_cvt_pk_bf16_f32 v131, v230, v231
    s_nop 0
    buffer_store_dwordx4 v[128:131], v39, s[16:19], s26 offen offset:2048 sc0 sc1
    v_cvt_pk_bf16_f32 v132, v232, v233
    v_cvt_pk_bf16_f32 v133, v234, v235
    v_cvt_pk_bf16_f32 v134, v236, v237
    v_cvt_pk_bf16_f32 v135, v238, v239
    s_nop 0
    buffer_store_dwordx4 v[132:135], v39, s[16:19], s27 offen offset:0 sc0 sc1
    v_cvt_pk_bf16_f32 v136, v240, v241
    v_cvt_pk_bf16_f32 v137, v242, v243
    v_cvt_pk_bf16_f32 v138, v244, v245
    v_cvt_pk_bf16_f32 v139, v246, v247
    s_nop 0
    buffer_store_dwordx4 v[136:139], v39, s[16:19], s27 offen offset:1024 sc0 sc1
    v_cvt_pk_bf16_f32 v140, v248, v249
    v_cvt_pk_bf16_f32 v141, v250, v251
    v_cvt_pk_bf16_f32 v142, v252, v253
    v_cvt_pk_bf16_f32 v143, v254, v255
    s_nop 0
    buffer_store_dwordx4 v[140:143], v39, s[16:19], s27 offen offset:2048 sc0 sc1
    v_cvt_pk_bf16_f32 v104, v176, v177
    v_cvt_pk_bf16_f32 v105, v178, v179
    v_cvt_pk_bf16_f32 v106, v180, v181
    v_cvt_pk_bf16_f32 v107, v182, v183
    s_nop 0
    buffer_store_dwordx4 v[104:107], v39, s[16:19], s24 offen offset:2048 sc0 sc1
    v_cvt_pk_bf16_f32 v108, v184, v185
    v_cvt_pk_bf16_f32 v109, v186, v187
    v_cvt_pk_bf16_f32 v110, v188, v189
    v_cvt_pk_bf16_f32 v111, v190, v191
    s_nop 0
    buffer_store_dwordx4 v[108:111], v39, s[16:19], s25 offen offset:0 sc0 sc1
    v_cvt_pk_bf16_f32 v96, v160, v161
    v_cvt_pk_bf16_f32 v97, v162, v163
    v_cvt_pk_bf16_f32 v98, v164, v165
    v_cvt_pk_bf16_f32 v99, v166, v167
    s_nop 0
    buffer_store_dwordx4 v[96:99], v39, s[16:19], s24 offen offset:0 sc0 sc1
    v_cvt_pk_bf16_f32 v100, v168, v169
    v_cvt_pk_bf16_f32 v101, v170, v171
    v_cvt_pk_bf16_f32 v102, v172, v173
    v_cvt_pk_bf16_f32 v103, v174, v175
    s_nop 0
    buffer_store_dwordx4 v[100:103], v39, s[16:19], s24 offen offset:1024 sc0 sc1
    s_waitcnt vmcnt(0)
    s_barrier
    s_cmp_lg_u32 s32, 0
    s_cbranch_scc1 L_PUB12100
    v_mov_b32 v10, s68
    v_mov_b32 v11, 0
    s_mov_b64 exec, 1
    buffer_store_dword v10, v11, s[16:19], s50 offen sc0 sc1
    s_mov_b64 exec, -1
L_PUB12100:
L_QEND:
    s_waitcnt vmcnt(0) lgkmcnt(0)
L_END:
    s_endpgm
L_CODE_END:

.section .rodata,"a"
.p2align 6
.amdhsa_kernel gated_mix__sliding_local_dilated__glu_gated_glu__prompt_kernel
  .amdhsa_next_free_vgpr 512
  .amdhsa_next_free_sgpr 102
  .amdhsa_accum_offset 256
  .amdhsa_group_segment_fixed_size 0
  .amdhsa_kernarg_size 88
  .amdhsa_user_sgpr_count 2
  .amdhsa_user_sgpr_kernarg_segment_ptr 1
  .amdhsa_system_sgpr_workgroup_id_x 1
.end_amdhsa_kernel
```
